```python
import torch

def _softmax(x, axis=-1):
    return torch.softmax(x, dim=axis)

def _gelu(x):
    return torch.nn.functional.gelu(x, approximate='tanh')

def _silu(x):
    return torch.nn.functional.silu(x)

def _sigmoid(x):
    return torch.sigmoid(x)

def _layernorm(x, axis=-1, eps=1e-05):
    m = x.mean(dim=axis, keepdim=True)
    v = x.var(dim=axis, keepdim=True, unbiased=False)
    return (x - m) / torch.sqrt(v + eps)

def _scatter_add(tgt, idx, src, axis=0):
    return tgt.clone().index_add_(axis, idx, src)

def _segment_sum(src, seg, n):
    out = torch.zeros((n,) + src.shape[1:], dtype=src.dtype)
    return out.index_add_(0, seg, src)

def _pad(x, pw):
    flat = tuple((v for pair in reversed(pw) for v in pair))
    return torch.nn.functional.pad(x, flat)
kernel_name = 'concat_heads__ssm_conv_h3__memory_aug_recurrent_mem_tr__prompt'

def setup_inputs():

    _w = lambda a: (lambda t: t.to(torch.bfloat16) if t.is_floating_point() else t)(torch.as_tensor(a))

    def _A_setup():
        B, S, D = (1, 2048, 1024)
        ks = 4
        return {'q': _w((lambda *s: torch.randn(*s, dtype=torch.bfloat16) * 0.05)(B, S, D)), 'k': _w((lambda *s: torch.randn(*s, dtype=torch.bfloat16) * 0.4)(B, S, D)), 'v': _w((lambda *s: torch.randn(*s, dtype=torch.bfloat16) * 0.4)(B, S, D)), 'shift_k': _w((lambda *s: torch.randn(*s, dtype=torch.bfloat16) * 0.4)(D, ks) * 0.5), 'ssm_k': _w((lambda *s: torch.randn(*s, dtype=torch.bfloat16) * 0.4)(D, S) * (1.0 / S ** 0.5)), 'ssm_D': _w((lambda *s: torch.randn(*s, dtype=torch.bfloat16) * 0.4)(D))}
    _A_in = _A_setup()

    def _B_setup():
        B, S, Dm = (1, 2048, 1024)
        H, Dh = (32, 128)
        M, seg = (8, 32)
        seg = min(seg, S)
        S = S // seg * seg
        return {'x': _w((lambda *s: torch.randn(*s, dtype=torch.bfloat16) * 0.05)(B, S, Dm)), 'mem0': _w((lambda *s: torch.randn(*s, dtype=torch.bfloat16) * 0.4)(B, M, Dm)), 'Wq': _w((lambda *s: torch.randn(*s, dtype=torch.bfloat16) * 6.4)(Dm, H, Dh) * Dm ** (-0.5)), 'Wk': _w((lambda *s: torch.randn(*s, dtype=torch.bfloat16) * 6.4)(Dm, H, Dh) * Dm ** (-0.5)), 'Wv': _w((lambda *s: torch.randn(*s, dtype=torch.bfloat16) * 0.4)(Dm, H, Dh) * Dm ** (-0.5)), 'Wo': _w((lambda *s: torch.randn(*s, dtype=torch.bfloat16) * 0.4)(H, Dh, Dm) * (H * Dh) ** (-0.5)), 'seg_len': seg}
    _B_in = _B_setup()
    return {'A_q': _A_in['q'], 'A_k': _A_in['k'], 'A_v': _A_in['v'], 'A_shift_k': _A_in['shift_k'], 'A_ssm_k': _A_in['ssm_k'], 'A_ssm_D': _A_in['ssm_D'], 'B_x': _B_in['x'], 'B_mem0': _B_in['mem0'], 'B_Wq': _B_in['Wq'], 'B_Wk': _B_in['Wk'], 'B_Wv': _B_in['Wv'], 'B_Wo': _B_in['Wo'], 'B_seg_len': _B_in['seg_len']}

def reference(A_q, A_k, A_v, A_shift_k, A_ssm_k, A_ssm_D, B_x, B_mem0, B_Wq, B_Wk, B_Wv, B_Wo, B_seg_len):

    def _A_ref(q, k, v, shift_k, ssm_k, ssm_D):
        B, S, D = q.shape
        ks = shift_k.shape[-1]
        k_pad = _pad(k, ((0, 0), (ks - 1, 0), (0, 0)))
        k_shift = torch.zeros_like(k)
        for t in range(ks):
            k_shift = k_shift + k_pad[:, t:t + S, :] * shift_k[:, ks - 1 - t][None, None, :]
        kv = k_shift * v
        L = 2 * S
        kv_pad = _pad(kv, ((0, 0), (0, S), (0, 0)))
        kf_pad = _pad(ssm_k, ((0, 0), (0, S)))
        kv_f = (lambda x, axes=(-2, -1): torch.fft.rfft2(x.float(), dim=axes))(kv_pad[:, None, :, :], axes=(1, 2))
        kf_f = (lambda x, axes=(-2, -1): torch.fft.rfft2(x.float(), dim=axes))(kf_pad[:, None, :], axes=(1, 2))
        kf_f = (lambda x, *d: x.permute(*d))(kf_f, 1, 2, 0)
        y_f = kv_f * kf_f[None, :, :, :]
        y = (lambda x, s, axes=(-2, -1): torch.fft.irfft2(x, s=s, dim=axes).to(torch.bfloat16))(y_f, (1, L), axes=(1, 2))[:, 0, :S, :]
        y = y + kv * ssm_D[None, None, :]
        return q * y

    def _B_ref(x, mem0, Wq, Wk, Wv, Wo, seg_len):
        B, S, Dm = x.shape
        H, Dh = (Wq.shape[1], Wq.shape[2])
        M = mem0.shape[1]
        scale = Dh ** (-0.5)
        n_seg = S // seg_len
        L = M + seg_len
        idx = torch.arange(L)
        mask = (idx[:, None] < M) | (idx[:, None] >= idx[None, :])
        mem = mem0
        outs = []
        for s in range(n_seg):
            xs = x[:, s * seg_len:(s + 1) * seg_len, :].clone()
            h = torch.concatenate([mem, xs], axis=1)
            q = torch.einsum('btd,dhe->bhte', h, Wq)
            k = torch.einsum('btd,dhe->bhte', h, Wk)
            v = torch.einsum('btd,dhe->bhte', h, Wv)
            scores = torch.einsum('bhqe,bhke->bhqk', q, k) * scale
            scores = torch.where(mask[None, None], scores, -1000000000.0)
            p = _softmax(scores, axis=-1)
            o = torch.einsum('bhqk,bhke->bhqe', p, v)
            o = torch.einsum('bhte,hed->btd', o, Wo)
            mem = o[:, :M, :].clone()
            outs.append(o[:, M:, :])
        return torch.concatenate(outs, axis=1)
    a = _A_ref(A_q, A_k, A_v, A_shift_k, A_ssm_k, A_ssm_D)
    b = _B_ref(B_x, B_mem0, B_Wq, B_Wk, B_Wv, B_Wo, B_seg_len)
    return torch.concatenate([a, b], axis=-1)
```

```asm
; @launch grid=(256,1,1) block=(512,1,1) lds=163840
.amdgcn_target "amdgcn-amd-amdhsa--gfx950"
.text
.p2align 8
.globl concat_heads__ssm_conv_h3__memory_aug_recurrent_mem_tr__prompt_kernel
.type concat_heads__ssm_conv_h3__memory_aug_recurrent_mem_tr__prompt_kernel,@function
concat_heads__ssm_conv_h3__memory_aug_recurrent_mem_tr__prompt_kernel:
s_cmp_ge_u32 s2, 256
s_cbranch_scc1 L_end
s_load_dwordx2 s[4:5], s[0:1], 120
s_load_dwordx2 s[28:29], s[0:1], 112
s_getreg_b32 s13, hwreg(HW_REG_XCC_ID)
s_and_b32 s13, s13, 7
s_lshr_b32 s14, s2, 3
v_lshrrev_b32 v1, 6, v0
v_and_b32 v0, 63, v0
v_readfirstlane_b32 s15, v1
s_mov_b32 s30, 256
s_mov_b32 s31, 0x20000
s_mov_b32 s6, 222298112
s_mov_b32 s7, 0x20000
s_mov_b32 s19, 0
s_mov_b32 s16, 0
s_mov_b32 s17, 0
s_and_b32 s12, s15, 3
v_lshlrev_b32 v1, 4, v0
v_mov_b32 v4, -1
v_mov_b32 v5, -1
v_mov_b32 v6, -1
v_mov_b32 v7, -1
s_waitcnt lgkmcnt(0)
s_add_u32 s4, s4, 0x1fffff
s_addc_u32 s5, s5, 0
s_and_b32 s4, s4, 0xffe00000

s_cmp_ge_u32 s13, 4
s_cbranch_scc1 L_noprobe
s_cmp_lt_u32 s14, 24
s_cbranch_scc1 L_noprobe
s_cmp_lg_u32 s15, 7
s_cbranch_scc1 L_probewait
s_and_b32 s22, s13, 3
s_bfe_u32 s23, s14, 0x10001
s_lshl_b32 s20, s22, 19
s_lshl_b32 s21, s14, 14
s_add_u32 s20, s20, s21
s_lshl_b32 s21, s23, 12
s_add_u32 s20, s20, s21
s_lshl_b32 s21, s14, 7
s_add_u32 s20, s20, s21
s_xor_b32 s21, s20, 8192
s_mov_b32 s22, 0
s_mov_b32 s23, 0
s_mov_b64 exec, 0xff
s_branch L_probe
.p2align 6
L_probe:
buffer_store_dwordx4 v[4:7], v1, s[4:7], s20 offen sc1
buffer_store_dwordx4 v[4:7], v1, s[4:7], s21 offen sc1
s_waitcnt vmcnt(1)
s_memtime s[42:43]
s_waitcnt vmcnt(0)
s_memtime s[44:45]
s_waitcnt lgkmcnt(0)
s_sub_u32 s24, s44, s42
s_min_u32 s24, s24, 400
s_cmp_eq_u32 s22, 0
s_cselect_b32 s24, 0, s24
s_sub_u32 s23, s24, s23
s_xor_b32 s20, s20, 8192
s_xor_b32 s21, s21, 8192
s_add_u32 s22, s22, 1
s_cmp_lt_u32 s22, 3
s_cbranch_scc1 L_probe
s_mov_b64 exec, -1
s_cmp_lt_i32 s23, 0
s_cselect_b32 s17, 0x100000, 0
L_probewait:
s_barrier
L_noprobe:
s_cmp_lg_u32 s15, 7
s_cbranch_scc1 L_role
s_setprio 3
s_bitcmp1_b32 s2, 2
s_cbranch_scc1 L_arr
s_lshr_b32 s25, s2, 3
s_lshl_b32 s25, s25, 2
s_and_b32 s20, s2, 3
s_add_u32 s25, s25, s20
s_mul_i32 s20, s25, 24576
buffer_store_dwordx4 v[4:7], v1, s[4:7], s20 offen offset:0 sc1
buffer_store_dwordx4 v[4:7], v1, s[4:7], s20 offen offset:1024 sc1
buffer_store_dwordx4 v[4:7], v1, s[4:7], s20 offen offset:2048 sc1
buffer_store_dwordx4 v[4:7], v1, s[4:7], s20 offen offset:3072 sc1
s_add_u32 s20, s20, 4096
buffer_store_dwordx4 v[4:7], v1, s[4:7], s20 offen offset:0 sc1
buffer_store_dwordx4 v[4:7], v1, s[4:7], s20 offen offset:1024 sc1
buffer_store_dwordx4 v[4:7], v1, s[4:7], s20 offen offset:2048 sc1
buffer_store_dwordx4 v[4:7], v1, s[4:7], s20 offen offset:3072 sc1
s_add_u32 s20, s20, 4096
buffer_store_dwordx4 v[4:7], v1, s[4:7], s20 offen offset:0 sc1
buffer_store_dwordx4 v[4:7], v1, s[4:7], s20 offen offset:1024 sc1
buffer_store_dwordx4 v[4:7], v1, s[4:7], s20 offen offset:2048 sc1
buffer_store_dwordx4 v[4:7], v1, s[4:7], s20 offen offset:3072 sc1
s_add_u32 s20, s20, 4096
buffer_store_dwordx4 v[4:7], v1, s[4:7], s20 offen offset:0 sc1
buffer_store_dwordx4 v[4:7], v1, s[4:7], s20 offen offset:1024 sc1
buffer_store_dwordx4 v[4:7], v1, s[4:7], s20 offen offset:2048 sc1
buffer_store_dwordx4 v[4:7], v1, s[4:7], s20 offen offset:3072 sc1
s_add_u32 s20, s20, 4096
buffer_store_dwordx4 v[4:7], v1, s[4:7], s20 offen offset:0 sc1
buffer_store_dwordx4 v[4:7], v1, s[4:7], s20 offen offset:1024 sc1
buffer_store_dwordx4 v[4:7], v1, s[4:7], s20 offen offset:2048 sc1
buffer_store_dwordx4 v[4:7], v1, s[4:7], s20 offen offset:3072 sc1
s_add_u32 s20, s20, 4096
buffer_store_dwordx4 v[4:7], v1, s[4:7], s20 offen offset:0 sc1
buffer_store_dwordx4 v[4:7], v1, s[4:7], s20 offen offset:1024 sc1
buffer_store_dwordx4 v[4:7], v1, s[4:7], s20 offen offset:2048 sc1
buffer_store_dwordx4 v[4:7], v1, s[4:7], s20 offen offset:3072 sc1
s_add_u32 s20, s20, 4096
s_lshr_b32 s21, s25, 3
s_and_b32 s22, s25, 7
s_lshl_b32 s20, s21, 21
s_lshl_b32 s23, s22, 12
s_add_u32 s20, s20, s23
s_add_u32 s21, s20, 104857600
buffer_store_dwordx4 v[4:7], v1, s[4:7], s21 offen offset:0 sc1
buffer_store_dwordx4 v[4:7], v1, s[4:7], s21 offen offset:1024 sc1
buffer_store_dwordx4 v[4:7], v1, s[4:7], s21 offen offset:2048 sc1
buffer_store_dwordx4 v[4:7], v1, s[4:7], s21 offen offset:3072 sc1
s_add_u32 s21, s20, 155189248
buffer_store_dwordx4 v[4:7], v1, s[4:7], s21 offen offset:0 sc1
buffer_store_dwordx4 v[4:7], v1, s[4:7], s21 offen offset:1024 sc1
buffer_store_dwordx4 v[4:7], v1, s[4:7], s21 offen offset:2048 sc1
buffer_store_dwordx4 v[4:7], v1, s[4:7], s21 offen offset:3072 sc1
s_add_u32 s21, s20, 156237824
buffer_store_dwordx4 v[4:7], v1, s[4:7], s21 offen offset:0 sc1
buffer_store_dwordx4 v[4:7], v1, s[4:7], s21 offen offset:1024 sc1
buffer_store_dwordx4 v[4:7], v1, s[4:7], s21 offen offset:2048 sc1
buffer_store_dwordx4 v[4:7], v1, s[4:7], s21 offen offset:3072 sc1
s_add_u32 s21, s20, 188743680
buffer_store_dwordx4 v[4:7], v1, s[4:7], s21 offen offset:0 sc1
buffer_store_dwordx4 v[4:7], v1, s[4:7], s21 offen offset:1024 sc1
buffer_store_dwordx4 v[4:7], v1, s[4:7], s21 offen offset:2048 sc1
buffer_store_dwordx4 v[4:7], v1, s[4:7], s21 offen offset:3072 sc1
s_add_u32 s21, s20, 189792256
buffer_store_dwordx4 v[4:7], v1, s[4:7], s21 offen offset:0 sc1
buffer_store_dwordx4 v[4:7], v1, s[4:7], s21 offen offset:1024 sc1
buffer_store_dwordx4 v[4:7], v1, s[4:7], s21 offen offset:2048 sc1
buffer_store_dwordx4 v[4:7], v1, s[4:7], s21 offen offset:3072 sc1
s_lshl_b32 s20, s25, 8
s_add_u32 s20, s20, 3932160
v_mov_b32 v8, 0
v_lshlrev_b32 v2, 2, v0
buffer_store_dword v8, v2, s[4:7], s20 offen sc1
L_arr:
s_waitcnt vmcnt(0)
s_lshl_b32 s20, 1, s14
s_add_u32 s21, s17, 0x100
v_mov_b32 v8, s20
v_mov_b32 v9, s21
s_lshl_b32 s20, s13, 5
v_mov_b32 v2, s20
s_mov_b64 exec, 1
buffer_atomic_add_x2 v[8:9], v2, s[28:31], 0 offen
s_mov_b64 exec, -1
s_setprio 0
s_nop 1
L_role:
s_cmp_lt_u32 s13, 4
s_cbranch_scc1 L_chain
s_sub_u32 s22, s13, 4
s_and_b32 s20, s14, 7
s_lshr_b32 s33, s14, 3
s_lshl_b32 s32, s22, 3
s_add_u32 s32, s32, s20
s_cmp_lt_u32 s33, 2
s_cbranch_scc1 L_kv
s_lshl_b32 s23, s33, 3
s_add_u32 s10, s0, s23
s_addc_u32 s11, s1, 0
s_load_dwordx2 s[8:9], s[10:11], 56
s_mul_i32 s23, s15, 786432
s_lshl_b32 s24, s32, 8
s_add_u32 s24, s24, s23
s_add_u32 s24, s24, 2097152
v_bfe_u32 v3, v0, 4, 2
v_lshlrev_b32 v2, 13, v3
v_bfe_u32 v3, v0, 0, 4
v_lshl_add_u32 v2, v3, 4, v2
v_add_u32 v2, s24, v2
s_waitcnt lgkmcnt(0)
s_mov_b32 s10, 8388608
s_mov_b32 s11, 0x20000
s_mov_b32 s24, 0
buffer_load_dwordx4 v[8:11], v2, s[8:11], s24 offen
s_mov_b32 s25, 32768
buffer_load_dwordx4 v[12:15], v2, s[8:11], s25 offen
s_mov_b32 s24, 65536
buffer_load_dwordx4 v[16:19], v2, s[8:11], s24 offen
s_mov_b32 s25, 98304
buffer_load_dwordx4 v[20:23], v2, s[8:11], s25 offen
s_mov_b32 s24, 131072
buffer_load_dwordx4 v[24:27], v2, s[8:11], s24 offen
s_mov_b32 s25, 163840
buffer_load_dwordx4 v[28:31], v2, s[8:11], s25 offen
s_mov_b32 s24, 196608
buffer_load_dwordx4 v[32:35], v2, s[8:11], s24 offen
s_mov_b32 s25, 229376
buffer_load_dwordx4 v[36:39], v2, s[8:11], s25 offen
s_mov_b32 s24, 262144
buffer_load_dwordx4 v[40:43], v2, s[8:11], s24 offen
s_mov_b32 s25, 294912
buffer_load_dwordx4 v[44:47], v2, s[8:11], s25 offen
s_mov_b32 s24, 327680
buffer_load_dwordx4 v[48:51], v2, s[8:11], s24 offen
s_mov_b32 s25, 360448
buffer_load_dwordx4 v[52:55], v2, s[8:11], s25 offen
s_mov_b32 s24, 393216
buffer_load_dwordx4 v[56:59], v2, s[8:11], s24 offen
s_mov_b32 s25, 425984
buffer_load_dwordx4 v[60:63], v2, s[8:11], s25 offen
s_mov_b32 s24, 458752
buffer_load_dwordx4 v[64:67], v2, s[8:11], s24 offen
s_mov_b32 s25, 491520
buffer_load_dwordx4 v[68:71], v2, s[8:11], s25 offen
s_mov_b32 s24, 524288
buffer_load_dwordx4 v[72:75], v2, s[8:11], s24 offen
s_mov_b32 s25, 557056
buffer_load_dwordx4 v[76:79], v2, s[8:11], s25 offen
s_mov_b32 s24, 589824
buffer_load_dwordx4 v[80:83], v2, s[8:11], s24 offen
s_mov_b32 s25, 622592
buffer_load_dwordx4 v[84:87], v2, s[8:11], s25 offen
s_mov_b32 s24, 655360
buffer_load_dwordx4 v[88:91], v2, s[8:11], s24 offen
s_mov_b32 s25, 688128
buffer_load_dwordx4 v[92:95], v2, s[8:11], s25 offen
s_mov_b32 s24, 720896
buffer_load_dwordx4 v[96:99], v2, s[8:11], s24 offen
s_mov_b32 s25, 753664
buffer_load_dwordx4 v[100:103], v2, s[8:11], s25 offen
s_waitcnt vmcnt(0)
s_cmp_eq_u32 s33, 2
s_cbranch_scc1 L_qa
s_and_b32 s33, s13, 3
s_and_b32 s32, s14, 7
s_mov_b32 s40, 0
s_mov_b32 s18, 0
s_cmp_lg_u32 s16, 0
s_cbranch_scc1 rdy_1
v_and_b32 v1, 7, v0
v_lshlrev_b32 v1, 5, v1
s_cmp_eq_u32 s15, 0
s_cbranch_scc1 rdy_2
s_barrier
rdy_2:
buffer_load_dwordx2 v[130:131], v1, s[28:31], 0 offen sc1
rdy_5:
s_mov_b32 s20, 0
s_waitcnt vmcnt(0)
v_readlane_b32 s21, v131, 0
s_nop 0
s_lshr_b32 s21, s21, 8
s_add_u32 s20, s20, s21
v_readlane_b32 s21, v131, 1
s_nop 0
s_lshr_b32 s21, s21, 8
s_add_u32 s20, s20, s21
v_readlane_b32 s21, v131, 2
s_nop 0
s_lshr_b32 s21, s21, 8
s_add_u32 s20, s20, s21
v_readlane_b32 s21, v131, 3
s_nop 0
s_lshr_b32 s21, s21, 8
s_add_u32 s20, s20, s21
v_readlane_b32 s21, v131, 4
s_nop 0
s_lshr_b32 s21, s21, 8
s_add_u32 s20, s20, s21
v_readlane_b32 s21, v131, 5
s_nop 0
s_lshr_b32 s21, s21, 8
s_add_u32 s20, s20, s21
v_readlane_b32 s21, v131, 6
s_nop 0
s_lshr_b32 s21, s21, 8
s_add_u32 s20, s20, s21
v_readlane_b32 s21, v131, 7
s_nop 0
s_lshr_b32 s21, s21, 8
s_add_u32 s20, s20, s21
s_and_b32 s21, s20, 0xfff
s_cmp_ge_u32 s21, 256
s_cbranch_scc1 rdy_3
s_add_u32 s19, s19, 1
s_cmp_gt_u32 s19, 1048576
s_cbranch_scc1 L_end
s_sleep 8
s_branch rdy_2
rdy_3:
s_cmp_lg_u32 s15, 0
s_cbranch_scc1 rdy_4
s_barrier
rdy_4:
s_lshr_b32 s20, s20, 12
s_cmp_gt_u32 s20, 16
s_cselect_b32 s17, 8192, 0
v_and_b32 v131, 0xfffff, v131
v_cmp_ne_u32 vcc, -1, v130
s_cbranch_vccnz L_restart
v_cmp_ne_u32 vcc, 0x2000, v131
s_cbranch_vccnz L_restart
rdy_1:
s_mov_b32 s40, 0
s_mov_b32 s18, 0
v_mov_b32 v249, 0
s_cmp_lg_u32 s15, 0
s_cbranch_scc1 hold_6
s_lshl_b32 s41, s32, 8
s_add_u32 s41, s41, 3932160
s_xor_b32 s41, s41, s17
s_cmp_gt_u32 s40, s18
s_cbranch_scc0 pf_7
pf_8:
hold_6:
s_barrier
s_mov_b32 s40, 0
s_mov_b32 s18, 0
s_lshl_b32 s41, s32, 2
s_add_u32 s41, s41, s33
s_load_dwordx2 s[52:53], s[0:1], 8
s_mov_b32 s54, 4194304
s_mov_b32 s55, 0x20000
s_waitcnt lgkmcnt(0)
s_load_dwordx2 s[56:57], s[0:1], 16
s_mov_b32 s58, 4194304
s_mov_b32 s59, 0x20000
s_waitcnt lgkmcnt(0)
s_load_dwordx2 s[8:9], s[0:1], 24
s_mov_b32 s10, 8192
s_mov_b32 s11, 0x20000
s_waitcnt lgkmcnt(0)
s_mov_b32 s60, 0xffff0000
s_mov_b32 s61, 0
s_lshl_b32 s20, s41, 17
s_lshl_b32 s21, s15, 14
s_add_u32 s20, s20, s21
v_lshlrev_b32 v240, 4, v0
v_add_u32 v237, s20, v240
s_sub_u32 s21, s20, 8192
s_cmp_eq_u32 s20, 0
s_cselect_b32 s21, 0x40000000, s21
v_add_u32 v238, s21, v240
v_lshlrev_b32 v242, 6, v0
v_and_b32 v236, 7, v0
v_xor_b32 v236, s15, v236
v_lshlrev_b32 v236, 4, v236
v_lshl_add_u32 v239, v0, 11, v236
s_lshl_b32 s20, s15, 14
v_add_u32 v240, s20, v240
v_bfe_u32 v236, v0, 4, 2
v_lshlrev_b32 v241, 14, v236
v_bfe_u32 v236, v0, 3, 1
v_lshl_add_u32 v241, v236, 12, v241
v_bfe_u32 v236, v0, 0, 3
v_lshl_add_u32 v241, v236, 4, v241
s_bfe_u32 s21, s15, 0x10001
s_lshl_b32 s62, s15, 20
s_lshl_b32 s22, s21, 13
s_add_u32 s62, s62, s22
s_lshl_b32 s22, s41, 7
s_add_u32 s62, s62, s22
s_add_u32 s62, s62, 138412032
s_xor_b32 s62, s62, s17
s_xor_b32 s62, s62, 0x2000
s_mov_b32 s20, 0
buffer_load_dwordx4 v[2:5], v238, s[52:55], s20 offen offset:0 nt
s_mov_b32 s21, 0
buffer_load_dwordx4 v[6:9], v238, s[52:55], s21 offen offset:2048 nt
s_mov_b32 s20, 4096
buffer_load_dwordx4 v[10:13], v238, s[52:55], s20 offen offset:0 nt
s_mov_b32 s21, 4096
buffer_load_dwordx4 v[14:17], v238, s[52:55], s21 offen offset:2048 nt
s_mov_b32 s20, 0
buffer_load_dwordx4 v[18:21], v237, s[52:55], s20 offen offset:0 nt
s_mov_b32 s21, 0
buffer_load_dwordx4 v[22:25], v237, s[52:55], s21 offen offset:2048 nt
s_mov_b32 s20, 4096
buffer_load_dwordx4 v[26:29], v237, s[52:55], s20 offen offset:0 nt
s_mov_b32 s21, 4096
buffer_load_dwordx4 v[30:33], v237, s[52:55], s21 offen offset:2048 nt
s_mov_b32 s20, 8192
buffer_load_dwordx4 v[34:37], v237, s[52:55], s20 offen offset:0 nt
s_mov_b32 s21, 8192
buffer_load_dwordx4 v[38:41], v237, s[52:55], s21 offen offset:2048 nt
s_mov_b32 s20, 12288
buffer_load_dwordx4 v[42:45], v237, s[52:55], s20 offen offset:0 nt
s_mov_b32 s21, 12288
buffer_load_dwordx4 v[46:49], v237, s[52:55], s21 offen offset:2048 nt
s_mov_b32 s21, 4096
buffer_load_dwordx4 v[50:53], v238, s[56:59], s21 offen offset:2048 nt
s_mov_b32 s20, 0
buffer_load_dwordx4 v[54:57], v237, s[56:59], s20 offen offset:0 nt
s_mov_b32 s21, 0
buffer_load_dwordx4 v[58:61], v237, s[56:59], s21 offen offset:2048 nt
s_mov_b32 s20, 4096
buffer_load_dwordx4 v[62:65], v237, s[56:59], s20 offen offset:0 nt
s_mov_b32 s21, 4096
buffer_load_dwordx4 v[66:69], v237, s[56:59], s21 offen offset:2048 nt
s_mov_b32 s20, 8192
buffer_load_dwordx4 v[70:73], v237, s[56:59], s20 offen offset:0 nt
s_mov_b32 s21, 8192
buffer_load_dwordx4 v[74:77], v237, s[56:59], s21 offen offset:2048 nt
s_mov_b32 s20, 12288
buffer_load_dwordx4 v[78:81], v237, s[56:59], s20 offen offset:0 nt
s_mov_b32 s21, 12288
buffer_load_dwordx4 v[82:85], v237, s[56:59], s21 offen offset:2048 nt
s_mov_b32 s20, 0
buffer_load_dwordx4 v[86:89], v242, s[8:11], s20 offen offset:0
buffer_load_dwordx4 v[90:93], v242, s[8:11], s20 offen offset:16
buffer_load_dwordx4 v[94:97], v242, s[8:11], s20 offen offset:32
buffer_load_dwordx4 v[98:101], v242, s[8:11], s20 offen offset:48
s_barrier
s_mov_b32 s20, 0
buffer_load_dwordx4 v[136:139], v238, s[52:55], s20 offen offset:1024 nt
s_mov_b32 s21, 0
buffer_load_dwordx4 v[140:143], v238, s[52:55], s21 offen offset:3072 nt
s_mov_b32 s20, 4096
buffer_load_dwordx4 v[144:147], v238, s[52:55], s20 offen offset:1024 nt
s_mov_b32 s21, 4096
buffer_load_dwordx4 v[148:151], v238, s[52:55], s21 offen offset:3072 nt
s_mov_b32 s20, 0
buffer_load_dwordx4 v[152:155], v237, s[52:55], s20 offen offset:1024 nt
s_mov_b32 s21, 0
buffer_load_dwordx4 v[156:159], v237, s[52:55], s21 offen offset:3072 nt
s_mov_b32 s20, 4096
buffer_load_dwordx4 v[160:163], v237, s[52:55], s20 offen offset:1024 nt
s_mov_b32 s21, 4096
buffer_load_dwordx4 v[164:167], v237, s[52:55], s21 offen offset:3072 nt
s_mov_b32 s20, 8192
buffer_load_dwordx4 v[168:171], v237, s[52:55], s20 offen offset:1024 nt
s_mov_b32 s21, 8192
buffer_load_dwordx4 v[172:175], v237, s[52:55], s21 offen offset:3072 nt
s_mov_b32 s20, 12288
buffer_load_dwordx4 v[176:179], v237, s[52:55], s20 offen offset:1024 nt
s_mov_b32 s21, 12288
buffer_load_dwordx4 v[180:183], v237, s[52:55], s21 offen offset:3072 nt
s_mov_b32 s21, 4096
buffer_load_dwordx4 v[184:187], v238, s[56:59], s21 offen offset:3072 nt
s_mov_b32 s20, 0
buffer_load_dwordx4 v[188:191], v237, s[56:59], s20 offen offset:1024 nt
s_mov_b32 s21, 0
buffer_load_dwordx4 v[192:195], v237, s[56:59], s21 offen offset:3072 nt
s_mov_b32 s20, 4096
buffer_load_dwordx4 v[196:199], v237, s[56:59], s20 offen offset:1024 nt
s_mov_b32 s21, 4096
buffer_load_dwordx4 v[200:203], v237, s[56:59], s21 offen offset:3072 nt
s_mov_b32 s20, 8192
buffer_load_dwordx4 v[204:207], v237, s[56:59], s20 offen offset:1024 nt
s_mov_b32 s21, 8192
buffer_load_dwordx4 v[208:211], v237, s[56:59], s21 offen offset:3072 nt
s_mov_b32 s20, 12288
buffer_load_dwordx4 v[212:215], v237, s[56:59], s20 offen offset:1024 nt
s_mov_b32 s21, 12288
buffer_load_dwordx4 v[216:219], v237, s[56:59], s21 offen offset:3072 nt
s_mov_b32 s20, 4096
buffer_load_dwordx4 v[220:223], v242, s[8:11], s20 offen offset:0
buffer_load_dwordx4 v[224:227], v242, s[8:11], s20 offen offset:16
buffer_load_dwordx4 v[228:231], v242, s[8:11], s20 offen offset:32
buffer_load_dwordx4 v[232:235], v242, s[8:11], s20 offen offset:48
s_waitcnt vmcnt(25)
v_lshlrev_b32 v114, 16, v86
v_and_b32 v115, s60, v86
v_lshlrev_b32 v116, 16, v87
v_and_b32 v117, s60, v87
v_lshlrev_b32 v102, 16, v2
v_lshlrev_b32 v103, 16, v6
v_lshlrev_b32 v104, 16, v10
v_lshlrev_b32 v105, 16, v14
v_lshlrev_b32 v106, 16, v18
v_lshlrev_b32 v107, 16, v22
v_lshlrev_b32 v108, 16, v26
v_lshlrev_b32 v109, 16, v30
v_lshlrev_b32 v110, 16, v34
v_lshlrev_b32 v111, 16, v38
v_lshlrev_b32 v112, 16, v42
v_lshlrev_b32 v113, 16, v46
v_mul_f32 v118, v102, v117
v_fmac_f32 v118, v103, v116
v_fmac_f32 v118, v104, v115
v_fmac_f32 v118, v105, v114
v_lshlrev_b32 v127, 16, v50
v_mul_f32 v118, v118, v127
v_mul_f32 v119, v103, v117
v_fmac_f32 v119, v104, v116
v_fmac_f32 v119, v105, v115
v_fmac_f32 v119, v106, v114
v_lshlrev_b32 v127, 16, v54
v_mul_f32 v119, v119, v127
v_mul_f32 v120, v104, v117
v_fmac_f32 v120, v105, v116
v_fmac_f32 v120, v106, v115
v_fmac_f32 v120, v107, v114
v_lshlrev_b32 v127, 16, v58
v_mul_f32 v120, v120, v127
v_mul_f32 v121, v105, v117
v_fmac_f32 v121, v106, v116
v_fmac_f32 v121, v107, v115
v_fmac_f32 v121, v108, v114
v_lshlrev_b32 v127, 16, v62
v_mul_f32 v121, v121, v127
v_mul_f32 v122, v106, v117
v_fmac_f32 v122, v107, v116
v_fmac_f32 v122, v108, v115
v_fmac_f32 v122, v109, v114
v_lshlrev_b32 v127, 16, v66
v_mul_f32 v122, v122, v127
v_mul_f32 v123, v107, v117
v_fmac_f32 v123, v108, v116
v_fmac_f32 v123, v109, v115
v_fmac_f32 v123, v110, v114
v_lshlrev_b32 v127, 16, v70
v_mul_f32 v123, v123, v127
v_mul_f32 v124, v108, v117
v_fmac_f32 v124, v109, v116
v_fmac_f32 v124, v110, v115
v_fmac_f32 v124, v111, v114
v_lshlrev_b32 v127, 16, v74
v_mul_f32 v124, v124, v127
v_mul_f32 v125, v109, v117
v_fmac_f32 v125, v110, v116
v_fmac_f32 v125, v111, v115
v_fmac_f32 v125, v112, v114
v_lshlrev_b32 v127, 16, v78
v_mul_f32 v125, v125, v127
v_mul_f32 v126, v110, v117
v_fmac_f32 v126, v111, v116
v_fmac_f32 v126, v112, v115
v_fmac_f32 v126, v113, v114
v_lshlrev_b32 v127, 16, v82
v_mul_f32 v126, v126, v127
v_cvt_pk_bf16_f32 v128, v125, v124
v_cvt_pk_bf16_f32 v132, v126, v125
v_cvt_pk_bf16_f32 v129, v123, v122
v_cvt_pk_bf16_f32 v133, v124, v123
v_cvt_pk_bf16_f32 v130, v121, v120
v_cvt_pk_bf16_f32 v134, v122, v121
v_cvt_pk_bf16_f32 v131, v119, v118
v_cvt_pk_bf16_f32 v135, v120, v119
ds_write_b128 v239, v[128:131] offset:0
ds_write_b128 v239, v[132:135] offset:128
v_lshlrev_b32 v114, 16, v88
v_and_b32 v115, s60, v88
v_lshlrev_b32 v116, 16, v89
v_and_b32 v117, s60, v89
v_and_b32 v102, s60, v2
v_and_b32 v103, s60, v6
v_and_b32 v104, s60, v10
v_and_b32 v105, s60, v14
v_and_b32 v106, s60, v18
v_and_b32 v107, s60, v22
v_and_b32 v108, s60, v26
v_and_b32 v109, s60, v30
v_and_b32 v110, s60, v34
v_and_b32 v111, s60, v38
v_and_b32 v112, s60, v42
v_and_b32 v113, s60, v46
v_mul_f32 v118, v102, v117
v_fmac_f32 v118, v103, v116
v_fmac_f32 v118, v104, v115
v_fmac_f32 v118, v105, v114
v_and_b32 v127, s60, v50
v_mul_f32 v118, v118, v127
v_mul_f32 v119, v103, v117
v_fmac_f32 v119, v104, v116
v_fmac_f32 v119, v105, v115
v_fmac_f32 v119, v106, v114
v_and_b32 v127, s60, v54
v_mul_f32 v119, v119, v127
v_mul_f32 v120, v104, v117
v_fmac_f32 v120, v105, v116
v_fmac_f32 v120, v106, v115
v_fmac_f32 v120, v107, v114
v_and_b32 v127, s60, v58
v_mul_f32 v120, v120, v127
v_mul_f32 v121, v105, v117
v_fmac_f32 v121, v106, v116
v_fmac_f32 v121, v107, v115
v_fmac_f32 v121, v108, v114
v_and_b32 v127, s60, v62
v_mul_f32 v121, v121, v127
v_mul_f32 v122, v106, v117
v_fmac_f32 v122, v107, v116
v_fmac_f32 v122, v108, v115
v_fmac_f32 v122, v109, v114
v_and_b32 v127, s60, v66
v_mul_f32 v122, v122, v127
v_mul_f32 v123, v107, v117
v_fmac_f32 v123, v108, v116
v_fmac_f32 v123, v109, v115
v_fmac_f32 v123, v110, v114
v_and_b32 v127, s60, v70
v_mul_f32 v123, v123, v127
v_mul_f32 v124, v108, v117
v_fmac_f32 v124, v109, v116
v_fmac_f32 v124, v110, v115
v_fmac_f32 v124, v111, v114
v_and_b32 v127, s60, v74
v_mul_f32 v124, v124, v127
v_mul_f32 v125, v109, v117
v_fmac_f32 v125, v110, v116
v_fmac_f32 v125, v111, v115
v_fmac_f32 v125, v112, v114
v_and_b32 v127, s60, v78
v_mul_f32 v125, v125, v127
v_mul_f32 v126, v110, v117
v_fmac_f32 v126, v111, v116
v_fmac_f32 v126, v112, v115
v_fmac_f32 v126, v113, v114
v_and_b32 v127, s60, v82
v_mul_f32 v126, v126, v127
v_cvt_pk_bf16_f32 v128, v125, v124
v_cvt_pk_bf16_f32 v132, v126, v125
v_cvt_pk_bf16_f32 v129, v123, v122
v_cvt_pk_bf16_f32 v133, v124, v123
v_cvt_pk_bf16_f32 v130, v121, v120
v_cvt_pk_bf16_f32 v134, v122, v121
v_cvt_pk_bf16_f32 v131, v119, v118
v_cvt_pk_bf16_f32 v135, v120, v119
ds_write_b128 v239, v[128:131] offset:256
ds_write_b128 v239, v[132:135] offset:384
v_lshlrev_b32 v114, 16, v90
v_and_b32 v115, s60, v90
v_lshlrev_b32 v116, 16, v91
v_and_b32 v117, s60, v91
v_lshlrev_b32 v102, 16, v3
v_lshlrev_b32 v103, 16, v7
v_lshlrev_b32 v104, 16, v11
v_lshlrev_b32 v105, 16, v15
v_lshlrev_b32 v106, 16, v19
v_lshlrev_b32 v107, 16, v23
v_lshlrev_b32 v108, 16, v27
v_lshlrev_b32 v109, 16, v31
v_lshlrev_b32 v110, 16, v35
v_lshlrev_b32 v111, 16, v39
v_lshlrev_b32 v112, 16, v43
v_lshlrev_b32 v113, 16, v47
v_mul_f32 v118, v102, v117
v_fmac_f32 v118, v103, v116
v_fmac_f32 v118, v104, v115
v_fmac_f32 v118, v105, v114
v_lshlrev_b32 v127, 16, v51
v_mul_f32 v118, v118, v127
v_mul_f32 v119, v103, v117
v_fmac_f32 v119, v104, v116
v_fmac_f32 v119, v105, v115
v_fmac_f32 v119, v106, v114
v_lshlrev_b32 v127, 16, v55
v_mul_f32 v119, v119, v127
v_mul_f32 v120, v104, v117
v_fmac_f32 v120, v105, v116
v_fmac_f32 v120, v106, v115
v_fmac_f32 v120, v107, v114
v_lshlrev_b32 v127, 16, v59
v_mul_f32 v120, v120, v127
v_mul_f32 v121, v105, v117
v_fmac_f32 v121, v106, v116
v_fmac_f32 v121, v107, v115
v_fmac_f32 v121, v108, v114
v_lshlrev_b32 v127, 16, v63
v_mul_f32 v121, v121, v127
v_mul_f32 v122, v106, v117
v_fmac_f32 v122, v107, v116
v_fmac_f32 v122, v108, v115
v_fmac_f32 v122, v109, v114
v_lshlrev_b32 v127, 16, v67
v_mul_f32 v122, v122, v127
v_mul_f32 v123, v107, v117
v_fmac_f32 v123, v108, v116
v_fmac_f32 v123, v109, v115
v_fmac_f32 v123, v110, v114
v_lshlrev_b32 v127, 16, v71
v_mul_f32 v123, v123, v127
v_mul_f32 v124, v108, v117
v_fmac_f32 v124, v109, v116
v_fmac_f32 v124, v110, v115
v_fmac_f32 v124, v111, v114
v_lshlrev_b32 v127, 16, v75
v_mul_f32 v124, v124, v127
v_mul_f32 v125, v109, v117
v_fmac_f32 v125, v110, v116
v_fmac_f32 v125, v111, v115
v_fmac_f32 v125, v112, v114
v_lshlrev_b32 v127, 16, v79
v_mul_f32 v125, v125, v127
v_mul_f32 v126, v110, v117
v_fmac_f32 v126, v111, v116
v_fmac_f32 v126, v112, v115
v_fmac_f32 v126, v113, v114
v_lshlrev_b32 v127, 16, v83
v_mul_f32 v126, v126, v127
v_cvt_pk_bf16_f32 v128, v125, v124
v_cvt_pk_bf16_f32 v132, v126, v125
v_cvt_pk_bf16_f32 v129, v123, v122
v_cvt_pk_bf16_f32 v133, v124, v123
v_cvt_pk_bf16_f32 v130, v121, v120
v_cvt_pk_bf16_f32 v134, v122, v121
v_cvt_pk_bf16_f32 v131, v119, v118
v_cvt_pk_bf16_f32 v135, v120, v119
ds_write_b128 v239, v[128:131] offset:512
ds_write_b128 v239, v[132:135] offset:640
v_lshlrev_b32 v114, 16, v92
v_and_b32 v115, s60, v92
v_lshlrev_b32 v116, 16, v93
v_and_b32 v117, s60, v93
v_and_b32 v102, s60, v3
v_and_b32 v103, s60, v7
v_and_b32 v104, s60, v11
v_and_b32 v105, s60, v15
v_and_b32 v106, s60, v19
v_and_b32 v107, s60, v23
v_and_b32 v108, s60, v27
v_and_b32 v109, s60, v31
v_and_b32 v110, s60, v35
v_and_b32 v111, s60, v39
v_and_b32 v112, s60, v43
v_and_b32 v113, s60, v47
v_mul_f32 v118, v102, v117
v_fmac_f32 v118, v103, v116
v_fmac_f32 v118, v104, v115
v_fmac_f32 v118, v105, v114
v_and_b32 v127, s60, v51
v_mul_f32 v118, v118, v127
v_mul_f32 v119, v103, v117
v_fmac_f32 v119, v104, v116
v_fmac_f32 v119, v105, v115
v_fmac_f32 v119, v106, v114
v_and_b32 v127, s60, v55
v_mul_f32 v119, v119, v127
v_mul_f32 v120, v104, v117
v_fmac_f32 v120, v105, v116
v_fmac_f32 v120, v106, v115
v_fmac_f32 v120, v107, v114
v_and_b32 v127, s60, v59
v_mul_f32 v120, v120, v127
v_mul_f32 v121, v105, v117
v_fmac_f32 v121, v106, v116
v_fmac_f32 v121, v107, v115
v_fmac_f32 v121, v108, v114
v_and_b32 v127, s60, v63
v_mul_f32 v121, v121, v127
v_mul_f32 v122, v106, v117
v_fmac_f32 v122, v107, v116
v_fmac_f32 v122, v108, v115
v_fmac_f32 v122, v109, v114
v_and_b32 v127, s60, v67
v_mul_f32 v122, v122, v127
v_mul_f32 v123, v107, v117
v_fmac_f32 v123, v108, v116
v_fmac_f32 v123, v109, v115
v_fmac_f32 v123, v110, v114
v_and_b32 v127, s60, v71
v_mul_f32 v123, v123, v127
v_mul_f32 v124, v108, v117
v_fmac_f32 v124, v109, v116
v_fmac_f32 v124, v110, v115
v_fmac_f32 v124, v111, v114
v_and_b32 v127, s60, v75
v_mul_f32 v124, v124, v127
v_mul_f32 v125, v109, v117
v_fmac_f32 v125, v110, v116
v_fmac_f32 v125, v111, v115
v_fmac_f32 v125, v112, v114
v_and_b32 v127, s60, v79
v_mul_f32 v125, v125, v127
v_mul_f32 v126, v110, v117
v_fmac_f32 v126, v111, v116
v_fmac_f32 v126, v112, v115
v_fmac_f32 v126, v113, v114
v_and_b32 v127, s60, v83
v_mul_f32 v126, v126, v127
v_cvt_pk_bf16_f32 v128, v125, v124
v_cvt_pk_bf16_f32 v132, v126, v125
v_cvt_pk_bf16_f32 v129, v123, v122
v_cvt_pk_bf16_f32 v133, v124, v123
v_cvt_pk_bf16_f32 v130, v121, v120
v_cvt_pk_bf16_f32 v134, v122, v121
v_cvt_pk_bf16_f32 v131, v119, v118
v_cvt_pk_bf16_f32 v135, v120, v119
ds_write_b128 v239, v[128:131] offset:768
ds_write_b128 v239, v[132:135] offset:896
v_lshlrev_b32 v114, 16, v94
v_and_b32 v115, s60, v94
v_lshlrev_b32 v116, 16, v95
v_and_b32 v117, s60, v95
v_lshlrev_b32 v102, 16, v4
v_lshlrev_b32 v103, 16, v8
v_lshlrev_b32 v104, 16, v12
v_lshlrev_b32 v105, 16, v16
v_lshlrev_b32 v106, 16, v20
v_lshlrev_b32 v107, 16, v24
v_lshlrev_b32 v108, 16, v28
v_lshlrev_b32 v109, 16, v32
v_lshlrev_b32 v110, 16, v36
v_lshlrev_b32 v111, 16, v40
v_lshlrev_b32 v112, 16, v44
v_lshlrev_b32 v113, 16, v48
v_mul_f32 v118, v102, v117
v_fmac_f32 v118, v103, v116
v_fmac_f32 v118, v104, v115
v_fmac_f32 v118, v105, v114
v_lshlrev_b32 v127, 16, v52
v_mul_f32 v118, v118, v127
v_mul_f32 v119, v103, v117
v_fmac_f32 v119, v104, v116
v_fmac_f32 v119, v105, v115
v_fmac_f32 v119, v106, v114
v_lshlrev_b32 v127, 16, v56
v_mul_f32 v119, v119, v127
v_mul_f32 v120, v104, v117
v_fmac_f32 v120, v105, v116
v_fmac_f32 v120, v106, v115
v_fmac_f32 v120, v107, v114
v_lshlrev_b32 v127, 16, v60
v_mul_f32 v120, v120, v127
v_mul_f32 v121, v105, v117
v_fmac_f32 v121, v106, v116
v_fmac_f32 v121, v107, v115
v_fmac_f32 v121, v108, v114
v_lshlrev_b32 v127, 16, v64
v_mul_f32 v121, v121, v127
v_mul_f32 v122, v106, v117
v_fmac_f32 v122, v107, v116
v_fmac_f32 v122, v108, v115
v_fmac_f32 v122, v109, v114
v_lshlrev_b32 v127, 16, v68
v_mul_f32 v122, v122, v127
v_mul_f32 v123, v107, v117
v_fmac_f32 v123, v108, v116
v_fmac_f32 v123, v109, v115
v_fmac_f32 v123, v110, v114
v_lshlrev_b32 v127, 16, v72
v_mul_f32 v123, v123, v127
v_mul_f32 v124, v108, v117
v_fmac_f32 v124, v109, v116
v_fmac_f32 v124, v110, v115
v_fmac_f32 v124, v111, v114
v_lshlrev_b32 v127, 16, v76
v_mul_f32 v124, v124, v127
v_mul_f32 v125, v109, v117
v_fmac_f32 v125, v110, v116
v_fmac_f32 v125, v111, v115
v_fmac_f32 v125, v112, v114
v_lshlrev_b32 v127, 16, v80
v_mul_f32 v125, v125, v127
v_mul_f32 v126, v110, v117
v_fmac_f32 v126, v111, v116
v_fmac_f32 v126, v112, v115
v_fmac_f32 v126, v113, v114
v_lshlrev_b32 v127, 16, v84
v_mul_f32 v126, v126, v127
v_cvt_pk_bf16_f32 v128, v125, v124
v_cvt_pk_bf16_f32 v132, v126, v125
v_cvt_pk_bf16_f32 v129, v123, v122
v_cvt_pk_bf16_f32 v133, v124, v123
v_cvt_pk_bf16_f32 v130, v121, v120
v_cvt_pk_bf16_f32 v134, v122, v121
v_cvt_pk_bf16_f32 v131, v119, v118
v_cvt_pk_bf16_f32 v135, v120, v119
ds_write_b128 v239, v[128:131] offset:1024
ds_write_b128 v239, v[132:135] offset:1152
v_lshlrev_b32 v114, 16, v96
v_and_b32 v115, s60, v96
v_lshlrev_b32 v116, 16, v97
v_and_b32 v117, s60, v97
v_and_b32 v102, s60, v4
v_and_b32 v103, s60, v8
v_and_b32 v104, s60, v12
v_and_b32 v105, s60, v16
v_and_b32 v106, s60, v20
v_and_b32 v107, s60, v24
v_and_b32 v108, s60, v28
v_and_b32 v109, s60, v32
v_and_b32 v110, s60, v36
v_and_b32 v111, s60, v40
v_and_b32 v112, s60, v44
v_and_b32 v113, s60, v48
v_mul_f32 v118, v102, v117
v_fmac_f32 v118, v103, v116
v_fmac_f32 v118, v104, v115
v_fmac_f32 v118, v105, v114
v_and_b32 v127, s60, v52
v_mul_f32 v118, v118, v127
v_mul_f32 v119, v103, v117
v_fmac_f32 v119, v104, v116
v_fmac_f32 v119, v105, v115
v_fmac_f32 v119, v106, v114
v_and_b32 v127, s60, v56
v_mul_f32 v119, v119, v127
v_mul_f32 v120, v104, v117
v_fmac_f32 v120, v105, v116
v_fmac_f32 v120, v106, v115
v_fmac_f32 v120, v107, v114
v_and_b32 v127, s60, v60
v_mul_f32 v120, v120, v127
v_mul_f32 v121, v105, v117
v_fmac_f32 v121, v106, v116
v_fmac_f32 v121, v107, v115
v_fmac_f32 v121, v108, v114
v_and_b32 v127, s60, v64
v_mul_f32 v121, v121, v127
v_mul_f32 v122, v106, v117
v_fmac_f32 v122, v107, v116
v_fmac_f32 v122, v108, v115
v_fmac_f32 v122, v109, v114
v_and_b32 v127, s60, v68
v_mul_f32 v122, v122, v127
v_mul_f32 v123, v107, v117
v_fmac_f32 v123, v108, v116
v_fmac_f32 v123, v109, v115
v_fmac_f32 v123, v110, v114
v_and_b32 v127, s60, v72
v_mul_f32 v123, v123, v127
v_mul_f32 v124, v108, v117
v_fmac_f32 v124, v109, v116
v_fmac_f32 v124, v110, v115
v_fmac_f32 v124, v111, v114
v_and_b32 v127, s60, v76
v_mul_f32 v124, v124, v127
v_mul_f32 v125, v109, v117
v_fmac_f32 v125, v110, v116
v_fmac_f32 v125, v111, v115
v_fmac_f32 v125, v112, v114
v_and_b32 v127, s60, v80
v_mul_f32 v125, v125, v127
v_mul_f32 v126, v110, v117
v_fmac_f32 v126, v111, v116
v_fmac_f32 v126, v112, v115
v_fmac_f32 v126, v113, v114
v_and_b32 v127, s60, v84
v_mul_f32 v126, v126, v127
v_cvt_pk_bf16_f32 v128, v125, v124
v_cvt_pk_bf16_f32 v132, v126, v125
v_cvt_pk_bf16_f32 v129, v123, v122
v_cvt_pk_bf16_f32 v133, v124, v123
v_cvt_pk_bf16_f32 v130, v121, v120
v_cvt_pk_bf16_f32 v134, v122, v121
v_cvt_pk_bf16_f32 v131, v119, v118
v_cvt_pk_bf16_f32 v135, v120, v119
ds_write_b128 v239, v[128:131] offset:1280
ds_write_b128 v239, v[132:135] offset:1408
v_lshlrev_b32 v114, 16, v98
v_and_b32 v115, s60, v98
v_lshlrev_b32 v116, 16, v99
v_and_b32 v117, s60, v99
v_lshlrev_b32 v102, 16, v5
v_lshlrev_b32 v103, 16, v9
v_lshlrev_b32 v104, 16, v13
v_lshlrev_b32 v105, 16, v17
v_lshlrev_b32 v106, 16, v21
v_lshlrev_b32 v107, 16, v25
v_lshlrev_b32 v108, 16, v29
v_lshlrev_b32 v109, 16, v33
v_lshlrev_b32 v110, 16, v37
v_lshlrev_b32 v111, 16, v41
v_lshlrev_b32 v112, 16, v45
v_lshlrev_b32 v113, 16, v49
v_mul_f32 v118, v102, v117
v_fmac_f32 v118, v103, v116
v_fmac_f32 v118, v104, v115
v_fmac_f32 v118, v105, v114
v_lshlrev_b32 v127, 16, v53
v_mul_f32 v118, v118, v127
v_mul_f32 v119, v103, v117
v_fmac_f32 v119, v104, v116
v_fmac_f32 v119, v105, v115
v_fmac_f32 v119, v106, v114
v_lshlrev_b32 v127, 16, v57
v_mul_f32 v119, v119, v127
v_mul_f32 v120, v104, v117
v_fmac_f32 v120, v105, v116
v_fmac_f32 v120, v106, v115
v_fmac_f32 v120, v107, v114
v_lshlrev_b32 v127, 16, v61
v_mul_f32 v120, v120, v127
v_mul_f32 v121, v105, v117
v_fmac_f32 v121, v106, v116
v_fmac_f32 v121, v107, v115
v_fmac_f32 v121, v108, v114
v_lshlrev_b32 v127, 16, v65
v_mul_f32 v121, v121, v127
v_mul_f32 v122, v106, v117
v_fmac_f32 v122, v107, v116
v_fmac_f32 v122, v108, v115
v_fmac_f32 v122, v109, v114
v_lshlrev_b32 v127, 16, v69
v_mul_f32 v122, v122, v127
v_mul_f32 v123, v107, v117
v_fmac_f32 v123, v108, v116
v_fmac_f32 v123, v109, v115
v_fmac_f32 v123, v110, v114
v_lshlrev_b32 v127, 16, v73
v_mul_f32 v123, v123, v127
v_mul_f32 v124, v108, v117
v_fmac_f32 v124, v109, v116
v_fmac_f32 v124, v110, v115
v_fmac_f32 v124, v111, v114
v_lshlrev_b32 v127, 16, v77
v_mul_f32 v124, v124, v127
v_mul_f32 v125, v109, v117
v_fmac_f32 v125, v110, v116
v_fmac_f32 v125, v111, v115
v_fmac_f32 v125, v112, v114
v_lshlrev_b32 v127, 16, v81
v_mul_f32 v125, v125, v127
v_mul_f32 v126, v110, v117
v_fmac_f32 v126, v111, v116
v_fmac_f32 v126, v112, v115
v_fmac_f32 v126, v113, v114
v_lshlrev_b32 v127, 16, v85
v_mul_f32 v126, v126, v127
v_cvt_pk_bf16_f32 v128, v125, v124
v_cvt_pk_bf16_f32 v132, v126, v125
v_cvt_pk_bf16_f32 v129, v123, v122
v_cvt_pk_bf16_f32 v133, v124, v123
v_cvt_pk_bf16_f32 v130, v121, v120
v_cvt_pk_bf16_f32 v134, v122, v121
v_cvt_pk_bf16_f32 v131, v119, v118
v_cvt_pk_bf16_f32 v135, v120, v119
ds_write_b128 v239, v[128:131] offset:1536
ds_write_b128 v239, v[132:135] offset:1664
v_lshlrev_b32 v114, 16, v100
v_and_b32 v115, s60, v100
v_lshlrev_b32 v116, 16, v101
v_and_b32 v117, s60, v101
v_and_b32 v102, s60, v5
v_and_b32 v103, s60, v9
v_and_b32 v104, s60, v13
v_and_b32 v105, s60, v17
v_and_b32 v106, s60, v21
v_and_b32 v107, s60, v25
v_and_b32 v108, s60, v29
v_and_b32 v109, s60, v33
v_and_b32 v110, s60, v37
v_and_b32 v111, s60, v41
v_and_b32 v112, s60, v45
v_and_b32 v113, s60, v49
v_mul_f32 v118, v102, v117
v_fmac_f32 v118, v103, v116
v_fmac_f32 v118, v104, v115
v_fmac_f32 v118, v105, v114
v_and_b32 v127, s60, v53
v_mul_f32 v118, v118, v127
v_mul_f32 v119, v103, v117
v_fmac_f32 v119, v104, v116
v_fmac_f32 v119, v105, v115
v_fmac_f32 v119, v106, v114
v_and_b32 v127, s60, v57
v_mul_f32 v119, v119, v127
v_mul_f32 v120, v104, v117
v_fmac_f32 v120, v105, v116
v_fmac_f32 v120, v106, v115
v_fmac_f32 v120, v107, v114
v_and_b32 v127, s60, v61
v_mul_f32 v120, v120, v127
v_mul_f32 v121, v105, v117
v_fmac_f32 v121, v106, v116
v_fmac_f32 v121, v107, v115
v_fmac_f32 v121, v108, v114
v_and_b32 v127, s60, v65
v_mul_f32 v121, v121, v127
v_mul_f32 v122, v106, v117
v_fmac_f32 v122, v107, v116
v_fmac_f32 v122, v108, v115
v_fmac_f32 v122, v109, v114
v_and_b32 v127, s60, v69
v_mul_f32 v122, v122, v127
v_mul_f32 v123, v107, v117
v_fmac_f32 v123, v108, v116
v_fmac_f32 v123, v109, v115
v_fmac_f32 v123, v110, v114
v_and_b32 v127, s60, v73
v_mul_f32 v123, v123, v127
v_mul_f32 v124, v108, v117
v_fmac_f32 v124, v109, v116
v_fmac_f32 v124, v110, v115
v_fmac_f32 v124, v111, v114
v_and_b32 v127, s60, v77
v_mul_f32 v124, v124, v127
v_mul_f32 v125, v109, v117
v_fmac_f32 v125, v110, v116
v_fmac_f32 v125, v111, v115
v_fmac_f32 v125, v112, v114
v_and_b32 v127, s60, v81
v_mul_f32 v125, v125, v127
v_mul_f32 v126, v110, v117
v_fmac_f32 v126, v111, v116
v_fmac_f32 v126, v112, v115
v_fmac_f32 v126, v113, v114
v_and_b32 v127, s60, v85
v_mul_f32 v126, v126, v127
v_cvt_pk_bf16_f32 v128, v125, v124
v_cvt_pk_bf16_f32 v132, v126, v125
v_cvt_pk_bf16_f32 v129, v123, v122
v_cvt_pk_bf16_f32 v133, v124, v123
v_cvt_pk_bf16_f32 v130, v121, v120
v_cvt_pk_bf16_f32 v134, v122, v121
v_cvt_pk_bf16_f32 v131, v119, v118
v_cvt_pk_bf16_f32 v135, v120, v119
ds_write_b128 v239, v[128:131] offset:1792
ds_write_b128 v239, v[132:135] offset:1920
s_waitcnt lgkmcnt(0)
s_barrier
ds_read_b128 v[2:5], v240 offset:0
ds_read_b128 v[6:9], v240 offset:1024
ds_read_b128 v[10:13], v240 offset:2048
ds_read_b128 v[14:17], v240 offset:3072
ds_read_b128 v[18:21], v240 offset:4096
ds_read_b128 v[22:25], v240 offset:5120
ds_read_b128 v[26:29], v240 offset:6144
ds_read_b128 v[30:33], v240 offset:7168
ds_read_b128 v[34:37], v240 offset:8192
ds_read_b128 v[38:41], v240 offset:9216
ds_read_b128 v[42:45], v240 offset:10240
ds_read_b128 v[46:49], v240 offset:11264
s_waitcnt lgkmcnt(4)
ds_read_b128 v[50:53], v240 offset:12288
ds_read_b128 v[54:57], v240 offset:13312
ds_read_b128 v[58:61], v240 offset:14336
ds_read_b128 v[62:65], v240 offset:15360
s_waitcnt lgkmcnt(0)
s_waitcnt vmcnt(0)
s_barrier
v_lshlrev_b32 v114, 16, v220
v_and_b32 v115, s60, v220
v_lshlrev_b32 v116, 16, v221
v_and_b32 v117, s60, v221
v_lshlrev_b32 v102, 16, v136
v_lshlrev_b32 v103, 16, v140
v_lshlrev_b32 v104, 16, v144
v_lshlrev_b32 v105, 16, v148
v_lshlrev_b32 v106, 16, v152
v_lshlrev_b32 v107, 16, v156
v_lshlrev_b32 v108, 16, v160
v_lshlrev_b32 v109, 16, v164
v_lshlrev_b32 v110, 16, v168
v_lshlrev_b32 v111, 16, v172
v_lshlrev_b32 v112, 16, v176
v_lshlrev_b32 v113, 16, v180
v_mul_f32 v118, v102, v117
v_fmac_f32 v118, v103, v116
v_fmac_f32 v118, v104, v115
v_fmac_f32 v118, v105, v114
v_lshlrev_b32 v127, 16, v184
v_mul_f32 v118, v118, v127
v_mul_f32 v119, v103, v117
v_fmac_f32 v119, v104, v116
v_fmac_f32 v119, v105, v115
v_fmac_f32 v119, v106, v114
v_lshlrev_b32 v127, 16, v188
v_mul_f32 v119, v119, v127
v_mul_f32 v120, v104, v117
v_fmac_f32 v120, v105, v116
v_fmac_f32 v120, v106, v115
v_fmac_f32 v120, v107, v114
v_lshlrev_b32 v127, 16, v192
v_mul_f32 v120, v120, v127
v_mul_f32 v121, v105, v117
v_fmac_f32 v121, v106, v116
v_fmac_f32 v121, v107, v115
v_fmac_f32 v121, v108, v114
v_lshlrev_b32 v127, 16, v196
v_mul_f32 v121, v121, v127
s_waitcnt vmcnt(0)
v_xor_b32 v236, 0, v241
s_add_u32 s20, s62, 0
buffer_store_dwordx4 v[2:5], v236, s[4:7], s20 offen sc1
v_mul_f32 v122, v106, v117
v_fmac_f32 v122, v107, v116
v_fmac_f32 v122, v108, v115
v_fmac_f32 v122, v109, v114
v_lshlrev_b32 v127, 16, v200
v_mul_f32 v122, v122, v127
v_mul_f32 v123, v107, v117
v_fmac_f32 v123, v108, v116
v_fmac_f32 v123, v109, v115
v_fmac_f32 v123, v110, v114
v_lshlrev_b32 v127, 16, v204
v_mul_f32 v123, v123, v127
v_mul_f32 v124, v108, v117
v_fmac_f32 v124, v109, v116
v_fmac_f32 v124, v110, v115
v_fmac_f32 v124, v111, v114
v_lshlrev_b32 v127, 16, v208
v_mul_f32 v124, v124, v127
v_mul_f32 v125, v109, v117
v_fmac_f32 v125, v110, v116
v_fmac_f32 v125, v111, v115
v_fmac_f32 v125, v112, v114
v_lshlrev_b32 v127, 16, v212
v_mul_f32 v125, v125, v127
v_mul_f32 v126, v110, v117
v_fmac_f32 v126, v111, v116
v_fmac_f32 v126, v112, v115
v_fmac_f32 v126, v113, v114
v_lshlrev_b32 v127, 16, v216
v_mul_f32 v126, v126, v127
v_cvt_pk_bf16_f32 v128, v125, v124
v_cvt_pk_bf16_f32 v132, v126, v125
v_cvt_pk_bf16_f32 v129, v123, v122
v_cvt_pk_bf16_f32 v133, v124, v123
v_cvt_pk_bf16_f32 v130, v121, v120
v_cvt_pk_bf16_f32 v134, v122, v121
v_cvt_pk_bf16_f32 v131, v119, v118
v_cvt_pk_bf16_f32 v135, v120, v119
ds_write_b128 v239, v[128:131] offset:0
ds_write_b128 v239, v[132:135] offset:128
s_waitcnt vmcnt(0)
s_add_u32 s21, s62, 65536
buffer_store_dwordx4 v[6:9], v236, s[4:7], s21 offen sc1
v_lshlrev_b32 v114, 16, v222
v_and_b32 v115, s60, v222
v_lshlrev_b32 v116, 16, v223
v_and_b32 v117, s60, v223
v_and_b32 v102, s60, v136
v_and_b32 v103, s60, v140
v_and_b32 v104, s60, v144
v_and_b32 v105, s60, v148
v_and_b32 v106, s60, v152
v_and_b32 v107, s60, v156
v_and_b32 v108, s60, v160
v_and_b32 v109, s60, v164
v_and_b32 v110, s60, v168
v_and_b32 v111, s60, v172
v_and_b32 v112, s60, v176
v_and_b32 v113, s60, v180
v_mul_f32 v118, v102, v117
v_fmac_f32 v118, v103, v116
v_fmac_f32 v118, v104, v115
v_fmac_f32 v118, v105, v114
v_and_b32 v127, s60, v184
v_mul_f32 v118, v118, v127
v_mul_f32 v119, v103, v117
v_fmac_f32 v119, v104, v116
v_fmac_f32 v119, v105, v115
v_fmac_f32 v119, v106, v114
v_and_b32 v127, s60, v188
v_mul_f32 v119, v119, v127
v_mul_f32 v120, v104, v117
v_fmac_f32 v120, v105, v116
v_fmac_f32 v120, v106, v115
v_fmac_f32 v120, v107, v114
v_and_b32 v127, s60, v192
v_mul_f32 v120, v120, v127
v_mul_f32 v121, v105, v117
v_fmac_f32 v121, v106, v116
v_fmac_f32 v121, v107, v115
v_fmac_f32 v121, v108, v114
v_and_b32 v127, s60, v196
v_mul_f32 v121, v121, v127
s_waitcnt vmcnt(0)
v_xor_b32 v236, 16, v241
s_add_u32 s20, s62, 131072
buffer_store_dwordx4 v[10:13], v236, s[4:7], s20 offen sc1
v_mul_f32 v122, v106, v117
v_fmac_f32 v122, v107, v116
v_fmac_f32 v122, v108, v115
v_fmac_f32 v122, v109, v114
v_and_b32 v127, s60, v200
v_mul_f32 v122, v122, v127
v_mul_f32 v123, v107, v117
v_fmac_f32 v123, v108, v116
v_fmac_f32 v123, v109, v115
v_fmac_f32 v123, v110, v114
v_and_b32 v127, s60, v204
v_mul_f32 v123, v123, v127
v_mul_f32 v124, v108, v117
v_fmac_f32 v124, v109, v116
v_fmac_f32 v124, v110, v115
v_fmac_f32 v124, v111, v114
v_and_b32 v127, s60, v208
v_mul_f32 v124, v124, v127
v_mul_f32 v125, v109, v117
v_fmac_f32 v125, v110, v116
v_fmac_f32 v125, v111, v115
v_fmac_f32 v125, v112, v114
v_and_b32 v127, s60, v212
v_mul_f32 v125, v125, v127
v_mul_f32 v126, v110, v117
v_fmac_f32 v126, v111, v116
v_fmac_f32 v126, v112, v115
v_fmac_f32 v126, v113, v114
v_and_b32 v127, s60, v216
v_mul_f32 v126, v126, v127
v_cvt_pk_bf16_f32 v128, v125, v124
v_cvt_pk_bf16_f32 v132, v126, v125
v_cvt_pk_bf16_f32 v129, v123, v122
v_cvt_pk_bf16_f32 v133, v124, v123
v_cvt_pk_bf16_f32 v130, v121, v120
v_cvt_pk_bf16_f32 v134, v122, v121
v_cvt_pk_bf16_f32 v131, v119, v118
v_cvt_pk_bf16_f32 v135, v120, v119
ds_write_b128 v239, v[128:131] offset:256
ds_write_b128 v239, v[132:135] offset:384
s_waitcnt vmcnt(0)
s_add_u32 s21, s62, 196608
buffer_store_dwordx4 v[14:17], v236, s[4:7], s21 offen sc1
v_lshlrev_b32 v114, 16, v224
v_and_b32 v115, s60, v224
v_lshlrev_b32 v116, 16, v225
v_and_b32 v117, s60, v225
v_lshlrev_b32 v102, 16, v137
v_lshlrev_b32 v103, 16, v141
v_lshlrev_b32 v104, 16, v145
v_lshlrev_b32 v105, 16, v149
v_lshlrev_b32 v106, 16, v153
v_lshlrev_b32 v107, 16, v157
v_lshlrev_b32 v108, 16, v161
v_lshlrev_b32 v109, 16, v165
v_lshlrev_b32 v110, 16, v169
v_lshlrev_b32 v111, 16, v173
v_lshlrev_b32 v112, 16, v177
v_lshlrev_b32 v113, 16, v181
v_mul_f32 v118, v102, v117
v_fmac_f32 v118, v103, v116
v_fmac_f32 v118, v104, v115
v_fmac_f32 v118, v105, v114
v_lshlrev_b32 v127, 16, v185
v_mul_f32 v118, v118, v127
v_mul_f32 v119, v103, v117
v_fmac_f32 v119, v104, v116
v_fmac_f32 v119, v105, v115
v_fmac_f32 v119, v106, v114
v_lshlrev_b32 v127, 16, v189
v_mul_f32 v119, v119, v127
v_mul_f32 v120, v104, v117
v_fmac_f32 v120, v105, v116
v_fmac_f32 v120, v106, v115
v_fmac_f32 v120, v107, v114
v_lshlrev_b32 v127, 16, v193
v_mul_f32 v120, v120, v127
v_mul_f32 v121, v105, v117
v_fmac_f32 v121, v106, v116
v_fmac_f32 v121, v107, v115
v_fmac_f32 v121, v108, v114
v_lshlrev_b32 v127, 16, v197
v_mul_f32 v121, v121, v127
s_waitcnt vmcnt(0)
v_xor_b32 v236, 32, v241
s_add_u32 s20, s62, 262144
buffer_store_dwordx4 v[18:21], v236, s[4:7], s20 offen sc1
v_mul_f32 v122, v106, v117
v_fmac_f32 v122, v107, v116
v_fmac_f32 v122, v108, v115
v_fmac_f32 v122, v109, v114
v_lshlrev_b32 v127, 16, v201
v_mul_f32 v122, v122, v127
v_mul_f32 v123, v107, v117
v_fmac_f32 v123, v108, v116
v_fmac_f32 v123, v109, v115
v_fmac_f32 v123, v110, v114
v_lshlrev_b32 v127, 16, v205
v_mul_f32 v123, v123, v127
v_mul_f32 v124, v108, v117
v_fmac_f32 v124, v109, v116
v_fmac_f32 v124, v110, v115
v_fmac_f32 v124, v111, v114
v_lshlrev_b32 v127, 16, v209
v_mul_f32 v124, v124, v127
v_mul_f32 v125, v109, v117
v_fmac_f32 v125, v110, v116
v_fmac_f32 v125, v111, v115
v_fmac_f32 v125, v112, v114
v_lshlrev_b32 v127, 16, v213
v_mul_f32 v125, v125, v127
v_mul_f32 v126, v110, v117
v_fmac_f32 v126, v111, v116
v_fmac_f32 v126, v112, v115
v_fmac_f32 v126, v113, v114
v_lshlrev_b32 v127, 16, v217
v_mul_f32 v126, v126, v127
v_cvt_pk_bf16_f32 v128, v125, v124
v_cvt_pk_bf16_f32 v132, v126, v125
v_cvt_pk_bf16_f32 v129, v123, v122
v_cvt_pk_bf16_f32 v133, v124, v123
v_cvt_pk_bf16_f32 v130, v121, v120
v_cvt_pk_bf16_f32 v134, v122, v121
v_cvt_pk_bf16_f32 v131, v119, v118
v_cvt_pk_bf16_f32 v135, v120, v119
ds_write_b128 v239, v[128:131] offset:512
ds_write_b128 v239, v[132:135] offset:640
s_waitcnt vmcnt(0)
s_add_u32 s21, s62, 327680
buffer_store_dwordx4 v[22:25], v236, s[4:7], s21 offen sc1
v_lshlrev_b32 v114, 16, v226
v_and_b32 v115, s60, v226
v_lshlrev_b32 v116, 16, v227
v_and_b32 v117, s60, v227
v_and_b32 v102, s60, v137
v_and_b32 v103, s60, v141
v_and_b32 v104, s60, v145
v_and_b32 v105, s60, v149
v_and_b32 v106, s60, v153
v_and_b32 v107, s60, v157
v_and_b32 v108, s60, v161
v_and_b32 v109, s60, v165
v_and_b32 v110, s60, v169
v_and_b32 v111, s60, v173
v_and_b32 v112, s60, v177
v_and_b32 v113, s60, v181
v_mul_f32 v118, v102, v117
v_fmac_f32 v118, v103, v116
v_fmac_f32 v118, v104, v115
v_fmac_f32 v118, v105, v114
v_and_b32 v127, s60, v185
v_mul_f32 v118, v118, v127
v_mul_f32 v119, v103, v117
v_fmac_f32 v119, v104, v116
v_fmac_f32 v119, v105, v115
v_fmac_f32 v119, v106, v114
v_and_b32 v127, s60, v189
v_mul_f32 v119, v119, v127
v_mul_f32 v120, v104, v117
v_fmac_f32 v120, v105, v116
v_fmac_f32 v120, v106, v115
v_fmac_f32 v120, v107, v114
v_and_b32 v127, s60, v193
v_mul_f32 v120, v120, v127
v_mul_f32 v121, v105, v117
v_fmac_f32 v121, v106, v116
v_fmac_f32 v121, v107, v115
v_fmac_f32 v121, v108, v114
v_and_b32 v127, s60, v197
v_mul_f32 v121, v121, v127
s_waitcnt vmcnt(0)
v_xor_b32 v236, 48, v241
s_add_u32 s20, s62, 393216
buffer_store_dwordx4 v[26:29], v236, s[4:7], s20 offen sc1
v_mul_f32 v122, v106, v117
v_fmac_f32 v122, v107, v116
v_fmac_f32 v122, v108, v115
v_fmac_f32 v122, v109, v114
v_and_b32 v127, s60, v201
v_mul_f32 v122, v122, v127
v_mul_f32 v123, v107, v117
v_fmac_f32 v123, v108, v116
v_fmac_f32 v123, v109, v115
v_fmac_f32 v123, v110, v114
v_and_b32 v127, s60, v205
v_mul_f32 v123, v123, v127
v_mul_f32 v124, v108, v117
v_fmac_f32 v124, v109, v116
v_fmac_f32 v124, v110, v115
v_fmac_f32 v124, v111, v114
v_and_b32 v127, s60, v209
v_mul_f32 v124, v124, v127
v_mul_f32 v125, v109, v117
v_fmac_f32 v125, v110, v116
v_fmac_f32 v125, v111, v115
v_fmac_f32 v125, v112, v114
v_and_b32 v127, s60, v213
v_mul_f32 v125, v125, v127
v_mul_f32 v126, v110, v117
v_fmac_f32 v126, v111, v116
v_fmac_f32 v126, v112, v115
v_fmac_f32 v126, v113, v114
v_and_b32 v127, s60, v217
v_mul_f32 v126, v126, v127
v_cvt_pk_bf16_f32 v128, v125, v124
v_cvt_pk_bf16_f32 v132, v126, v125
v_cvt_pk_bf16_f32 v129, v123, v122
v_cvt_pk_bf16_f32 v133, v124, v123
v_cvt_pk_bf16_f32 v130, v121, v120
v_cvt_pk_bf16_f32 v134, v122, v121
v_cvt_pk_bf16_f32 v131, v119, v118
v_cvt_pk_bf16_f32 v135, v120, v119
ds_write_b128 v239, v[128:131] offset:768
ds_write_b128 v239, v[132:135] offset:896
s_waitcnt vmcnt(0)
s_add_u32 s21, s62, 458752
buffer_store_dwordx4 v[30:33], v236, s[4:7], s21 offen sc1
v_lshlrev_b32 v114, 16, v228
v_and_b32 v115, s60, v228
v_lshlrev_b32 v116, 16, v229
v_and_b32 v117, s60, v229
v_lshlrev_b32 v102, 16, v138
v_lshlrev_b32 v103, 16, v142
v_lshlrev_b32 v104, 16, v146
v_lshlrev_b32 v105, 16, v150
v_lshlrev_b32 v106, 16, v154
v_lshlrev_b32 v107, 16, v158
v_lshlrev_b32 v108, 16, v162
v_lshlrev_b32 v109, 16, v166
v_lshlrev_b32 v110, 16, v170
v_lshlrev_b32 v111, 16, v174
v_lshlrev_b32 v112, 16, v178
v_lshlrev_b32 v113, 16, v182
v_mul_f32 v118, v102, v117
v_fmac_f32 v118, v103, v116
v_fmac_f32 v118, v104, v115
v_fmac_f32 v118, v105, v114
v_lshlrev_b32 v127, 16, v186
v_mul_f32 v118, v118, v127
v_mul_f32 v119, v103, v117
v_fmac_f32 v119, v104, v116
v_fmac_f32 v119, v105, v115
v_fmac_f32 v119, v106, v114
v_lshlrev_b32 v127, 16, v190
v_mul_f32 v119, v119, v127
v_mul_f32 v120, v104, v117
v_fmac_f32 v120, v105, v116
v_fmac_f32 v120, v106, v115
v_fmac_f32 v120, v107, v114
v_lshlrev_b32 v127, 16, v194
v_mul_f32 v120, v120, v127
v_mul_f32 v121, v105, v117
v_fmac_f32 v121, v106, v116
v_fmac_f32 v121, v107, v115
v_fmac_f32 v121, v108, v114
v_lshlrev_b32 v127, 16, v198
v_mul_f32 v121, v121, v127
s_waitcnt vmcnt(0)
v_xor_b32 v236, 64, v241
s_add_u32 s20, s62, 524288
buffer_store_dwordx4 v[34:37], v236, s[4:7], s20 offen sc1
v_mul_f32 v122, v106, v117
v_fmac_f32 v122, v107, v116
v_fmac_f32 v122, v108, v115
v_fmac_f32 v122, v109, v114
v_lshlrev_b32 v127, 16, v202
v_mul_f32 v122, v122, v127
v_mul_f32 v123, v107, v117
v_fmac_f32 v123, v108, v116
v_fmac_f32 v123, v109, v115
v_fmac_f32 v123, v110, v114
v_lshlrev_b32 v127, 16, v206
v_mul_f32 v123, v123, v127
v_mul_f32 v124, v108, v117
v_fmac_f32 v124, v109, v116
v_fmac_f32 v124, v110, v115
v_fmac_f32 v124, v111, v114
v_lshlrev_b32 v127, 16, v210
v_mul_f32 v124, v124, v127
v_mul_f32 v125, v109, v117
v_fmac_f32 v125, v110, v116
v_fmac_f32 v125, v111, v115
v_fmac_f32 v125, v112, v114
v_lshlrev_b32 v127, 16, v214
v_mul_f32 v125, v125, v127
v_mul_f32 v126, v110, v117
v_fmac_f32 v126, v111, v116
v_fmac_f32 v126, v112, v115
v_fmac_f32 v126, v113, v114
v_lshlrev_b32 v127, 16, v218
v_mul_f32 v126, v126, v127
v_cvt_pk_bf16_f32 v128, v125, v124
v_cvt_pk_bf16_f32 v132, v126, v125
v_cvt_pk_bf16_f32 v129, v123, v122
v_cvt_pk_bf16_f32 v133, v124, v123
v_cvt_pk_bf16_f32 v130, v121, v120
v_cvt_pk_bf16_f32 v134, v122, v121
v_cvt_pk_bf16_f32 v131, v119, v118
v_cvt_pk_bf16_f32 v135, v120, v119
ds_write_b128 v239, v[128:131] offset:1024
ds_write_b128 v239, v[132:135] offset:1152
s_waitcnt vmcnt(0)
s_add_u32 s21, s62, 589824
buffer_store_dwordx4 v[38:41], v236, s[4:7], s21 offen sc1
v_lshlrev_b32 v114, 16, v230
v_and_b32 v115, s60, v230
v_lshlrev_b32 v116, 16, v231
v_and_b32 v117, s60, v231
v_and_b32 v102, s60, v138
v_and_b32 v103, s60, v142
v_and_b32 v104, s60, v146
v_and_b32 v105, s60, v150
v_and_b32 v106, s60, v154
v_and_b32 v107, s60, v158
v_and_b32 v108, s60, v162
v_and_b32 v109, s60, v166
v_and_b32 v110, s60, v170
v_and_b32 v111, s60, v174
v_and_b32 v112, s60, v178
v_and_b32 v113, s60, v182
v_mul_f32 v118, v102, v117
v_fmac_f32 v118, v103, v116
v_fmac_f32 v118, v104, v115
v_fmac_f32 v118, v105, v114
v_and_b32 v127, s60, v186
v_mul_f32 v118, v118, v127
v_mul_f32 v119, v103, v117
v_fmac_f32 v119, v104, v116
v_fmac_f32 v119, v105, v115
v_fmac_f32 v119, v106, v114
v_and_b32 v127, s60, v190
v_mul_f32 v119, v119, v127
v_mul_f32 v120, v104, v117
v_fmac_f32 v120, v105, v116
v_fmac_f32 v120, v106, v115
v_fmac_f32 v120, v107, v114
v_and_b32 v127, s60, v194
v_mul_f32 v120, v120, v127
v_mul_f32 v121, v105, v117
v_fmac_f32 v121, v106, v116
v_fmac_f32 v121, v107, v115
v_fmac_f32 v121, v108, v114
v_and_b32 v127, s60, v198
v_mul_f32 v121, v121, v127
s_waitcnt vmcnt(0)
v_xor_b32 v236, 80, v241
s_add_u32 s20, s62, 655360
buffer_store_dwordx4 v[42:45], v236, s[4:7], s20 offen sc1
v_mul_f32 v122, v106, v117
v_fmac_f32 v122, v107, v116
v_fmac_f32 v122, v108, v115
v_fmac_f32 v122, v109, v114
v_and_b32 v127, s60, v202
v_mul_f32 v122, v122, v127
v_mul_f32 v123, v107, v117
v_fmac_f32 v123, v108, v116
v_fmac_f32 v123, v109, v115
v_fmac_f32 v123, v110, v114
v_and_b32 v127, s60, v206
v_mul_f32 v123, v123, v127
v_mul_f32 v124, v108, v117
v_fmac_f32 v124, v109, v116
v_fmac_f32 v124, v110, v115
v_fmac_f32 v124, v111, v114
v_and_b32 v127, s60, v210
v_mul_f32 v124, v124, v127
v_mul_f32 v125, v109, v117
v_fmac_f32 v125, v110, v116
v_fmac_f32 v125, v111, v115
v_fmac_f32 v125, v112, v114
v_and_b32 v127, s60, v214
v_mul_f32 v125, v125, v127
v_mul_f32 v126, v110, v117
v_fmac_f32 v126, v111, v116
v_fmac_f32 v126, v112, v115
v_fmac_f32 v126, v113, v114
v_and_b32 v127, s60, v218
v_mul_f32 v126, v126, v127
v_cvt_pk_bf16_f32 v128, v125, v124
v_cvt_pk_bf16_f32 v132, v126, v125
v_cvt_pk_bf16_f32 v129, v123, v122
v_cvt_pk_bf16_f32 v133, v124, v123
v_cvt_pk_bf16_f32 v130, v121, v120
v_cvt_pk_bf16_f32 v134, v122, v121
v_cvt_pk_bf16_f32 v131, v119, v118
v_cvt_pk_bf16_f32 v135, v120, v119
ds_write_b128 v239, v[128:131] offset:1280
ds_write_b128 v239, v[132:135] offset:1408
s_waitcnt vmcnt(0)
s_add_u32 s21, s62, 720896
buffer_store_dwordx4 v[46:49], v236, s[4:7], s21 offen sc1
v_lshlrev_b32 v114, 16, v232
v_and_b32 v115, s60, v232
v_lshlrev_b32 v116, 16, v233
v_and_b32 v117, s60, v233
v_lshlrev_b32 v102, 16, v139
v_lshlrev_b32 v103, 16, v143
v_lshlrev_b32 v104, 16, v147
v_lshlrev_b32 v105, 16, v151
v_lshlrev_b32 v106, 16, v155
v_lshlrev_b32 v107, 16, v159
v_lshlrev_b32 v108, 16, v163
v_lshlrev_b32 v109, 16, v167
v_lshlrev_b32 v110, 16, v171
v_lshlrev_b32 v111, 16, v175
v_lshlrev_b32 v112, 16, v179
v_lshlrev_b32 v113, 16, v183
v_mul_f32 v118, v102, v117
v_fmac_f32 v118, v103, v116
v_fmac_f32 v118, v104, v115
v_fmac_f32 v118, v105, v114
v_lshlrev_b32 v127, 16, v187
v_mul_f32 v118, v118, v127
v_mul_f32 v119, v103, v117
v_fmac_f32 v119, v104, v116
v_fmac_f32 v119, v105, v115
v_fmac_f32 v119, v106, v114
v_lshlrev_b32 v127, 16, v191
v_mul_f32 v119, v119, v127
v_mul_f32 v120, v104, v117
v_fmac_f32 v120, v105, v116
v_fmac_f32 v120, v106, v115
v_fmac_f32 v120, v107, v114
v_lshlrev_b32 v127, 16, v195
v_mul_f32 v120, v120, v127
v_mul_f32 v121, v105, v117
v_fmac_f32 v121, v106, v116
v_fmac_f32 v121, v107, v115
v_fmac_f32 v121, v108, v114
v_lshlrev_b32 v127, 16, v199
v_mul_f32 v121, v121, v127
s_waitcnt vmcnt(0)
v_xor_b32 v236, 96, v241
s_add_u32 s20, s62, 786432
buffer_store_dwordx4 v[50:53], v236, s[4:7], s20 offen sc1
v_mul_f32 v122, v106, v117
v_fmac_f32 v122, v107, v116
v_fmac_f32 v122, v108, v115
v_fmac_f32 v122, v109, v114
v_lshlrev_b32 v127, 16, v203
v_mul_f32 v122, v122, v127
v_mul_f32 v123, v107, v117
v_fmac_f32 v123, v108, v116
v_fmac_f32 v123, v109, v115
v_fmac_f32 v123, v110, v114
v_lshlrev_b32 v127, 16, v207
v_mul_f32 v123, v123, v127
v_mul_f32 v124, v108, v117
v_fmac_f32 v124, v109, v116
v_fmac_f32 v124, v110, v115
v_fmac_f32 v124, v111, v114
v_lshlrev_b32 v127, 16, v211
v_mul_f32 v124, v124, v127
v_mul_f32 v125, v109, v117
v_fmac_f32 v125, v110, v116
v_fmac_f32 v125, v111, v115
v_fmac_f32 v125, v112, v114
v_lshlrev_b32 v127, 16, v215
v_mul_f32 v125, v125, v127
v_mul_f32 v126, v110, v117
v_fmac_f32 v126, v111, v116
v_fmac_f32 v126, v112, v115
v_fmac_f32 v126, v113, v114
v_lshlrev_b32 v127, 16, v219
v_mul_f32 v126, v126, v127
v_cvt_pk_bf16_f32 v128, v125, v124
v_cvt_pk_bf16_f32 v132, v126, v125
v_cvt_pk_bf16_f32 v129, v123, v122
v_cvt_pk_bf16_f32 v133, v124, v123
v_cvt_pk_bf16_f32 v130, v121, v120
v_cvt_pk_bf16_f32 v134, v122, v121
v_cvt_pk_bf16_f32 v131, v119, v118
v_cvt_pk_bf16_f32 v135, v120, v119
ds_write_b128 v239, v[128:131] offset:1536
ds_write_b128 v239, v[132:135] offset:1664
s_waitcnt vmcnt(0)
s_add_u32 s21, s62, 851968
buffer_store_dwordx4 v[54:57], v236, s[4:7], s21 offen sc1
v_lshlrev_b32 v114, 16, v234
v_and_b32 v115, s60, v234
v_lshlrev_b32 v116, 16, v235
v_and_b32 v117, s60, v235
v_and_b32 v102, s60, v139
v_and_b32 v103, s60, v143
v_and_b32 v104, s60, v147
v_and_b32 v105, s60, v151
v_and_b32 v106, s60, v155
v_and_b32 v107, s60, v159
v_and_b32 v108, s60, v163
v_and_b32 v109, s60, v167
v_and_b32 v110, s60, v171
v_and_b32 v111, s60, v175
v_and_b32 v112, s60, v179
v_and_b32 v113, s60, v183
v_mul_f32 v118, v102, v117
v_fmac_f32 v118, v103, v116
v_fmac_f32 v118, v104, v115
v_fmac_f32 v118, v105, v114
v_and_b32 v127, s60, v187
v_mul_f32 v118, v118, v127
v_mul_f32 v119, v103, v117
v_fmac_f32 v119, v104, v116
v_fmac_f32 v119, v105, v115
v_fmac_f32 v119, v106, v114
v_and_b32 v127, s60, v191
v_mul_f32 v119, v119, v127
v_mul_f32 v120, v104, v117
v_fmac_f32 v120, v105, v116
v_fmac_f32 v120, v106, v115
v_fmac_f32 v120, v107, v114
v_and_b32 v127, s60, v195
v_mul_f32 v120, v120, v127
v_mul_f32 v121, v105, v117
v_fmac_f32 v121, v106, v116
v_fmac_f32 v121, v107, v115
v_fmac_f32 v121, v108, v114
v_and_b32 v127, s60, v199
v_mul_f32 v121, v121, v127
s_waitcnt vmcnt(0)
v_xor_b32 v236, 112, v241
s_add_u32 s20, s62, 917504
buffer_store_dwordx4 v[58:61], v236, s[4:7], s20 offen sc1
v_mul_f32 v122, v106, v117
v_fmac_f32 v122, v107, v116
v_fmac_f32 v122, v108, v115
v_fmac_f32 v122, v109, v114
v_and_b32 v127, s60, v203
v_mul_f32 v122, v122, v127
v_mul_f32 v123, v107, v117
v_fmac_f32 v123, v108, v116
v_fmac_f32 v123, v109, v115
v_fmac_f32 v123, v110, v114
v_and_b32 v127, s60, v207
v_mul_f32 v123, v123, v127
v_mul_f32 v124, v108, v117
v_fmac_f32 v124, v109, v116
v_fmac_f32 v124, v110, v115
v_fmac_f32 v124, v111, v114
v_and_b32 v127, s60, v211
v_mul_f32 v124, v124, v127
v_mul_f32 v125, v109, v117
v_fmac_f32 v125, v110, v116
v_fmac_f32 v125, v111, v115
v_fmac_f32 v125, v112, v114
v_and_b32 v127, s60, v215
v_mul_f32 v125, v125, v127
v_mul_f32 v126, v110, v117
v_fmac_f32 v126, v111, v116
v_fmac_f32 v126, v112, v115
v_fmac_f32 v126, v113, v114
v_and_b32 v127, s60, v219
v_mul_f32 v126, v126, v127
v_cvt_pk_bf16_f32 v128, v125, v124
v_cvt_pk_bf16_f32 v132, v126, v125
v_cvt_pk_bf16_f32 v129, v123, v122
v_cvt_pk_bf16_f32 v133, v124, v123
v_cvt_pk_bf16_f32 v130, v121, v120
v_cvt_pk_bf16_f32 v134, v122, v121
v_cvt_pk_bf16_f32 v131, v119, v118
v_cvt_pk_bf16_f32 v135, v120, v119
ds_write_b128 v239, v[128:131] offset:1792
ds_write_b128 v239, v[132:135] offset:1920
s_waitcnt vmcnt(0)
s_add_u32 s21, s62, 983040
buffer_store_dwordx4 v[62:65], v236, s[4:7], s21 offen sc1
s_waitcnt lgkmcnt(0)
s_barrier
ds_read_b128 v[136:139], v240 offset:0
ds_read_b128 v[140:143], v240 offset:1024
ds_read_b128 v[144:147], v240 offset:2048
ds_read_b128 v[148:151], v240 offset:3072
ds_read_b128 v[152:155], v240 offset:4096
ds_read_b128 v[156:159], v240 offset:5120
ds_read_b128 v[160:163], v240 offset:6144
ds_read_b128 v[164:167], v240 offset:7168
ds_read_b128 v[168:171], v240 offset:8192
ds_read_b128 v[172:175], v240 offset:9216
ds_read_b128 v[176:179], v240 offset:10240
ds_read_b128 v[180:183], v240 offset:11264
s_waitcnt lgkmcnt(4)
ds_read_b128 v[184:187], v240 offset:12288
ds_read_b128 v[188:191], v240 offset:13312
ds_read_b128 v[192:195], v240 offset:14336
ds_read_b128 v[196:199], v240 offset:15360
s_waitcnt lgkmcnt(0)
s_waitcnt vmcnt(0)
v_xor_b32 v236, 0, v241
s_add_u32 s20, s62, 8388608
buffer_store_dwordx4 v[136:139], v236, s[4:7], s20 offen sc1
s_waitcnt vmcnt(0)
s_add_u32 s21, s62, 8454144
buffer_store_dwordx4 v[140:143], v236, s[4:7], s21 offen sc1
s_waitcnt vmcnt(0)
v_xor_b32 v236, 16, v241
s_add_u32 s20, s62, 8519680
buffer_store_dwordx4 v[144:147], v236, s[4:7], s20 offen sc1
s_waitcnt vmcnt(0)
s_add_u32 s21, s62, 8585216
buffer_store_dwordx4 v[148:151], v236, s[4:7], s21 offen sc1
s_waitcnt vmcnt(0)
v_xor_b32 v236, 32, v241
s_add_u32 s20, s62, 8650752
buffer_store_dwordx4 v[152:155], v236, s[4:7], s20 offen sc1
s_waitcnt vmcnt(0)
s_add_u32 s21, s62, 8716288
buffer_store_dwordx4 v[156:159], v236, s[4:7], s21 offen sc1
s_waitcnt vmcnt(0)
v_xor_b32 v236, 48, v241
s_add_u32 s20, s62, 8781824
buffer_store_dwordx4 v[160:163], v236, s[4:7], s20 offen sc1
s_waitcnt vmcnt(0)
s_add_u32 s21, s62, 8847360
buffer_store_dwordx4 v[164:167], v236, s[4:7], s21 offen sc1
s_waitcnt vmcnt(0)
v_xor_b32 v236, 64, v241
s_add_u32 s20, s62, 8912896
buffer_store_dwordx4 v[168:171], v236, s[4:7], s20 offen sc1
s_waitcnt vmcnt(0)
s_add_u32 s21, s62, 8978432
buffer_store_dwordx4 v[172:175], v236, s[4:7], s21 offen sc1
s_waitcnt vmcnt(0)
v_xor_b32 v236, 80, v241
s_add_u32 s20, s62, 9043968
buffer_store_dwordx4 v[176:179], v236, s[4:7], s20 offen sc1
s_waitcnt vmcnt(0)
s_add_u32 s21, s62, 9109504
buffer_store_dwordx4 v[180:183], v236, s[4:7], s21 offen sc1
s_waitcnt vmcnt(0)
v_xor_b32 v236, 96, v241
s_add_u32 s20, s62, 9175040
buffer_store_dwordx4 v[184:187], v236, s[4:7], s20 offen sc1
s_waitcnt vmcnt(0)
s_add_u32 s21, s62, 9240576
buffer_store_dwordx4 v[188:191], v236, s[4:7], s21 offen sc1
s_waitcnt vmcnt(0)
v_xor_b32 v236, 112, v241
s_add_u32 s20, s62, 9306112
buffer_store_dwordx4 v[192:195], v236, s[4:7], s20 offen sc1
s_waitcnt vmcnt(0)
s_add_u32 s21, s62, 9371648
buffer_store_dwordx4 v[196:199], v236, s[4:7], s21 offen sc1
s_add_u32 s44, s15, s14
s_and_b32 s44, s44, 7
s_lshl_b32 s20, s33, 3
s_add_u32 s44, s44, s20
s_lshr_b32 s49, s15, 2
s_load_dwordx2 s[8:9], s[0:1], 88
s_mov_b32 s10, 8388608
s_mov_b32 s11, 0x20000
s_waitcnt lgkmcnt(0)
s_lshl_b32 s22, s44, 18
s_lshl_b32 s21, s32, 8
s_add_u32 s22, s22, s21
v_bfe_u32 v2, v0, 4, 2
v_lshlrev_b32 v1, 11, v2
v_bfe_u32 v2, v0, 0, 4
v_lshl_add_u32 v1, v2, 4, v1
v_add_u32 v1, s22, v1
s_mov_b32 s20, 0
buffer_load_dwordx4 v[2:5], v1, s[8:11], s20 offen
s_mov_b32 s21, 8192
buffer_load_dwordx4 v[6:9], v1, s[8:11], s21 offen
s_mov_b32 s20, 16384
buffer_load_dwordx4 v[10:13], v1, s[8:11], s20 offen
s_mov_b32 s21, 24576
buffer_load_dwordx4 v[14:17], v1, s[8:11], s21 offen
s_mov_b32 s20, 32768
buffer_load_dwordx4 v[18:21], v1, s[8:11], s20 offen
s_mov_b32 s21, 40960
buffer_load_dwordx4 v[22:25], v1, s[8:11], s21 offen
s_mov_b32 s20, 49152
buffer_load_dwordx4 v[26:29], v1, s[8:11], s20 offen
s_mov_b32 s21, 57344
buffer_load_dwordx4 v[30:33], v1, s[8:11], s21 offen
s_mov_b32 s20, 65536
buffer_load_dwordx4 v[34:37], v1, s[8:11], s20 offen
s_mov_b32 s21, 73728
buffer_load_dwordx4 v[38:41], v1, s[8:11], s21 offen
s_mov_b32 s20, 81920
buffer_load_dwordx4 v[42:45], v1, s[8:11], s20 offen
s_mov_b32 s21, 90112
buffer_load_dwordx4 v[46:49], v1, s[8:11], s21 offen
s_mov_b32 s20, 98304
buffer_load_dwordx4 v[50:53], v1, s[8:11], s20 offen
s_mov_b32 s21, 106496
buffer_load_dwordx4 v[54:57], v1, s[8:11], s21 offen
s_mov_b32 s20, 114688
buffer_load_dwordx4 v[58:61], v1, s[8:11], s20 offen
s_mov_b32 s21, 122880
buffer_load_dwordx4 v[62:65], v1, s[8:11], s21 offen
s_mov_b32 s20, 131072
buffer_load_dwordx4 v[66:69], v1, s[8:11], s20 offen
s_mov_b32 s21, 139264
buffer_load_dwordx4 v[70:73], v1, s[8:11], s21 offen
s_mov_b32 s20, 147456
buffer_load_dwordx4 v[74:77], v1, s[8:11], s20 offen
s_mov_b32 s21, 155648
buffer_load_dwordx4 v[78:81], v1, s[8:11], s21 offen
s_mov_b32 s20, 163840
buffer_load_dwordx4 v[82:85], v1, s[8:11], s20 offen
s_mov_b32 s21, 172032
buffer_load_dwordx4 v[86:89], v1, s[8:11], s21 offen
s_mov_b32 s20, 180224
buffer_load_dwordx4 v[90:93], v1, s[8:11], s20 offen
s_mov_b32 s21, 188416
buffer_load_dwordx4 v[94:97], v1, s[8:11], s21 offen
s_mov_b32 s20, 196608
buffer_load_dwordx4 v[98:101], v1, s[8:11], s20 offen
s_mov_b32 s21, 204800
buffer_load_dwordx4 v[102:105], v1, s[8:11], s21 offen
s_mov_b32 s20, 212992
buffer_load_dwordx4 v[106:109], v1, s[8:11], s20 offen
s_mov_b32 s21, 221184
buffer_load_dwordx4 v[110:113], v1, s[8:11], s21 offen
s_mov_b32 s20, 229376
buffer_load_dwordx4 v[114:117], v1, s[8:11], s20 offen
s_mov_b32 s21, 237568
buffer_load_dwordx4 v[118:121], v1, s[8:11], s21 offen
s_mov_b32 s20, 245760
buffer_load_dwordx4 v[122:125], v1, s[8:11], s20 offen
s_mov_b32 s21, 253952
buffer_load_dwordx4 v[126:129], v1, s[8:11], s21 offen
s_waitcnt vmcnt(32)
s_barrier
s_cmp_lg_u32 s15, 0
s_cbranch_scc1 kvt_9
s_lshl_b32 s20, s41, 7
s_add_u32 s20, s20, 3940352
s_xor_b32 s20, s20, s17
v_mov_b32 v236, 1
v_mov_b32 v237, 0
s_mov_b64 exec, 1
buffer_store_dword v236, v237, s[4:7], s20 offen sc1
s_mov_b64 exec, -1
kvt_9:
L_oent:
s_lshl_b32 s20, s15, 13
v_bfe_u32 v1, v0, 4, 2
v_lshlrev_b32 v251, 8, v1
v_bfe_u32 v1, v0, 0, 4
v_lshl_add_u32 v251, v1, 4, v251
v_add_u32 v251, s20, v251
v_bfe_u32 v1, v0, 4, 2
v_lshlrev_b32 v1, 6, v1
v_xor_b32 v251, v251, v1
v_bfe_u32 v1, v0, 4, 2
v_lshlrev_b32 v194, 11, v1
v_bfe_u32 v1, v0, 2, 2
v_lshl_add_u32 v194, v1, 8, v194
v_bfe_u32 v1, v0, 2, 2
v_lshl_add_u32 v194, v1, 6, v194
v_bfe_u32 v1, v0, 0, 2
v_lshl_add_u32 v194, v1, 4, v194
v_add_u32 v194, s20, v194
v_xor_b32 v195, 64, v194
v_xor_b32 v196, 128, v194
v_xor_b32 v197, 192, v194
s_waitcnt vmcnt(24)
ds_write_b128 v251, v[2:5] offset:0
ds_write_b128 v251, v[6:9] offset:1024
ds_write_b128 v251, v[10:13] offset:2048
ds_write_b128 v251, v[14:17] offset:3072
ds_write_b128 v251, v[18:21] offset:4096
ds_write_b128 v251, v[22:25] offset:5120
ds_write_b128 v251, v[26:29] offset:6144
ds_write_b128 v251, v[30:33] offset:7168
s_waitcnt lgkmcnt(4)
ds_read_b64_tr_b16 v[2:3], v194 offset:0
ds_read_b64_tr_b16 v[4:5], v194 offset:1024
ds_read_b64_tr_b16 v[6:7], v194 offset:8
ds_read_b64_tr_b16 v[8:9], v194 offset:1032
ds_read_b64_tr_b16 v[10:11], v195 offset:0
ds_read_b64_tr_b16 v[12:13], v195 offset:1024
ds_read_b64_tr_b16 v[14:15], v195 offset:8
ds_read_b64_tr_b16 v[16:17], v195 offset:1032
s_waitcnt lgkmcnt(4)
ds_read_b64_tr_b16 v[18:19], v196 offset:0
ds_read_b64_tr_b16 v[20:21], v196 offset:1024
ds_read_b64_tr_b16 v[22:23], v196 offset:8
ds_read_b64_tr_b16 v[24:25], v196 offset:1032
ds_read_b64_tr_b16 v[26:27], v197 offset:0
ds_read_b64_tr_b16 v[28:29], v197 offset:1024
ds_read_b64_tr_b16 v[30:31], v197 offset:8
ds_read_b64_tr_b16 v[32:33], v197 offset:1032
s_waitcnt lgkmcnt(4)
s_waitcnt vmcnt(16)
ds_write_b128 v251, v[34:37] offset:0
ds_write_b128 v251, v[38:41] offset:1024
ds_write_b128 v251, v[42:45] offset:2048
ds_write_b128 v251, v[46:49] offset:3072
ds_write_b128 v251, v[50:53] offset:4096
ds_write_b128 v251, v[54:57] offset:5120
ds_write_b128 v251, v[58:61] offset:6144
ds_write_b128 v251, v[62:65] offset:7168
s_waitcnt lgkmcnt(4)
ds_read_b64_tr_b16 v[34:35], v194 offset:0
ds_read_b64_tr_b16 v[36:37], v194 offset:1024
ds_read_b64_tr_b16 v[38:39], v194 offset:8
ds_read_b64_tr_b16 v[40:41], v194 offset:1032
ds_read_b64_tr_b16 v[42:43], v195 offset:0
ds_read_b64_tr_b16 v[44:45], v195 offset:1024
ds_read_b64_tr_b16 v[46:47], v195 offset:8
ds_read_b64_tr_b16 v[48:49], v195 offset:1032
s_waitcnt lgkmcnt(4)
ds_read_b64_tr_b16 v[50:51], v196 offset:0
ds_read_b64_tr_b16 v[52:53], v196 offset:1024
ds_read_b64_tr_b16 v[54:55], v196 offset:8
ds_read_b64_tr_b16 v[56:57], v196 offset:1032
ds_read_b64_tr_b16 v[58:59], v197 offset:0
ds_read_b64_tr_b16 v[60:61], v197 offset:1024
ds_read_b64_tr_b16 v[62:63], v197 offset:8
ds_read_b64_tr_b16 v[64:65], v197 offset:1032
s_waitcnt lgkmcnt(4)
s_waitcnt vmcnt(8)
ds_write_b128 v251, v[66:69] offset:0
ds_write_b128 v251, v[70:73] offset:1024
ds_write_b128 v251, v[74:77] offset:2048
ds_write_b128 v251, v[78:81] offset:3072
ds_write_b128 v251, v[82:85] offset:4096
ds_write_b128 v251, v[86:89] offset:5120
ds_write_b128 v251, v[90:93] offset:6144
ds_write_b128 v251, v[94:97] offset:7168
s_waitcnt lgkmcnt(4)
ds_read_b64_tr_b16 v[66:67], v194 offset:0
ds_read_b64_tr_b16 v[68:69], v194 offset:1024
ds_read_b64_tr_b16 v[70:71], v194 offset:8
ds_read_b64_tr_b16 v[72:73], v194 offset:1032
ds_read_b64_tr_b16 v[74:75], v195 offset:0
ds_read_b64_tr_b16 v[76:77], v195 offset:1024
ds_read_b64_tr_b16 v[78:79], v195 offset:8
ds_read_b64_tr_b16 v[80:81], v195 offset:1032
s_waitcnt lgkmcnt(4)
ds_read_b64_tr_b16 v[82:83], v196 offset:0
ds_read_b64_tr_b16 v[84:85], v196 offset:1024
ds_read_b64_tr_b16 v[86:87], v196 offset:8
ds_read_b64_tr_b16 v[88:89], v196 offset:1032
ds_read_b64_tr_b16 v[90:91], v197 offset:0
ds_read_b64_tr_b16 v[92:93], v197 offset:1024
ds_read_b64_tr_b16 v[94:95], v197 offset:8
ds_read_b64_tr_b16 v[96:97], v197 offset:1032
s_waitcnt lgkmcnt(4)
s_waitcnt vmcnt(0)
ds_write_b128 v251, v[98:101] offset:0
ds_write_b128 v251, v[102:105] offset:1024
ds_write_b128 v251, v[106:109] offset:2048
ds_write_b128 v251, v[110:113] offset:3072
ds_write_b128 v251, v[114:117] offset:4096
ds_write_b128 v251, v[118:121] offset:5120
ds_write_b128 v251, v[122:125] offset:6144
ds_write_b128 v251, v[126:129] offset:7168
s_waitcnt lgkmcnt(4)
ds_read_b64_tr_b16 v[98:99], v194 offset:0
ds_read_b64_tr_b16 v[100:101], v194 offset:1024
ds_read_b64_tr_b16 v[102:103], v194 offset:8
ds_read_b64_tr_b16 v[104:105], v194 offset:1032
ds_read_b64_tr_b16 v[106:107], v195 offset:0
ds_read_b64_tr_b16 v[108:109], v195 offset:1024
ds_read_b64_tr_b16 v[110:111], v195 offset:8
ds_read_b64_tr_b16 v[112:113], v195 offset:1032
s_waitcnt lgkmcnt(4)
ds_read_b64_tr_b16 v[114:115], v196 offset:0
ds_read_b64_tr_b16 v[116:117], v196 offset:1024
ds_read_b64_tr_b16 v[118:119], v196 offset:8
ds_read_b64_tr_b16 v[120:121], v196 offset:1032
ds_read_b64_tr_b16 v[122:123], v197 offset:0
ds_read_b64_tr_b16 v[124:125], v197 offset:1024
ds_read_b64_tr_b16 v[126:127], v197 offset:8
ds_read_b64_tr_b16 v[128:129], v197 offset:1032
s_waitcnt lgkmcnt(4)
s_load_dwordx2 s[36:37], s[0:1], 104
s_mov_b32 s38, 8388608
s_mov_b32 s39, 0x20000
s_waitcnt lgkmcnt(0)
v_lshlrev_b32 v249, 4, v0
v_lshlrev_b32 v250, 3, v0
s_mov_b32 s50, 0xffff0000
v_mov_b32 v240, -1
v_mov_b32 v241, -1
s_lshl_b32 s20, s15, 13
v_add_u32 v251, s20, v249
s_lshl_b32 s23, s49, 1
s_add_u32 s23, s23, 1
s_xor_b32 s22, s33, s23
s_lshl_b32 s20, s22, 11
s_lshl_b32 s21, s12, 8
s_add_u32 s20, s20, s21
v_bfe_u32 v1, v0, 4, 1
v_lshlrev_b32 v252, 13, v1
v_bfe_u32 v1, v0, 5, 1
v_lshl_add_u32 v252, v1, 10, v252
v_bfe_u32 v1, v0, 0, 4
v_lshl_add_u32 v252, v1, 4, v252
v_add_u32 v252, s20, v252
s_lshl_b32 s24, s32, 2
s_add_u32 s24, s24, s22
s_lshl_b32 s47, s24, 21
s_lshl_b32 s20, s23, 11
s_add_u32 s47, s47, s20
s_lshl_b32 s20, s12, 9
s_add_u32 s47, s47, s20
s_add_u32 s47, s47, 155197440
s_and_b32 s20, s24, 3
s_lshl_b32 s20, s20, 13
s_xor_b32 s47, s47, s20
s_xor_b32 s47, s47, s17
s_xor_b32 s22, s22, 3
s_xor_b32 s23, s23, 3
s_lshl_b32 s24, s32, 2
s_add_u32 s24, s24, s22
s_lshl_b32 s48, s24, 21
s_lshl_b32 s20, s23, 11
s_add_u32 s48, s48, s20
s_lshl_b32 s20, s12, 9
s_add_u32 s48, s48, s20
s_add_u32 s48, s48, 155197440
s_and_b32 s20, s24, 3
s_lshl_b32 s20, s20, 13
s_xor_b32 s48, s48, s20
s_xor_b32 s48, s48, s17
s_lshl_b32 s20, s32, 8
s_lshl_b32 s21, s33, 6
s_add_u32 s20, s20, s21
s_lshl_b32 s21, s12, 4
s_add_u32 s20, s20, s21
s_add_u32 s20, s20, 2048
v_bfe_u32 v1, v0, 5, 1
v_lshlrev_b32 v253, 16, v1
v_bfe_u32 v1, v0, 0, 4
v_lshl_add_u32 v253, v1, 12, v253
v_bfe_u32 v1, v0, 4, 1
v_lshl_add_u32 v253, v1, 3, v253
v_add_u32 v253, s20, v253
v_lshrrev_b32 v1, 2, v0
v_and_b32 v1, 8, v1
v_xor_b32 v254, v0, v1
v_and_b32 v1, 15, v254
v_mov_b32 v230, 0
v_mov_b32 v234, 0x3f80
v_cmp_eq_u32 vcc, 0, v1
s_nop 1
v_cndmask_b32 v230, v230, v234, vcc
v_mov_b32 v234, 0x3f800000
v_cmp_eq_u32 vcc, 1, v1
s_nop 1
v_cndmask_b32 v230, v230, v234, vcc
v_mov_b32 v231, 0
v_mov_b32 v234, 0x3f80
v_cmp_eq_u32 vcc, 2, v1
s_nop 1
v_cndmask_b32 v231, v231, v234, vcc
v_mov_b32 v234, 0x3f800000
v_cmp_eq_u32 vcc, 3, v1
s_nop 1
v_cndmask_b32 v231, v231, v234, vcc
v_mov_b32 v232, 0
v_mov_b32 v234, 0x3f80
v_cmp_eq_u32 vcc, 4, v1
s_nop 1
v_cndmask_b32 v232, v232, v234, vcc
v_mov_b32 v234, 0x3f800000
v_cmp_eq_u32 vcc, 5, v1
s_nop 1
v_cndmask_b32 v232, v232, v234, vcc
v_mov_b32 v233, 0
v_mov_b32 v234, 0x3f80
v_cmp_eq_u32 vcc, 6, v1
s_nop 1
v_cndmask_b32 v233, v233, v234, vcc
v_mov_b32 v234, 0x3f800000
v_cmp_eq_u32 vcc, 7, v1
s_nop 1
v_cndmask_b32 v233, v233, v234, vcc
s_lshl_b32 s20, s44, 8
s_add_u32 s20, s20, s17
s_add_u32 s20, s20, 3948544
v_bfe_u32 v1, v0, 0, 2
v_lshlrev_b32 v254, 6, v1
v_add_u32 v254, s20, v254
s_lshl_b32 s41, s44, 20
s_add_u32 s41, s41, 71311360
s_and_b32 s21, s44, 1
s_lshl_b32 s21, s21, 14
s_xor_b32 s41, s41, s21
s_and_b32 s21, s44, 2
s_lshl_b32 s21, s21, 12
s_xor_b32 s41, s41, s21
s_xor_b32 s41, s41, s17
s_waitcnt lgkmcnt(0)
s_barrier
s_cmp_eq_u32 s49, 1
s_cbranch_scc1 ohi_10
s_cmp_eq_u32 s18, 0
s_cbranch_scc1 omain_11
s_and_b32 s43, s18, 1
s_add_u32 s43, s43, 64
s_mov_b32 s40, 0
oh_14:
s_lshl_b32 s45, s18, 14
s_xor_b32 s45, s45, s41
s_add_u32 s42, s45, 4096
s_cmp_gt_u32 s40, s18
s_cbranch_scc1 oh_15
v_lshlrev_b32 v1, 6, v0
buffer_load_dword v194, v1, s[4:7], s45 offen sc1
buffer_load_dword v194, v1, s[4:7], s42 offen sc1
s_branch of_12
of_13:
s_sleep 16
of_12:
s_add_u32 s19, s19, 1
s_cmp_gt_u32 s19, 1048576
s_cbranch_scc1 L_end
buffer_load_dword v248, v254, s[4:7], 0 offen sc1
s_waitcnt vmcnt(0)
v_min_u32_dpp v248, v248, v248 quad_perm:[1,0,3,2] row_mask:0xf bank_mask:0xf
s_nop 1
v_min_u32_dpp v248, v248, v248 quad_perm:[2,3,0,1] row_mask:0xf bank_mask:0xf
s_nop 0
v_readfirstlane_b32 s40, v248
s_cmp_lt_u32 s40, s18
s_cbranch_scc1 of_13
s_cmp_gt_u32 s40, s18
s_cbranch_scc0 of_12
oh_15:
buffer_load_dwordx4 v[194:197], v249, s[4:7], s45 offen offset:0 sc1
buffer_load_dwordx4 v[198:201], v249, s[4:7], s45 offen offset:1024 sc1
buffer_load_dwordx4 v[202:205], v249, s[4:7], s45 offen offset:2048 sc1
buffer_load_dwordx4 v[206:209], v249, s[4:7], s45 offen offset:3072 sc1
buffer_load_dwordx4 v[210:213], v249, s[4:7], s42 offen offset:0 sc1
buffer_load_dwordx4 v[214:217], v249, s[4:7], s42 offen offset:1024 sc1
buffer_load_dwordx4 v[218:221], v249, s[4:7], s42 offen offset:2048 sc1
buffer_load_dwordx4 v[222:225], v249, s[4:7], s42 offen offset:3072 sc1
s_waitcnt vmcnt(7)
v_mfma_f32_16x16x32_bf16 v[130:133], v[2:5], v[194:197], 0
v_mfma_f32_16x16x32_bf16 v[134:137], v[6:9], v[194:197], 0
v_mfma_f32_16x16x32_bf16 v[146:149], v[10:13], v[194:197], 0
v_mfma_f32_16x16x32_bf16 v[150:153], v[14:17], v[194:197], 0
v_mfma_f32_16x16x32_bf16 v[162:165], v[18:21], v[194:197], 0
v_mfma_f32_16x16x32_bf16 v[166:169], v[22:25], v[194:197], 0
v_mfma_f32_16x16x32_bf16 v[178:181], v[26:29], v[194:197], 0
v_mfma_f32_16x16x32_bf16 v[182:185], v[30:33], v[194:197], 0
s_waitcnt vmcnt(6)
v_mfma_f32_16x16x32_bf16 v[138:141], v[2:5], v[198:201], 0
v_mfma_f32_16x16x32_bf16 v[142:145], v[6:9], v[198:201], 0
v_mfma_f32_16x16x32_bf16 v[154:157], v[10:13], v[198:201], 0
v_mfma_f32_16x16x32_bf16 v[158:161], v[14:17], v[198:201], 0
v_mfma_f32_16x16x32_bf16 v[170:173], v[18:21], v[198:201], 0
v_mfma_f32_16x16x32_bf16 v[174:177], v[22:25], v[198:201], 0
v_mfma_f32_16x16x32_bf16 v[186:189], v[26:29], v[198:201], 0
v_mfma_f32_16x16x32_bf16 v[190:193], v[30:33], v[198:201], 0
s_waitcnt vmcnt(5)
v_mfma_f32_16x16x32_bf16 v[130:133], v[34:37], v[202:205], v[130:133]
v_mfma_f32_16x16x32_bf16 v[134:137], v[38:41], v[202:205], v[134:137]
v_mfma_f32_16x16x32_bf16 v[146:149], v[42:45], v[202:205], v[146:149]
v_mfma_f32_16x16x32_bf16 v[150:153], v[46:49], v[202:205], v[150:153]
v_mfma_f32_16x16x32_bf16 v[162:165], v[50:53], v[202:205], v[162:165]
v_mfma_f32_16x16x32_bf16 v[166:169], v[54:57], v[202:205], v[166:169]
v_mfma_f32_16x16x32_bf16 v[178:181], v[58:61], v[202:205], v[178:181]
v_mfma_f32_16x16x32_bf16 v[182:185], v[62:65], v[202:205], v[182:185]
s_waitcnt vmcnt(4)
v_mfma_f32_16x16x32_bf16 v[138:141], v[34:37], v[206:209], v[138:141]
v_mfma_f32_16x16x32_bf16 v[142:145], v[38:41], v[206:209], v[142:145]
v_mfma_f32_16x16x32_bf16 v[154:157], v[42:45], v[206:209], v[154:157]
v_mfma_f32_16x16x32_bf16 v[158:161], v[46:49], v[206:209], v[158:161]
v_mfma_f32_16x16x32_bf16 v[170:173], v[50:53], v[206:209], v[170:173]
v_mfma_f32_16x16x32_bf16 v[174:177], v[54:57], v[206:209], v[174:177]
v_mfma_f32_16x16x32_bf16 v[186:189], v[58:61], v[206:209], v[186:189]
v_mfma_f32_16x16x32_bf16 v[190:193], v[62:65], v[206:209], v[190:193]
s_waitcnt vmcnt(3)
v_mfma_f32_16x16x32_bf16 v[130:133], v[66:69], v[210:213], v[130:133]
v_mfma_f32_16x16x32_bf16 v[134:137], v[70:73], v[210:213], v[134:137]
v_mfma_f32_16x16x32_bf16 v[146:149], v[74:77], v[210:213], v[146:149]
v_mfma_f32_16x16x32_bf16 v[150:153], v[78:81], v[210:213], v[150:153]
v_mfma_f32_16x16x32_bf16 v[162:165], v[82:85], v[210:213], v[162:165]
v_mfma_f32_16x16x32_bf16 v[166:169], v[86:89], v[210:213], v[166:169]
v_mfma_f32_16x16x32_bf16 v[178:181], v[90:93], v[210:213], v[178:181]
v_mfma_f32_16x16x32_bf16 v[182:185], v[94:97], v[210:213], v[182:185]
s_waitcnt vmcnt(2)
v_mfma_f32_16x16x32_bf16 v[138:141], v[66:69], v[214:217], v[138:141]
v_mfma_f32_16x16x32_bf16 v[142:145], v[70:73], v[214:217], v[142:145]
v_mfma_f32_16x16x32_bf16 v[154:157], v[74:77], v[214:217], v[154:157]
v_mfma_f32_16x16x32_bf16 v[158:161], v[78:81], v[214:217], v[158:161]
v_mfma_f32_16x16x32_bf16 v[170:173], v[82:85], v[214:217], v[170:173]
v_mfma_f32_16x16x32_bf16 v[174:177], v[86:89], v[214:217], v[174:177]
v_mfma_f32_16x16x32_bf16 v[186:189], v[90:93], v[214:217], v[186:189]
v_mfma_f32_16x16x32_bf16 v[190:193], v[94:97], v[214:217], v[190:193]
s_waitcnt vmcnt(1)
v_mfma_f32_16x16x32_bf16 v[130:133], v[98:101], v[218:221], v[130:133]
v_mfma_f32_16x16x32_bf16 v[134:137], v[102:105], v[218:221], v[134:137]
v_mfma_f32_16x16x32_bf16 v[146:149], v[106:109], v[218:221], v[146:149]
v_mfma_f32_16x16x32_bf16 v[150:153], v[110:113], v[218:221], v[150:153]
v_mfma_f32_16x16x32_bf16 v[162:165], v[114:117], v[218:221], v[162:165]
v_mfma_f32_16x16x32_bf16 v[166:169], v[118:121], v[218:221], v[166:169]
v_mfma_f32_16x16x32_bf16 v[178:181], v[122:125], v[218:221], v[178:181]
v_mfma_f32_16x16x32_bf16 v[182:185], v[126:129], v[218:221], v[182:185]
s_waitcnt vmcnt(0)
v_mfma_f32_16x16x32_bf16 v[138:141], v[98:101], v[222:225], v[138:141]
v_mfma_f32_16x16x32_bf16 v[142:145], v[102:105], v[222:225], v[142:145]
v_mfma_f32_16x16x32_bf16 v[154:157], v[106:109], v[222:225], v[154:157]
v_mfma_f32_16x16x32_bf16 v[158:161], v[110:113], v[222:225], v[158:161]
v_mfma_f32_16x16x32_bf16 v[170:173], v[114:117], v[222:225], v[170:173]
v_mfma_f32_16x16x32_bf16 v[174:177], v[118:121], v[222:225], v[174:177]
v_mfma_f32_16x16x32_bf16 v[186:189], v[122:125], v[222:225], v[186:189]
v_mfma_f32_16x16x32_bf16 v[190:193], v[126:129], v[222:225], v[190:193]
s_nop 7
v_cvt_pk_bf16_f32 v130, v130, v131
v_cvt_pk_bf16_f32 v131, v132, v133
v_cvt_pk_bf16_f32 v132, v134, v135
v_cvt_pk_bf16_f32 v133, v136, v137
ds_write_b128 v251, v[130:133] offset:0
v_cvt_pk_bf16_f32 v134, v138, v139
v_cvt_pk_bf16_f32 v135, v140, v141
v_cvt_pk_bf16_f32 v136, v142, v143
v_cvt_pk_bf16_f32 v137, v144, v145
ds_write_b128 v251, v[134:137] offset:1024
v_cvt_pk_bf16_f32 v138, v146, v147
v_cvt_pk_bf16_f32 v139, v148, v149
v_cvt_pk_bf16_f32 v140, v150, v151
v_cvt_pk_bf16_f32 v141, v152, v153
ds_write_b128 v251, v[138:141] offset:2048
v_cvt_pk_bf16_f32 v142, v154, v155
v_cvt_pk_bf16_f32 v143, v156, v157
v_cvt_pk_bf16_f32 v144, v158, v159
v_cvt_pk_bf16_f32 v145, v160, v161
ds_write_b128 v251, v[142:145] offset:3072
v_cvt_pk_bf16_f32 v146, v162, v163
v_cvt_pk_bf16_f32 v147, v164, v165
v_cvt_pk_bf16_f32 v148, v166, v167
v_cvt_pk_bf16_f32 v149, v168, v169
ds_write_b128 v251, v[146:149] offset:4096
v_cvt_pk_bf16_f32 v150, v170, v171
v_cvt_pk_bf16_f32 v151, v172, v173
v_cvt_pk_bf16_f32 v152, v174, v175
v_cvt_pk_bf16_f32 v153, v176, v177
ds_write_b128 v251, v[150:153] offset:5120
v_cvt_pk_bf16_f32 v154, v178, v179
v_cvt_pk_bf16_f32 v155, v180, v181
v_cvt_pk_bf16_f32 v156, v182, v183
v_cvt_pk_bf16_f32 v157, v184, v185
ds_write_b128 v251, v[154:157] offset:6144
v_cvt_pk_bf16_f32 v158, v186, v187
v_cvt_pk_bf16_f32 v159, v188, v189
v_cvt_pk_bf16_f32 v160, v190, v191
v_cvt_pk_bf16_f32 v161, v192, v193
ds_write_b128 v251, v[158:161] offset:7168
v_xor_b32 v251, 0x10000, v251
s_waitcnt lgkmcnt(0)
s_barrier
s_waitcnt lgkmcnt(4)
ds_read_b128 v[162:165], v252 offset:0
ds_read_b128 v[166:169], v252 offset:16384
ds_read_b128 v[170:173], v252 offset:32768
ds_read_b128 v[174:177], v252 offset:49152
v_xor_b32 v252, 6144, v252
ds_read_b128 v[178:181], v252 offset:0
ds_read_b128 v[182:185], v252 offset:16384
ds_read_b128 v[186:189], v252 offset:32768
ds_read_b128 v[190:193], v252 offset:49152
v_xor_b32 v252, 71680, v252
s_waitcnt lgkmcnt(7)
v_mfma_f32_16x16x32_bf16 v[244:247], v[230:233], v[162:165], 0
s_waitcnt lgkmcnt(6)
v_mfma_f32_16x16x32_bf16 v[244:247], v[230:233], v[166:169], v[244:247]
s_waitcnt lgkmcnt(5)
v_mfma_f32_16x16x32_bf16 v[244:247], v[230:233], v[170:173], v[244:247]
s_waitcnt lgkmcnt(4)
v_mfma_f32_16x16x32_bf16 v[244:247], v[230:233], v[174:177], v[244:247]
s_waitcnt lgkmcnt(3)
v_mfma_f32_16x16x32_bf16 v[226:229], v[230:233], v[178:181], 0
s_waitcnt lgkmcnt(2)
v_mfma_f32_16x16x32_bf16 v[226:229], v[230:233], v[182:185], v[226:229]
s_waitcnt lgkmcnt(1)
v_mfma_f32_16x16x32_bf16 v[226:229], v[230:233], v[186:189], v[226:229]
s_waitcnt lgkmcnt(0)
v_mfma_f32_16x16x32_bf16 v[226:229], v[230:233], v[190:193], v[226:229]
s_add_u32 s20, s43, 0
s_lshl_b32 s20, s20, 14
s_xor_b32 s20, s20, s47
v_cvt_pk_bf16_f32 v244, v244, v245
v_cvt_pk_bf16_f32 v245, v246, v247
v_min_u32 v244, -2, v244
v_min_u32 v245, -2, v245
buffer_store_dwordx2 v[244:245], v250, s[4:7], s20 offen sc1
s_add_u32 s20, s43, 0
s_lshl_b32 s20, s20, 14
s_xor_b32 s20, s20, s48
s_nop 1
v_cvt_pk_bf16_f32 v226, v226, v227
v_cvt_pk_bf16_f32 v227, v228, v229
v_min_u32 v226, -2, v226
v_min_u32 v227, -2, v227
buffer_store_dwordx2 v[226:227], v250, s[4:7], s20 offen sc1
s_add_u32 s43, s43, 2
s_add_u32 s18, s18, 2
s_lshr_b32 s20, s18, 1
s_cmp_eq_u32 s20, 28
s_cselect_b32 s20, 6, 0
s_add_u32 s18, s18, s20
s_cmp_lt_u32 s18, 64
s_cbranch_scc1 oh_14
s_waitcnt vmcnt(0)
s_branch L_end
omain_11:
ocold_16:
s_cmp_gt_u32 s40, s18
s_cbranch_scc0 of_21
of_22:
s_cmp_ge_u32 s18, 56
s_cselect_b32 s25, 0, 0
s_add_u32 s45, s18, s25
s_lshl_b32 s45, s45, 14
s_xor_b32 s45, s45, s41
s_add_u32 s42, s45, 4096
buffer_load_dwordx4 v[194:197], v249, s[4:7], s45 offen offset:0 sc1
buffer_load_dwordx4 v[198:201], v249, s[4:7], s45 offen offset:1024 sc1
buffer_load_dwordx4 v[202:205], v249, s[4:7], s45 offen offset:2048 sc1
buffer_load_dwordx4 v[206:209], v249, s[4:7], s45 offen offset:3072 sc1
buffer_load_dwordx4 v[210:213], v249, s[4:7], s42 offen offset:0 sc1
buffer_load_dwordx4 v[214:217], v249, s[4:7], s42 offen offset:1024 sc1
buffer_load_dwordx4 v[218:221], v249, s[4:7], s42 offen offset:2048 sc1
buffer_load_dwordx4 v[222:225], v249, s[4:7], s42 offen offset:3072 sc1
owarm_17:
s_setprio 1
buffer_load_dword v248, v254, s[4:7], 0 offen sc1
s_add_u32 s43, s18, 1
s_cmp_gt_u32 s40, s43
s_cbranch_scc0 onp_18
s_cmp_ge_u32 s43, 56
s_cselect_b32 s25, 0, 0
s_add_u32 s45, s43, s25
s_lshl_b32 s45, s45, 14
s_xor_b32 s45, s45, s41
s_add_u32 s42, s45, 4096
s_waitcnt vmcnt(8)
v_mfma_f32_16x16x32_bf16 v[130:133], v[2:5], v[194:197], 0
v_mfma_f32_16x16x32_bf16 v[134:137], v[6:9], v[194:197], 0
v_mfma_f32_16x16x32_bf16 v[146:149], v[10:13], v[194:197], 0
v_mfma_f32_16x16x32_bf16 v[150:153], v[14:17], v[194:197], 0
v_mfma_f32_16x16x32_bf16 v[162:165], v[18:21], v[194:197], 0
v_mfma_f32_16x16x32_bf16 v[166:169], v[22:25], v[194:197], 0
v_mfma_f32_16x16x32_bf16 v[178:181], v[26:29], v[194:197], 0
v_mfma_f32_16x16x32_bf16 v[182:185], v[30:33], v[194:197], 0
buffer_load_dwordx4 v[194:197], v249, s[4:7], s45 offen offset:0 sc1
s_waitcnt vmcnt(8)
v_mfma_f32_16x16x32_bf16 v[138:141], v[2:5], v[198:201], 0
v_mfma_f32_16x16x32_bf16 v[142:145], v[6:9], v[198:201], 0
v_mfma_f32_16x16x32_bf16 v[154:157], v[10:13], v[198:201], 0
v_mfma_f32_16x16x32_bf16 v[158:161], v[14:17], v[198:201], 0
v_mfma_f32_16x16x32_bf16 v[170:173], v[18:21], v[198:201], 0
v_mfma_f32_16x16x32_bf16 v[174:177], v[22:25], v[198:201], 0
v_mfma_f32_16x16x32_bf16 v[186:189], v[26:29], v[198:201], 0
v_mfma_f32_16x16x32_bf16 v[190:193], v[30:33], v[198:201], 0
buffer_load_dwordx4 v[198:201], v249, s[4:7], s45 offen offset:1024 sc1
s_waitcnt vmcnt(8)
v_mfma_f32_16x16x32_bf16 v[130:133], v[34:37], v[202:205], v[130:133]
v_mfma_f32_16x16x32_bf16 v[134:137], v[38:41], v[202:205], v[134:137]
v_mfma_f32_16x16x32_bf16 v[146:149], v[42:45], v[202:205], v[146:149]
v_mfma_f32_16x16x32_bf16 v[150:153], v[46:49], v[202:205], v[150:153]
v_mfma_f32_16x16x32_bf16 v[162:165], v[50:53], v[202:205], v[162:165]
v_mfma_f32_16x16x32_bf16 v[166:169], v[54:57], v[202:205], v[166:169]
v_mfma_f32_16x16x32_bf16 v[178:181], v[58:61], v[202:205], v[178:181]
v_mfma_f32_16x16x32_bf16 v[182:185], v[62:65], v[202:205], v[182:185]
buffer_load_dwordx4 v[202:205], v249, s[4:7], s45 offen offset:2048 sc1
s_waitcnt vmcnt(8)
v_mfma_f32_16x16x32_bf16 v[138:141], v[34:37], v[206:209], v[138:141]
v_mfma_f32_16x16x32_bf16 v[142:145], v[38:41], v[206:209], v[142:145]
v_mfma_f32_16x16x32_bf16 v[154:157], v[42:45], v[206:209], v[154:157]
v_mfma_f32_16x16x32_bf16 v[158:161], v[46:49], v[206:209], v[158:161]
v_mfma_f32_16x16x32_bf16 v[170:173], v[50:53], v[206:209], v[170:173]
v_mfma_f32_16x16x32_bf16 v[174:177], v[54:57], v[206:209], v[174:177]
v_mfma_f32_16x16x32_bf16 v[186:189], v[58:61], v[206:209], v[186:189]
v_mfma_f32_16x16x32_bf16 v[190:193], v[62:65], v[206:209], v[190:193]
buffer_load_dwordx4 v[206:209], v249, s[4:7], s45 offen offset:3072 sc1
s_waitcnt vmcnt(8)
v_mfma_f32_16x16x32_bf16 v[130:133], v[66:69], v[210:213], v[130:133]
v_mfma_f32_16x16x32_bf16 v[134:137], v[70:73], v[210:213], v[134:137]
v_mfma_f32_16x16x32_bf16 v[146:149], v[74:77], v[210:213], v[146:149]
v_mfma_f32_16x16x32_bf16 v[150:153], v[78:81], v[210:213], v[150:153]
v_mfma_f32_16x16x32_bf16 v[162:165], v[82:85], v[210:213], v[162:165]
v_mfma_f32_16x16x32_bf16 v[166:169], v[86:89], v[210:213], v[166:169]
v_mfma_f32_16x16x32_bf16 v[178:181], v[90:93], v[210:213], v[178:181]
v_mfma_f32_16x16x32_bf16 v[182:185], v[94:97], v[210:213], v[182:185]
buffer_load_dwordx4 v[210:213], v249, s[4:7], s42 offen offset:0 sc1
s_waitcnt vmcnt(8)
v_mfma_f32_16x16x32_bf16 v[138:141], v[66:69], v[214:217], v[138:141]
v_mfma_f32_16x16x32_bf16 v[142:145], v[70:73], v[214:217], v[142:145]
v_mfma_f32_16x16x32_bf16 v[154:157], v[74:77], v[214:217], v[154:157]
v_mfma_f32_16x16x32_bf16 v[158:161], v[78:81], v[214:217], v[158:161]
v_mfma_f32_16x16x32_bf16 v[170:173], v[82:85], v[214:217], v[170:173]
v_mfma_f32_16x16x32_bf16 v[174:177], v[86:89], v[214:217], v[174:177]
v_mfma_f32_16x16x32_bf16 v[186:189], v[90:93], v[214:217], v[186:189]
v_mfma_f32_16x16x32_bf16 v[190:193], v[94:97], v[214:217], v[190:193]
buffer_load_dwordx4 v[214:217], v249, s[4:7], s42 offen offset:1024 sc1
s_waitcnt vmcnt(8)
v_mfma_f32_16x16x32_bf16 v[130:133], v[98:101], v[218:221], v[130:133]
v_mfma_f32_16x16x32_bf16 v[134:137], v[102:105], v[218:221], v[134:137]
v_mfma_f32_16x16x32_bf16 v[146:149], v[106:109], v[218:221], v[146:149]
v_mfma_f32_16x16x32_bf16 v[150:153], v[110:113], v[218:221], v[150:153]
v_mfma_f32_16x16x32_bf16 v[162:165], v[114:117], v[218:221], v[162:165]
v_mfma_f32_16x16x32_bf16 v[166:169], v[118:121], v[218:221], v[166:169]
v_mfma_f32_16x16x32_bf16 v[178:181], v[122:125], v[218:221], v[178:181]
v_mfma_f32_16x16x32_bf16 v[182:185], v[126:129], v[218:221], v[182:185]
buffer_load_dwordx4 v[218:221], v249, s[4:7], s42 offen offset:2048 sc1
s_waitcnt vmcnt(8)
v_mfma_f32_16x16x32_bf16 v[138:141], v[98:101], v[222:225], v[138:141]
v_mfma_f32_16x16x32_bf16 v[142:145], v[102:105], v[222:225], v[142:145]
v_mfma_f32_16x16x32_bf16 v[154:157], v[106:109], v[222:225], v[154:157]
v_mfma_f32_16x16x32_bf16 v[158:161], v[110:113], v[222:225], v[158:161]
v_mfma_f32_16x16x32_bf16 v[170:173], v[114:117], v[222:225], v[170:173]
v_mfma_f32_16x16x32_bf16 v[174:177], v[118:121], v[222:225], v[174:177]
v_mfma_f32_16x16x32_bf16 v[186:189], v[122:125], v[222:225], v[186:189]
v_mfma_f32_16x16x32_bf16 v[190:193], v[126:129], v[222:225], v[190:193]
buffer_load_dwordx4 v[222:225], v249, s[4:7], s42 offen offset:3072 sc1
s_waitcnt vmcnt(8)
s_mov_b32 s46, 1
s_branch ored_19
onp_18:
s_waitcnt vmcnt(8)
v_mfma_f32_16x16x32_bf16 v[130:133], v[2:5], v[194:197], 0
v_mfma_f32_16x16x32_bf16 v[134:137], v[6:9], v[194:197], 0
v_mfma_f32_16x16x32_bf16 v[146:149], v[10:13], v[194:197], 0
v_mfma_f32_16x16x32_bf16 v[150:153], v[14:17], v[194:197], 0
v_mfma_f32_16x16x32_bf16 v[162:165], v[18:21], v[194:197], 0
v_mfma_f32_16x16x32_bf16 v[166:169], v[22:25], v[194:197], 0
v_mfma_f32_16x16x32_bf16 v[178:181], v[26:29], v[194:197], 0
v_mfma_f32_16x16x32_bf16 v[182:185], v[30:33], v[194:197], 0
s_waitcnt vmcnt(7)
v_mfma_f32_16x16x32_bf16 v[138:141], v[2:5], v[198:201], 0
v_mfma_f32_16x16x32_bf16 v[142:145], v[6:9], v[198:201], 0
v_mfma_f32_16x16x32_bf16 v[154:157], v[10:13], v[198:201], 0
v_mfma_f32_16x16x32_bf16 v[158:161], v[14:17], v[198:201], 0
v_mfma_f32_16x16x32_bf16 v[170:173], v[18:21], v[198:201], 0
v_mfma_f32_16x16x32_bf16 v[174:177], v[22:25], v[198:201], 0
v_mfma_f32_16x16x32_bf16 v[186:189], v[26:29], v[198:201], 0
v_mfma_f32_16x16x32_bf16 v[190:193], v[30:33], v[198:201], 0
s_waitcnt vmcnt(6)
v_mfma_f32_16x16x32_bf16 v[130:133], v[34:37], v[202:205], v[130:133]
v_mfma_f32_16x16x32_bf16 v[134:137], v[38:41], v[202:205], v[134:137]
v_mfma_f32_16x16x32_bf16 v[146:149], v[42:45], v[202:205], v[146:149]
v_mfma_f32_16x16x32_bf16 v[150:153], v[46:49], v[202:205], v[150:153]
v_mfma_f32_16x16x32_bf16 v[162:165], v[50:53], v[202:205], v[162:165]
v_mfma_f32_16x16x32_bf16 v[166:169], v[54:57], v[202:205], v[166:169]
v_mfma_f32_16x16x32_bf16 v[178:181], v[58:61], v[202:205], v[178:181]
v_mfma_f32_16x16x32_bf16 v[182:185], v[62:65], v[202:205], v[182:185]
s_waitcnt vmcnt(5)
v_mfma_f32_16x16x32_bf16 v[138:141], v[34:37], v[206:209], v[138:141]
v_mfma_f32_16x16x32_bf16 v[142:145], v[38:41], v[206:209], v[142:145]
v_mfma_f32_16x16x32_bf16 v[154:157], v[42:45], v[206:209], v[154:157]
v_mfma_f32_16x16x32_bf16 v[158:161], v[46:49], v[206:209], v[158:161]
v_mfma_f32_16x16x32_bf16 v[170:173], v[50:53], v[206:209], v[170:173]
v_mfma_f32_16x16x32_bf16 v[174:177], v[54:57], v[206:209], v[174:177]
v_mfma_f32_16x16x32_bf16 v[186:189], v[58:61], v[206:209], v[186:189]
v_mfma_f32_16x16x32_bf16 v[190:193], v[62:65], v[206:209], v[190:193]
buffer_load_dword v248, v254, s[4:7], 0 offen sc1
s_waitcnt vmcnt(5)
v_mfma_f32_16x16x32_bf16 v[130:133], v[66:69], v[210:213], v[130:133]
v_mfma_f32_16x16x32_bf16 v[134:137], v[70:73], v[210:213], v[134:137]
v_mfma_f32_16x16x32_bf16 v[146:149], v[74:77], v[210:213], v[146:149]
v_mfma_f32_16x16x32_bf16 v[150:153], v[78:81], v[210:213], v[150:153]
v_mfma_f32_16x16x32_bf16 v[162:165], v[82:85], v[210:213], v[162:165]
v_mfma_f32_16x16x32_bf16 v[166:169], v[86:89], v[210:213], v[166:169]
v_mfma_f32_16x16x32_bf16 v[178:181], v[90:93], v[210:213], v[178:181]
v_mfma_f32_16x16x32_bf16 v[182:185], v[94:97], v[210:213], v[182:185]
s_waitcnt vmcnt(4)
v_mfma_f32_16x16x32_bf16 v[138:141], v[66:69], v[214:217], v[138:141]
v_mfma_f32_16x16x32_bf16 v[142:145], v[70:73], v[214:217], v[142:145]
v_mfma_f32_16x16x32_bf16 v[154:157], v[74:77], v[214:217], v[154:157]
v_mfma_f32_16x16x32_bf16 v[158:161], v[78:81], v[214:217], v[158:161]
v_mfma_f32_16x16x32_bf16 v[170:173], v[82:85], v[214:217], v[170:173]
v_mfma_f32_16x16x32_bf16 v[174:177], v[86:89], v[214:217], v[174:177]
v_mfma_f32_16x16x32_bf16 v[186:189], v[90:93], v[214:217], v[186:189]
v_mfma_f32_16x16x32_bf16 v[190:193], v[94:97], v[214:217], v[190:193]
s_waitcnt vmcnt(3)
v_mfma_f32_16x16x32_bf16 v[130:133], v[98:101], v[218:221], v[130:133]
v_mfma_f32_16x16x32_bf16 v[134:137], v[102:105], v[218:221], v[134:137]
v_mfma_f32_16x16x32_bf16 v[146:149], v[106:109], v[218:221], v[146:149]
v_mfma_f32_16x16x32_bf16 v[150:153], v[110:113], v[218:221], v[150:153]
v_mfma_f32_16x16x32_bf16 v[162:165], v[114:117], v[218:221], v[162:165]
v_mfma_f32_16x16x32_bf16 v[166:169], v[118:121], v[218:221], v[166:169]
v_mfma_f32_16x16x32_bf16 v[178:181], v[122:125], v[218:221], v[178:181]
v_mfma_f32_16x16x32_bf16 v[182:185], v[126:129], v[218:221], v[182:185]
s_waitcnt vmcnt(2)
v_mfma_f32_16x16x32_bf16 v[138:141], v[98:101], v[222:225], v[138:141]
v_mfma_f32_16x16x32_bf16 v[142:145], v[102:105], v[222:225], v[142:145]
v_mfma_f32_16x16x32_bf16 v[154:157], v[106:109], v[222:225], v[154:157]
v_mfma_f32_16x16x32_bf16 v[158:161], v[110:113], v[222:225], v[158:161]
v_mfma_f32_16x16x32_bf16 v[170:173], v[114:117], v[222:225], v[170:173]
v_mfma_f32_16x16x32_bf16 v[174:177], v[118:121], v[222:225], v[174:177]
v_mfma_f32_16x16x32_bf16 v[186:189], v[122:125], v[222:225], v[186:189]
v_mfma_f32_16x16x32_bf16 v[190:193], v[126:129], v[222:225], v[190:193]
s_waitcnt vmcnt(0)
s_mov_b32 s46, 0
ored_19:
s_setprio 3
s_barrier
v_min_u32_dpp v248, v248, v248 quad_perm:[1,0,3,2] row_mask:0xf bank_mask:0xf
s_nop 1
v_min_u32_dpp v248, v248, v248 quad_perm:[2,3,0,1] row_mask:0xf bank_mask:0xf
s_nop 0
v_readfirstlane_b32 s40, v248
s_sub_u32 s25, s40, 0
s_max_i32 s25, s25, 56
s_min_u32 s40, s40, s25
s_min_u32 s40, s40, 62
s_cmp_eq_u32 s46, 1
s_cbranch_scc1 olp_23
s_cmp_gt_u32 s40, s43
s_cbranch_scc0 olp_23
s_mov_b32 s46, 1
s_cmp_ge_u32 s43, 56
s_cselect_b32 s25, 0, 0
s_add_u32 s45, s43, s25
s_lshl_b32 s45, s45, 14
s_xor_b32 s45, s45, s41
s_add_u32 s42, s45, 4096
buffer_load_dwordx4 v[194:197], v249, s[4:7], s45 offen offset:0 sc1
buffer_load_dwordx4 v[198:201], v249, s[4:7], s45 offen offset:1024 sc1
buffer_load_dwordx4 v[202:205], v249, s[4:7], s45 offen offset:2048 sc1
buffer_load_dwordx4 v[206:209], v249, s[4:7], s45 offen offset:3072 sc1
buffer_load_dwordx4 v[210:213], v249, s[4:7], s42 offen offset:0 sc1
buffer_load_dwordx4 v[214:217], v249, s[4:7], s42 offen offset:1024 sc1
buffer_load_dwordx4 v[218:221], v249, s[4:7], s42 offen offset:2048 sc1
buffer_load_dwordx4 v[222:225], v249, s[4:7], s42 offen offset:3072 sc1
olp_23:
v_cvt_pk_bf16_f32 v130, v130, v131
v_cvt_pk_bf16_f32 v131, v132, v133
v_cvt_pk_bf16_f32 v132, v134, v135
v_cvt_pk_bf16_f32 v133, v136, v137
ds_write_b128 v251, v[130:133] offset:0
v_cvt_pk_bf16_f32 v134, v138, v139
v_cvt_pk_bf16_f32 v135, v140, v141
v_cvt_pk_bf16_f32 v136, v142, v143
v_cvt_pk_bf16_f32 v137, v144, v145
ds_write_b128 v251, v[134:137] offset:1024
v_cvt_pk_bf16_f32 v138, v146, v147
v_cvt_pk_bf16_f32 v139, v148, v149
v_cvt_pk_bf16_f32 v140, v150, v151
v_cvt_pk_bf16_f32 v141, v152, v153
ds_write_b128 v251, v[138:141] offset:2048
v_cvt_pk_bf16_f32 v142, v154, v155
v_cvt_pk_bf16_f32 v143, v156, v157
v_cvt_pk_bf16_f32 v144, v158, v159
v_cvt_pk_bf16_f32 v145, v160, v161
ds_write_b128 v251, v[142:145] offset:3072
v_cvt_pk_bf16_f32 v146, v162, v163
v_cvt_pk_bf16_f32 v147, v164, v165
v_cvt_pk_bf16_f32 v148, v166, v167
v_cvt_pk_bf16_f32 v149, v168, v169
ds_write_b128 v251, v[146:149] offset:4096
v_cvt_pk_bf16_f32 v150, v170, v171
v_cvt_pk_bf16_f32 v151, v172, v173
v_cvt_pk_bf16_f32 v152, v174, v175
v_cvt_pk_bf16_f32 v153, v176, v177
ds_write_b128 v251, v[150:153] offset:5120
v_cvt_pk_bf16_f32 v154, v178, v179
v_cvt_pk_bf16_f32 v155, v180, v181
v_cvt_pk_bf16_f32 v156, v182, v183
v_cvt_pk_bf16_f32 v157, v184, v185
ds_write_b128 v251, v[154:157] offset:6144
v_cvt_pk_bf16_f32 v158, v186, v187
v_cvt_pk_bf16_f32 v159, v188, v189
v_cvt_pk_bf16_f32 v160, v190, v191
v_cvt_pk_bf16_f32 v161, v192, v193
ds_write_b128 v251, v[158:161] offset:7168
v_xor_b32 v251, 0x10000, v251
osk_25:
s_cmp_eq_u32 s18, 0
s_cbranch_scc1 osk_24
s_waitcnt lgkmcnt(4)
ds_read_b128 v[162:165], v252 offset:0
ds_read_b128 v[166:169], v252 offset:16384
ds_read_b128 v[170:173], v252 offset:32768
ds_read_b128 v[174:177], v252 offset:49152
v_xor_b32 v252, 6144, v252
ds_read_b128 v[178:181], v252 offset:0
ds_read_b128 v[182:185], v252 offset:16384
ds_read_b128 v[186:189], v252 offset:32768
ds_read_b128 v[190:193], v252 offset:49152
v_xor_b32 v252, 71680, v252
s_waitcnt lgkmcnt(7)
v_mfma_f32_16x16x32_bf16 v[244:247], v[230:233], v[162:165], 0
s_waitcnt lgkmcnt(6)
v_mfma_f32_16x16x32_bf16 v[244:247], v[230:233], v[166:169], v[244:247]
s_waitcnt lgkmcnt(5)
v_mfma_f32_16x16x32_bf16 v[244:247], v[230:233], v[170:173], v[244:247]
s_waitcnt lgkmcnt(4)
v_mfma_f32_16x16x32_bf16 v[244:247], v[230:233], v[174:177], v[244:247]
s_waitcnt lgkmcnt(3)
v_mfma_f32_16x16x32_bf16 v[226:229], v[230:233], v[178:181], 0
s_waitcnt lgkmcnt(2)
v_mfma_f32_16x16x32_bf16 v[226:229], v[230:233], v[182:185], v[226:229]
s_waitcnt lgkmcnt(1)
v_mfma_f32_16x16x32_bf16 v[226:229], v[230:233], v[186:189], v[226:229]
s_waitcnt lgkmcnt(0)
v_mfma_f32_16x16x32_bf16 v[226:229], v[230:233], v[190:193], v[226:229]
s_add_u32 s20, s18, -1
s_lshl_b32 s20, s20, 14
s_xor_b32 s20, s20, s47
v_cvt_pk_bf16_f32 v244, v244, v245
v_cvt_pk_bf16_f32 v245, v246, v247
v_min_u32 v244, -2, v244
v_min_u32 v245, -2, v245
buffer_store_dwordx2 v[244:245], v250, s[4:7], s20 offen sc1
s_add_u32 s20, s18, 1
s_lshl_b32 s20, s20, 14
s_xor_b32 s20, s20, s47
buffer_store_dwordx2 v[240:241], v250, s[4:7], s20 offen sc1
s_add_u32 s20, s18, -1
s_lshl_b32 s20, s20, 14
s_xor_b32 s20, s20, s48
s_nop 1
v_cvt_pk_bf16_f32 v226, v226, v227
v_cvt_pk_bf16_f32 v227, v228, v229
v_min_u32 v226, -2, v226
v_min_u32 v227, -2, v227
buffer_store_dwordx2 v[226:227], v250, s[4:7], s20 offen sc1
s_add_u32 s20, s18, 1
s_lshl_b32 s20, s20, 14
s_xor_b32 s20, s20, s48
buffer_store_dwordx2 v[240:241], v250, s[4:7], s20 offen sc1
osk_24:
s_waitcnt lgkmcnt(0)
s_mov_b32 s18, s43
s_cmp_ge_u32 s18, 62
s_cbranch_scc1 ofin_20
s_cmp_eq_u32 s46, 1
s_cbranch_scc1 owarm_17
s_branch ocold_16
ofin_20:
s_waitcnt vmcnt(0) lgkmcnt(0)
s_barrier
s_waitcnt lgkmcnt(4)
ds_read_b128 v[162:165], v252 offset:0
ds_read_b128 v[166:169], v252 offset:16384
ds_read_b128 v[170:173], v252 offset:32768
ds_read_b128 v[174:177], v252 offset:49152
v_xor_b32 v252, 6144, v252
ds_read_b128 v[178:181], v252 offset:0
ds_read_b128 v[182:185], v252 offset:16384
ds_read_b128 v[186:189], v252 offset:32768
ds_read_b128 v[190:193], v252 offset:49152
v_xor_b32 v252, 71680, v252
s_waitcnt lgkmcnt(7)
v_mfma_f32_16x16x32_bf16 v[244:247], v[230:233], v[162:165], 0
s_waitcnt lgkmcnt(6)
v_mfma_f32_16x16x32_bf16 v[244:247], v[230:233], v[166:169], v[244:247]
s_waitcnt lgkmcnt(5)
v_mfma_f32_16x16x32_bf16 v[244:247], v[230:233], v[170:173], v[244:247]
s_waitcnt lgkmcnt(4)
v_mfma_f32_16x16x32_bf16 v[244:247], v[230:233], v[174:177], v[244:247]
s_waitcnt lgkmcnt(3)
v_mfma_f32_16x16x32_bf16 v[226:229], v[230:233], v[178:181], 0
s_waitcnt lgkmcnt(2)
v_mfma_f32_16x16x32_bf16 v[226:229], v[230:233], v[182:185], v[226:229]
s_waitcnt lgkmcnt(1)
v_mfma_f32_16x16x32_bf16 v[226:229], v[230:233], v[186:189], v[226:229]
s_waitcnt lgkmcnt(0)
v_mfma_f32_16x16x32_bf16 v[226:229], v[230:233], v[190:193], v[226:229]
s_add_u32 s20, s18, -1
s_lshl_b32 s20, s20, 14
s_xor_b32 s20, s20, s47
v_cvt_pk_bf16_f32 v244, v244, v245
v_cvt_pk_bf16_f32 v245, v246, v247
v_min_u32 v244, -2, v244
v_min_u32 v245, -2, v245
buffer_store_dwordx2 v[244:245], v250, s[4:7], s20 offen sc1
s_add_u32 s20, s18, -1
s_lshl_b32 s20, s20, 14
s_xor_b32 s20, s20, s48
s_nop 1
v_cvt_pk_bf16_f32 v226, v226, v227
v_cvt_pk_bf16_f32 v227, v228, v229
v_min_u32 v226, -2, v226
v_min_u32 v227, -2, v227
buffer_store_dwordx2 v[226:227], v250, s[4:7], s20 offen sc1
s_waitcnt vmcnt(0)
s_branch L_end
ohi_10:
s_cmp_eq_u32 s18, 0
s_cbranch_scc1 omain_26
s_and_b32 s43, s18, 1
s_add_u32 s43, s43, 64
s_mov_b32 s40, 0
oh_29:
s_lshl_b32 s45, s18, 14
s_xor_b32 s45, s45, s41
s_add_u32 s42, s45, 4096
s_cmp_gt_u32 s40, s18
s_cbranch_scc1 oh_30
v_lshlrev_b32 v1, 6, v0
buffer_load_dword v194, v1, s[4:7], s45 offen sc1
buffer_load_dword v194, v1, s[4:7], s42 offen sc1
s_branch of_27
of_28:
s_sleep 16
of_27:
s_add_u32 s19, s19, 1
s_cmp_gt_u32 s19, 1048576
s_cbranch_scc1 L_end
buffer_load_dword v248, v254, s[4:7], 0 offen sc1
s_waitcnt vmcnt(0)
v_min_u32_dpp v248, v248, v248 quad_perm:[1,0,3,2] row_mask:0xf bank_mask:0xf
s_nop 1
v_min_u32_dpp v248, v248, v248 quad_perm:[2,3,0,1] row_mask:0xf bank_mask:0xf
s_nop 0
v_readfirstlane_b32 s40, v248
s_cmp_lt_u32 s40, s18
s_cbranch_scc1 of_28
s_cmp_gt_u32 s40, s18
s_cbranch_scc0 of_27
oh_30:
buffer_load_dwordx4 v[194:197], v249, s[4:7], s45 offen offset:0 sc1
buffer_load_dwordx4 v[198:201], v249, s[4:7], s45 offen offset:1024 sc1
buffer_load_dwordx4 v[202:205], v249, s[4:7], s45 offen offset:2048 sc1
buffer_load_dwordx4 v[206:209], v249, s[4:7], s45 offen offset:3072 sc1
buffer_load_dwordx4 v[210:213], v249, s[4:7], s42 offen offset:0 sc1
buffer_load_dwordx4 v[214:217], v249, s[4:7], s42 offen offset:1024 sc1
buffer_load_dwordx4 v[218:221], v249, s[4:7], s42 offen offset:2048 sc1
buffer_load_dwordx4 v[222:225], v249, s[4:7], s42 offen offset:3072 sc1
s_waitcnt vmcnt(7)
v_mfma_f32_16x16x32_bf16 v[130:133], v[2:5], v[194:197], 0
v_mfma_f32_16x16x32_bf16 v[134:137], v[6:9], v[194:197], 0
v_mfma_f32_16x16x32_bf16 v[146:149], v[10:13], v[194:197], 0
v_mfma_f32_16x16x32_bf16 v[150:153], v[14:17], v[194:197], 0
v_mfma_f32_16x16x32_bf16 v[162:165], v[18:21], v[194:197], 0
v_mfma_f32_16x16x32_bf16 v[166:169], v[22:25], v[194:197], 0
v_mfma_f32_16x16x32_bf16 v[178:181], v[26:29], v[194:197], 0
v_mfma_f32_16x16x32_bf16 v[182:185], v[30:33], v[194:197], 0
s_waitcnt vmcnt(6)
v_mfma_f32_16x16x32_bf16 v[138:141], v[2:5], v[198:201], 0
v_mfma_f32_16x16x32_bf16 v[142:145], v[6:9], v[198:201], 0
v_mfma_f32_16x16x32_bf16 v[154:157], v[10:13], v[198:201], 0
v_mfma_f32_16x16x32_bf16 v[158:161], v[14:17], v[198:201], 0
v_mfma_f32_16x16x32_bf16 v[170:173], v[18:21], v[198:201], 0
v_mfma_f32_16x16x32_bf16 v[174:177], v[22:25], v[198:201], 0
v_mfma_f32_16x16x32_bf16 v[186:189], v[26:29], v[198:201], 0
v_mfma_f32_16x16x32_bf16 v[190:193], v[30:33], v[198:201], 0
s_waitcnt vmcnt(5)
v_mfma_f32_16x16x32_bf16 v[130:133], v[34:37], v[202:205], v[130:133]
v_mfma_f32_16x16x32_bf16 v[134:137], v[38:41], v[202:205], v[134:137]
v_mfma_f32_16x16x32_bf16 v[146:149], v[42:45], v[202:205], v[146:149]
v_mfma_f32_16x16x32_bf16 v[150:153], v[46:49], v[202:205], v[150:153]
v_mfma_f32_16x16x32_bf16 v[162:165], v[50:53], v[202:205], v[162:165]
v_mfma_f32_16x16x32_bf16 v[166:169], v[54:57], v[202:205], v[166:169]
v_mfma_f32_16x16x32_bf16 v[178:181], v[58:61], v[202:205], v[178:181]
v_mfma_f32_16x16x32_bf16 v[182:185], v[62:65], v[202:205], v[182:185]
s_waitcnt vmcnt(4)
v_mfma_f32_16x16x32_bf16 v[138:141], v[34:37], v[206:209], v[138:141]
v_mfma_f32_16x16x32_bf16 v[142:145], v[38:41], v[206:209], v[142:145]
v_mfma_f32_16x16x32_bf16 v[154:157], v[42:45], v[206:209], v[154:157]
v_mfma_f32_16x16x32_bf16 v[158:161], v[46:49], v[206:209], v[158:161]
v_mfma_f32_16x16x32_bf16 v[170:173], v[50:53], v[206:209], v[170:173]
v_mfma_f32_16x16x32_bf16 v[174:177], v[54:57], v[206:209], v[174:177]
v_mfma_f32_16x16x32_bf16 v[186:189], v[58:61], v[206:209], v[186:189]
v_mfma_f32_16x16x32_bf16 v[190:193], v[62:65], v[206:209], v[190:193]
s_waitcnt vmcnt(3)
v_mfma_f32_16x16x32_bf16 v[130:133], v[66:69], v[210:213], v[130:133]
v_mfma_f32_16x16x32_bf16 v[134:137], v[70:73], v[210:213], v[134:137]
v_mfma_f32_16x16x32_bf16 v[146:149], v[74:77], v[210:213], v[146:149]
v_mfma_f32_16x16x32_bf16 v[150:153], v[78:81], v[210:213], v[150:153]
v_mfma_f32_16x16x32_bf16 v[162:165], v[82:85], v[210:213], v[162:165]
v_mfma_f32_16x16x32_bf16 v[166:169], v[86:89], v[210:213], v[166:169]
v_mfma_f32_16x16x32_bf16 v[178:181], v[90:93], v[210:213], v[178:181]
v_mfma_f32_16x16x32_bf16 v[182:185], v[94:97], v[210:213], v[182:185]
s_waitcnt vmcnt(2)
v_mfma_f32_16x16x32_bf16 v[138:141], v[66:69], v[214:217], v[138:141]
v_mfma_f32_16x16x32_bf16 v[142:145], v[70:73], v[214:217], v[142:145]
v_mfma_f32_16x16x32_bf16 v[154:157], v[74:77], v[214:217], v[154:157]
v_mfma_f32_16x16x32_bf16 v[158:161], v[78:81], v[214:217], v[158:161]
v_mfma_f32_16x16x32_bf16 v[170:173], v[82:85], v[214:217], v[170:173]
v_mfma_f32_16x16x32_bf16 v[174:177], v[86:89], v[214:217], v[174:177]
v_mfma_f32_16x16x32_bf16 v[186:189], v[90:93], v[214:217], v[186:189]
v_mfma_f32_16x16x32_bf16 v[190:193], v[94:97], v[214:217], v[190:193]
s_waitcnt vmcnt(1)
v_mfma_f32_16x16x32_bf16 v[130:133], v[98:101], v[218:221], v[130:133]
v_mfma_f32_16x16x32_bf16 v[134:137], v[102:105], v[218:221], v[134:137]
v_mfma_f32_16x16x32_bf16 v[146:149], v[106:109], v[218:221], v[146:149]
v_mfma_f32_16x16x32_bf16 v[150:153], v[110:113], v[218:221], v[150:153]
v_mfma_f32_16x16x32_bf16 v[162:165], v[114:117], v[218:221], v[162:165]
v_mfma_f32_16x16x32_bf16 v[166:169], v[118:121], v[218:221], v[166:169]
v_mfma_f32_16x16x32_bf16 v[178:181], v[122:125], v[218:221], v[178:181]
v_mfma_f32_16x16x32_bf16 v[182:185], v[126:129], v[218:221], v[182:185]
s_waitcnt vmcnt(0)
v_mfma_f32_16x16x32_bf16 v[138:141], v[98:101], v[222:225], v[138:141]
v_mfma_f32_16x16x32_bf16 v[142:145], v[102:105], v[222:225], v[142:145]
v_mfma_f32_16x16x32_bf16 v[154:157], v[106:109], v[222:225], v[154:157]
v_mfma_f32_16x16x32_bf16 v[158:161], v[110:113], v[222:225], v[158:161]
v_mfma_f32_16x16x32_bf16 v[170:173], v[114:117], v[222:225], v[170:173]
v_mfma_f32_16x16x32_bf16 v[174:177], v[118:121], v[222:225], v[174:177]
v_mfma_f32_16x16x32_bf16 v[186:189], v[122:125], v[222:225], v[186:189]
v_mfma_f32_16x16x32_bf16 v[190:193], v[126:129], v[222:225], v[190:193]
s_nop 7
v_cvt_pk_bf16_f32 v130, v130, v131
v_cvt_pk_bf16_f32 v131, v132, v133
v_cvt_pk_bf16_f32 v132, v134, v135
v_cvt_pk_bf16_f32 v133, v136, v137
ds_write_b128 v251, v[130:133] offset:0
v_cvt_pk_bf16_f32 v134, v138, v139
v_cvt_pk_bf16_f32 v135, v140, v141
v_cvt_pk_bf16_f32 v136, v142, v143
v_cvt_pk_bf16_f32 v137, v144, v145
ds_write_b128 v251, v[134:137] offset:1024
v_cvt_pk_bf16_f32 v138, v146, v147
v_cvt_pk_bf16_f32 v139, v148, v149
v_cvt_pk_bf16_f32 v140, v150, v151
v_cvt_pk_bf16_f32 v141, v152, v153
ds_write_b128 v251, v[138:141] offset:2048
v_cvt_pk_bf16_f32 v142, v154, v155
v_cvt_pk_bf16_f32 v143, v156, v157
v_cvt_pk_bf16_f32 v144, v158, v159
v_cvt_pk_bf16_f32 v145, v160, v161
ds_write_b128 v251, v[142:145] offset:3072
v_cvt_pk_bf16_f32 v146, v162, v163
v_cvt_pk_bf16_f32 v147, v164, v165
v_cvt_pk_bf16_f32 v148, v166, v167
v_cvt_pk_bf16_f32 v149, v168, v169
ds_write_b128 v251, v[146:149] offset:4096
v_cvt_pk_bf16_f32 v150, v170, v171
v_cvt_pk_bf16_f32 v151, v172, v173
v_cvt_pk_bf16_f32 v152, v174, v175
v_cvt_pk_bf16_f32 v153, v176, v177
ds_write_b128 v251, v[150:153] offset:5120
v_cvt_pk_bf16_f32 v154, v178, v179
v_cvt_pk_bf16_f32 v155, v180, v181
v_cvt_pk_bf16_f32 v156, v182, v183
v_cvt_pk_bf16_f32 v157, v184, v185
ds_write_b128 v251, v[154:157] offset:6144
v_cvt_pk_bf16_f32 v158, v186, v187
v_cvt_pk_bf16_f32 v159, v188, v189
v_cvt_pk_bf16_f32 v160, v190, v191
v_cvt_pk_bf16_f32 v161, v192, v193
ds_write_b128 v251, v[158:161] offset:7168
v_xor_b32 v251, 0x10000, v251
s_waitcnt lgkmcnt(0)
s_barrier
s_waitcnt lgkmcnt(4)
ds_read_b128 v[162:165], v252 offset:0
ds_read_b128 v[166:169], v252 offset:16384
ds_read_b128 v[170:173], v252 offset:32768
ds_read_b128 v[174:177], v252 offset:49152
v_xor_b32 v252, 6144, v252
ds_read_b128 v[178:181], v252 offset:0
ds_read_b128 v[182:185], v252 offset:16384
ds_read_b128 v[186:189], v252 offset:32768
ds_read_b128 v[190:193], v252 offset:49152
v_xor_b32 v252, 71680, v252
s_waitcnt lgkmcnt(7)
v_mfma_f32_16x16x32_bf16 v[244:247], v[230:233], v[162:165], 0
s_waitcnt lgkmcnt(6)
v_mfma_f32_16x16x32_bf16 v[244:247], v[230:233], v[166:169], v[244:247]
s_waitcnt lgkmcnt(5)
v_mfma_f32_16x16x32_bf16 v[244:247], v[230:233], v[170:173], v[244:247]
s_waitcnt lgkmcnt(4)
v_mfma_f32_16x16x32_bf16 v[244:247], v[230:233], v[174:177], v[244:247]
s_waitcnt lgkmcnt(3)
v_mfma_f32_16x16x32_bf16 v[226:229], v[230:233], v[178:181], 0
s_waitcnt lgkmcnt(2)
v_mfma_f32_16x16x32_bf16 v[226:229], v[230:233], v[182:185], v[226:229]
s_waitcnt lgkmcnt(1)
v_mfma_f32_16x16x32_bf16 v[226:229], v[230:233], v[186:189], v[226:229]
s_waitcnt lgkmcnt(0)
v_mfma_f32_16x16x32_bf16 v[226:229], v[230:233], v[190:193], v[226:229]
s_add_u32 s20, s43, 0
s_lshl_b32 s20, s20, 14
s_xor_b32 s20, s20, s47
v_cvt_pk_bf16_f32 v244, v244, v245
v_cvt_pk_bf16_f32 v245, v246, v247
v_min_u32 v244, -2, v244
v_min_u32 v245, -2, v245
buffer_store_dwordx2 v[244:245], v250, s[4:7], s20 offen sc1
s_add_u32 s23, s43, 0
s_lshl_b32 s23, s23, 14
s_xor_b32 s23, s23, s48
s_waitcnt vmcnt(0)
s_add_u32 s24, s23, 4096
buffer_load_dwordx2 v[234:235], v250, s[4:7], s23 offen offset:2048 sc1
buffer_load_dwordx2 v[236:237], v250, s[4:7], s24 offen sc1
buffer_load_dwordx2 v[238:239], v250, s[4:7], s24 offen offset:2048 sc1
s_waitcnt vmcnt(0)
oc_31:
v_max3_u32 v1, v234, v235, v236
v_max3_u32 v1, v1, v237, v238
v_max_u32 v1, v1, v239
v_cmp_eq_u32 vcc, -1, v1
s_cbranch_vccnz oc_32
v_lshlrev_b32 v1, 16, v234
v_and_b32 v234, s50, v234
v_add_f32 v226, v226, v1
v_add_f32 v227, v227, v234
v_lshlrev_b32 v1, 16, v235
v_and_b32 v235, s50, v235
v_add_f32 v228, v228, v1
v_add_f32 v229, v229, v235
v_lshlrev_b32 v1, 16, v236
v_and_b32 v236, s50, v236
v_add_f32 v226, v226, v1
v_add_f32 v227, v227, v236
v_lshlrev_b32 v1, 16, v237
v_and_b32 v237, s50, v237
v_add_f32 v228, v228, v1
v_add_f32 v229, v229, v237
v_lshlrev_b32 v1, 16, v238
v_and_b32 v238, s50, v238
v_add_f32 v226, v226, v1
v_add_f32 v227, v227, v238
v_lshlrev_b32 v1, 16, v239
v_and_b32 v239, s50, v239
v_add_f32 v228, v228, v1
v_add_f32 v229, v229, v239
v_cvt_pk_bf16_f32 v242, v226, v227
v_cvt_pk_bf16_f32 v243, v228, v229
s_sub_u32 s20, s18, 0
s_lshl_b32 s20, s20, 17
buffer_store_dwordx2 v[242:243], v253, s[36:39], s20 offen nt
s_add_u32 s43, s43, 2
s_add_u32 s18, s18, 2
s_lshr_b32 s20, s18, 1
s_cmp_eq_u32 s20, 28
s_cselect_b32 s20, 6, 0
s_add_u32 s18, s18, s20
s_cmp_lt_u32 s18, 64
s_cbranch_scc1 oh_29
s_waitcnt vmcnt(0)
s_branch L_end
omain_26:
ocold_33:
s_cmp_gt_u32 s40, s18
s_cbranch_scc0 of_38
of_39:
s_cmp_ge_u32 s18, 56
s_cselect_b32 s25, 0, 0
s_add_u32 s45, s18, s25
s_lshl_b32 s45, s45, 14
s_xor_b32 s45, s45, s41
s_add_u32 s42, s45, 4096
buffer_load_dwordx4 v[194:197], v249, s[4:7], s45 offen offset:0 sc1
buffer_load_dwordx4 v[198:201], v249, s[4:7], s45 offen offset:1024 sc1
buffer_load_dwordx4 v[202:205], v249, s[4:7], s45 offen offset:2048 sc1
buffer_load_dwordx4 v[206:209], v249, s[4:7], s45 offen offset:3072 sc1
buffer_load_dwordx4 v[210:213], v249, s[4:7], s42 offen offset:0 sc1
buffer_load_dwordx4 v[214:217], v249, s[4:7], s42 offen offset:1024 sc1
buffer_load_dwordx4 v[218:221], v249, s[4:7], s42 offen offset:2048 sc1
buffer_load_dwordx4 v[222:225], v249, s[4:7], s42 offen offset:3072 sc1
owarm_34:
s_waitcnt lgkmcnt(0)
s_barrier
s_setprio 2
buffer_load_dword v248, v254, s[4:7], 0 offen sc1
s_sub_u32 s23, s18, 2
s_max_i32 s23, s23, 0
s_lshl_b32 s23, s23, 14
s_xor_b32 s23, s23, s48
s_add_u32 s24, s23, 4096
buffer_load_dwordx2 v[234:235], v250, s[4:7], s23 offen offset:2048 sc1
buffer_load_dwordx2 v[236:237], v250, s[4:7], s24 offen sc1
buffer_load_dwordx2 v[238:239], v250, s[4:7], s24 offen offset:2048 sc1
s_add_u32 s43, s18, 1
s_cmp_gt_u32 s40, s43
s_cbranch_scc0 onp_35
s_cmp_ge_u32 s43, 56
s_cselect_b32 s25, 0, 0
s_add_u32 s45, s43, s25
s_lshl_b32 s45, s45, 14
s_xor_b32 s45, s45, s41
s_add_u32 s42, s45, 4096
s_waitcnt vmcnt(11)
v_mfma_f32_16x16x32_bf16 v[130:133], v[2:5], v[194:197], 0
v_mfma_f32_16x16x32_bf16 v[134:137], v[6:9], v[194:197], 0
v_mfma_f32_16x16x32_bf16 v[146:149], v[10:13], v[194:197], 0
v_mfma_f32_16x16x32_bf16 v[150:153], v[14:17], v[194:197], 0
v_mfma_f32_16x16x32_bf16 v[162:165], v[18:21], v[194:197], 0
v_mfma_f32_16x16x32_bf16 v[166:169], v[22:25], v[194:197], 0
v_mfma_f32_16x16x32_bf16 v[178:181], v[26:29], v[194:197], 0
v_mfma_f32_16x16x32_bf16 v[182:185], v[30:33], v[194:197], 0
buffer_load_dwordx4 v[194:197], v249, s[4:7], s45 offen offset:0 sc1
s_waitcnt vmcnt(11)
v_mfma_f32_16x16x32_bf16 v[138:141], v[2:5], v[198:201], 0
v_mfma_f32_16x16x32_bf16 v[142:145], v[6:9], v[198:201], 0
v_mfma_f32_16x16x32_bf16 v[154:157], v[10:13], v[198:201], 0
v_mfma_f32_16x16x32_bf16 v[158:161], v[14:17], v[198:201], 0
v_mfma_f32_16x16x32_bf16 v[170:173], v[18:21], v[198:201], 0
v_mfma_f32_16x16x32_bf16 v[174:177], v[22:25], v[198:201], 0
v_mfma_f32_16x16x32_bf16 v[186:189], v[26:29], v[198:201], 0
v_mfma_f32_16x16x32_bf16 v[190:193], v[30:33], v[198:201], 0
buffer_load_dwordx4 v[198:201], v249, s[4:7], s45 offen offset:1024 sc1
s_waitcnt vmcnt(11)
v_mfma_f32_16x16x32_bf16 v[130:133], v[34:37], v[202:205], v[130:133]
v_mfma_f32_16x16x32_bf16 v[134:137], v[38:41], v[202:205], v[134:137]
v_mfma_f32_16x16x32_bf16 v[146:149], v[42:45], v[202:205], v[146:149]
v_mfma_f32_16x16x32_bf16 v[150:153], v[46:49], v[202:205], v[150:153]
v_mfma_f32_16x16x32_bf16 v[162:165], v[50:53], v[202:205], v[162:165]
v_mfma_f32_16x16x32_bf16 v[166:169], v[54:57], v[202:205], v[166:169]
v_mfma_f32_16x16x32_bf16 v[178:181], v[58:61], v[202:205], v[178:181]
v_mfma_f32_16x16x32_bf16 v[182:185], v[62:65], v[202:205], v[182:185]
buffer_load_dwordx4 v[202:205], v249, s[4:7], s45 offen offset:2048 sc1
s_waitcnt vmcnt(11)
v_mfma_f32_16x16x32_bf16 v[138:141], v[34:37], v[206:209], v[138:141]
v_mfma_f32_16x16x32_bf16 v[142:145], v[38:41], v[206:209], v[142:145]
v_mfma_f32_16x16x32_bf16 v[154:157], v[42:45], v[206:209], v[154:157]
v_mfma_f32_16x16x32_bf16 v[158:161], v[46:49], v[206:209], v[158:161]
v_mfma_f32_16x16x32_bf16 v[170:173], v[50:53], v[206:209], v[170:173]
v_mfma_f32_16x16x32_bf16 v[174:177], v[54:57], v[206:209], v[174:177]
v_mfma_f32_16x16x32_bf16 v[186:189], v[58:61], v[206:209], v[186:189]
v_mfma_f32_16x16x32_bf16 v[190:193], v[62:65], v[206:209], v[190:193]
buffer_load_dwordx4 v[206:209], v249, s[4:7], s45 offen offset:3072 sc1
s_waitcnt vmcnt(11)
v_mfma_f32_16x16x32_bf16 v[130:133], v[66:69], v[210:213], v[130:133]
v_mfma_f32_16x16x32_bf16 v[134:137], v[70:73], v[210:213], v[134:137]
v_mfma_f32_16x16x32_bf16 v[146:149], v[74:77], v[210:213], v[146:149]
v_mfma_f32_16x16x32_bf16 v[150:153], v[78:81], v[210:213], v[150:153]
v_mfma_f32_16x16x32_bf16 v[162:165], v[82:85], v[210:213], v[162:165]
v_mfma_f32_16x16x32_bf16 v[166:169], v[86:89], v[210:213], v[166:169]
v_mfma_f32_16x16x32_bf16 v[178:181], v[90:93], v[210:213], v[178:181]
v_mfma_f32_16x16x32_bf16 v[182:185], v[94:97], v[210:213], v[182:185]
buffer_load_dwordx4 v[210:213], v249, s[4:7], s42 offen offset:0 sc1
s_waitcnt vmcnt(11)
v_mfma_f32_16x16x32_bf16 v[138:141], v[66:69], v[214:217], v[138:141]
v_mfma_f32_16x16x32_bf16 v[142:145], v[70:73], v[214:217], v[142:145]
v_mfma_f32_16x16x32_bf16 v[154:157], v[74:77], v[214:217], v[154:157]
v_mfma_f32_16x16x32_bf16 v[158:161], v[78:81], v[214:217], v[158:161]
v_mfma_f32_16x16x32_bf16 v[170:173], v[82:85], v[214:217], v[170:173]
v_mfma_f32_16x16x32_bf16 v[174:177], v[86:89], v[214:217], v[174:177]
v_mfma_f32_16x16x32_bf16 v[186:189], v[90:93], v[214:217], v[186:189]
v_mfma_f32_16x16x32_bf16 v[190:193], v[94:97], v[214:217], v[190:193]
buffer_load_dwordx4 v[214:217], v249, s[4:7], s42 offen offset:1024 sc1
s_waitcnt vmcnt(11)
v_mfma_f32_16x16x32_bf16 v[130:133], v[98:101], v[218:221], v[130:133]
v_mfma_f32_16x16x32_bf16 v[134:137], v[102:105], v[218:221], v[134:137]
v_mfma_f32_16x16x32_bf16 v[146:149], v[106:109], v[218:221], v[146:149]
v_mfma_f32_16x16x32_bf16 v[150:153], v[110:113], v[218:221], v[150:153]
v_mfma_f32_16x16x32_bf16 v[162:165], v[114:117], v[218:221], v[162:165]
v_mfma_f32_16x16x32_bf16 v[166:169], v[118:121], v[218:221], v[166:169]
v_mfma_f32_16x16x32_bf16 v[178:181], v[122:125], v[218:221], v[178:181]
v_mfma_f32_16x16x32_bf16 v[182:185], v[126:129], v[218:221], v[182:185]
buffer_load_dwordx4 v[218:221], v249, s[4:7], s42 offen offset:2048 sc1
s_waitcnt vmcnt(11)
v_mfma_f32_16x16x32_bf16 v[138:141], v[98:101], v[222:225], v[138:141]
v_mfma_f32_16x16x32_bf16 v[142:145], v[102:105], v[222:225], v[142:145]
v_mfma_f32_16x16x32_bf16 v[154:157], v[106:109], v[222:225], v[154:157]
v_mfma_f32_16x16x32_bf16 v[158:161], v[110:113], v[222:225], v[158:161]
v_mfma_f32_16x16x32_bf16 v[170:173], v[114:117], v[222:225], v[170:173]
v_mfma_f32_16x16x32_bf16 v[174:177], v[118:121], v[222:225], v[174:177]
v_mfma_f32_16x16x32_bf16 v[186:189], v[122:125], v[222:225], v[186:189]
v_mfma_f32_16x16x32_bf16 v[190:193], v[126:129], v[222:225], v[190:193]
buffer_load_dwordx4 v[222:225], v249, s[4:7], s42 offen offset:3072 sc1
s_waitcnt vmcnt(8)
s_mov_b32 s46, 1
s_branch ored_36
onp_35:
s_waitcnt vmcnt(11)
v_mfma_f32_16x16x32_bf16 v[130:133], v[2:5], v[194:197], 0
v_mfma_f32_16x16x32_bf16 v[134:137], v[6:9], v[194:197], 0
v_mfma_f32_16x16x32_bf16 v[146:149], v[10:13], v[194:197], 0
v_mfma_f32_16x16x32_bf16 v[150:153], v[14:17], v[194:197], 0
v_mfma_f32_16x16x32_bf16 v[162:165], v[18:21], v[194:197], 0
v_mfma_f32_16x16x32_bf16 v[166:169], v[22:25], v[194:197], 0
v_mfma_f32_16x16x32_bf16 v[178:181], v[26:29], v[194:197], 0
v_mfma_f32_16x16x32_bf16 v[182:185], v[30:33], v[194:197], 0
s_waitcnt vmcnt(10)
v_mfma_f32_16x16x32_bf16 v[138:141], v[2:5], v[198:201], 0
v_mfma_f32_16x16x32_bf16 v[142:145], v[6:9], v[198:201], 0
v_mfma_f32_16x16x32_bf16 v[154:157], v[10:13], v[198:201], 0
v_mfma_f32_16x16x32_bf16 v[158:161], v[14:17], v[198:201], 0
v_mfma_f32_16x16x32_bf16 v[170:173], v[18:21], v[198:201], 0
v_mfma_f32_16x16x32_bf16 v[174:177], v[22:25], v[198:201], 0
v_mfma_f32_16x16x32_bf16 v[186:189], v[26:29], v[198:201], 0
v_mfma_f32_16x16x32_bf16 v[190:193], v[30:33], v[198:201], 0
s_waitcnt vmcnt(9)
v_mfma_f32_16x16x32_bf16 v[130:133], v[34:37], v[202:205], v[130:133]
v_mfma_f32_16x16x32_bf16 v[134:137], v[38:41], v[202:205], v[134:137]
v_mfma_f32_16x16x32_bf16 v[146:149], v[42:45], v[202:205], v[146:149]
v_mfma_f32_16x16x32_bf16 v[150:153], v[46:49], v[202:205], v[150:153]
v_mfma_f32_16x16x32_bf16 v[162:165], v[50:53], v[202:205], v[162:165]
v_mfma_f32_16x16x32_bf16 v[166:169], v[54:57], v[202:205], v[166:169]
v_mfma_f32_16x16x32_bf16 v[178:181], v[58:61], v[202:205], v[178:181]
v_mfma_f32_16x16x32_bf16 v[182:185], v[62:65], v[202:205], v[182:185]
s_waitcnt vmcnt(8)
v_mfma_f32_16x16x32_bf16 v[138:141], v[34:37], v[206:209], v[138:141]
v_mfma_f32_16x16x32_bf16 v[142:145], v[38:41], v[206:209], v[142:145]
v_mfma_f32_16x16x32_bf16 v[154:157], v[42:45], v[206:209], v[154:157]
v_mfma_f32_16x16x32_bf16 v[158:161], v[46:49], v[206:209], v[158:161]
v_mfma_f32_16x16x32_bf16 v[170:173], v[50:53], v[206:209], v[170:173]
v_mfma_f32_16x16x32_bf16 v[174:177], v[54:57], v[206:209], v[174:177]
v_mfma_f32_16x16x32_bf16 v[186:189], v[58:61], v[206:209], v[186:189]
v_mfma_f32_16x16x32_bf16 v[190:193], v[62:65], v[206:209], v[190:193]
buffer_load_dword v248, v254, s[4:7], 0 offen sc1
s_waitcnt vmcnt(8)
v_mfma_f32_16x16x32_bf16 v[130:133], v[66:69], v[210:213], v[130:133]
v_mfma_f32_16x16x32_bf16 v[134:137], v[70:73], v[210:213], v[134:137]
v_mfma_f32_16x16x32_bf16 v[146:149], v[74:77], v[210:213], v[146:149]
v_mfma_f32_16x16x32_bf16 v[150:153], v[78:81], v[210:213], v[150:153]
v_mfma_f32_16x16x32_bf16 v[162:165], v[82:85], v[210:213], v[162:165]
v_mfma_f32_16x16x32_bf16 v[166:169], v[86:89], v[210:213], v[166:169]
v_mfma_f32_16x16x32_bf16 v[178:181], v[90:93], v[210:213], v[178:181]
v_mfma_f32_16x16x32_bf16 v[182:185], v[94:97], v[210:213], v[182:185]
s_waitcnt vmcnt(7)
v_mfma_f32_16x16x32_bf16 v[138:141], v[66:69], v[214:217], v[138:141]
v_mfma_f32_16x16x32_bf16 v[142:145], v[70:73], v[214:217], v[142:145]
v_mfma_f32_16x16x32_bf16 v[154:157], v[74:77], v[214:217], v[154:157]
v_mfma_f32_16x16x32_bf16 v[158:161], v[78:81], v[214:217], v[158:161]
v_mfma_f32_16x16x32_bf16 v[170:173], v[82:85], v[214:217], v[170:173]
v_mfma_f32_16x16x32_bf16 v[174:177], v[86:89], v[214:217], v[174:177]
v_mfma_f32_16x16x32_bf16 v[186:189], v[90:93], v[214:217], v[186:189]
v_mfma_f32_16x16x32_bf16 v[190:193], v[94:97], v[214:217], v[190:193]
s_waitcnt vmcnt(6)
v_mfma_f32_16x16x32_bf16 v[130:133], v[98:101], v[218:221], v[130:133]
v_mfma_f32_16x16x32_bf16 v[134:137], v[102:105], v[218:221], v[134:137]
v_mfma_f32_16x16x32_bf16 v[146:149], v[106:109], v[218:221], v[146:149]
v_mfma_f32_16x16x32_bf16 v[150:153], v[110:113], v[218:221], v[150:153]
v_mfma_f32_16x16x32_bf16 v[162:165], v[114:117], v[218:221], v[162:165]
v_mfma_f32_16x16x32_bf16 v[166:169], v[118:121], v[218:221], v[166:169]
v_mfma_f32_16x16x32_bf16 v[178:181], v[122:125], v[218:221], v[178:181]
v_mfma_f32_16x16x32_bf16 v[182:185], v[126:129], v[218:221], v[182:185]
s_waitcnt vmcnt(5)
v_mfma_f32_16x16x32_bf16 v[138:141], v[98:101], v[222:225], v[138:141]
v_mfma_f32_16x16x32_bf16 v[142:145], v[102:105], v[222:225], v[142:145]
v_mfma_f32_16x16x32_bf16 v[154:157], v[106:109], v[222:225], v[154:157]
v_mfma_f32_16x16x32_bf16 v[158:161], v[110:113], v[222:225], v[158:161]
v_mfma_f32_16x16x32_bf16 v[170:173], v[114:117], v[222:225], v[170:173]
v_mfma_f32_16x16x32_bf16 v[174:177], v[118:121], v[222:225], v[174:177]
v_mfma_f32_16x16x32_bf16 v[186:189], v[122:125], v[222:225], v[186:189]
v_mfma_f32_16x16x32_bf16 v[190:193], v[126:129], v[222:225], v[190:193]
s_waitcnt vmcnt(0)
s_mov_b32 s46, 0
ored_36:
s_setprio 3
v_min_u32_dpp v248, v248, v248 quad_perm:[1,0,3,2] row_mask:0xf bank_mask:0xf
s_nop 1
v_min_u32_dpp v248, v248, v248 quad_perm:[2,3,0,1] row_mask:0xf bank_mask:0xf
s_nop 0
v_readfirstlane_b32 s40, v248
s_sub_u32 s25, s40, 0
s_max_i32 s25, s25, 56
s_min_u32 s40, s40, s25
s_min_u32 s40, s40, 62
s_cmp_eq_u32 s46, 1
s_cbranch_scc1 olp_40
s_cmp_gt_u32 s40, s43
s_cbranch_scc0 olp_40
s_mov_b32 s46, 1
s_cmp_ge_u32 s43, 56
s_cselect_b32 s25, 0, 0
s_add_u32 s45, s43, s25
s_lshl_b32 s45, s45, 14
s_xor_b32 s45, s45, s41
s_add_u32 s42, s45, 4096
buffer_load_dwordx4 v[194:197], v249, s[4:7], s45 offen offset:0 sc1
buffer_load_dwordx4 v[198:201], v249, s[4:7], s45 offen offset:1024 sc1
buffer_load_dwordx4 v[202:205], v249, s[4:7], s45 offen offset:2048 sc1
buffer_load_dwordx4 v[206:209], v249, s[4:7], s45 offen offset:3072 sc1
buffer_load_dwordx4 v[210:213], v249, s[4:7], s42 offen offset:0 sc1
buffer_load_dwordx4 v[214:217], v249, s[4:7], s42 offen offset:1024 sc1
buffer_load_dwordx4 v[218:221], v249, s[4:7], s42 offen offset:2048 sc1
buffer_load_dwordx4 v[222:225], v249, s[4:7], s42 offen offset:3072 sc1
olp_40:
v_cvt_pk_bf16_f32 v130, v130, v131
v_cvt_pk_bf16_f32 v131, v132, v133
v_cvt_pk_bf16_f32 v132, v134, v135
v_cvt_pk_bf16_f32 v133, v136, v137
ds_write_b128 v251, v[130:133] offset:0
v_cvt_pk_bf16_f32 v134, v138, v139
v_cvt_pk_bf16_f32 v135, v140, v141
v_cvt_pk_bf16_f32 v136, v142, v143
v_cvt_pk_bf16_f32 v137, v144, v145
ds_write_b128 v251, v[134:137] offset:1024
v_cvt_pk_bf16_f32 v138, v146, v147
v_cvt_pk_bf16_f32 v139, v148, v149
v_cvt_pk_bf16_f32 v140, v150, v151
v_cvt_pk_bf16_f32 v141, v152, v153
ds_write_b128 v251, v[138:141] offset:2048
v_cvt_pk_bf16_f32 v142, v154, v155
v_cvt_pk_bf16_f32 v143, v156, v157
v_cvt_pk_bf16_f32 v144, v158, v159
v_cvt_pk_bf16_f32 v145, v160, v161
ds_write_b128 v251, v[142:145] offset:3072
v_cvt_pk_bf16_f32 v146, v162, v163
v_cvt_pk_bf16_f32 v147, v164, v165
v_cvt_pk_bf16_f32 v148, v166, v167
v_cvt_pk_bf16_f32 v149, v168, v169
ds_write_b128 v251, v[146:149] offset:4096
v_cvt_pk_bf16_f32 v150, v170, v171
v_cvt_pk_bf16_f32 v151, v172, v173
v_cvt_pk_bf16_f32 v152, v174, v175
v_cvt_pk_bf16_f32 v153, v176, v177
ds_write_b128 v251, v[150:153] offset:5120
v_cvt_pk_bf16_f32 v154, v178, v179
v_cvt_pk_bf16_f32 v155, v180, v181
v_cvt_pk_bf16_f32 v156, v182, v183
v_cvt_pk_bf16_f32 v157, v184, v185
ds_write_b128 v251, v[154:157] offset:6144
v_cvt_pk_bf16_f32 v158, v186, v187
v_cvt_pk_bf16_f32 v159, v188, v189
v_cvt_pk_bf16_f32 v160, v190, v191
v_cvt_pk_bf16_f32 v161, v192, v193
ds_write_b128 v251, v[158:161] offset:7168
v_xor_b32 v251, 0x10000, v251
s_cmp_lt_u32 s18, 2
s_cbranch_scc1 osk_42
oc_43:
v_max3_u32 v1, v234, v235, v236
v_max3_u32 v1, v1, v237, v238
v_max_u32 v1, v1, v239
v_cmp_eq_u32 vcc, -1, v1
s_cbranch_vccnz oc_44
v_lshlrev_b32 v1, 16, v234
v_and_b32 v234, s50, v234
v_add_f32 v226, v226, v1
v_add_f32 v227, v227, v234
v_lshlrev_b32 v1, 16, v235
v_and_b32 v235, s50, v235
v_add_f32 v228, v228, v1
v_add_f32 v229, v229, v235
v_lshlrev_b32 v1, 16, v236
v_and_b32 v236, s50, v236
v_add_f32 v226, v226, v1
v_add_f32 v227, v227, v236
v_lshlrev_b32 v1, 16, v237
v_and_b32 v237, s50, v237
v_add_f32 v228, v228, v1
v_add_f32 v229, v229, v237
v_lshlrev_b32 v1, 16, v238
v_and_b32 v238, s50, v238
v_add_f32 v226, v226, v1
v_add_f32 v227, v227, v238
v_lshlrev_b32 v1, 16, v239
v_and_b32 v239, s50, v239
v_add_f32 v228, v228, v1
v_add_f32 v229, v229, v239
v_cvt_pk_bf16_f32 v242, v226, v227
v_cvt_pk_bf16_f32 v243, v228, v229
s_sub_u32 s20, s18, 2
s_cmp_ge_u32 s20, 56
s_cselect_b32 s25, 0, 0
s_add_u32 s20, s20, s25
s_lshl_b32 s20, s20, 17
buffer_store_dwordx2 v[242:243], v253, s[36:39], s20 offen nt
osk_42:
s_cmp_eq_u32 s18, 0
s_cbranch_scc1 osk_41
s_waitcnt lgkmcnt(4)
ds_read_b128 v[162:165], v252 offset:0
ds_read_b128 v[166:169], v252 offset:16384
ds_read_b128 v[170:173], v252 offset:32768
ds_read_b128 v[174:177], v252 offset:49152
v_xor_b32 v252, 6144, v252
ds_read_b128 v[178:181], v252 offset:0
ds_read_b128 v[182:185], v252 offset:16384
ds_read_b128 v[186:189], v252 offset:32768
ds_read_b128 v[190:193], v252 offset:49152
v_xor_b32 v252, 71680, v252
s_waitcnt lgkmcnt(7)
v_mfma_f32_16x16x32_bf16 v[244:247], v[230:233], v[162:165], 0
s_waitcnt lgkmcnt(6)
v_mfma_f32_16x16x32_bf16 v[244:247], v[230:233], v[166:169], v[244:247]
s_waitcnt lgkmcnt(5)
v_mfma_f32_16x16x32_bf16 v[244:247], v[230:233], v[170:173], v[244:247]
s_waitcnt lgkmcnt(4)
v_mfma_f32_16x16x32_bf16 v[244:247], v[230:233], v[174:177], v[244:247]
s_waitcnt lgkmcnt(3)
v_mfma_f32_16x16x32_bf16 v[226:229], v[230:233], v[178:181], 0
s_waitcnt lgkmcnt(2)
v_mfma_f32_16x16x32_bf16 v[226:229], v[230:233], v[182:185], v[226:229]
s_waitcnt lgkmcnt(1)
v_mfma_f32_16x16x32_bf16 v[226:229], v[230:233], v[186:189], v[226:229]
s_waitcnt lgkmcnt(0)
v_mfma_f32_16x16x32_bf16 v[226:229], v[230:233], v[190:193], v[226:229]
s_add_u32 s20, s18, -1
s_lshl_b32 s20, s20, 14
s_xor_b32 s20, s20, s47
v_cvt_pk_bf16_f32 v244, v244, v245
v_cvt_pk_bf16_f32 v245, v246, v247
v_min_u32 v244, -2, v244
v_min_u32 v245, -2, v245
buffer_store_dwordx2 v[244:245], v250, s[4:7], s20 offen sc1
s_add_u32 s20, s18, 1
s_lshl_b32 s20, s20, 14
s_xor_b32 s20, s20, s47
buffer_store_dwordx2 v[240:241], v250, s[4:7], s20 offen sc1
osk_41:
s_waitcnt lgkmcnt(0)
s_mov_b32 s18, s43
s_cmp_ge_u32 s18, 62
s_cbranch_scc1 ofin_37
s_cmp_eq_u32 s46, 1
s_cbranch_scc1 owarm_34
s_branch ocold_33
ofin_37:
s_waitcnt vmcnt(0) lgkmcnt(0)
s_barrier
s_sub_u32 s23, s18, 2
s_max_i32 s23, s23, 0
s_lshl_b32 s23, s23, 14
s_xor_b32 s23, s23, s48
s_add_u32 s24, s23, 4096
buffer_load_dwordx2 v[234:235], v250, s[4:7], s23 offen offset:2048 sc1
buffer_load_dwordx2 v[236:237], v250, s[4:7], s24 offen sc1
buffer_load_dwordx2 v[238:239], v250, s[4:7], s24 offen offset:2048 sc1
v_mov_b32 v194, v226
v_mov_b32 v195, v227
v_mov_b32 v196, v228
v_mov_b32 v197, v229
s_waitcnt lgkmcnt(4)
ds_read_b128 v[162:165], v252 offset:0
ds_read_b128 v[166:169], v252 offset:16384
ds_read_b128 v[170:173], v252 offset:32768
ds_read_b128 v[174:177], v252 offset:49152
v_xor_b32 v252, 6144, v252
ds_read_b128 v[178:181], v252 offset:0
ds_read_b128 v[182:185], v252 offset:16384
ds_read_b128 v[186:189], v252 offset:32768
ds_read_b128 v[190:193], v252 offset:49152
v_xor_b32 v252, 71680, v252
s_waitcnt lgkmcnt(7)
v_mfma_f32_16x16x32_bf16 v[244:247], v[230:233], v[162:165], 0
s_waitcnt lgkmcnt(6)
v_mfma_f32_16x16x32_bf16 v[244:247], v[230:233], v[166:169], v[244:247]
s_waitcnt lgkmcnt(5)
v_mfma_f32_16x16x32_bf16 v[244:247], v[230:233], v[170:173], v[244:247]
s_waitcnt lgkmcnt(4)
v_mfma_f32_16x16x32_bf16 v[244:247], v[230:233], v[174:177], v[244:247]
s_waitcnt lgkmcnt(3)
v_mfma_f32_16x16x32_bf16 v[226:229], v[230:233], v[178:181], 0
s_waitcnt lgkmcnt(2)
v_mfma_f32_16x16x32_bf16 v[226:229], v[230:233], v[182:185], v[226:229]
s_waitcnt lgkmcnt(1)
v_mfma_f32_16x16x32_bf16 v[226:229], v[230:233], v[186:189], v[226:229]
s_waitcnt lgkmcnt(0)
v_mfma_f32_16x16x32_bf16 v[226:229], v[230:233], v[190:193], v[226:229]
s_add_u32 s20, s18, -1
s_lshl_b32 s20, s20, 14
s_xor_b32 s20, s20, s47
v_cvt_pk_bf16_f32 v244, v244, v245
v_cvt_pk_bf16_f32 v245, v246, v247
v_min_u32 v244, -2, v244
v_min_u32 v245, -2, v245
buffer_store_dwordx2 v[244:245], v250, s[4:7], s20 offen sc1
s_waitcnt vmcnt(0)
oc_45:
v_max3_u32 v1, v234, v235, v236
v_max3_u32 v1, v1, v237, v238
v_max_u32 v1, v1, v239
v_cmp_eq_u32 vcc, -1, v1
s_cbranch_vccnz oc_46
v_lshlrev_b32 v1, 16, v234
v_and_b32 v234, s50, v234
v_add_f32 v194, v194, v1
v_add_f32 v195, v195, v234
v_lshlrev_b32 v1, 16, v235
v_and_b32 v235, s50, v235
v_add_f32 v196, v196, v1
v_add_f32 v197, v197, v235
v_lshlrev_b32 v1, 16, v236
v_and_b32 v236, s50, v236
v_add_f32 v194, v194, v1
v_add_f32 v195, v195, v236
v_lshlrev_b32 v1, 16, v237
v_and_b32 v237, s50, v237
v_add_f32 v196, v196, v1
v_add_f32 v197, v197, v237
v_lshlrev_b32 v1, 16, v238
v_and_b32 v238, s50, v238
v_add_f32 v194, v194, v1
v_add_f32 v195, v195, v238
v_lshlrev_b32 v1, 16, v239
v_and_b32 v239, s50, v239
v_add_f32 v196, v196, v1
v_add_f32 v197, v197, v239
v_cvt_pk_bf16_f32 v242, v194, v195
v_cvt_pk_bf16_f32 v243, v196, v197
s_sub_u32 s20, s18, 2
s_cmp_ge_u32 s20, 56
s_cselect_b32 s25, 0, 0
s_add_u32 s20, s20, s25
s_lshl_b32 s20, s20, 17
buffer_store_dwordx2 v[242:243], v253, s[36:39], s20 offen nt
s_sub_u32 s23, s18, 1
s_max_i32 s23, s23, 0
s_lshl_b32 s23, s23, 14
s_xor_b32 s23, s23, s48
s_add_u32 s24, s23, 4096
buffer_load_dwordx2 v[234:235], v250, s[4:7], s23 offen offset:2048 sc1
buffer_load_dwordx2 v[236:237], v250, s[4:7], s24 offen sc1
buffer_load_dwordx2 v[238:239], v250, s[4:7], s24 offen offset:2048 sc1
s_waitcnt vmcnt(0)
oc_47:
v_max3_u32 v1, v234, v235, v236
v_max3_u32 v1, v1, v237, v238
v_max_u32 v1, v1, v239
v_cmp_eq_u32 vcc, -1, v1
s_cbranch_vccnz oc_48
v_lshlrev_b32 v1, 16, v234
v_and_b32 v234, s50, v234
v_add_f32 v226, v226, v1
v_add_f32 v227, v227, v234
v_lshlrev_b32 v1, 16, v235
v_and_b32 v235, s50, v235
v_add_f32 v228, v228, v1
v_add_f32 v229, v229, v235
v_lshlrev_b32 v1, 16, v236
v_and_b32 v236, s50, v236
v_add_f32 v226, v226, v1
v_add_f32 v227, v227, v236
v_lshlrev_b32 v1, 16, v237
v_and_b32 v237, s50, v237
v_add_f32 v228, v228, v1
v_add_f32 v229, v229, v237
v_lshlrev_b32 v1, 16, v238
v_and_b32 v238, s50, v238
v_add_f32 v226, v226, v1
v_add_f32 v227, v227, v238
v_lshlrev_b32 v1, 16, v239
v_and_b32 v239, s50, v239
v_add_f32 v228, v228, v1
v_add_f32 v229, v229, v239
v_cvt_pk_bf16_f32 v242, v226, v227
v_cvt_pk_bf16_f32 v243, v228, v229
s_sub_u32 s20, s18, 1
s_cmp_ge_u32 s20, 56
s_cselect_b32 s25, 0, 0
s_add_u32 s20, s20, s25
s_lshl_b32 s20, s20, 17
buffer_store_dwordx2 v[242:243], v253, s[36:39], s20 offen nt
s_waitcnt vmcnt(0)
s_branch L_end
pf_7:
s_add_u32 s19, s19, 1
s_cmp_gt_u32 s19, 1048576
s_cbranch_scc1 L_end
buffer_load_dword v248, v249, s[4:7], s41 offen sc1
s_waitcnt vmcnt(0)
v_readfirstlane_b32 s40, v248
s_cmp_gt_u32 s40, s18
s_cbranch_scc1 pf_8
s_sleep 4
s_branch pf_7
of_21:
s_add_u32 s19, s19, 1
s_cmp_gt_u32 s19, 1048576
s_cbranch_scc1 L_end
buffer_load_dword v248, v254, s[4:7], 0 offen sc1
s_waitcnt vmcnt(0)
v_min_u32_dpp v248, v248, v248 quad_perm:[1,0,3,2] row_mask:0xf bank_mask:0xf
s_nop 1
v_min_u32_dpp v248, v248, v248 quad_perm:[2,3,0,1] row_mask:0xf bank_mask:0xf
s_nop 0
v_readfirstlane_b32 s40, v248
s_sub_u32 s25, s40, 0
s_max_i32 s25, s25, 56
s_min_u32 s40, s40, s25
s_min_u32 s40, s40, 62
s_cmp_gt_u32 s40, s18
s_cbranch_scc1 of_22
s_sleep 4
s_branch of_21
oc_32:
s_add_u32 s19, s19, 1
s_cmp_gt_u32 s19, 1048576
s_cbranch_scc1 L_end
s_add_u32 s24, s23, 4096
buffer_load_dwordx2 v[234:235], v250, s[4:7], s23 offen offset:2048 sc1
buffer_load_dwordx2 v[236:237], v250, s[4:7], s24 offen sc1
buffer_load_dwordx2 v[238:239], v250, s[4:7], s24 offen offset:2048 sc1
s_waitcnt vmcnt(0)
s_branch oc_31
of_38:
s_add_u32 s19, s19, 1
s_cmp_gt_u32 s19, 1048576
s_cbranch_scc1 L_end
buffer_load_dword v248, v254, s[4:7], 0 offen sc1
s_waitcnt vmcnt(0)
v_min_u32_dpp v248, v248, v248 quad_perm:[1,0,3,2] row_mask:0xf bank_mask:0xf
s_nop 1
v_min_u32_dpp v248, v248, v248 quad_perm:[2,3,0,1] row_mask:0xf bank_mask:0xf
s_nop 0
v_readfirstlane_b32 s40, v248
s_sub_u32 s25, s40, 0
s_max_i32 s25, s25, 56
s_min_u32 s40, s40, s25
s_min_u32 s40, s40, 62
s_cmp_gt_u32 s40, s18
s_cbranch_scc1 of_39
s_sleep 4
s_branch of_38
oc_44:
s_add_u32 s19, s19, 1
s_cmp_gt_u32 s19, 1048576
s_cbranch_scc1 L_end
s_add_u32 s24, s23, 4096
buffer_load_dwordx2 v[234:235], v250, s[4:7], s23 offen offset:2048 sc1
buffer_load_dwordx2 v[236:237], v250, s[4:7], s24 offen sc1
buffer_load_dwordx2 v[238:239], v250, s[4:7], s24 offen offset:2048 sc1
s_waitcnt vmcnt(0)
s_branch oc_43
oc_46:
s_add_u32 s19, s19, 1
s_cmp_gt_u32 s19, 1048576
s_cbranch_scc1 L_end
s_add_u32 s24, s23, 4096
buffer_load_dwordx2 v[234:235], v250, s[4:7], s23 offen offset:2048 sc1
buffer_load_dwordx2 v[236:237], v250, s[4:7], s24 offen sc1
buffer_load_dwordx2 v[238:239], v250, s[4:7], s24 offen offset:2048 sc1
s_waitcnt vmcnt(0)
s_branch oc_45
oc_48:
s_add_u32 s19, s19, 1
s_cmp_gt_u32 s19, 1048576
s_cbranch_scc1 L_end
s_add_u32 s24, s23, 4096
buffer_load_dwordx2 v[234:235], v250, s[4:7], s23 offen offset:2048 sc1
buffer_load_dwordx2 v[236:237], v250, s[4:7], s24 offen sc1
buffer_load_dwordx2 v[238:239], v250, s[4:7], s24 offen offset:2048 sc1
s_waitcnt vmcnt(0)
s_branch oc_47
L_restart:
s_waitcnt vmcnt(0) lgkmcnt(0)
s_barrier
s_mov_b32 s16, 1
s_mov_b32 s17, 0
s_and_b32 s13, s2, 7
s_branch L_role
L_end:
s_endpgm
L_qa:
s_lshr_b32 s34, s15, 2
s_mov_b32 s40, 0
s_mov_b32 s42, 1040356334
s_mov_b32 s43, 0
s_mov_b32 s44, 0xffff0000
s_load_dwordx2 s[48:49], s[0:1], 48
s_mov_b32 s50, 4194304
s_mov_b32 s51, 0x20000
s_waitcnt lgkmcnt(0)
s_lshr_b32 s22, s15, 2
s_and_b32 s23, s12, 1
s_lshl_b32 s23, s23, 2
v_lshrrev_b32 v1, 4, v0
v_or_b32 v1, s23, v1
v_and_b32 v174, 7, v0
v_xor_b32 v174, v174, v1
v_lshlrev_b32 v174, 4, v174
v_lshrrev_b32 v1, 3, v0
v_lshl_add_u32 v174, v1, 11, v174
s_lshl_b32 s20, s12, 14
s_lshl_b32 s21, s22, 10
s_add_u32 s20, s20, s21
v_add_u32 v174, s20, v174
v_xor_b32 v177, 1024, v174
s_lshl_b32 s52, s22, 15
s_lshl_b32 s21, s12, 10
s_add_u32 s52, s52, s21
v_bfe_u32 v1, v0, 1, 3
v_lshrrev_b32 v175, 4, v0
v_xor_b32 v175, v175, v1
v_lshlrev_b32 v175, 4, v175
v_and_b32 v1, 15, v0
v_lshl_add_u32 v175, v1, 7, v175
s_lshl_b32 s20, s22, 15
v_add_u32 v175, s20, v175
v_xor_b32 v176, 64, v175
s_mov_b32 s18, 0
s_cmp_lg_u32 s16, 0
s_cbranch_scc1 rdy_49
v_and_b32 v1, 7, v0
v_lshlrev_b32 v1, 5, v1
s_cmp_eq_u32 s15, 0
s_cbranch_scc1 rdy_50
s_barrier
rdy_50:
buffer_load_dwordx2 v[130:131], v1, s[28:31], 0 offen sc1
rdy_53:
s_mov_b32 s20, 0
s_waitcnt vmcnt(0)
v_readlane_b32 s21, v131, 0
s_nop 0
s_lshr_b32 s21, s21, 8
s_add_u32 s20, s20, s21
v_readlane_b32 s21, v131, 1
s_nop 0
s_lshr_b32 s21, s21, 8
s_add_u32 s20, s20, s21
v_readlane_b32 s21, v131, 2
s_nop 0
s_lshr_b32 s21, s21, 8
s_add_u32 s20, s20, s21
v_readlane_b32 s21, v131, 3
s_nop 0
s_lshr_b32 s21, s21, 8
s_add_u32 s20, s20, s21
v_readlane_b32 s21, v131, 4
s_nop 0
s_lshr_b32 s21, s21, 8
s_add_u32 s20, s20, s21
v_readlane_b32 s21, v131, 5
s_nop 0
s_lshr_b32 s21, s21, 8
s_add_u32 s20, s20, s21
v_readlane_b32 s21, v131, 6
s_nop 0
s_lshr_b32 s21, s21, 8
s_add_u32 s20, s20, s21
v_readlane_b32 s21, v131, 7
s_nop 0
s_lshr_b32 s21, s21, 8
s_add_u32 s20, s20, s21
s_and_b32 s21, s20, 0xfff
s_cmp_ge_u32 s21, 256
s_cbranch_scc1 rdy_51
s_add_u32 s19, s19, 1
s_cmp_gt_u32 s19, 1048576
s_cbranch_scc1 L_end
s_sleep 8
s_branch rdy_50
rdy_51:
s_cmp_lg_u32 s15, 0
s_cbranch_scc1 rdy_52
s_barrier
rdy_52:
s_lshr_b32 s20, s20, 12
s_cmp_gt_u32 s20, 16
s_cselect_b32 s17, 8192, 0
v_and_b32 v131, 0xfffff, v131
v_cmp_ne_u32 vcc, -1, v130
s_cbranch_vccnz L_restart
v_cmp_ne_u32 vcc, 0x2000, v131
s_cbranch_vccnz L_restart
rdy_49:
s_mov_b32 s40, 0
s_mov_b32 s18, 0
v_mov_b32 v170, 0
s_cmp_lg_u32 s15, 0
s_cbranch_scc1 hold_54
s_lshl_b32 s35, s32, 8
s_add_u32 s35, s35, 3932160
s_xor_b32 s35, s35, s17
s_cmp_gt_u32 s40, s18
s_cbranch_scc0 pf_55
pf_56:
hold_54:
s_barrier
s_mov_b32 s40, 0
s_mov_b32 s18, 0
s_lshl_b32 s20, s18, 16
s_mov_b32 s21, s52
s_add_u32 m0, s21, 0
s_nop 0
buffer_load_dwordx4 v174, s[48:51], s20 offen offset:0 lds
s_add_u32 m0, s21, 3968
s_nop 0
buffer_load_dwordx4 v174, s[48:51], s20 offen offset:128 lds
s_add_u32 m0, s21, 7936
s_nop 0
buffer_load_dwordx4 v174, s[48:51], s20 offen offset:256 lds
s_add_u32 m0, s21, 11904
s_nop 0
buffer_load_dwordx4 v174, s[48:51], s20 offen offset:384 lds
s_add_u32 m0, s21, 15872
s_nop 0
buffer_load_dwordx4 v174, s[48:51], s20 offen offset:512 lds
s_add_u32 m0, s21, 19840
s_nop 0
buffer_load_dwordx4 v174, s[48:51], s20 offen offset:640 lds
s_add_u32 m0, s21, 23808
s_nop 0
buffer_load_dwordx4 v174, s[48:51], s20 offen offset:768 lds
s_add_u32 m0, s21, 27776
s_nop 0
buffer_load_dwordx4 v174, s[48:51], s20 offen offset:896 lds
s_load_dwordx2 s[8:9], s[0:1], 64
s_mov_b32 s10, 8388608
s_mov_b32 s11, 0x20000
s_waitcnt lgkmcnt(0)
s_lshl_b32 s22, s15, 20
s_lshl_b32 s21, s32, 8
s_add_u32 s22, s22, s21
v_bfe_u32 v1, v0, 4, 2
v_lshlrev_b32 v172, 13, v1
v_bfe_u32 v1, v0, 0, 4
v_lshl_add_u32 v172, v1, 4, v172
v_add_u32 v172, s22, v172
s_mov_b32 s20, 0
buffer_load_dwordx4 v[2:5], v172, s[8:11], s20 offen nt
s_mov_b32 s21, 32768
buffer_load_dwordx4 v[6:9], v172, s[8:11], s21 offen nt
s_mov_b32 s20, 65536
buffer_load_dwordx4 v[10:13], v172, s[8:11], s20 offen nt
s_mov_b32 s21, 98304
buffer_load_dwordx4 v[14:17], v172, s[8:11], s21 offen nt
s_mov_b32 s20, 131072
buffer_load_dwordx4 v[18:21], v172, s[8:11], s20 offen nt
s_mov_b32 s21, 163840
buffer_load_dwordx4 v[22:25], v172, s[8:11], s21 offen nt
s_mov_b32 s20, 196608
buffer_load_dwordx4 v[26:29], v172, s[8:11], s20 offen nt
s_mov_b32 s21, 229376
buffer_load_dwordx4 v[30:33], v172, s[8:11], s21 offen nt
s_mov_b32 s20, 262144
buffer_load_dwordx4 v[34:37], v172, s[8:11], s20 offen nt
s_mov_b32 s21, 294912
buffer_load_dwordx4 v[38:41], v172, s[8:11], s21 offen nt
s_mov_b32 s20, 327680
buffer_load_dwordx4 v[42:45], v172, s[8:11], s20 offen nt
s_mov_b32 s21, 360448
buffer_load_dwordx4 v[46:49], v172, s[8:11], s21 offen nt
s_mov_b32 s20, 393216
buffer_load_dwordx4 v[50:53], v172, s[8:11], s20 offen nt
s_mov_b32 s21, 425984
buffer_load_dwordx4 v[54:57], v172, s[8:11], s21 offen nt
s_mov_b32 s20, 458752
buffer_load_dwordx4 v[58:61], v172, s[8:11], s20 offen nt
s_mov_b32 s21, 491520
buffer_load_dwordx4 v[62:65], v172, s[8:11], s21 offen nt
s_mov_b32 s20, 524288
buffer_load_dwordx4 v[66:69], v172, s[8:11], s20 offen nt
s_mov_b32 s21, 557056
buffer_load_dwordx4 v[70:73], v172, s[8:11], s21 offen nt
s_mov_b32 s20, 589824
buffer_load_dwordx4 v[74:77], v172, s[8:11], s20 offen nt
s_mov_b32 s21, 622592
buffer_load_dwordx4 v[78:81], v172, s[8:11], s21 offen nt
s_mov_b32 s20, 655360
buffer_load_dwordx4 v[82:85], v172, s[8:11], s20 offen nt
s_mov_b32 s21, 688128
buffer_load_dwordx4 v[86:89], v172, s[8:11], s21 offen nt
s_mov_b32 s20, 720896
buffer_load_dwordx4 v[90:93], v172, s[8:11], s20 offen nt
s_mov_b32 s21, 753664
buffer_load_dwordx4 v[94:97], v172, s[8:11], s21 offen nt
s_mov_b32 s20, 786432
buffer_load_dwordx4 v[98:101], v172, s[8:11], s20 offen nt
s_mov_b32 s21, 819200
buffer_load_dwordx4 v[102:105], v172, s[8:11], s21 offen nt
s_mov_b32 s20, 851968
buffer_load_dwordx4 v[106:109], v172, s[8:11], s20 offen nt
s_mov_b32 s21, 884736
buffer_load_dwordx4 v[110:113], v172, s[8:11], s21 offen nt
s_mov_b32 s20, 917504
buffer_load_dwordx4 v[114:117], v172, s[8:11], s20 offen nt
s_mov_b32 s21, 950272
buffer_load_dwordx4 v[118:121], v172, s[8:11], s21 offen nt
s_mov_b32 s20, 983040
buffer_load_dwordx4 v[122:125], v172, s[8:11], s20 offen nt
s_mov_b32 s21, 1015808
buffer_load_dwordx4 v[126:129], v172, s[8:11], s21 offen nt
s_lshl_b32 s20, s15, 13
s_add_u32 s20, s20, 65536
v_bfe_u32 v1, v0, 4, 2
v_lshlrev_b32 v172, 8, v1
v_bfe_u32 v1, v0, 0, 4
v_lshl_add_u32 v172, v1, 4, v172
v_add_u32 v172, s20, v172
v_bfe_u32 v1, v0, 4, 2
v_lshlrev_b32 v1, 6, v1
v_xor_b32 v172, v172, v1
s_lshr_b32 s21, s15, 2
s_lshl_b32 s20, s21, 15
s_lshl_b32 s22, s12, 6
s_add_u32 s20, s20, s22
s_add_u32 s20, s20, 65536
v_bfe_u32 v1, v0, 4, 2
v_lshlrev_b32 v170, 11, v1
v_bfe_u32 v1, v0, 2, 2
v_lshl_add_u32 v170, v1, 8, v170
v_bfe_u32 v1, v0, 0, 2
v_lshl_add_u32 v170, v1, 4, v170
v_add_u32 v170, s20, v170
v_bfe_u32 v1, v0, 2, 2
v_lshlrev_b32 v1, 6, v1
v_xor_b32 v170, v170, v1
s_waitcnt vmcnt(31)
ds_write_b128 v172, v[2:5] offset:0
s_waitcnt vmcnt(30)
ds_write_b128 v172, v[6:9] offset:1024
s_waitcnt vmcnt(29)
ds_write_b128 v172, v[10:13] offset:2048
s_waitcnt vmcnt(28)
ds_write_b128 v172, v[14:17] offset:3072
s_waitcnt vmcnt(27)
ds_write_b128 v172, v[18:21] offset:4096
s_waitcnt vmcnt(26)
ds_write_b128 v172, v[22:25] offset:5120
s_waitcnt vmcnt(25)
ds_write_b128 v172, v[26:29] offset:6144
s_waitcnt vmcnt(24)
ds_write_b128 v172, v[30:33] offset:7168
s_waitcnt lgkmcnt(0)
s_barrier
ds_read_b64_tr_b16 v[2:3], v170 offset:0
ds_read_b64_tr_b16 v[4:5], v170 offset:1024
ds_read_b64_tr_b16 v[6:7], v170 offset:8
ds_read_b64_tr_b16 v[8:9], v170 offset:1032
ds_read_b64_tr_b16 v[10:11], v170 offset:8192
ds_read_b64_tr_b16 v[12:13], v170 offset:9216
ds_read_b64_tr_b16 v[14:15], v170 offset:8200
ds_read_b64_tr_b16 v[16:17], v170 offset:9224
ds_read_b64_tr_b16 v[18:19], v170 offset:16384
ds_read_b64_tr_b16 v[20:21], v170 offset:17408
ds_read_b64_tr_b16 v[22:23], v170 offset:16392
ds_read_b64_tr_b16 v[24:25], v170 offset:17416
s_waitcnt lgkmcnt(8)
ds_read_b64_tr_b16 v[26:27], v170 offset:24576
ds_read_b64_tr_b16 v[28:29], v170 offset:25600
ds_read_b64_tr_b16 v[30:31], v170 offset:24584
ds_read_b64_tr_b16 v[32:33], v170 offset:25608
s_waitcnt lgkmcnt(0)
s_barrier
s_waitcnt vmcnt(23)
ds_write_b128 v172, v[34:37] offset:0
s_waitcnt vmcnt(22)
ds_write_b128 v172, v[38:41] offset:1024
s_waitcnt vmcnt(21)
ds_write_b128 v172, v[42:45] offset:2048
s_waitcnt vmcnt(20)
ds_write_b128 v172, v[46:49] offset:3072
s_waitcnt vmcnt(19)
ds_write_b128 v172, v[50:53] offset:4096
s_waitcnt vmcnt(18)
ds_write_b128 v172, v[54:57] offset:5120
s_waitcnt vmcnt(17)
ds_write_b128 v172, v[58:61] offset:6144
s_waitcnt vmcnt(16)
ds_write_b128 v172, v[62:65] offset:7168
s_waitcnt lgkmcnt(0)
s_barrier
ds_read_b64_tr_b16 v[34:35], v170 offset:0
ds_read_b64_tr_b16 v[36:37], v170 offset:1024
ds_read_b64_tr_b16 v[38:39], v170 offset:8
ds_read_b64_tr_b16 v[40:41], v170 offset:1032
ds_read_b64_tr_b16 v[42:43], v170 offset:8192
ds_read_b64_tr_b16 v[44:45], v170 offset:9216
ds_read_b64_tr_b16 v[46:47], v170 offset:8200
ds_read_b64_tr_b16 v[48:49], v170 offset:9224
ds_read_b64_tr_b16 v[50:51], v170 offset:16384
ds_read_b64_tr_b16 v[52:53], v170 offset:17408
ds_read_b64_tr_b16 v[54:55], v170 offset:16392
ds_read_b64_tr_b16 v[56:57], v170 offset:17416
s_waitcnt lgkmcnt(8)
ds_read_b64_tr_b16 v[58:59], v170 offset:24576
ds_read_b64_tr_b16 v[60:61], v170 offset:25600
ds_read_b64_tr_b16 v[62:63], v170 offset:24584
ds_read_b64_tr_b16 v[64:65], v170 offset:25608
s_waitcnt lgkmcnt(0)
s_barrier
s_waitcnt vmcnt(15)
ds_write_b128 v172, v[66:69] offset:0
s_waitcnt vmcnt(14)
ds_write_b128 v172, v[70:73] offset:1024
s_waitcnt vmcnt(13)
ds_write_b128 v172, v[74:77] offset:2048
s_waitcnt vmcnt(12)
ds_write_b128 v172, v[78:81] offset:3072
s_waitcnt vmcnt(11)
ds_write_b128 v172, v[82:85] offset:4096
s_waitcnt vmcnt(10)
ds_write_b128 v172, v[86:89] offset:5120
s_waitcnt vmcnt(9)
ds_write_b128 v172, v[90:93] offset:6144
s_waitcnt vmcnt(8)
ds_write_b128 v172, v[94:97] offset:7168
s_waitcnt lgkmcnt(0)
s_barrier
ds_read_b64_tr_b16 v[66:67], v170 offset:0
ds_read_b64_tr_b16 v[68:69], v170 offset:1024
ds_read_b64_tr_b16 v[70:71], v170 offset:8
ds_read_b64_tr_b16 v[72:73], v170 offset:1032
ds_read_b64_tr_b16 v[74:75], v170 offset:8192
ds_read_b64_tr_b16 v[76:77], v170 offset:9216
ds_read_b64_tr_b16 v[78:79], v170 offset:8200
ds_read_b64_tr_b16 v[80:81], v170 offset:9224
ds_read_b64_tr_b16 v[82:83], v170 offset:16384
ds_read_b64_tr_b16 v[84:85], v170 offset:17408
ds_read_b64_tr_b16 v[86:87], v170 offset:16392
ds_read_b64_tr_b16 v[88:89], v170 offset:17416
s_waitcnt lgkmcnt(8)
ds_read_b64_tr_b16 v[90:91], v170 offset:24576
ds_read_b64_tr_b16 v[92:93], v170 offset:25600
ds_read_b64_tr_b16 v[94:95], v170 offset:24584
ds_read_b64_tr_b16 v[96:97], v170 offset:25608
s_waitcnt lgkmcnt(0)
s_barrier
s_waitcnt vmcnt(7)
ds_write_b128 v172, v[98:101] offset:0
s_waitcnt vmcnt(6)
ds_write_b128 v172, v[102:105] offset:1024
s_waitcnt vmcnt(5)
ds_write_b128 v172, v[106:109] offset:2048
s_waitcnt vmcnt(4)
ds_write_b128 v172, v[110:113] offset:3072
s_waitcnt vmcnt(3)
ds_write_b128 v172, v[114:117] offset:4096
s_waitcnt vmcnt(2)
ds_write_b128 v172, v[118:121] offset:5120
s_waitcnt vmcnt(1)
ds_write_b128 v172, v[122:125] offset:6144
s_waitcnt vmcnt(0)
ds_write_b128 v172, v[126:129] offset:7168
s_waitcnt lgkmcnt(0)
s_barrier
ds_read_b64_tr_b16 v[98:99], v170 offset:0
ds_read_b64_tr_b16 v[100:101], v170 offset:1024
ds_read_b64_tr_b16 v[102:103], v170 offset:8
ds_read_b64_tr_b16 v[104:105], v170 offset:1032
ds_read_b64_tr_b16 v[106:107], v170 offset:8192
ds_read_b64_tr_b16 v[108:109], v170 offset:9216
ds_read_b64_tr_b16 v[110:111], v170 offset:8200
ds_read_b64_tr_b16 v[112:113], v170 offset:9224
ds_read_b64_tr_b16 v[114:115], v170 offset:16384
ds_read_b64_tr_b16 v[116:117], v170 offset:17408
ds_read_b64_tr_b16 v[118:119], v170 offset:16392
ds_read_b64_tr_b16 v[120:121], v170 offset:17416
s_waitcnt lgkmcnt(8)
ds_read_b64_tr_b16 v[122:123], v170 offset:24576
ds_read_b64_tr_b16 v[124:125], v170 offset:25600
ds_read_b64_tr_b16 v[126:127], v170 offset:24584
ds_read_b64_tr_b16 v[128:129], v170 offset:25608
s_waitcnt lgkmcnt(0)
s_barrier
v_lshlrev_b32 v171, 4, v0
s_lshl_b32 s20, s12, 11
s_add_u32 s20, s20, 131072
v_add_u32 v172, s20, v171
v_mov_b32 v1, 2147483632
v_cmp_ne_u32 vcc, 0, v0
s_nop 1
v_cndmask_b32 v173, 0, v1, vcc
s_xor_b32 s22, s34, 1
s_lshl_b32 s36, s32, 8
s_lshl_b32 s21, s22, 7
s_add_u32 s36, s36, s21
s_add_u32 s36, s36, 3932160
s_xor_b32 s36, s36, s17
s_waitcnt vmcnt(0)
s_barrier
s_cmp_eq_u32 s34, 1
s_cbranch_scc1 qah_57
s_lshr_b32 s26, s12, 1
s_and_b32 s27, s12, 1
v_add_u32 v174, 139264, v171
s_mov_b32 s20, 155648
v_bfe_u32 v1, v0, 4, 2
v_lshlrev_b32 v177, 7, v1
v_bfe_u32 v1, v0, 0, 3
v_lshl_add_u32 v177, v1, 4, v177
v_add_u32 v177, s20, v177
s_lshl_b32 s20, s27, 10
s_add_u32 s20, s20, 157696
v_bfe_u32 v1, v0, 4, 1
v_lshlrev_b32 v252, 8, v1
v_bfe_u32 v1, v0, 0, 4
v_lshl_add_u32 v252, v1, 4, v252
v_add_u32 v252, s20, v252
s_lshl_b32 s38, s32, 20
s_add_u32 s38, s38, 71311360
s_and_b32 s21, s32, 1
s_lshl_b32 s21, s21, 14
s_xor_b32 s38, s38, s21
s_and_b32 s21, s32, 2
s_lshl_b32 s21, s21, 12
s_xor_b32 s38, s38, s21
s_xor_b32 s38, s38, s17
s_lshl_b32 s20, s27, 12
s_lshl_b32 s21, s26, 10
s_add_u32 s20, s20, s21
v_bfe_u32 v1, v0, 0, 6
v_lshlrev_b32 v253, 4, v1
v_add_u32 v253, s20, v253
s_lshl_b32 s35, s32, 20
s_lshl_b32 s21, s27, 12
s_add_u32 s35, s35, s21
s_add_u32 s35, s35, 37756928
s_and_b32 s21, s32, 1
s_lshl_b32 s21, s21, 14
s_xor_b32 s35, s35, s21
s_and_b32 s21, s32, 2
s_lshl_b32 s21, s21, 12
s_xor_b32 s35, s35, s21
s_xor_b32 s35, s35, s17
s_lshl_b32 s37, s32, 8
s_lshl_b32 s21, s12, 6
s_add_u32 s37, s37, s21
s_add_u32 s37, s37, s17
s_add_u32 s37, s37, 3948544
v_mov_b32 v250, 4284592614
v_cmp_le_u32 vcc, 32, v0
s_nop 1
v_cndmask_b32 v242, 0, v250, vcc
v_mov_b32 v246, 0x3f803f80
v_cndmask_b32 v243, 0, v250, vcc
v_mov_b32 v247, 0x3f803f80
v_cndmask_b32 v244, 0, v250, vcc
v_mov_b32 v248, 0x3f803f80
v_cndmask_b32 v245, 0, v250, vcc
v_mov_b32 v249, 0x3f803f80
v_lshrrev_b32 v1, 4, v0
v_lshlrev_b32 v1, 2, v1
v_and_b32 v251, 15, v0
v_sub_u32 v1, v251, v1
v_cmp_gt_i32 vcc, 0, v1
s_nop 1
v_cndmask_b32 v238, 0, v250, vcc
v_cmp_gt_i32 vcc, 1, v1
s_nop 1
v_cndmask_b32 v239, 0, v250, vcc
v_cmp_gt_i32 vcc, 2, v1
s_nop 1
v_cndmask_b32 v240, 0, v250, vcc
v_cmp_gt_i32 vcc, 3, v1
s_nop 1
v_cndmask_b32 v241, 0, v250, vcc
s_cmp_eq_u32 s16, 0
s_cselect_b32 s45, 63, 0x7f
s_cmp_eq_u32 s26, 1
s_cbranch_scc1 qa1_58
s_setprio 1
ds_read_b128 v[146:149], v175 offset:0
ds_read_b128 v[150:153], v175 offset:2048
ds_read_b128 v[154:157], v176 offset:0
ds_read_b128 v[158:161], v176 offset:2048
ds_read_b128 v[162:165], v175 offset:4096
ds_read_b128 v[166:169], v175 offset:6144
s_waitcnt lgkmcnt(5)
v_mfma_f32_16x16x32_bf16 v[130:133], v[2:5], v[146:149], 0
v_mfma_f32_16x16x32_bf16 v[134:137], v[6:9], v[146:149], 0
ds_read_b128 v[146:149], v176 offset:4096
s_waitcnt lgkmcnt(5)
v_mfma_f32_16x16x32_bf16 v[138:141], v[2:5], v[150:153], 0
v_mfma_f32_16x16x32_bf16 v[142:145], v[6:9], v[150:153], 0
ds_read_b128 v[150:153], v176 offset:6144
s_waitcnt lgkmcnt(5)
v_mfma_f32_16x16x32_bf16 v[130:133], v[34:37], v[154:157], v[130:133]
v_mfma_f32_16x16x32_bf16 v[134:137], v[38:41], v[154:157], v[134:137]
ds_read_b128 v[154:157], v175 offset:8192
s_waitcnt lgkmcnt(5)
v_mfma_f32_16x16x32_bf16 v[138:141], v[34:37], v[158:161], v[138:141]
v_mfma_f32_16x16x32_bf16 v[142:145], v[38:41], v[158:161], v[142:145]
ds_read_b128 v[158:161], v175 offset:10240
s_waitcnt lgkmcnt(5)
v_mfma_f32_16x16x32_bf16 v[130:133], v[66:69], v[162:165], v[130:133]
v_mfma_f32_16x16x32_bf16 v[134:137], v[70:73], v[162:165], v[134:137]
ds_read_b128 v[162:165], v176 offset:8192
s_waitcnt lgkmcnt(5)
v_mfma_f32_16x16x32_bf16 v[138:141], v[66:69], v[166:169], v[138:141]
v_mfma_f32_16x16x32_bf16 v[142:145], v[70:73], v[166:169], v[142:145]
ds_read_b128 v[166:169], v176 offset:10240
s_waitcnt lgkmcnt(5)
v_mfma_f32_16x16x32_bf16 v[130:133], v[98:101], v[146:149], v[130:133]
v_mfma_f32_16x16x32_bf16 v[134:137], v[102:105], v[146:149], v[134:137]
ds_read_b128 v[146:149], v175 offset:12288
s_waitcnt lgkmcnt(5)
v_mfma_f32_16x16x32_bf16 v[138:141], v[98:101], v[150:153], v[138:141]
v_mfma_f32_16x16x32_bf16 v[142:145], v[102:105], v[150:153], v[142:145]
ds_read_b128 v[150:153], v175 offset:14336
s_waitcnt lgkmcnt(5)
v_mfma_f32_16x16x32_bf16 v[130:133], v[10:13], v[154:157], v[130:133]
v_mfma_f32_16x16x32_bf16 v[134:137], v[14:17], v[154:157], v[134:137]
ds_read_b128 v[154:157], v176 offset:12288
s_waitcnt lgkmcnt(5)
v_mfma_f32_16x16x32_bf16 v[138:141], v[10:13], v[158:161], v[138:141]
v_mfma_f32_16x16x32_bf16 v[142:145], v[14:17], v[158:161], v[142:145]
ds_read_b128 v[158:161], v176 offset:14336
s_waitcnt lgkmcnt(5)
v_mfma_f32_16x16x32_bf16 v[130:133], v[42:45], v[162:165], v[130:133]
v_mfma_f32_16x16x32_bf16 v[134:137], v[46:49], v[162:165], v[134:137]
ds_read_b128 v[162:165], v175 offset:16384
s_waitcnt lgkmcnt(5)
v_mfma_f32_16x16x32_bf16 v[138:141], v[42:45], v[166:169], v[138:141]
v_mfma_f32_16x16x32_bf16 v[142:145], v[46:49], v[166:169], v[142:145]
ds_read_b128 v[166:169], v175 offset:18432
s_waitcnt lgkmcnt(5)
v_mfma_f32_16x16x32_bf16 v[130:133], v[74:77], v[146:149], v[130:133]
v_mfma_f32_16x16x32_bf16 v[134:137], v[78:81], v[146:149], v[134:137]
ds_read_b128 v[146:149], v176 offset:16384
s_waitcnt lgkmcnt(5)
v_mfma_f32_16x16x32_bf16 v[138:141], v[74:77], v[150:153], v[138:141]
v_mfma_f32_16x16x32_bf16 v[142:145], v[78:81], v[150:153], v[142:145]
ds_read_b128 v[150:153], v176 offset:18432
s_waitcnt lgkmcnt(5)
v_mfma_f32_16x16x32_bf16 v[130:133], v[106:109], v[154:157], v[130:133]
v_mfma_f32_16x16x32_bf16 v[134:137], v[110:113], v[154:157], v[134:137]
ds_read_b128 v[154:157], v175 offset:20480
s_waitcnt lgkmcnt(5)
v_mfma_f32_16x16x32_bf16 v[138:141], v[106:109], v[158:161], v[138:141]
v_mfma_f32_16x16x32_bf16 v[142:145], v[110:113], v[158:161], v[142:145]
ds_read_b128 v[158:161], v175 offset:22528
s_waitcnt lgkmcnt(5)
v_mfma_f32_16x16x32_bf16 v[130:133], v[18:21], v[162:165], v[130:133]
v_mfma_f32_16x16x32_bf16 v[134:137], v[22:25], v[162:165], v[134:137]
ds_read_b128 v[162:165], v176 offset:20480
s_waitcnt lgkmcnt(5)
v_mfma_f32_16x16x32_bf16 v[138:141], v[18:21], v[166:169], v[138:141]
v_mfma_f32_16x16x32_bf16 v[142:145], v[22:25], v[166:169], v[142:145]
ds_read_b128 v[166:169], v176 offset:22528
s_waitcnt lgkmcnt(5)
v_mfma_f32_16x16x32_bf16 v[130:133], v[50:53], v[146:149], v[130:133]
v_mfma_f32_16x16x32_bf16 v[134:137], v[54:57], v[146:149], v[134:137]
ds_read_b128 v[146:149], v175 offset:24576
s_waitcnt lgkmcnt(5)
v_mfma_f32_16x16x32_bf16 v[138:141], v[50:53], v[150:153], v[138:141]
v_mfma_f32_16x16x32_bf16 v[142:145], v[54:57], v[150:153], v[142:145]
ds_read_b128 v[150:153], v175 offset:26624
s_waitcnt lgkmcnt(5)
v_mfma_f32_16x16x32_bf16 v[130:133], v[82:85], v[154:157], v[130:133]
v_mfma_f32_16x16x32_bf16 v[134:137], v[86:89], v[154:157], v[134:137]
ds_read_b128 v[154:157], v176 offset:24576
s_waitcnt lgkmcnt(5)
v_mfma_f32_16x16x32_bf16 v[138:141], v[82:85], v[158:161], v[138:141]
v_mfma_f32_16x16x32_bf16 v[142:145], v[86:89], v[158:161], v[142:145]
ds_read_b128 v[158:161], v176 offset:26624
s_waitcnt lgkmcnt(5)
v_mfma_f32_16x16x32_bf16 v[130:133], v[114:117], v[162:165], v[130:133]
v_mfma_f32_16x16x32_bf16 v[134:137], v[118:121], v[162:165], v[134:137]
ds_read_b128 v[162:165], v175 offset:28672
s_waitcnt lgkmcnt(5)
v_mfma_f32_16x16x32_bf16 v[138:141], v[114:117], v[166:169], v[138:141]
v_mfma_f32_16x16x32_bf16 v[142:145], v[118:121], v[166:169], v[142:145]
ds_read_b128 v[166:169], v175 offset:30720
s_waitcnt lgkmcnt(5)
v_mfma_f32_16x16x32_bf16 v[130:133], v[26:29], v[146:149], v[130:133]
v_mfma_f32_16x16x32_bf16 v[134:137], v[30:33], v[146:149], v[134:137]
ds_read_b128 v[146:149], v176 offset:28672
s_waitcnt lgkmcnt(5)
v_mfma_f32_16x16x32_bf16 v[138:141], v[26:29], v[150:153], v[138:141]
v_mfma_f32_16x16x32_bf16 v[142:145], v[30:33], v[150:153], v[142:145]
ds_read_b128 v[150:153], v176 offset:30720
s_waitcnt lgkmcnt(5)
v_mfma_f32_16x16x32_bf16 v[130:133], v[58:61], v[154:157], v[130:133]
v_mfma_f32_16x16x32_bf16 v[134:137], v[62:65], v[154:157], v[134:137]
s_waitcnt lgkmcnt(4)
v_mfma_f32_16x16x32_bf16 v[138:141], v[58:61], v[158:161], v[138:141]
v_mfma_f32_16x16x32_bf16 v[142:145], v[62:65], v[158:161], v[142:145]
s_waitcnt lgkmcnt(3)
v_mfma_f32_16x16x32_bf16 v[130:133], v[90:93], v[162:165], v[130:133]
v_mfma_f32_16x16x32_bf16 v[134:137], v[94:97], v[162:165], v[134:137]
s_waitcnt lgkmcnt(2)
v_mfma_f32_16x16x32_bf16 v[138:141], v[90:93], v[166:169], v[138:141]
v_mfma_f32_16x16x32_bf16 v[142:145], v[94:97], v[166:169], v[142:145]
s_waitcnt lgkmcnt(1)
v_mfma_f32_16x16x32_bf16 v[130:133], v[122:125], v[146:149], v[130:133]
v_mfma_f32_16x16x32_bf16 v[134:137], v[126:129], v[146:149], v[134:137]
s_waitcnt lgkmcnt(0)
v_mfma_f32_16x16x32_bf16 v[138:141], v[122:125], v[150:153], v[138:141]
v_mfma_f32_16x16x32_bf16 v[142:145], v[126:129], v[150:153], v[142:145]
s_setprio 0
v_xor_b32 v175, 0x10000, v175
v_xor_b32 v176, 0x10000, v176
s_barrier
s_nop 6
v_cvt_pk_bf16_f32 v146, v130, v131
v_cvt_pk_bf16_f32 v147, v132, v133
v_cvt_pk_bf16_f32 v148, v134, v135
v_cvt_pk_bf16_f32 v149, v136, v137
v_cvt_pk_bf16_f32 v150, v138, v139
v_cvt_pk_bf16_f32 v151, v140, v141
v_cvt_pk_bf16_f32 v152, v142, v143
v_cvt_pk_bf16_f32 v153, v144, v145
ds_write_b128 v172, v[146:149]
ds_write_b128 v172, v[150:153] offset:1024
s_cmp_gt_u32 s40, s18
s_cbranch_scc0 pf_59
pf_60:
s_lshl_b32 s22, s18, 14
s_xor_b32 s22, s22, s35
buffer_load_dwordx4 v[210:213], v171, s[4:7], s22 offen offset:0 sc1
buffer_load_dwordx4 v[214:217], v171, s[4:7], s22 offen offset:1024 sc1
buffer_load_dwordx4 v[218:221], v171, s[4:7], s22 offen offset:2048 sc1
buffer_load_dwordx4 v[222:225], v171, s[4:7], s22 offen offset:3072 sc1
s_add_u32 s18, s18, 1
s_waitcnt lgkmcnt(0)
s_barrier
qal_61:
s_setprio 1
ds_read_b128 v[146:149], v175 offset:0
ds_read_b128 v[150:153], v175 offset:2048
ds_read_b128 v[154:157], v176 offset:0
ds_read_b128 v[158:161], v176 offset:2048
ds_read_b128 v[162:165], v175 offset:4096
ds_read_b128 v[166:169], v175 offset:6144
s_waitcnt lgkmcnt(5)
v_mfma_f32_16x16x32_bf16 v[130:133], v[2:5], v[146:149], 0
v_mfma_f32_16x16x32_bf16 v[134:137], v[6:9], v[146:149], 0
ds_read_b128 v[146:149], v176 offset:4096
s_waitcnt lgkmcnt(5)
v_mfma_f32_16x16x32_bf16 v[138:141], v[2:5], v[150:153], 0
v_mfma_f32_16x16x32_bf16 v[142:145], v[6:9], v[150:153], 0
ds_read_b128 v[150:153], v176 offset:6144
s_waitcnt lgkmcnt(5)
v_mfma_f32_16x16x32_bf16 v[130:133], v[34:37], v[154:157], v[130:133]
v_mfma_f32_16x16x32_bf16 v[134:137], v[38:41], v[154:157], v[134:137]
ds_read_b128 v[154:157], v175 offset:8192
s_waitcnt lgkmcnt(5)
v_mfma_f32_16x16x32_bf16 v[138:141], v[34:37], v[158:161], v[138:141]
v_mfma_f32_16x16x32_bf16 v[142:145], v[38:41], v[158:161], v[142:145]
ds_read_b128 v[158:161], v175 offset:10240
s_waitcnt lgkmcnt(5)
v_mfma_f32_16x16x32_bf16 v[130:133], v[66:69], v[162:165], v[130:133]
v_mfma_f32_16x16x32_bf16 v[134:137], v[70:73], v[162:165], v[134:137]
ds_read_b128 v[162:165], v176 offset:8192
s_waitcnt lgkmcnt(5)
v_mfma_f32_16x16x32_bf16 v[138:141], v[66:69], v[166:169], v[138:141]
v_mfma_f32_16x16x32_bf16 v[142:145], v[70:73], v[166:169], v[142:145]
ds_read_b128 v[166:169], v176 offset:10240
s_waitcnt lgkmcnt(5)
v_mfma_f32_16x16x32_bf16 v[130:133], v[98:101], v[146:149], v[130:133]
v_mfma_f32_16x16x32_bf16 v[134:137], v[102:105], v[146:149], v[134:137]
ds_read_b128 v[146:149], v175 offset:12288
s_waitcnt lgkmcnt(5)
v_mfma_f32_16x16x32_bf16 v[138:141], v[98:101], v[150:153], v[138:141]
v_mfma_f32_16x16x32_bf16 v[142:145], v[102:105], v[150:153], v[142:145]
ds_read_b128 v[150:153], v175 offset:14336
s_waitcnt lgkmcnt(5)
v_mfma_f32_16x16x32_bf16 v[130:133], v[10:13], v[154:157], v[130:133]
v_mfma_f32_16x16x32_bf16 v[134:137], v[14:17], v[154:157], v[134:137]
ds_read_b128 v[154:157], v176 offset:12288
s_waitcnt lgkmcnt(5)
v_mfma_f32_16x16x32_bf16 v[138:141], v[10:13], v[158:161], v[138:141]
v_mfma_f32_16x16x32_bf16 v[142:145], v[14:17], v[158:161], v[142:145]
ds_read_b128 v[158:161], v176 offset:14336
s_waitcnt lgkmcnt(5)
v_mfma_f32_16x16x32_bf16 v[130:133], v[42:45], v[162:165], v[130:133]
v_mfma_f32_16x16x32_bf16 v[134:137], v[46:49], v[162:165], v[134:137]
ds_read_b128 v[162:165], v175 offset:16384
s_waitcnt lgkmcnt(5)
v_mfma_f32_16x16x32_bf16 v[138:141], v[42:45], v[166:169], v[138:141]
v_mfma_f32_16x16x32_bf16 v[142:145], v[46:49], v[166:169], v[142:145]
ds_read_b128 v[166:169], v175 offset:18432
s_waitcnt lgkmcnt(5)
v_mfma_f32_16x16x32_bf16 v[130:133], v[74:77], v[146:149], v[130:133]
v_mfma_f32_16x16x32_bf16 v[134:137], v[78:81], v[146:149], v[134:137]
ds_read_b128 v[146:149], v176 offset:16384
s_waitcnt lgkmcnt(5)
v_mfma_f32_16x16x32_bf16 v[138:141], v[74:77], v[150:153], v[138:141]
v_mfma_f32_16x16x32_bf16 v[142:145], v[78:81], v[150:153], v[142:145]
ds_read_b128 v[150:153], v176 offset:18432
s_waitcnt lgkmcnt(5)
v_mfma_f32_16x16x32_bf16 v[130:133], v[106:109], v[154:157], v[130:133]
v_mfma_f32_16x16x32_bf16 v[134:137], v[110:113], v[154:157], v[134:137]
ds_read_b128 v[154:157], v175 offset:20480
s_waitcnt lgkmcnt(5)
v_mfma_f32_16x16x32_bf16 v[138:141], v[106:109], v[158:161], v[138:141]
v_mfma_f32_16x16x32_bf16 v[142:145], v[110:113], v[158:161], v[142:145]
ds_read_b128 v[158:161], v175 offset:22528
s_waitcnt lgkmcnt(5)
v_mfma_f32_16x16x32_bf16 v[130:133], v[18:21], v[162:165], v[130:133]
v_mfma_f32_16x16x32_bf16 v[134:137], v[22:25], v[162:165], v[134:137]
ds_read_b128 v[162:165], v176 offset:20480
s_waitcnt lgkmcnt(5)
v_mfma_f32_16x16x32_bf16 v[138:141], v[18:21], v[166:169], v[138:141]
v_mfma_f32_16x16x32_bf16 v[142:145], v[22:25], v[166:169], v[142:145]
ds_read_b128 v[166:169], v176 offset:22528
s_waitcnt lgkmcnt(5)
v_mfma_f32_16x16x32_bf16 v[130:133], v[50:53], v[146:149], v[130:133]
v_mfma_f32_16x16x32_bf16 v[134:137], v[54:57], v[146:149], v[134:137]
ds_read_b128 v[146:149], v175 offset:24576
s_waitcnt lgkmcnt(5)
v_mfma_f32_16x16x32_bf16 v[138:141], v[50:53], v[150:153], v[138:141]
v_mfma_f32_16x16x32_bf16 v[142:145], v[54:57], v[150:153], v[142:145]
ds_read_b128 v[150:153], v175 offset:26624
s_waitcnt lgkmcnt(5)
v_mfma_f32_16x16x32_bf16 v[130:133], v[82:85], v[154:157], v[130:133]
v_mfma_f32_16x16x32_bf16 v[134:137], v[86:89], v[154:157], v[134:137]
ds_read_b128 v[154:157], v176 offset:24576
s_waitcnt lgkmcnt(5)
v_mfma_f32_16x16x32_bf16 v[138:141], v[82:85], v[158:161], v[138:141]
v_mfma_f32_16x16x32_bf16 v[142:145], v[86:89], v[158:161], v[142:145]
ds_read_b128 v[158:161], v176 offset:26624
s_waitcnt lgkmcnt(5)
v_mfma_f32_16x16x32_bf16 v[130:133], v[114:117], v[162:165], v[130:133]
v_mfma_f32_16x16x32_bf16 v[134:137], v[118:121], v[162:165], v[134:137]
ds_read_b128 v[162:165], v175 offset:28672
s_waitcnt lgkmcnt(5)
v_mfma_f32_16x16x32_bf16 v[138:141], v[114:117], v[166:169], v[138:141]
v_mfma_f32_16x16x32_bf16 v[142:145], v[118:121], v[166:169], v[142:145]
ds_read_b128 v[166:169], v175 offset:30720
s_waitcnt lgkmcnt(5)
v_mfma_f32_16x16x32_bf16 v[130:133], v[26:29], v[146:149], v[130:133]
v_mfma_f32_16x16x32_bf16 v[134:137], v[30:33], v[146:149], v[134:137]
ds_read_b128 v[146:149], v176 offset:28672
s_waitcnt lgkmcnt(5)
v_mfma_f32_16x16x32_bf16 v[138:141], v[26:29], v[150:153], v[138:141]
v_mfma_f32_16x16x32_bf16 v[142:145], v[30:33], v[150:153], v[142:145]
ds_read_b128 v[150:153], v176 offset:30720
s_waitcnt lgkmcnt(5)
v_mfma_f32_16x16x32_bf16 v[130:133], v[58:61], v[154:157], v[130:133]
v_mfma_f32_16x16x32_bf16 v[134:137], v[62:65], v[154:157], v[134:137]
s_waitcnt lgkmcnt(4)
v_mfma_f32_16x16x32_bf16 v[138:141], v[58:61], v[158:161], v[138:141]
v_mfma_f32_16x16x32_bf16 v[142:145], v[62:65], v[158:161], v[142:145]
s_waitcnt lgkmcnt(3)
v_mfma_f32_16x16x32_bf16 v[130:133], v[90:93], v[162:165], v[130:133]
v_mfma_f32_16x16x32_bf16 v[134:137], v[94:97], v[162:165], v[134:137]
s_waitcnt lgkmcnt(2)
v_mfma_f32_16x16x32_bf16 v[138:141], v[90:93], v[166:169], v[138:141]
v_mfma_f32_16x16x32_bf16 v[142:145], v[94:97], v[166:169], v[142:145]
s_waitcnt lgkmcnt(1)
v_mfma_f32_16x16x32_bf16 v[130:133], v[122:125], v[146:149], v[130:133]
v_mfma_f32_16x16x32_bf16 v[134:137], v[126:129], v[146:149], v[134:137]
s_waitcnt lgkmcnt(0)
v_mfma_f32_16x16x32_bf16 v[138:141], v[122:125], v[150:153], v[138:141]
v_mfma_f32_16x16x32_bf16 v[142:145], v[126:129], v[150:153], v[142:145]
s_setprio 0
v_xor_b32 v175, 0x10000, v175
v_xor_b32 v176, 0x10000, v176
s_sub_u32 s20, s18, 1
v_mov_b32 v1, s20
s_waitcnt vmcnt(4)
s_sub_u32 s25, s18, 1
s_cmp_ge_i32 s25, s45
s_cbranch_scc1 ql_62
buffer_store_dword v1, v173, s[4:7], s37 offen sc1
ql_63:
s_barrier
s_nop 6
v_cvt_pk_bf16_f32 v146, v130, v131
v_cvt_pk_bf16_f32 v147, v132, v133
v_cvt_pk_bf16_f32 v148, v134, v135
v_cvt_pk_bf16_f32 v149, v136, v137
v_cvt_pk_bf16_f32 v150, v138, v139
v_cvt_pk_bf16_f32 v151, v140, v141
v_cvt_pk_bf16_f32 v152, v142, v143
v_cvt_pk_bf16_f32 v153, v144, v145
ds_write_b128 v172, v[146:149]
ds_write_b128 v172, v[150:153] offset:1024
ds_read_b128 v[130:133], v174 offset:0
ds_read_b128 v[178:181], v174 offset:8192
ds_read_b128 v[146:149], v177 offset:0
ds_read_b128 v[134:137], v174 offset:1024
ds_read_b128 v[182:185], v174 offset:9216
ds_read_b128 v[150:153], v177 offset:512
ds_read_b128 v[138:141], v174 offset:2048
ds_read_b128 v[186:189], v174 offset:10240
ds_read_b128 v[154:157], v177 offset:1024
ds_read_b128 v[142:145], v174 offset:3072
ds_read_b128 v[190:193], v174 offset:11264
ds_read_b128 v[158:161], v177 offset:1536
s_setprio 3
s_waitcnt lgkmcnt(9)
v_mfma_f32_16x16x32_bf16 v[226:229], v[178:181], v[130:133], v[238:241]
ds_read_b128 v[162:165], v252 offset:0
ds_read_b128 v[166:169], v252 offset:512
v_mfma_f32_16x16x32_bf16 v[234:237], v[146:149], v[130:133], v[242:245]
s_waitcnt lgkmcnt(8)
v_mfma_f32_16x16x32_bf16 v[226:229], v[182:185], v[134:137], v[226:229]
v_mfma_f32_16x16x32_bf16 v[234:237], v[150:153], v[134:137], v[234:237]
s_waitcnt lgkmcnt(5)
v_mfma_f32_16x16x32_bf16 v[226:229], v[186:189], v[138:141], v[226:229]
v_mfma_f32_16x16x32_bf16 v[234:237], v[154:157], v[138:141], v[234:237]
s_waitcnt lgkmcnt(2)
v_mfma_f32_16x16x32_bf16 v[226:229], v[190:193], v[142:145], v[226:229]
v_mfma_f32_16x16x32_bf16 v[234:237], v[158:161], v[142:145], v[234:237]
s_setprio 0
s_nop 7
v_max3_f32 v170, v234, v235, v236
v_max3_f32 v170, v170, v237, v226
v_max3_f32 v1, v227, v228, v229
v_max_f32 v170, v170, v1
v_max_f32 v1, v170, v1
s_nop 1
v_permlane32_swap_b32 v170, v1
v_max_f32 v250, v170, v1
v_max_f32 v251, v170, v1
s_nop 1
v_permlane16_swap_b32 v250, v251
v_max_f32 v170, v250, v251
v_mul_f32 v170, s42, v170
v_fma_f32 v226, v226, s42, -v170
v_fma_f32 v227, v227, s42, -v170
v_fma_f32 v228, v228, s42, -v170
v_fma_f32 v229, v229, s42, -v170
v_fma_f32 v234, v234, s42, -v170
v_fma_f32 v235, v235, s42, -v170
v_fma_f32 v236, v236, s42, -v170
v_fma_f32 v237, v237, s42, -v170
v_exp_f32 v226, v226
v_exp_f32 v227, v227
v_exp_f32 v228, v228
v_exp_f32 v229, v229
v_exp_f32 v234, v234
v_exp_f32 v235, v235
v_exp_f32 v236, v236
v_exp_f32 v237, v237
v_cvt_pk_bf16_f32 v194, v226, v227
v_cvt_pk_bf16_f32 v195, v228, v229
v_mov_b32 v196, 0
v_mov_b32 v197, 0
v_cvt_pk_bf16_f32 v250, v234, v235
v_cvt_pk_bf16_f32 v251, v236, v237
s_waitcnt vmcnt(1) lgkmcnt(0)
s_setprio 3
v_mfma_f32_16x16x32_bf16 v[198:201], v[246:249], v[194:197], 0
v_mfma_f32_16x16x32_bf16 v[178:181], v[210:213], v[194:197], 0
v_mfma_f32_16x16x32_bf16 v[182:185], v[214:217], v[194:197], 0
v_mfma_f32_16x16x32_bf16 v[186:189], v[218:221], v[194:197], 0
v_mfma_f32_16x16x32_bf16 v[190:193], v[222:225], v[194:197], 0
s_nop 1
v_mfma_f32_16x16x16_bf16 v[198:201], v[246:247], v[250:251], v[198:201]
v_mfma_f32_16x16x16_bf16 v[178:181], v[162:163], v[250:251], v[178:181]
v_mfma_f32_16x16x16_bf16 v[182:185], v[164:165], v[250:251], v[182:185]
v_mfma_f32_16x16x16_bf16 v[186:189], v[166:167], v[250:251], v[186:189]
v_mfma_f32_16x16x16_bf16 v[190:193], v[168:169], v[250:251], v[190:193]
s_setprio 0
s_sub_u32 s22, s18, 1
s_lshl_b32 s22, s22, 14
s_xor_b32 s22, s22, s38
v_rcp_f32 v170, v198
s_nop 1
v_mul_f32 v178, v178, v170
v_mul_f32 v179, v179, v170
v_mul_f32 v180, v180, v170
v_mul_f32 v181, v181, v170
v_mul_f32 v182, v182, v170
v_mul_f32 v183, v183, v170
v_mul_f32 v184, v184, v170
v_mul_f32 v185, v185, v170
v_mul_f32 v186, v186, v170
v_mul_f32 v187, v187, v170
v_mul_f32 v188, v188, v170
v_mul_f32 v189, v189, v170
v_mul_f32 v190, v190, v170
v_mul_f32 v191, v191, v170
v_mul_f32 v192, v192, v170
v_mul_f32 v193, v193, v170
v_cvt_pk_bf16_f32 v202, v178, v179
v_cvt_pk_bf16_f32 v203, v180, v181
v_cvt_pk_bf16_f32 v204, v182, v183
v_cvt_pk_bf16_f32 v205, v184, v185
v_cvt_pk_bf16_f32 v206, v186, v187
v_cvt_pk_bf16_f32 v207, v188, v189
v_cvt_pk_bf16_f32 v208, v190, v191
v_cvt_pk_bf16_f32 v209, v192, v193
s_sub_u32 s25, s18, 0
s_cmp_ge_i32 s25, s45
s_cbranch_scc1 ql_64
buffer_store_dwordx4 v[202:205], v253, s[4:7], s22 offen sc1
buffer_store_dwordx4 v[206:209], v253, s[4:7], s22 offen offset:2048 sc1
ql_65:
s_cmp_gt_u32 s40, s18
s_cbranch_scc0 pf_66
pf_67:
s_lshl_b32 s22, s18, 14
s_xor_b32 s22, s22, s35
buffer_load_dwordx4 v[210:213], v171, s[4:7], s22 offen offset:0 sc1
buffer_load_dwordx4 v[214:217], v171, s[4:7], s22 offen offset:1024 sc1
buffer_load_dwordx4 v[218:221], v171, s[4:7], s22 offen offset:2048 sc1
buffer_load_dwordx4 v[222:225], v171, s[4:7], s22 offen offset:3072 sc1
s_add_u32 s18, s18, 1
s_cmp_lt_u32 s18, 64
s_barrier
s_cbranch_scc1 qal_61
s_sub_u32 s20, s18, 1
v_mov_b32 v1, s20
s_waitcnt vmcnt(4)
s_sub_u32 s25, s18, 1
s_cmp_ge_i32 s25, s45
s_cbranch_scc1 ql_68
buffer_store_dword v1, v173, s[4:7], s37 offen sc1
ql_69:
s_barrier
ds_read_b128 v[130:133], v174 offset:0
ds_read_b128 v[178:181], v174 offset:8192
ds_read_b128 v[134:137], v174 offset:1024
ds_read_b128 v[182:185], v174 offset:9216
ds_read_b128 v[138:141], v174 offset:2048
ds_read_b128 v[186:189], v174 offset:10240
ds_read_b128 v[142:145], v174 offset:3072
ds_read_b128 v[190:193], v174 offset:11264
s_waitcnt lgkmcnt(0)
v_mfma_f32_16x16x32_bf16 v[226:229], v[178:181], v[130:133], v[238:241]
v_mfma_f32_16x16x32_bf16 v[226:229], v[182:185], v[134:137], v[226:229]
v_mfma_f32_16x16x32_bf16 v[226:229], v[186:189], v[138:141], v[226:229]
v_mfma_f32_16x16x32_bf16 v[226:229], v[190:193], v[142:145], v[226:229]
s_barrier
ds_read_b128 v[146:149], v177 offset:0
ds_read_b128 v[150:153], v177 offset:512
ds_read_b128 v[154:157], v177 offset:1024
ds_read_b128 v[158:161], v177 offset:1536
ds_read_b128 v[162:165], v252
ds_read_b128 v[166:169], v252 offset:512
s_waitcnt lgkmcnt(5)
v_mfma_f32_16x16x32_bf16 v[234:237], v[146:149], v[130:133], v[242:245]
s_waitcnt lgkmcnt(4)
v_mfma_f32_16x16x32_bf16 v[234:237], v[150:153], v[134:137], v[234:237]
s_waitcnt lgkmcnt(3)
v_mfma_f32_16x16x32_bf16 v[234:237], v[154:157], v[138:141], v[234:237]
s_waitcnt lgkmcnt(2)
v_mfma_f32_16x16x32_bf16 v[234:237], v[158:161], v[142:145], v[234:237]
s_setprio 0
s_nop 7
v_max3_f32 v170, v234, v235, v236
v_max3_f32 v170, v170, v237, v226
v_max3_f32 v1, v227, v228, v229
v_max_f32 v170, v170, v1
v_max_f32 v1, v170, v1
s_nop 1
v_permlane32_swap_b32 v170, v1
v_max_f32 v250, v170, v1
v_max_f32 v251, v170, v1
s_nop 1
v_permlane16_swap_b32 v250, v251
v_max_f32 v170, v250, v251
v_mul_f32 v170, s42, v170
v_fma_f32 v226, v226, s42, -v170
v_fma_f32 v227, v227, s42, -v170
v_fma_f32 v228, v228, s42, -v170
v_fma_f32 v229, v229, s42, -v170
v_fma_f32 v234, v234, s42, -v170
v_fma_f32 v235, v235, s42, -v170
v_fma_f32 v236, v236, s42, -v170
v_fma_f32 v237, v237, s42, -v170
v_exp_f32 v226, v226
v_exp_f32 v227, v227
v_exp_f32 v228, v228
v_exp_f32 v229, v229
v_exp_f32 v234, v234
v_exp_f32 v235, v235
v_exp_f32 v236, v236
v_exp_f32 v237, v237
v_cvt_pk_bf16_f32 v194, v226, v227
v_cvt_pk_bf16_f32 v195, v228, v229
v_mov_b32 v196, 0
v_mov_b32 v197, 0
v_cvt_pk_bf16_f32 v250, v234, v235
v_cvt_pk_bf16_f32 v251, v236, v237
s_waitcnt vmcnt(1) lgkmcnt(0)
s_setprio 3
v_mfma_f32_16x16x32_bf16 v[198:201], v[246:249], v[194:197], 0
v_mfma_f32_16x16x32_bf16 v[178:181], v[210:213], v[194:197], 0
v_mfma_f32_16x16x32_bf16 v[182:185], v[214:217], v[194:197], 0
v_mfma_f32_16x16x32_bf16 v[186:189], v[218:221], v[194:197], 0
v_mfma_f32_16x16x32_bf16 v[190:193], v[222:225], v[194:197], 0
s_nop 1
v_mfma_f32_16x16x16_bf16 v[198:201], v[246:247], v[250:251], v[198:201]
v_mfma_f32_16x16x16_bf16 v[178:181], v[162:163], v[250:251], v[178:181]
v_mfma_f32_16x16x16_bf16 v[182:185], v[164:165], v[250:251], v[182:185]
v_mfma_f32_16x16x16_bf16 v[186:189], v[166:167], v[250:251], v[186:189]
v_mfma_f32_16x16x16_bf16 v[190:193], v[168:169], v[250:251], v[190:193]
s_setprio 0
s_sub_u32 s22, s18, 1
s_lshl_b32 s22, s22, 14
s_xor_b32 s22, s22, s38
v_rcp_f32 v170, v198
s_nop 1
v_mul_f32 v178, v178, v170
v_mul_f32 v179, v179, v170
v_mul_f32 v180, v180, v170
v_mul_f32 v181, v181, v170
v_mul_f32 v182, v182, v170
v_mul_f32 v183, v183, v170
v_mul_f32 v184, v184, v170
v_mul_f32 v185, v185, v170
v_mul_f32 v186, v186, v170
v_mul_f32 v187, v187, v170
v_mul_f32 v188, v188, v170
v_mul_f32 v189, v189, v170
v_mul_f32 v190, v190, v170
v_mul_f32 v191, v191, v170
v_mul_f32 v192, v192, v170
v_mul_f32 v193, v193, v170
v_cvt_pk_bf16_f32 v202, v178, v179
v_cvt_pk_bf16_f32 v203, v180, v181
v_cvt_pk_bf16_f32 v204, v182, v183
v_cvt_pk_bf16_f32 v205, v184, v185
v_cvt_pk_bf16_f32 v206, v186, v187
v_cvt_pk_bf16_f32 v207, v188, v189
v_cvt_pk_bf16_f32 v208, v190, v191
v_cvt_pk_bf16_f32 v209, v192, v193
s_sub_u32 s25, s18, 0
s_cmp_ge_i32 s25, s45
s_cbranch_scc1 ql_70
buffer_store_dwordx4 v[202:205], v253, s[4:7], s22 offen sc1
buffer_store_dwordx4 v[206:209], v253, s[4:7], s22 offen offset:2048 sc1
ql_71:
s_add_u32 s18, s18, 1
s_sub_u32 s20, s18, 1
v_mov_b32 v1, s20
s_waitcnt vmcnt(0)
s_sub_u32 s25, s18, 1
s_cmp_ge_i32 s25, s45
s_cbranch_scc1 ql_72
buffer_store_dword v1, v173, s[4:7], s37 offen sc1
ql_73:
s_branch L_end
qa1_58:
s_setprio 1
ds_read_b128 v[146:149], v175 offset:0
ds_read_b128 v[150:153], v175 offset:2048
ds_read_b128 v[154:157], v176 offset:0
ds_read_b128 v[158:161], v176 offset:2048
ds_read_b128 v[162:165], v175 offset:4096
ds_read_b128 v[166:169], v175 offset:6144
s_waitcnt lgkmcnt(5)
v_mfma_f32_16x16x32_bf16 v[130:133], v[2:5], v[146:149], 0
v_mfma_f32_16x16x32_bf16 v[134:137], v[6:9], v[146:149], 0
ds_read_b128 v[146:149], v176 offset:4096
s_waitcnt lgkmcnt(5)
v_mfma_f32_16x16x32_bf16 v[138:141], v[2:5], v[150:153], 0
v_mfma_f32_16x16x32_bf16 v[142:145], v[6:9], v[150:153], 0
ds_read_b128 v[150:153], v176 offset:6144
s_waitcnt lgkmcnt(5)
v_mfma_f32_16x16x32_bf16 v[130:133], v[34:37], v[154:157], v[130:133]
v_mfma_f32_16x16x32_bf16 v[134:137], v[38:41], v[154:157], v[134:137]
ds_read_b128 v[154:157], v175 offset:8192
s_waitcnt lgkmcnt(5)
v_mfma_f32_16x16x32_bf16 v[138:141], v[34:37], v[158:161], v[138:141]
v_mfma_f32_16x16x32_bf16 v[142:145], v[38:41], v[158:161], v[142:145]
ds_read_b128 v[158:161], v175 offset:10240
s_waitcnt lgkmcnt(5)
v_mfma_f32_16x16x32_bf16 v[130:133], v[66:69], v[162:165], v[130:133]
v_mfma_f32_16x16x32_bf16 v[134:137], v[70:73], v[162:165], v[134:137]
ds_read_b128 v[162:165], v176 offset:8192
s_waitcnt lgkmcnt(5)
v_mfma_f32_16x16x32_bf16 v[138:141], v[66:69], v[166:169], v[138:141]
v_mfma_f32_16x16x32_bf16 v[142:145], v[70:73], v[166:169], v[142:145]
ds_read_b128 v[166:169], v176 offset:10240
s_waitcnt lgkmcnt(5)
v_mfma_f32_16x16x32_bf16 v[130:133], v[98:101], v[146:149], v[130:133]
v_mfma_f32_16x16x32_bf16 v[134:137], v[102:105], v[146:149], v[134:137]
ds_read_b128 v[146:149], v175 offset:12288
s_waitcnt lgkmcnt(5)
v_mfma_f32_16x16x32_bf16 v[138:141], v[98:101], v[150:153], v[138:141]
v_mfma_f32_16x16x32_bf16 v[142:145], v[102:105], v[150:153], v[142:145]
ds_read_b128 v[150:153], v175 offset:14336
s_waitcnt lgkmcnt(5)
v_mfma_f32_16x16x32_bf16 v[130:133], v[10:13], v[154:157], v[130:133]
v_mfma_f32_16x16x32_bf16 v[134:137], v[14:17], v[154:157], v[134:137]
ds_read_b128 v[154:157], v176 offset:12288
s_waitcnt lgkmcnt(5)
v_mfma_f32_16x16x32_bf16 v[138:141], v[10:13], v[158:161], v[138:141]
v_mfma_f32_16x16x32_bf16 v[142:145], v[14:17], v[158:161], v[142:145]
ds_read_b128 v[158:161], v176 offset:14336
s_waitcnt lgkmcnt(5)
v_mfma_f32_16x16x32_bf16 v[130:133], v[42:45], v[162:165], v[130:133]
v_mfma_f32_16x16x32_bf16 v[134:137], v[46:49], v[162:165], v[134:137]
ds_read_b128 v[162:165], v175 offset:16384
s_waitcnt lgkmcnt(5)
v_mfma_f32_16x16x32_bf16 v[138:141], v[42:45], v[166:169], v[138:141]
v_mfma_f32_16x16x32_bf16 v[142:145], v[46:49], v[166:169], v[142:145]
ds_read_b128 v[166:169], v175 offset:18432
s_waitcnt lgkmcnt(5)
v_mfma_f32_16x16x32_bf16 v[130:133], v[74:77], v[146:149], v[130:133]
v_mfma_f32_16x16x32_bf16 v[134:137], v[78:81], v[146:149], v[134:137]
ds_read_b128 v[146:149], v176 offset:16384
s_waitcnt lgkmcnt(5)
v_mfma_f32_16x16x32_bf16 v[138:141], v[74:77], v[150:153], v[138:141]
v_mfma_f32_16x16x32_bf16 v[142:145], v[78:81], v[150:153], v[142:145]
ds_read_b128 v[150:153], v176 offset:18432
s_waitcnt lgkmcnt(5)
v_mfma_f32_16x16x32_bf16 v[130:133], v[106:109], v[154:157], v[130:133]
v_mfma_f32_16x16x32_bf16 v[134:137], v[110:113], v[154:157], v[134:137]
ds_read_b128 v[154:157], v175 offset:20480
s_waitcnt lgkmcnt(5)
v_mfma_f32_16x16x32_bf16 v[138:141], v[106:109], v[158:161], v[138:141]
v_mfma_f32_16x16x32_bf16 v[142:145], v[110:113], v[158:161], v[142:145]
ds_read_b128 v[158:161], v175 offset:22528
s_waitcnt lgkmcnt(5)
v_mfma_f32_16x16x32_bf16 v[130:133], v[18:21], v[162:165], v[130:133]
v_mfma_f32_16x16x32_bf16 v[134:137], v[22:25], v[162:165], v[134:137]
ds_read_b128 v[162:165], v176 offset:20480
s_waitcnt lgkmcnt(5)
v_mfma_f32_16x16x32_bf16 v[138:141], v[18:21], v[166:169], v[138:141]
v_mfma_f32_16x16x32_bf16 v[142:145], v[22:25], v[166:169], v[142:145]
ds_read_b128 v[166:169], v176 offset:22528
s_waitcnt lgkmcnt(5)
v_mfma_f32_16x16x32_bf16 v[130:133], v[50:53], v[146:149], v[130:133]
v_mfma_f32_16x16x32_bf16 v[134:137], v[54:57], v[146:149], v[134:137]
ds_read_b128 v[146:149], v175 offset:24576
s_waitcnt lgkmcnt(5)
v_mfma_f32_16x16x32_bf16 v[138:141], v[50:53], v[150:153], v[138:141]
v_mfma_f32_16x16x32_bf16 v[142:145], v[54:57], v[150:153], v[142:145]
ds_read_b128 v[150:153], v175 offset:26624
s_waitcnt lgkmcnt(5)
v_mfma_f32_16x16x32_bf16 v[130:133], v[82:85], v[154:157], v[130:133]
v_mfma_f32_16x16x32_bf16 v[134:137], v[86:89], v[154:157], v[134:137]
ds_read_b128 v[154:157], v176 offset:24576
s_waitcnt lgkmcnt(5)
v_mfma_f32_16x16x32_bf16 v[138:141], v[82:85], v[158:161], v[138:141]
v_mfma_f32_16x16x32_bf16 v[142:145], v[86:89], v[158:161], v[142:145]
ds_read_b128 v[158:161], v176 offset:26624
s_waitcnt lgkmcnt(5)
v_mfma_f32_16x16x32_bf16 v[130:133], v[114:117], v[162:165], v[130:133]
v_mfma_f32_16x16x32_bf16 v[134:137], v[118:121], v[162:165], v[134:137]
ds_read_b128 v[162:165], v175 offset:28672
s_waitcnt lgkmcnt(5)
v_mfma_f32_16x16x32_bf16 v[138:141], v[114:117], v[166:169], v[138:141]
v_mfma_f32_16x16x32_bf16 v[142:145], v[118:121], v[166:169], v[142:145]
ds_read_b128 v[166:169], v175 offset:30720
s_waitcnt lgkmcnt(5)
v_mfma_f32_16x16x32_bf16 v[130:133], v[26:29], v[146:149], v[130:133]
v_mfma_f32_16x16x32_bf16 v[134:137], v[30:33], v[146:149], v[134:137]
ds_read_b128 v[146:149], v176 offset:28672
s_waitcnt lgkmcnt(5)
v_mfma_f32_16x16x32_bf16 v[138:141], v[26:29], v[150:153], v[138:141]
v_mfma_f32_16x16x32_bf16 v[142:145], v[30:33], v[150:153], v[142:145]
ds_read_b128 v[150:153], v176 offset:30720
s_waitcnt lgkmcnt(5)
v_mfma_f32_16x16x32_bf16 v[130:133], v[58:61], v[154:157], v[130:133]
v_mfma_f32_16x16x32_bf16 v[134:137], v[62:65], v[154:157], v[134:137]
s_waitcnt lgkmcnt(4)
v_mfma_f32_16x16x32_bf16 v[138:141], v[58:61], v[158:161], v[138:141]
v_mfma_f32_16x16x32_bf16 v[142:145], v[62:65], v[158:161], v[142:145]
s_waitcnt lgkmcnt(3)
v_mfma_f32_16x16x32_bf16 v[130:133], v[90:93], v[162:165], v[130:133]
v_mfma_f32_16x16x32_bf16 v[134:137], v[94:97], v[162:165], v[134:137]
s_waitcnt lgkmcnt(2)
v_mfma_f32_16x16x32_bf16 v[138:141], v[90:93], v[166:169], v[138:141]
v_mfma_f32_16x16x32_bf16 v[142:145], v[94:97], v[166:169], v[142:145]
s_waitcnt lgkmcnt(1)
v_mfma_f32_16x16x32_bf16 v[130:133], v[122:125], v[146:149], v[130:133]
v_mfma_f32_16x16x32_bf16 v[134:137], v[126:129], v[146:149], v[134:137]
s_waitcnt lgkmcnt(0)
v_mfma_f32_16x16x32_bf16 v[138:141], v[122:125], v[150:153], v[138:141]
v_mfma_f32_16x16x32_bf16 v[142:145], v[126:129], v[150:153], v[142:145]
s_setprio 0
v_xor_b32 v175, 0x10000, v175
v_xor_b32 v176, 0x10000, v176
s_barrier
s_nop 6
v_cvt_pk_bf16_f32 v146, v130, v131
v_cvt_pk_bf16_f32 v147, v132, v133
v_cvt_pk_bf16_f32 v148, v134, v135
v_cvt_pk_bf16_f32 v149, v136, v137
v_cvt_pk_bf16_f32 v150, v138, v139
v_cvt_pk_bf16_f32 v151, v140, v141
v_cvt_pk_bf16_f32 v152, v142, v143
v_cvt_pk_bf16_f32 v153, v144, v145
ds_write_b128 v172, v[146:149]
ds_write_b128 v172, v[150:153] offset:1024
s_cmp_gt_u32 s40, s18
s_cbranch_scc0 pf_74
pf_75:
s_lshl_b32 s22, s18, 14
s_xor_b32 s22, s22, s35
buffer_load_dwordx4 v[210:213], v171, s[4:7], s22 offen offset:0 sc1
buffer_load_dwordx4 v[214:217], v171, s[4:7], s22 offen offset:1024 sc1
buffer_load_dwordx4 v[218:221], v171, s[4:7], s22 offen offset:2048 sc1
buffer_load_dwordx4 v[222:225], v171, s[4:7], s22 offen offset:3072 sc1
s_add_u32 s18, s18, 1
s_waitcnt lgkmcnt(0)
s_barrier
qal_76:
s_setprio 1
ds_read_b128 v[146:149], v175 offset:0
ds_read_b128 v[150:153], v175 offset:2048
ds_read_b128 v[154:157], v176 offset:0
ds_read_b128 v[158:161], v176 offset:2048
ds_read_b128 v[162:165], v175 offset:4096
ds_read_b128 v[166:169], v175 offset:6144
s_waitcnt lgkmcnt(5)
v_mfma_f32_16x16x32_bf16 v[130:133], v[2:5], v[146:149], 0
v_mfma_f32_16x16x32_bf16 v[134:137], v[6:9], v[146:149], 0
ds_read_b128 v[146:149], v176 offset:4096
s_waitcnt lgkmcnt(5)
v_mfma_f32_16x16x32_bf16 v[138:141], v[2:5], v[150:153], 0
v_mfma_f32_16x16x32_bf16 v[142:145], v[6:9], v[150:153], 0
ds_read_b128 v[150:153], v176 offset:6144
s_waitcnt lgkmcnt(5)
v_mfma_f32_16x16x32_bf16 v[130:133], v[34:37], v[154:157], v[130:133]
v_mfma_f32_16x16x32_bf16 v[134:137], v[38:41], v[154:157], v[134:137]
ds_read_b128 v[154:157], v175 offset:8192
s_waitcnt lgkmcnt(5)
v_mfma_f32_16x16x32_bf16 v[138:141], v[34:37], v[158:161], v[138:141]
v_mfma_f32_16x16x32_bf16 v[142:145], v[38:41], v[158:161], v[142:145]
ds_read_b128 v[158:161], v175 offset:10240
s_waitcnt lgkmcnt(5)
v_mfma_f32_16x16x32_bf16 v[130:133], v[66:69], v[162:165], v[130:133]
v_mfma_f32_16x16x32_bf16 v[134:137], v[70:73], v[162:165], v[134:137]
ds_read_b128 v[162:165], v176 offset:8192
s_waitcnt lgkmcnt(5)
v_mfma_f32_16x16x32_bf16 v[138:141], v[66:69], v[166:169], v[138:141]
v_mfma_f32_16x16x32_bf16 v[142:145], v[70:73], v[166:169], v[142:145]
ds_read_b128 v[166:169], v176 offset:10240
s_waitcnt lgkmcnt(5)
v_mfma_f32_16x16x32_bf16 v[130:133], v[98:101], v[146:149], v[130:133]
v_mfma_f32_16x16x32_bf16 v[134:137], v[102:105], v[146:149], v[134:137]
ds_read_b128 v[146:149], v175 offset:12288
s_waitcnt lgkmcnt(5)
v_mfma_f32_16x16x32_bf16 v[138:141], v[98:101], v[150:153], v[138:141]
v_mfma_f32_16x16x32_bf16 v[142:145], v[102:105], v[150:153], v[142:145]
ds_read_b128 v[150:153], v175 offset:14336
s_waitcnt lgkmcnt(5)
v_mfma_f32_16x16x32_bf16 v[130:133], v[10:13], v[154:157], v[130:133]
v_mfma_f32_16x16x32_bf16 v[134:137], v[14:17], v[154:157], v[134:137]
ds_read_b128 v[154:157], v176 offset:12288
s_waitcnt lgkmcnt(5)
v_mfma_f32_16x16x32_bf16 v[138:141], v[10:13], v[158:161], v[138:141]
v_mfma_f32_16x16x32_bf16 v[142:145], v[14:17], v[158:161], v[142:145]
ds_read_b128 v[158:161], v176 offset:14336
s_waitcnt lgkmcnt(5)
v_mfma_f32_16x16x32_bf16 v[130:133], v[42:45], v[162:165], v[130:133]
v_mfma_f32_16x16x32_bf16 v[134:137], v[46:49], v[162:165], v[134:137]
ds_read_b128 v[162:165], v175 offset:16384
s_waitcnt lgkmcnt(5)
v_mfma_f32_16x16x32_bf16 v[138:141], v[42:45], v[166:169], v[138:141]
v_mfma_f32_16x16x32_bf16 v[142:145], v[46:49], v[166:169], v[142:145]
ds_read_b128 v[166:169], v175 offset:18432
s_waitcnt lgkmcnt(5)
v_mfma_f32_16x16x32_bf16 v[130:133], v[74:77], v[146:149], v[130:133]
v_mfma_f32_16x16x32_bf16 v[134:137], v[78:81], v[146:149], v[134:137]
ds_read_b128 v[146:149], v176 offset:16384
s_waitcnt lgkmcnt(5)
v_mfma_f32_16x16x32_bf16 v[138:141], v[74:77], v[150:153], v[138:141]
v_mfma_f32_16x16x32_bf16 v[142:145], v[78:81], v[150:153], v[142:145]
ds_read_b128 v[150:153], v176 offset:18432
s_waitcnt lgkmcnt(5)
v_mfma_f32_16x16x32_bf16 v[130:133], v[106:109], v[154:157], v[130:133]
v_mfma_f32_16x16x32_bf16 v[134:137], v[110:113], v[154:157], v[134:137]
ds_read_b128 v[154:157], v175 offset:20480
s_waitcnt lgkmcnt(5)
v_mfma_f32_16x16x32_bf16 v[138:141], v[106:109], v[158:161], v[138:141]
v_mfma_f32_16x16x32_bf16 v[142:145], v[110:113], v[158:161], v[142:145]
ds_read_b128 v[158:161], v175 offset:22528
s_waitcnt lgkmcnt(5)
v_mfma_f32_16x16x32_bf16 v[130:133], v[18:21], v[162:165], v[130:133]
v_mfma_f32_16x16x32_bf16 v[134:137], v[22:25], v[162:165], v[134:137]
ds_read_b128 v[162:165], v176 offset:20480
s_waitcnt lgkmcnt(5)
v_mfma_f32_16x16x32_bf16 v[138:141], v[18:21], v[166:169], v[138:141]
v_mfma_f32_16x16x32_bf16 v[142:145], v[22:25], v[166:169], v[142:145]
ds_read_b128 v[166:169], v176 offset:22528
s_waitcnt lgkmcnt(5)
v_mfma_f32_16x16x32_bf16 v[130:133], v[50:53], v[146:149], v[130:133]
v_mfma_f32_16x16x32_bf16 v[134:137], v[54:57], v[146:149], v[134:137]
ds_read_b128 v[146:149], v175 offset:24576
s_waitcnt lgkmcnt(5)
v_mfma_f32_16x16x32_bf16 v[138:141], v[50:53], v[150:153], v[138:141]
v_mfma_f32_16x16x32_bf16 v[142:145], v[54:57], v[150:153], v[142:145]
ds_read_b128 v[150:153], v175 offset:26624
s_waitcnt lgkmcnt(5)
v_mfma_f32_16x16x32_bf16 v[130:133], v[82:85], v[154:157], v[130:133]
v_mfma_f32_16x16x32_bf16 v[134:137], v[86:89], v[154:157], v[134:137]
ds_read_b128 v[154:157], v176 offset:24576
s_waitcnt lgkmcnt(5)
v_mfma_f32_16x16x32_bf16 v[138:141], v[82:85], v[158:161], v[138:141]
v_mfma_f32_16x16x32_bf16 v[142:145], v[86:89], v[158:161], v[142:145]
ds_read_b128 v[158:161], v176 offset:26624
s_waitcnt lgkmcnt(5)
v_mfma_f32_16x16x32_bf16 v[130:133], v[114:117], v[162:165], v[130:133]
v_mfma_f32_16x16x32_bf16 v[134:137], v[118:121], v[162:165], v[134:137]
ds_read_b128 v[162:165], v175 offset:28672
s_waitcnt lgkmcnt(5)
v_mfma_f32_16x16x32_bf16 v[138:141], v[114:117], v[166:169], v[138:141]
v_mfma_f32_16x16x32_bf16 v[142:145], v[118:121], v[166:169], v[142:145]
ds_read_b128 v[166:169], v175 offset:30720
s_waitcnt lgkmcnt(5)
v_mfma_f32_16x16x32_bf16 v[130:133], v[26:29], v[146:149], v[130:133]
v_mfma_f32_16x16x32_bf16 v[134:137], v[30:33], v[146:149], v[134:137]
ds_read_b128 v[146:149], v176 offset:28672
s_waitcnt lgkmcnt(5)
v_mfma_f32_16x16x32_bf16 v[138:141], v[26:29], v[150:153], v[138:141]
v_mfma_f32_16x16x32_bf16 v[142:145], v[30:33], v[150:153], v[142:145]
ds_read_b128 v[150:153], v176 offset:30720
s_waitcnt lgkmcnt(5)
v_mfma_f32_16x16x32_bf16 v[130:133], v[58:61], v[154:157], v[130:133]
v_mfma_f32_16x16x32_bf16 v[134:137], v[62:65], v[154:157], v[134:137]
s_waitcnt lgkmcnt(4)
v_mfma_f32_16x16x32_bf16 v[138:141], v[58:61], v[158:161], v[138:141]
v_mfma_f32_16x16x32_bf16 v[142:145], v[62:65], v[158:161], v[142:145]
s_waitcnt lgkmcnt(3)
v_mfma_f32_16x16x32_bf16 v[130:133], v[90:93], v[162:165], v[130:133]
v_mfma_f32_16x16x32_bf16 v[134:137], v[94:97], v[162:165], v[134:137]
s_waitcnt lgkmcnt(2)
v_mfma_f32_16x16x32_bf16 v[138:141], v[90:93], v[166:169], v[138:141]
v_mfma_f32_16x16x32_bf16 v[142:145], v[94:97], v[166:169], v[142:145]
s_waitcnt lgkmcnt(1)
v_mfma_f32_16x16x32_bf16 v[130:133], v[122:125], v[146:149], v[130:133]
v_mfma_f32_16x16x32_bf16 v[134:137], v[126:129], v[146:149], v[134:137]
s_waitcnt lgkmcnt(0)
v_mfma_f32_16x16x32_bf16 v[138:141], v[122:125], v[150:153], v[138:141]
v_mfma_f32_16x16x32_bf16 v[142:145], v[126:129], v[150:153], v[142:145]
s_setprio 0
v_xor_b32 v175, 0x10000, v175
v_xor_b32 v176, 0x10000, v176
s_sub_u32 s20, s18, 1
v_mov_b32 v1, s20
s_waitcnt vmcnt(4)
s_sub_u32 s25, s18, 1
s_cmp_ge_i32 s25, s45
s_cbranch_scc1 ql_77
buffer_store_dword v1, v173, s[4:7], s37 offen sc1
ql_78:
s_barrier
s_nop 6
v_cvt_pk_bf16_f32 v146, v130, v131
v_cvt_pk_bf16_f32 v147, v132, v133
v_cvt_pk_bf16_f32 v148, v134, v135
v_cvt_pk_bf16_f32 v149, v136, v137
v_cvt_pk_bf16_f32 v150, v138, v139
v_cvt_pk_bf16_f32 v151, v140, v141
v_cvt_pk_bf16_f32 v152, v142, v143
v_cvt_pk_bf16_f32 v153, v144, v145
ds_write_b128 v172, v[146:149]
ds_write_b128 v172, v[150:153] offset:1024
ds_read_b128 v[130:133], v174 offset:4096
ds_read_b128 v[178:181], v174 offset:8192
ds_read_b128 v[194:197], v174 offset:12288
ds_read_b128 v[146:149], v177 offset:0
ds_read_b128 v[134:137], v174 offset:5120
ds_read_b128 v[182:185], v174 offset:9216
ds_read_b128 v[198:201], v174 offset:13312
ds_read_b128 v[150:153], v177 offset:512
ds_read_b128 v[138:141], v174 offset:6144
ds_read_b128 v[186:189], v174 offset:10240
ds_read_b128 v[202:205], v174 offset:14336
ds_read_b128 v[154:157], v177 offset:1024
s_setprio 3
s_waitcnt lgkmcnt(8)
v_mfma_f32_16x16x32_bf16 v[226:229], v[178:181], v[130:133], 0
ds_read_b128 v[142:145], v174 offset:7168
ds_read_b128 v[190:193], v174 offset:11264
ds_read_b128 v[206:209], v174 offset:15360
ds_read_b128 v[158:161], v177 offset:1536
ds_read_b128 v[162:165], v252 offset:0
ds_read_b128 v[166:169], v252 offset:512
v_mfma_f32_16x16x32_bf16 v[230:233], v[194:197], v[130:133], v[238:241]
v_mfma_f32_16x16x32_bf16 v[234:237], v[146:149], v[130:133], v[242:245]
s_waitcnt lgkmcnt(10)
v_mfma_f32_16x16x32_bf16 v[226:229], v[182:185], v[134:137], v[226:229]
v_mfma_f32_16x16x32_bf16 v[230:233], v[198:201], v[134:137], v[230:233]
v_mfma_f32_16x16x32_bf16 v[234:237], v[150:153], v[134:137], v[234:237]
s_waitcnt lgkmcnt(6)
v_mfma_f32_16x16x32_bf16 v[226:229], v[186:189], v[138:141], v[226:229]
v_mfma_f32_16x16x32_bf16 v[230:233], v[202:205], v[138:141], v[230:233]
v_mfma_f32_16x16x32_bf16 v[234:237], v[154:157], v[138:141], v[234:237]
s_waitcnt lgkmcnt(2)
v_mfma_f32_16x16x32_bf16 v[226:229], v[190:193], v[142:145], v[226:229]
v_mfma_f32_16x16x32_bf16 v[230:233], v[206:209], v[142:145], v[230:233]
v_mfma_f32_16x16x32_bf16 v[234:237], v[158:161], v[142:145], v[234:237]
s_setprio 0
s_nop 7
v_max3_f32 v170, v234, v235, v236
v_max3_f32 v170, v170, v237, v226
v_max3_f32 v1, v227, v228, v229
v_max3_f32 v170, v170, v230, v231
v_max3_f32 v1, v1, v232, v233
v_max_f32 v170, v170, v1
v_max_f32 v1, v170, v1
s_nop 1
v_permlane32_swap_b32 v170, v1
v_max_f32 v250, v170, v1
v_max_f32 v251, v170, v1
s_nop 1
v_permlane16_swap_b32 v250, v251
v_max_f32 v170, v250, v251
v_mul_f32 v170, s42, v170
v_fma_f32 v226, v226, s42, -v170
v_fma_f32 v227, v227, s42, -v170
v_fma_f32 v228, v228, s42, -v170
v_fma_f32 v229, v229, s42, -v170
v_fma_f32 v230, v230, s42, -v170
v_fma_f32 v231, v231, s42, -v170
v_fma_f32 v232, v232, s42, -v170
v_fma_f32 v233, v233, s42, -v170
v_fma_f32 v234, v234, s42, -v170
v_fma_f32 v235, v235, s42, -v170
v_fma_f32 v236, v236, s42, -v170
v_fma_f32 v237, v237, s42, -v170
v_exp_f32 v226, v226
v_exp_f32 v227, v227
v_exp_f32 v228, v228
v_exp_f32 v229, v229
v_exp_f32 v230, v230
v_exp_f32 v231, v231
v_exp_f32 v232, v232
v_exp_f32 v233, v233
v_exp_f32 v234, v234
v_exp_f32 v235, v235
v_exp_f32 v236, v236
v_exp_f32 v237, v237
v_cvt_pk_bf16_f32 v194, v226, v227
v_cvt_pk_bf16_f32 v195, v228, v229
v_cvt_pk_bf16_f32 v196, v230, v231
v_cvt_pk_bf16_f32 v197, v232, v233
v_cvt_pk_bf16_f32 v250, v234, v235
v_cvt_pk_bf16_f32 v251, v236, v237
s_waitcnt vmcnt(1) lgkmcnt(0)
s_setprio 3
v_mfma_f32_16x16x32_bf16 v[198:201], v[246:249], v[194:197], 0
v_mfma_f32_16x16x32_bf16 v[178:181], v[210:213], v[194:197], 0
v_mfma_f32_16x16x32_bf16 v[182:185], v[214:217], v[194:197], 0
v_mfma_f32_16x16x32_bf16 v[186:189], v[218:221], v[194:197], 0
v_mfma_f32_16x16x32_bf16 v[190:193], v[222:225], v[194:197], 0
s_nop 1
v_mfma_f32_16x16x16_bf16 v[198:201], v[246:247], v[250:251], v[198:201]
v_mfma_f32_16x16x16_bf16 v[178:181], v[162:163], v[250:251], v[178:181]
v_mfma_f32_16x16x16_bf16 v[182:185], v[164:165], v[250:251], v[182:185]
v_mfma_f32_16x16x16_bf16 v[186:189], v[166:167], v[250:251], v[186:189]
v_mfma_f32_16x16x16_bf16 v[190:193], v[168:169], v[250:251], v[190:193]
s_setprio 0
s_sub_u32 s22, s18, 1
s_lshl_b32 s22, s22, 14
s_xor_b32 s22, s22, s38
v_rcp_f32 v170, v198
s_nop 1
v_mul_f32 v178, v178, v170
v_mul_f32 v179, v179, v170
v_mul_f32 v180, v180, v170
v_mul_f32 v181, v181, v170
v_mul_f32 v182, v182, v170
v_mul_f32 v183, v183, v170
v_mul_f32 v184, v184, v170
v_mul_f32 v185, v185, v170
v_mul_f32 v186, v186, v170
v_mul_f32 v187, v187, v170
v_mul_f32 v188, v188, v170
v_mul_f32 v189, v189, v170
v_mul_f32 v190, v190, v170
v_mul_f32 v191, v191, v170
v_mul_f32 v192, v192, v170
v_mul_f32 v193, v193, v170
v_cvt_pk_bf16_f32 v202, v178, v179
v_cvt_pk_bf16_f32 v203, v180, v181
v_cvt_pk_bf16_f32 v204, v182, v183
v_cvt_pk_bf16_f32 v205, v184, v185
v_cvt_pk_bf16_f32 v206, v186, v187
v_cvt_pk_bf16_f32 v207, v188, v189
v_cvt_pk_bf16_f32 v208, v190, v191
v_cvt_pk_bf16_f32 v209, v192, v193
s_sub_u32 s25, s18, 0
s_cmp_ge_i32 s25, s45
s_cbranch_scc1 ql_79
buffer_store_dwordx4 v[202:205], v253, s[4:7], s22 offen sc1
buffer_store_dwordx4 v[206:209], v253, s[4:7], s22 offen offset:2048 sc1
ql_80:
s_cmp_gt_u32 s40, s18
s_cbranch_scc0 pf_81
pf_82:
s_lshl_b32 s22, s18, 14
s_xor_b32 s22, s22, s35
buffer_load_dwordx4 v[210:213], v171, s[4:7], s22 offen offset:0 sc1
buffer_load_dwordx4 v[214:217], v171, s[4:7], s22 offen offset:1024 sc1
buffer_load_dwordx4 v[218:221], v171, s[4:7], s22 offen offset:2048 sc1
buffer_load_dwordx4 v[222:225], v171, s[4:7], s22 offen offset:3072 sc1
s_add_u32 s18, s18, 1
s_cmp_lt_u32 s18, 64
s_barrier
s_cbranch_scc1 qal_76
s_sub_u32 s20, s18, 1
v_mov_b32 v1, s20
s_waitcnt vmcnt(4)
s_sub_u32 s25, s18, 1
s_cmp_ge_i32 s25, s45
s_cbranch_scc1 ql_83
buffer_store_dword v1, v173, s[4:7], s37 offen sc1
ql_84:
s_barrier
ds_read_b128 v[130:133], v174 offset:4096
ds_read_b128 v[178:181], v174 offset:8192
ds_read_b128 v[194:197], v174 offset:12288
ds_read_b128 v[134:137], v174 offset:5120
ds_read_b128 v[182:185], v174 offset:9216
ds_read_b128 v[198:201], v174 offset:13312
ds_read_b128 v[138:141], v174 offset:6144
ds_read_b128 v[186:189], v174 offset:10240
ds_read_b128 v[202:205], v174 offset:14336
ds_read_b128 v[142:145], v174 offset:7168
ds_read_b128 v[190:193], v174 offset:11264
ds_read_b128 v[206:209], v174 offset:15360
s_waitcnt lgkmcnt(0)
v_mfma_f32_16x16x32_bf16 v[226:229], v[178:181], v[130:133], 0
v_mfma_f32_16x16x32_bf16 v[230:233], v[194:197], v[130:133], v[238:241]
v_mfma_f32_16x16x32_bf16 v[226:229], v[182:185], v[134:137], v[226:229]
v_mfma_f32_16x16x32_bf16 v[230:233], v[198:201], v[134:137], v[230:233]
v_mfma_f32_16x16x32_bf16 v[226:229], v[186:189], v[138:141], v[226:229]
v_mfma_f32_16x16x32_bf16 v[230:233], v[202:205], v[138:141], v[230:233]
v_mfma_f32_16x16x32_bf16 v[226:229], v[190:193], v[142:145], v[226:229]
v_mfma_f32_16x16x32_bf16 v[230:233], v[206:209], v[142:145], v[230:233]
s_barrier
ds_read_b128 v[146:149], v177 offset:0
ds_read_b128 v[150:153], v177 offset:512
ds_read_b128 v[154:157], v177 offset:1024
ds_read_b128 v[158:161], v177 offset:1536
ds_read_b128 v[162:165], v252
ds_read_b128 v[166:169], v252 offset:512
s_waitcnt lgkmcnt(5)
v_mfma_f32_16x16x32_bf16 v[234:237], v[146:149], v[130:133], v[242:245]
s_waitcnt lgkmcnt(4)
v_mfma_f32_16x16x32_bf16 v[234:237], v[150:153], v[134:137], v[234:237]
s_waitcnt lgkmcnt(3)
v_mfma_f32_16x16x32_bf16 v[234:237], v[154:157], v[138:141], v[234:237]
s_waitcnt lgkmcnt(2)
v_mfma_f32_16x16x32_bf16 v[234:237], v[158:161], v[142:145], v[234:237]
s_setprio 0
s_nop 7
v_max3_f32 v170, v234, v235, v236
v_max3_f32 v170, v170, v237, v226
v_max3_f32 v1, v227, v228, v229
v_max3_f32 v170, v170, v230, v231
v_max3_f32 v1, v1, v232, v233
v_max_f32 v170, v170, v1
v_max_f32 v1, v170, v1
s_nop 1
v_permlane32_swap_b32 v170, v1
v_max_f32 v250, v170, v1
v_max_f32 v251, v170, v1
s_nop 1
v_permlane16_swap_b32 v250, v251
v_max_f32 v170, v250, v251
v_mul_f32 v170, s42, v170
v_fma_f32 v226, v226, s42, -v170
v_fma_f32 v227, v227, s42, -v170
v_fma_f32 v228, v228, s42, -v170
v_fma_f32 v229, v229, s42, -v170
v_fma_f32 v230, v230, s42, -v170
v_fma_f32 v231, v231, s42, -v170
v_fma_f32 v232, v232, s42, -v170
v_fma_f32 v233, v233, s42, -v170
v_fma_f32 v234, v234, s42, -v170
v_fma_f32 v235, v235, s42, -v170
v_fma_f32 v236, v236, s42, -v170
v_fma_f32 v237, v237, s42, -v170
v_exp_f32 v226, v226
v_exp_f32 v227, v227
v_exp_f32 v228, v228
v_exp_f32 v229, v229
v_exp_f32 v230, v230
v_exp_f32 v231, v231
v_exp_f32 v232, v232
v_exp_f32 v233, v233
v_exp_f32 v234, v234
v_exp_f32 v235, v235
v_exp_f32 v236, v236
v_exp_f32 v237, v237
v_cvt_pk_bf16_f32 v194, v226, v227
v_cvt_pk_bf16_f32 v195, v228, v229
v_cvt_pk_bf16_f32 v196, v230, v231
v_cvt_pk_bf16_f32 v197, v232, v233
v_cvt_pk_bf16_f32 v250, v234, v235
v_cvt_pk_bf16_f32 v251, v236, v237
s_waitcnt vmcnt(1) lgkmcnt(0)
s_setprio 3
v_mfma_f32_16x16x32_bf16 v[198:201], v[246:249], v[194:197], 0
v_mfma_f32_16x16x32_bf16 v[178:181], v[210:213], v[194:197], 0
v_mfma_f32_16x16x32_bf16 v[182:185], v[214:217], v[194:197], 0
v_mfma_f32_16x16x32_bf16 v[186:189], v[218:221], v[194:197], 0
v_mfma_f32_16x16x32_bf16 v[190:193], v[222:225], v[194:197], 0
s_nop 1
v_mfma_f32_16x16x16_bf16 v[198:201], v[246:247], v[250:251], v[198:201]
v_mfma_f32_16x16x16_bf16 v[178:181], v[162:163], v[250:251], v[178:181]
v_mfma_f32_16x16x16_bf16 v[182:185], v[164:165], v[250:251], v[182:185]
v_mfma_f32_16x16x16_bf16 v[186:189], v[166:167], v[250:251], v[186:189]
v_mfma_f32_16x16x16_bf16 v[190:193], v[168:169], v[250:251], v[190:193]
s_setprio 0
s_sub_u32 s22, s18, 1
s_lshl_b32 s22, s22, 14
s_xor_b32 s22, s22, s38
v_rcp_f32 v170, v198
s_nop 1
v_mul_f32 v178, v178, v170
v_mul_f32 v179, v179, v170
v_mul_f32 v180, v180, v170
v_mul_f32 v181, v181, v170
v_mul_f32 v182, v182, v170
v_mul_f32 v183, v183, v170
v_mul_f32 v184, v184, v170
v_mul_f32 v185, v185, v170
v_mul_f32 v186, v186, v170
v_mul_f32 v187, v187, v170
v_mul_f32 v188, v188, v170
v_mul_f32 v189, v189, v170
v_mul_f32 v190, v190, v170
v_mul_f32 v191, v191, v170
v_mul_f32 v192, v192, v170
v_mul_f32 v193, v193, v170
v_cvt_pk_bf16_f32 v202, v178, v179
v_cvt_pk_bf16_f32 v203, v180, v181
v_cvt_pk_bf16_f32 v204, v182, v183
v_cvt_pk_bf16_f32 v205, v184, v185
v_cvt_pk_bf16_f32 v206, v186, v187
v_cvt_pk_bf16_f32 v207, v188, v189
v_cvt_pk_bf16_f32 v208, v190, v191
v_cvt_pk_bf16_f32 v209, v192, v193
s_sub_u32 s25, s18, 0
s_cmp_ge_i32 s25, s45
s_cbranch_scc1 ql_85
buffer_store_dwordx4 v[202:205], v253, s[4:7], s22 offen sc1
buffer_store_dwordx4 v[206:209], v253, s[4:7], s22 offen offset:2048 sc1
ql_86:
s_add_u32 s18, s18, 1
s_sub_u32 s20, s18, 1
v_mov_b32 v1, s20
s_waitcnt vmcnt(0)
s_sub_u32 s25, s18, 1
s_cmp_ge_i32 s25, s45
s_cbranch_scc1 ql_87
buffer_store_dword v1, v173, s[4:7], s37 offen sc1
ql_88:
s_branch L_end
qah_57:
s_lshl_b32 s20, s12, 10
s_add_u32 s20, s20, 139264
v_bfe_u32 v1, v0, 0, 6
v_lshlrev_b32 v192, 4, v1
v_add_u32 v192, s20, v192
s_lshl_b32 s20, s12, 10
s_add_u32 s20, s20, 155648
v_add_u32 v193, s20, v171
s_lshl_b32 s20, s12, 11
s_add_u32 s20, s20, 147456
v_add_u32 v194, s20, v171
s_lshl_b32 s35, s32, 20
s_lshl_b32 s21, s12, 11
s_add_u32 s35, s35, s21
s_add_u32 s35, s35, 4202496
s_and_b32 s21, s32, 1
s_lshl_b32 s21, s21, 14
s_xor_b32 s35, s35, s21
s_and_b32 s21, s32, 2
s_lshl_b32 s21, s21, 12
s_xor_b32 s35, s35, s21
s_lshr_b32 s22, s32, 1
s_and_b32 s23, s32, 1
s_lshl_b32 s38, s22, 21
s_lshl_b32 s21, s23, 12
s_add_u32 s38, s38, s21
s_lshl_b32 s21, s12, 10
s_add_u32 s38, s38, s21
s_add_u32 s38, s38, 104857600
s_and_b32 s21, s22, 3
s_lshl_b32 s21, s21, 13
s_xor_b32 s38, s38, s21
s_xor_b32 s35, s35, s17
s_xor_b32 s38, s38, s17
s_add_u32 s39, s18, 1
s_min_u32 s39, s39, 63
s_xor_b32 s43, s43, 0x10000
s_lshl_b32 s20, s39, 16
s_add_u32 s21, s52, s43
s_xor_b32 s21, s21, 0x8000
s_add_u32 m0, s21, 0
s_nop 0
buffer_load_dwordx4 v177, s[48:51], s20 offen offset:0 lds
s_add_u32 m0, s21, 3968
s_nop 0
buffer_load_dwordx4 v177, s[48:51], s20 offen offset:128 lds
s_add_u32 m0, s21, 7936
s_nop 0
buffer_load_dwordx4 v177, s[48:51], s20 offen offset:256 lds
s_add_u32 m0, s21, 11904
s_nop 0
buffer_load_dwordx4 v177, s[48:51], s20 offen offset:384 lds
s_add_u32 m0, s21, 15872
s_nop 0
buffer_load_dwordx4 v177, s[48:51], s20 offen offset:512 lds
s_add_u32 m0, s21, 19840
s_nop 0
buffer_load_dwordx4 v177, s[48:51], s20 offen offset:640 lds
s_add_u32 m0, s21, 23808
s_nop 0
buffer_load_dwordx4 v177, s[48:51], s20 offen offset:768 lds
s_add_u32 m0, s21, 27776
s_nop 0
buffer_load_dwordx4 v177, s[48:51], s20 offen offset:896 lds
s_lshl_b32 s20, s39, 16
s_add_u32 s21, s52, s43
s_add_u32 m0, s21, 0
s_nop 0
buffer_load_dwordx4 v174, s[48:51], s20 offen offset:0 lds
s_add_u32 m0, s21, 3968
s_nop 0
buffer_load_dwordx4 v174, s[48:51], s20 offen offset:128 lds
s_add_u32 m0, s21, 7936
s_nop 0
buffer_load_dwordx4 v174, s[48:51], s20 offen offset:256 lds
s_add_u32 m0, s21, 11904
s_nop 0
buffer_load_dwordx4 v174, s[48:51], s20 offen offset:384 lds
s_add_u32 m0, s21, 15872
s_nop 0
buffer_load_dwordx4 v174, s[48:51], s20 offen offset:512 lds
s_add_u32 m0, s21, 19840
s_nop 0
buffer_load_dwordx4 v174, s[48:51], s20 offen offset:640 lds
s_add_u32 m0, s21, 23808
s_nop 0
buffer_load_dwordx4 v174, s[48:51], s20 offen offset:768 lds
s_add_u32 m0, s21, 27776
s_nop 0
buffer_load_dwordx4 v174, s[48:51], s20 offen offset:896 lds
s_cmp_gt_u32 s40, s18
s_cbranch_scc0 pf_89
pf_90:
s_barrier
s_setprio 1
ds_read_b128 v[146:149], v175 offset:0
ds_read_b128 v[150:153], v175 offset:2048
ds_read_b128 v[154:157], v176 offset:0
ds_read_b128 v[158:161], v176 offset:2048
ds_read_b128 v[162:165], v175 offset:4096
ds_read_b128 v[166:169], v175 offset:6144
s_waitcnt lgkmcnt(5)
v_mfma_f32_16x16x32_bf16 v[130:133], v[2:5], v[146:149], 0
v_mfma_f32_16x16x32_bf16 v[134:137], v[6:9], v[146:149], 0
ds_read_b128 v[146:149], v176 offset:4096
s_waitcnt lgkmcnt(5)
v_mfma_f32_16x16x32_bf16 v[138:141], v[2:5], v[150:153], 0
v_mfma_f32_16x16x32_bf16 v[142:145], v[6:9], v[150:153], 0
s_lshl_b32 s23, s18, 14
s_xor_b32 s23, s23, s35
buffer_load_dwordx4 v[182:185], v171, s[4:7], s23 offen sc1
ds_read_b128 v[150:153], v176 offset:6144
s_waitcnt lgkmcnt(5)
v_mfma_f32_16x16x32_bf16 v[130:133], v[34:37], v[154:157], v[130:133]
v_mfma_f32_16x16x32_bf16 v[134:137], v[38:41], v[154:157], v[134:137]
buffer_load_dwordx4 v[186:189], v171, s[4:7], s23 offen offset:1024 sc1
ds_read_b128 v[154:157], v175 offset:8192
s_waitcnt lgkmcnt(5)
v_mfma_f32_16x16x32_bf16 v[138:141], v[34:37], v[158:161], v[138:141]
v_mfma_f32_16x16x32_bf16 v[142:145], v[38:41], v[158:161], v[142:145]
s_lshl_b32 s24, s18, 14
s_xor_b32 s24, s24, s38
buffer_load_dwordx4 v[178:181], v171, s[4:7], s24 offen sc1
ds_read_b128 v[158:161], v175 offset:10240
s_waitcnt lgkmcnt(5)
v_mfma_f32_16x16x32_bf16 v[130:133], v[66:69], v[162:165], v[130:133]
v_mfma_f32_16x16x32_bf16 v[134:137], v[70:73], v[162:165], v[134:137]
ds_read_b128 v[162:165], v176 offset:8192
s_waitcnt lgkmcnt(5)
v_mfma_f32_16x16x32_bf16 v[138:141], v[66:69], v[166:169], v[138:141]
v_mfma_f32_16x16x32_bf16 v[142:145], v[70:73], v[166:169], v[142:145]
ds_read_b128 v[166:169], v176 offset:10240
s_waitcnt lgkmcnt(5)
v_mfma_f32_16x16x32_bf16 v[130:133], v[98:101], v[146:149], v[130:133]
v_mfma_f32_16x16x32_bf16 v[134:137], v[102:105], v[146:149], v[134:137]
ds_read_b128 v[146:149], v175 offset:12288
s_waitcnt lgkmcnt(5)
v_mfma_f32_16x16x32_bf16 v[138:141], v[98:101], v[150:153], v[138:141]
v_mfma_f32_16x16x32_bf16 v[142:145], v[102:105], v[150:153], v[142:145]
ds_read_b128 v[150:153], v175 offset:14336
s_waitcnt lgkmcnt(5)
v_mfma_f32_16x16x32_bf16 v[130:133], v[10:13], v[154:157], v[130:133]
v_mfma_f32_16x16x32_bf16 v[134:137], v[14:17], v[154:157], v[134:137]
ds_read_b128 v[154:157], v176 offset:12288
s_waitcnt lgkmcnt(5)
v_mfma_f32_16x16x32_bf16 v[138:141], v[10:13], v[158:161], v[138:141]
v_mfma_f32_16x16x32_bf16 v[142:145], v[14:17], v[158:161], v[142:145]
ds_read_b128 v[158:161], v176 offset:14336
s_waitcnt lgkmcnt(5)
v_mfma_f32_16x16x32_bf16 v[130:133], v[42:45], v[162:165], v[130:133]
v_mfma_f32_16x16x32_bf16 v[134:137], v[46:49], v[162:165], v[134:137]
ds_read_b128 v[162:165], v175 offset:16384
s_waitcnt lgkmcnt(5)
v_mfma_f32_16x16x32_bf16 v[138:141], v[42:45], v[166:169], v[138:141]
v_mfma_f32_16x16x32_bf16 v[142:145], v[46:49], v[166:169], v[142:145]
ds_read_b128 v[166:169], v175 offset:18432
s_waitcnt lgkmcnt(5)
v_mfma_f32_16x16x32_bf16 v[130:133], v[74:77], v[146:149], v[130:133]
v_mfma_f32_16x16x32_bf16 v[134:137], v[78:81], v[146:149], v[134:137]
ds_read_b128 v[146:149], v176 offset:16384
s_waitcnt lgkmcnt(5)
v_mfma_f32_16x16x32_bf16 v[138:141], v[74:77], v[150:153], v[138:141]
v_mfma_f32_16x16x32_bf16 v[142:145], v[78:81], v[150:153], v[142:145]
ds_read_b128 v[150:153], v176 offset:18432
s_waitcnt lgkmcnt(5)
v_mfma_f32_16x16x32_bf16 v[130:133], v[106:109], v[154:157], v[130:133]
v_mfma_f32_16x16x32_bf16 v[134:137], v[110:113], v[154:157], v[134:137]
ds_read_b128 v[154:157], v175 offset:20480
s_waitcnt lgkmcnt(5)
v_mfma_f32_16x16x32_bf16 v[138:141], v[106:109], v[158:161], v[138:141]
v_mfma_f32_16x16x32_bf16 v[142:145], v[110:113], v[158:161], v[142:145]
ds_read_b128 v[158:161], v175 offset:22528
s_waitcnt lgkmcnt(5)
v_mfma_f32_16x16x32_bf16 v[130:133], v[18:21], v[162:165], v[130:133]
v_mfma_f32_16x16x32_bf16 v[134:137], v[22:25], v[162:165], v[134:137]
ds_read_b128 v[162:165], v176 offset:20480
s_waitcnt lgkmcnt(5)
v_mfma_f32_16x16x32_bf16 v[138:141], v[18:21], v[166:169], v[138:141]
v_mfma_f32_16x16x32_bf16 v[142:145], v[22:25], v[166:169], v[142:145]
ds_read_b128 v[166:169], v176 offset:22528
s_waitcnt lgkmcnt(5)
v_mfma_f32_16x16x32_bf16 v[130:133], v[50:53], v[146:149], v[130:133]
v_mfma_f32_16x16x32_bf16 v[134:137], v[54:57], v[146:149], v[134:137]
ds_read_b128 v[146:149], v175 offset:24576
s_waitcnt lgkmcnt(5)
v_mfma_f32_16x16x32_bf16 v[138:141], v[50:53], v[150:153], v[138:141]
v_mfma_f32_16x16x32_bf16 v[142:145], v[54:57], v[150:153], v[142:145]
ds_read_b128 v[150:153], v175 offset:26624
s_waitcnt lgkmcnt(5)
v_mfma_f32_16x16x32_bf16 v[130:133], v[82:85], v[154:157], v[130:133]
v_mfma_f32_16x16x32_bf16 v[134:137], v[86:89], v[154:157], v[134:137]
ds_read_b128 v[154:157], v176 offset:24576
s_waitcnt lgkmcnt(5)
v_mfma_f32_16x16x32_bf16 v[138:141], v[82:85], v[158:161], v[138:141]
v_mfma_f32_16x16x32_bf16 v[142:145], v[86:89], v[158:161], v[142:145]
ds_read_b128 v[158:161], v176 offset:26624
s_waitcnt lgkmcnt(5)
v_mfma_f32_16x16x32_bf16 v[130:133], v[114:117], v[162:165], v[130:133]
v_mfma_f32_16x16x32_bf16 v[134:137], v[118:121], v[162:165], v[134:137]
ds_read_b128 v[162:165], v175 offset:28672
s_waitcnt lgkmcnt(5)
v_mfma_f32_16x16x32_bf16 v[138:141], v[114:117], v[166:169], v[138:141]
v_mfma_f32_16x16x32_bf16 v[142:145], v[118:121], v[166:169], v[142:145]
ds_read_b128 v[166:169], v175 offset:30720
s_waitcnt lgkmcnt(5)
v_mfma_f32_16x16x32_bf16 v[130:133], v[26:29], v[146:149], v[130:133]
v_mfma_f32_16x16x32_bf16 v[134:137], v[30:33], v[146:149], v[134:137]
ds_read_b128 v[146:149], v176 offset:28672
s_waitcnt lgkmcnt(5)
v_mfma_f32_16x16x32_bf16 v[138:141], v[26:29], v[150:153], v[138:141]
v_mfma_f32_16x16x32_bf16 v[142:145], v[30:33], v[150:153], v[142:145]
ds_read_b128 v[150:153], v176 offset:30720
s_waitcnt lgkmcnt(5)
v_mfma_f32_16x16x32_bf16 v[130:133], v[58:61], v[154:157], v[130:133]
v_mfma_f32_16x16x32_bf16 v[134:137], v[62:65], v[154:157], v[134:137]
s_waitcnt lgkmcnt(4)
v_mfma_f32_16x16x32_bf16 v[138:141], v[58:61], v[158:161], v[138:141]
v_mfma_f32_16x16x32_bf16 v[142:145], v[62:65], v[158:161], v[142:145]
s_waitcnt lgkmcnt(3)
v_mfma_f32_16x16x32_bf16 v[130:133], v[90:93], v[162:165], v[130:133]
v_mfma_f32_16x16x32_bf16 v[134:137], v[94:97], v[162:165], v[134:137]
s_waitcnt lgkmcnt(2)
v_mfma_f32_16x16x32_bf16 v[138:141], v[90:93], v[166:169], v[138:141]
v_mfma_f32_16x16x32_bf16 v[142:145], v[94:97], v[166:169], v[142:145]
s_waitcnt lgkmcnt(1)
v_mfma_f32_16x16x32_bf16 v[130:133], v[122:125], v[146:149], v[130:133]
v_mfma_f32_16x16x32_bf16 v[134:137], v[126:129], v[146:149], v[134:137]
s_waitcnt lgkmcnt(0)
v_mfma_f32_16x16x32_bf16 v[138:141], v[122:125], v[150:153], v[138:141]
v_mfma_f32_16x16x32_bf16 v[142:145], v[126:129], v[150:153], v[142:145]
s_setprio 0
v_xor_b32 v175, 0x10000, v175
v_xor_b32 v176, 0x10000, v176
s_add_u32 s18, s18, 1
s_waitcnt vmcnt(0)
s_barrier
qal_91:
ds_read_b128 v[146:149], v172
ds_read_b128 v[150:153], v172 offset:1024
ds_write_b128 v194, v[182:185]
ds_write_b128 v194, v[186:189] offset:1024
s_add_u32 s39, s18, 1
s_min_u32 s39, s39, 63
s_xor_b32 s43, s43, 0x10000
s_waitcnt vmcnt(0) lgkmcnt(2)
v_lshlrev_b32 v190, 16, v146
v_and_b32 v191, s44, v146
v_add_f32 v190, v190, v130
v_add_f32 v191, v191, v131
v_cvt_pk_bf16_f32 v154, v190, v191
v_lshlrev_b32 v190, 16, v147
v_and_b32 v191, s44, v147
v_add_f32 v190, v190, v132
v_add_f32 v191, v191, v133
v_cvt_pk_bf16_f32 v155, v190, v191
v_lshlrev_b32 v190, 16, v148
v_and_b32 v191, s44, v148
v_add_f32 v190, v190, v134
v_add_f32 v191, v191, v135
v_cvt_pk_bf16_f32 v156, v190, v191
v_lshlrev_b32 v190, 16, v149
v_and_b32 v191, s44, v149
v_add_f32 v190, v190, v136
v_add_f32 v191, v191, v137
v_cvt_pk_bf16_f32 v157, v190, v191
v_lshlrev_b32 v190, 16, v150
v_and_b32 v191, s44, v150
v_add_f32 v190, v190, v138
v_add_f32 v191, v191, v139
v_cvt_pk_bf16_f32 v158, v190, v191
v_lshlrev_b32 v190, 16, v151
v_and_b32 v191, s44, v151
v_add_f32 v190, v190, v140
v_add_f32 v191, v191, v141
v_cvt_pk_bf16_f32 v159, v190, v191
v_lshlrev_b32 v190, 16, v152
v_and_b32 v191, s44, v152
v_add_f32 v190, v190, v142
v_add_f32 v191, v191, v143
v_cvt_pk_bf16_f32 v160, v190, v191
v_lshlrev_b32 v190, 16, v153
v_and_b32 v191, s44, v153
v_add_f32 v190, v190, v144
v_add_f32 v191, v191, v145
v_cvt_pk_bf16_f32 v161, v190, v191
ds_write_b128 v192, v[154:157]
ds_write_b128 v192, v[158:161] offset:4096
v_max3_u32 v1, v178, v179, v180
v_max_u32 v1, v1, v181
v_cmp_eq_u32 vcc, -1, v1
s_cbranch_vccnz qk_93
ds_write_b128 v193, v[178:181]
s_waitcnt lgkmcnt(0)
s_lshl_b32 s20, s39, 16
s_add_u32 s21, s52, s43
s_xor_b32 s21, s21, 0x8000
s_add_u32 m0, s21, 0
s_nop 0
buffer_load_dwordx4 v177, s[48:51], s20 offen offset:0 lds
s_add_u32 m0, s21, 3968
s_nop 0
buffer_load_dwordx4 v177, s[48:51], s20 offen offset:128 lds
s_add_u32 m0, s21, 7936
s_nop 0
buffer_load_dwordx4 v177, s[48:51], s20 offen offset:256 lds
s_add_u32 m0, s21, 11904
s_nop 0
buffer_load_dwordx4 v177, s[48:51], s20 offen offset:384 lds
qk_94:
s_cmp_gt_u32 s40, s18
s_cbranch_scc0 pf_96
pf_97:
s_waitcnt lgkmcnt(0)
s_barrier
s_setprio 1
ds_read_b128 v[146:149], v175 offset:0
ds_read_b128 v[150:153], v175 offset:2048
ds_read_b128 v[154:157], v176 offset:0
ds_read_b128 v[158:161], v176 offset:2048
ds_read_b128 v[162:165], v175 offset:4096
ds_read_b128 v[166:169], v175 offset:6144
s_waitcnt lgkmcnt(5)
v_mfma_f32_16x16x32_bf16 v[130:133], v[2:5], v[146:149], 0
v_mfma_f32_16x16x32_bf16 v[134:137], v[6:9], v[146:149], 0
ds_read_b128 v[146:149], v176 offset:4096
s_waitcnt lgkmcnt(5)
v_mfma_f32_16x16x32_bf16 v[138:141], v[2:5], v[150:153], 0
v_mfma_f32_16x16x32_bf16 v[142:145], v[6:9], v[150:153], 0
s_lshl_b32 s23, s18, 14
s_xor_b32 s23, s23, s35
buffer_load_dwordx4 v[182:185], v171, s[4:7], s23 offen sc1
ds_read_b128 v[150:153], v176 offset:6144
s_waitcnt lgkmcnt(5)
v_mfma_f32_16x16x32_bf16 v[130:133], v[34:37], v[154:157], v[130:133]
v_mfma_f32_16x16x32_bf16 v[134:137], v[38:41], v[154:157], v[134:137]
buffer_load_dwordx4 v[186:189], v171, s[4:7], s23 offen offset:1024 sc1
ds_read_b128 v[154:157], v175 offset:8192
s_waitcnt lgkmcnt(5)
v_mfma_f32_16x16x32_bf16 v[138:141], v[34:37], v[158:161], v[138:141]
v_mfma_f32_16x16x32_bf16 v[142:145], v[38:41], v[158:161], v[142:145]
s_lshl_b32 s24, s18, 14
s_xor_b32 s24, s24, s38
buffer_load_dwordx4 v[178:181], v171, s[4:7], s24 offen sc1
ds_read_b128 v[158:161], v175 offset:10240
s_waitcnt lgkmcnt(5)
v_mfma_f32_16x16x32_bf16 v[130:133], v[66:69], v[162:165], v[130:133]
v_mfma_f32_16x16x32_bf16 v[134:137], v[70:73], v[162:165], v[134:137]
s_add_u32 m0, s21, 15872
s_nop 0
buffer_load_dwordx4 v177, s[48:51], s20 offen offset:512 lds
ds_read_b128 v[162:165], v176 offset:8192
s_waitcnt lgkmcnt(5)
v_mfma_f32_16x16x32_bf16 v[138:141], v[66:69], v[166:169], v[138:141]
v_mfma_f32_16x16x32_bf16 v[142:145], v[70:73], v[166:169], v[142:145]
s_add_u32 m0, s21, 19840
s_nop 0
buffer_load_dwordx4 v177, s[48:51], s20 offen offset:640 lds
ds_read_b128 v[166:169], v176 offset:10240
s_waitcnt lgkmcnt(5)
v_mfma_f32_16x16x32_bf16 v[130:133], v[98:101], v[146:149], v[130:133]
v_mfma_f32_16x16x32_bf16 v[134:137], v[102:105], v[146:149], v[134:137]
s_add_u32 m0, s21, 23808
s_nop 0
buffer_load_dwordx4 v177, s[48:51], s20 offen offset:768 lds
ds_read_b128 v[146:149], v175 offset:12288
s_waitcnt lgkmcnt(5)
v_mfma_f32_16x16x32_bf16 v[138:141], v[98:101], v[150:153], v[138:141]
v_mfma_f32_16x16x32_bf16 v[142:145], v[102:105], v[150:153], v[142:145]
s_add_u32 m0, s21, 27776
s_nop 0
buffer_load_dwordx4 v177, s[48:51], s20 offen offset:896 lds
ds_read_b128 v[150:153], v175 offset:14336
s_waitcnt lgkmcnt(5)
v_mfma_f32_16x16x32_bf16 v[130:133], v[10:13], v[154:157], v[130:133]
v_mfma_f32_16x16x32_bf16 v[134:137], v[14:17], v[154:157], v[134:137]
s_lshl_b32 s20, s39, 16
s_add_u32 s21, s52, s43
s_add_u32 m0, s21, 0
s_nop 0
buffer_load_dwordx4 v174, s[48:51], s20 offen offset:0 lds
ds_read_b128 v[154:157], v176 offset:12288
s_waitcnt lgkmcnt(5)
v_mfma_f32_16x16x32_bf16 v[138:141], v[10:13], v[158:161], v[138:141]
v_mfma_f32_16x16x32_bf16 v[142:145], v[14:17], v[158:161], v[142:145]
s_add_u32 m0, s21, 3968
s_nop 0
buffer_load_dwordx4 v174, s[48:51], s20 offen offset:128 lds
ds_read_b128 v[158:161], v176 offset:14336
s_waitcnt lgkmcnt(5)
v_mfma_f32_16x16x32_bf16 v[130:133], v[42:45], v[162:165], v[130:133]
v_mfma_f32_16x16x32_bf16 v[134:137], v[46:49], v[162:165], v[134:137]
s_add_u32 m0, s21, 7936
s_nop 0
buffer_load_dwordx4 v174, s[48:51], s20 offen offset:256 lds
ds_read_b128 v[162:165], v175 offset:16384
s_waitcnt lgkmcnt(5)
v_mfma_f32_16x16x32_bf16 v[138:141], v[42:45], v[166:169], v[138:141]
v_mfma_f32_16x16x32_bf16 v[142:145], v[46:49], v[166:169], v[142:145]
s_add_u32 m0, s21, 11904
s_nop 0
buffer_load_dwordx4 v174, s[48:51], s20 offen offset:384 lds
ds_read_b128 v[166:169], v175 offset:18432
s_waitcnt lgkmcnt(5)
v_mfma_f32_16x16x32_bf16 v[130:133], v[74:77], v[146:149], v[130:133]
v_mfma_f32_16x16x32_bf16 v[134:137], v[78:81], v[146:149], v[134:137]
s_add_u32 m0, s21, 15872
s_nop 0
buffer_load_dwordx4 v174, s[48:51], s20 offen offset:512 lds
ds_read_b128 v[146:149], v176 offset:16384
s_waitcnt lgkmcnt(5)
v_mfma_f32_16x16x32_bf16 v[138:141], v[74:77], v[150:153], v[138:141]
v_mfma_f32_16x16x32_bf16 v[142:145], v[78:81], v[150:153], v[142:145]
s_add_u32 m0, s21, 19840
s_nop 0
buffer_load_dwordx4 v174, s[48:51], s20 offen offset:640 lds
ds_read_b128 v[150:153], v176 offset:18432
s_waitcnt lgkmcnt(5)
v_mfma_f32_16x16x32_bf16 v[130:133], v[106:109], v[154:157], v[130:133]
v_mfma_f32_16x16x32_bf16 v[134:137], v[110:113], v[154:157], v[134:137]
s_add_u32 m0, s21, 23808
s_nop 0
buffer_load_dwordx4 v174, s[48:51], s20 offen offset:768 lds
ds_read_b128 v[154:157], v175 offset:20480
s_waitcnt lgkmcnt(5)
v_mfma_f32_16x16x32_bf16 v[138:141], v[106:109], v[158:161], v[138:141]
v_mfma_f32_16x16x32_bf16 v[142:145], v[110:113], v[158:161], v[142:145]
s_add_u32 m0, s21, 27776
s_nop 0
buffer_load_dwordx4 v174, s[48:51], s20 offen offset:896 lds
ds_read_b128 v[158:161], v175 offset:22528
s_waitcnt lgkmcnt(5)
v_mfma_f32_16x16x32_bf16 v[130:133], v[18:21], v[162:165], v[130:133]
v_mfma_f32_16x16x32_bf16 v[134:137], v[22:25], v[162:165], v[134:137]
ds_read_b128 v[162:165], v176 offset:20480
s_waitcnt lgkmcnt(5)
v_mfma_f32_16x16x32_bf16 v[138:141], v[18:21], v[166:169], v[138:141]
v_mfma_f32_16x16x32_bf16 v[142:145], v[22:25], v[166:169], v[142:145]
ds_read_b128 v[166:169], v176 offset:22528
s_waitcnt lgkmcnt(5)
v_mfma_f32_16x16x32_bf16 v[130:133], v[50:53], v[146:149], v[130:133]
v_mfma_f32_16x16x32_bf16 v[134:137], v[54:57], v[146:149], v[134:137]
ds_read_b128 v[146:149], v175 offset:24576
s_waitcnt lgkmcnt(5)
v_mfma_f32_16x16x32_bf16 v[138:141], v[50:53], v[150:153], v[138:141]
v_mfma_f32_16x16x32_bf16 v[142:145], v[54:57], v[150:153], v[142:145]
ds_read_b128 v[150:153], v175 offset:26624
s_waitcnt lgkmcnt(5)
v_mfma_f32_16x16x32_bf16 v[130:133], v[82:85], v[154:157], v[130:133]
v_mfma_f32_16x16x32_bf16 v[134:137], v[86:89], v[154:157], v[134:137]
ds_read_b128 v[154:157], v176 offset:24576
s_waitcnt lgkmcnt(5)
v_mfma_f32_16x16x32_bf16 v[138:141], v[82:85], v[158:161], v[138:141]
v_mfma_f32_16x16x32_bf16 v[142:145], v[86:89], v[158:161], v[142:145]
ds_read_b128 v[158:161], v176 offset:26624
s_waitcnt lgkmcnt(5)
v_mfma_f32_16x16x32_bf16 v[130:133], v[114:117], v[162:165], v[130:133]
v_mfma_f32_16x16x32_bf16 v[134:137], v[118:121], v[162:165], v[134:137]
ds_read_b128 v[162:165], v175 offset:28672
s_waitcnt lgkmcnt(5)
v_mfma_f32_16x16x32_bf16 v[138:141], v[114:117], v[166:169], v[138:141]
v_mfma_f32_16x16x32_bf16 v[142:145], v[118:121], v[166:169], v[142:145]
ds_read_b128 v[166:169], v175 offset:30720
s_waitcnt lgkmcnt(5)
v_mfma_f32_16x16x32_bf16 v[130:133], v[26:29], v[146:149], v[130:133]
v_mfma_f32_16x16x32_bf16 v[134:137], v[30:33], v[146:149], v[134:137]
ds_read_b128 v[146:149], v176 offset:28672
s_waitcnt lgkmcnt(5)
v_mfma_f32_16x16x32_bf16 v[138:141], v[26:29], v[150:153], v[138:141]
v_mfma_f32_16x16x32_bf16 v[142:145], v[30:33], v[150:153], v[142:145]
ds_read_b128 v[150:153], v176 offset:30720
s_waitcnt lgkmcnt(5)
v_mfma_f32_16x16x32_bf16 v[130:133], v[58:61], v[154:157], v[130:133]
v_mfma_f32_16x16x32_bf16 v[134:137], v[62:65], v[154:157], v[134:137]
s_waitcnt lgkmcnt(4)
v_mfma_f32_16x16x32_bf16 v[138:141], v[58:61], v[158:161], v[138:141]
v_mfma_f32_16x16x32_bf16 v[142:145], v[62:65], v[158:161], v[142:145]
s_waitcnt lgkmcnt(3)
v_mfma_f32_16x16x32_bf16 v[130:133], v[90:93], v[162:165], v[130:133]
v_mfma_f32_16x16x32_bf16 v[134:137], v[94:97], v[162:165], v[134:137]
s_waitcnt lgkmcnt(2)
v_mfma_f32_16x16x32_bf16 v[138:141], v[90:93], v[166:169], v[138:141]
v_mfma_f32_16x16x32_bf16 v[142:145], v[94:97], v[166:169], v[142:145]
s_waitcnt lgkmcnt(1)
v_mfma_f32_16x16x32_bf16 v[130:133], v[122:125], v[146:149], v[130:133]
v_mfma_f32_16x16x32_bf16 v[134:137], v[126:129], v[146:149], v[134:137]
s_waitcnt lgkmcnt(0)
v_mfma_f32_16x16x32_bf16 v[138:141], v[122:125], v[150:153], v[138:141]
v_mfma_f32_16x16x32_bf16 v[142:145], v[126:129], v[150:153], v[142:145]
s_setprio 0
v_xor_b32 v175, 0x10000, v175
v_xor_b32 v176, 0x10000, v176
s_add_u32 s18, s18, 1
s_waitcnt vmcnt(8)
s_cmp_lt_u32 s18, 64
s_barrier
s_cbranch_scc1 qal_91
ds_read_b128 v[146:149], v172
ds_read_b128 v[150:153], v172 offset:1024
ds_write_b128 v194, v[182:185]
ds_write_b128 v194, v[186:189] offset:1024
s_waitcnt vmcnt(0) lgkmcnt(2)
v_lshlrev_b32 v190, 16, v146
v_and_b32 v191, s44, v146
v_add_f32 v190, v190, v130
v_add_f32 v191, v191, v131
v_cvt_pk_bf16_f32 v154, v190, v191
v_lshlrev_b32 v190, 16, v147
v_and_b32 v191, s44, v147
v_add_f32 v190, v190, v132
v_add_f32 v191, v191, v133
v_cvt_pk_bf16_f32 v155, v190, v191
v_lshlrev_b32 v190, 16, v148
v_and_b32 v191, s44, v148
v_add_f32 v190, v190, v134
v_add_f32 v191, v191, v135
v_cvt_pk_bf16_f32 v156, v190, v191
v_lshlrev_b32 v190, 16, v149
v_and_b32 v191, s44, v149
v_add_f32 v190, v190, v136
v_add_f32 v191, v191, v137
v_cvt_pk_bf16_f32 v157, v190, v191
v_lshlrev_b32 v190, 16, v150
v_and_b32 v191, s44, v150
v_add_f32 v190, v190, v138
v_add_f32 v191, v191, v139
v_cvt_pk_bf16_f32 v158, v190, v191
v_lshlrev_b32 v190, 16, v151
v_and_b32 v191, s44, v151
v_add_f32 v190, v190, v140
v_add_f32 v191, v191, v141
v_cvt_pk_bf16_f32 v159, v190, v191
v_lshlrev_b32 v190, 16, v152
v_and_b32 v191, s44, v152
v_add_f32 v190, v190, v142
v_add_f32 v191, v191, v143
v_cvt_pk_bf16_f32 v160, v190, v191
v_lshlrev_b32 v190, 16, v153
v_and_b32 v191, s44, v153
v_add_f32 v190, v190, v144
v_add_f32 v191, v191, v145
v_cvt_pk_bf16_f32 v161, v190, v191
ds_write_b128 v192, v[154:157]
ds_write_b128 v192, v[158:161] offset:4096
s_waitcnt lgkmcnt(0)
s_barrier
v_max3_u32 v1, v178, v179, v180
v_max_u32 v1, v1, v181
v_cmp_eq_u32 vcc, -1, v1
s_cbranch_vccnz qk_99
ds_write_b128 v193, v[178:181]
s_waitcnt lgkmcnt(0)
qk_100:
s_waitcnt lgkmcnt(0)
s_barrier
s_branch L_end
pf_55:
s_add_u32 s19, s19, 1
s_cmp_gt_u32 s19, 1048576
s_cbranch_scc1 L_end
buffer_load_dword v1, v170, s[4:7], s35 offen sc1
s_waitcnt vmcnt(0)
v_readfirstlane_b32 s40, v1
s_cmp_gt_u32 s40, s18
s_cbranch_scc1 pf_56
s_sleep 4
s_branch pf_55
pf_59:
s_add_u32 s19, s19, 1
s_cmp_gt_u32 s19, 1048576
s_cbranch_scc1 L_end
buffer_load_dword v1, v173, s[4:7], s36 offen sc1
s_waitcnt vmcnt(0)
v_readfirstlane_b32 s40, v1
s_cmp_gt_u32 s40, s18
s_cbranch_scc1 pf_60
s_sleep 4
s_branch pf_59
ql_62:
buffer_store_dword v1, v173, s[4:7], s37 offen
s_branch ql_63
ql_64:
buffer_store_dwordx4 v[202:205], v253, s[4:7], s22 offen
buffer_store_dwordx4 v[206:209], v253, s[4:7], s22 offen offset:2048
s_branch ql_65
pf_66:
s_add_u32 s19, s19, 1
s_cmp_gt_u32 s19, 1048576
s_cbranch_scc1 L_end
buffer_load_dword v1, v173, s[4:7], s36 offen sc1
s_waitcnt vmcnt(0)
v_readfirstlane_b32 s40, v1
s_cmp_gt_u32 s40, s18
s_cbranch_scc1 pf_67
s_sleep 4
s_branch pf_66
ql_68:
buffer_store_dword v1, v173, s[4:7], s37 offen
s_branch ql_69
ql_70:
buffer_store_dwordx4 v[202:205], v253, s[4:7], s22 offen
buffer_store_dwordx4 v[206:209], v253, s[4:7], s22 offen offset:2048
s_branch ql_71
ql_72:
buffer_store_dword v1, v173, s[4:7], s37 offen
s_branch ql_73
pf_74:
s_add_u32 s19, s19, 1
s_cmp_gt_u32 s19, 1048576
s_cbranch_scc1 L_end
buffer_load_dword v1, v173, s[4:7], s36 offen sc1
s_waitcnt vmcnt(0)
v_readfirstlane_b32 s40, v1
s_cmp_gt_u32 s40, s18
s_cbranch_scc1 pf_75
s_sleep 4
s_branch pf_74
ql_77:
buffer_store_dword v1, v173, s[4:7], s37 offen
s_branch ql_78
ql_79:
buffer_store_dwordx4 v[202:205], v253, s[4:7], s22 offen
buffer_store_dwordx4 v[206:209], v253, s[4:7], s22 offen offset:2048
s_branch ql_80
pf_81:
s_add_u32 s19, s19, 1
s_cmp_gt_u32 s19, 1048576
s_cbranch_scc1 L_end
buffer_load_dword v1, v173, s[4:7], s36 offen sc1
s_waitcnt vmcnt(0)
v_readfirstlane_b32 s40, v1
s_cmp_gt_u32 s40, s18
s_cbranch_scc1 pf_82
s_sleep 4
s_branch pf_81
ql_83:
buffer_store_dword v1, v173, s[4:7], s37 offen
s_branch ql_84
ql_85:
buffer_store_dwordx4 v[202:205], v253, s[4:7], s22 offen
buffer_store_dwordx4 v[206:209], v253, s[4:7], s22 offen offset:2048
s_branch ql_86
ql_87:
buffer_store_dword v1, v173, s[4:7], s37 offen
s_branch ql_88
pf_89:
s_add_u32 s19, s19, 1
s_cmp_gt_u32 s19, 1048576
s_cbranch_scc1 L_end
buffer_load_dword v1, v173, s[4:7], s36 offen sc1
s_waitcnt vmcnt(0)
v_readfirstlane_b32 s40, v1
s_cmp_gt_u32 s40, s18
s_cbranch_scc1 pf_90
s_sleep 4
s_branch pf_89
qk_93:
s_lshl_b32 s20, s39, 16
s_add_u32 s21, s52, s43
s_xor_b32 s21, s21, 0x8000
s_add_u32 m0, s21, 0
s_nop 0
buffer_load_dwordx4 v177, s[48:51], s20 offen offset:0 lds
s_add_u32 m0, s21, 3968
s_nop 0
buffer_load_dwordx4 v177, s[48:51], s20 offen offset:128 lds
s_add_u32 m0, s21, 7936
s_nop 0
buffer_load_dwordx4 v177, s[48:51], s20 offen offset:256 lds
s_add_u32 m0, s21, 11904
s_nop 0
buffer_load_dwordx4 v177, s[48:51], s20 offen offset:384 lds
qk_95:
s_add_u32 s19, s19, 1
s_cmp_gt_u32 s19, 1048576
s_cbranch_scc1 L_end
buffer_load_dwordx4 v[178:181], v171, s[4:7], s24 offen sc1
s_sleep 8
s_waitcnt vmcnt(0)
v_max3_u32 v1, v178, v179, v180
v_max_u32 v1, v1, v181
v_cmp_eq_u32 vcc, -1, v1
s_cbranch_vccnz qk_95
ds_write_b128 v193, v[178:181]
s_branch qk_94
pf_96:
s_add_u32 s19, s19, 1
s_cmp_gt_u32 s19, 1048576
s_cbranch_scc1 L_end
buffer_load_dword v1, v173, s[4:7], s36 offen sc1
s_waitcnt vmcnt(0)
v_readfirstlane_b32 s40, v1
s_cmp_gt_u32 s40, s18
s_cbranch_scc1 pf_97
s_sleep 4
s_branch pf_96
qk_99:

qk_101:
s_add_u32 s19, s19, 1
s_cmp_gt_u32 s19, 1048576
s_cbranch_scc1 L_end
buffer_load_dwordx4 v[178:181], v171, s[4:7], s24 offen sc1
s_sleep 0
s_waitcnt vmcnt(0)
v_max3_u32 v1, v178, v179, v180
v_max_u32 v1, v1, v181
v_cmp_eq_u32 vcc, -1, v1
s_cbranch_vccnz qk_101
ds_write_b128 v193, v[178:181]
s_branch qk_100
L_kv:
s_lshr_b32 s40, s15, 2
s_load_dwordx2 s[48:49], s[0:1], 48
s_mov_b32 s50, 4194304
s_mov_b32 s51, 0x20000
s_waitcnt lgkmcnt(0)
s_lshr_b32 s22, s15, 2
s_and_b32 s23, s12, 1
s_lshl_b32 s23, s23, 2
v_lshrrev_b32 v1, 4, v0
v_or_b32 v1, s23, v1
v_and_b32 v250, 7, v0
v_xor_b32 v250, v250, v1
v_lshlrev_b32 v250, 4, v250
v_lshrrev_b32 v1, 3, v0
v_lshl_add_u32 v250, v1, 11, v250
s_lshl_b32 s20, s12, 14
s_lshl_b32 s21, s22, 10
s_add_u32 s20, s20, s21
v_add_u32 v250, s20, v250
v_xor_b32 v253, 1024, v250
s_lshl_b32 s52, s22, 15
s_lshl_b32 s21, s12, 10
s_add_u32 s52, s52, s21
v_bfe_u32 v1, v0, 1, 3
v_lshrrev_b32 v251, 4, v0
v_xor_b32 v251, v251, v1
v_lshlrev_b32 v251, 4, v251
v_and_b32 v1, 15, v0
v_lshl_add_u32 v251, v1, 7, v251
s_lshl_b32 s20, s22, 15
v_add_u32 v251, s20, v251
v_xor_b32 v252, 64, v251
s_mov_b32 s18, 0
s_mov_b32 s41, 0
s_lshl_b32 s20, s18, 16
s_mov_b32 s21, s52
s_add_u32 m0, s21, 0
s_nop 0
buffer_load_dwordx4 v250, s[48:51], s20 offen offset:0 lds
s_add_u32 m0, s21, 3968
s_nop 0
buffer_load_dwordx4 v250, s[48:51], s20 offen offset:128 lds
s_add_u32 m0, s21, 7936
s_nop 0
buffer_load_dwordx4 v250, s[48:51], s20 offen offset:256 lds
s_add_u32 m0, s21, 11904
s_nop 0
buffer_load_dwordx4 v250, s[48:51], s20 offen offset:384 lds
s_add_u32 m0, s21, 15872
s_nop 0
buffer_load_dwordx4 v250, s[48:51], s20 offen offset:512 lds
s_add_u32 m0, s21, 19840
s_nop 0
buffer_load_dwordx4 v250, s[48:51], s20 offen offset:640 lds
s_add_u32 m0, s21, 23808
s_nop 0
buffer_load_dwordx4 v250, s[48:51], s20 offen offset:768 lds
s_add_u32 m0, s21, 27776
s_nop 0
buffer_load_dwordx4 v250, s[48:51], s20 offen offset:896 lds
s_cmp_eq_u32 s33, 1
s_cbranch_scc1 kvV_102
s_load_dwordx2 s[8:9], s[0:1], 72
s_mov_b32 s10, 8388608
s_mov_b32 s11, 0x20000
s_waitcnt lgkmcnt(0)
s_lshl_b32 s22, s15, 20
s_lshl_b32 s21, s32, 8
s_add_u32 s22, s22, s21
v_bfe_u32 v1, v0, 4, 2
v_lshlrev_b32 v202, 13, v1
v_bfe_u32 v1, v0, 0, 4
v_lshl_add_u32 v202, v1, 4, v202
v_add_u32 v202, s22, v202
s_mov_b32 s20, 0
buffer_load_dwordx4 v[2:5], v202, s[8:11], s20 offen nt
s_mov_b32 s21, 32768
buffer_load_dwordx4 v[6:9], v202, s[8:11], s21 offen nt
s_mov_b32 s20, 65536
buffer_load_dwordx4 v[10:13], v202, s[8:11], s20 offen nt
s_mov_b32 s21, 98304
buffer_load_dwordx4 v[14:17], v202, s[8:11], s21 offen nt
s_mov_b32 s20, 131072
buffer_load_dwordx4 v[18:21], v202, s[8:11], s20 offen nt
s_mov_b32 s21, 163840
buffer_load_dwordx4 v[22:25], v202, s[8:11], s21 offen nt
s_mov_b32 s20, 196608
buffer_load_dwordx4 v[26:29], v202, s[8:11], s20 offen nt
s_mov_b32 s21, 229376
buffer_load_dwordx4 v[30:33], v202, s[8:11], s21 offen nt
s_mov_b32 s20, 262144
buffer_load_dwordx4 v[34:37], v202, s[8:11], s20 offen nt
s_mov_b32 s21, 294912
buffer_load_dwordx4 v[38:41], v202, s[8:11], s21 offen nt
s_mov_b32 s20, 327680
buffer_load_dwordx4 v[42:45], v202, s[8:11], s20 offen nt
s_mov_b32 s21, 360448
buffer_load_dwordx4 v[46:49], v202, s[8:11], s21 offen nt
s_mov_b32 s20, 393216
buffer_load_dwordx4 v[50:53], v202, s[8:11], s20 offen nt
s_mov_b32 s21, 425984
buffer_load_dwordx4 v[54:57], v202, s[8:11], s21 offen nt
s_mov_b32 s20, 458752
buffer_load_dwordx4 v[58:61], v202, s[8:11], s20 offen nt
s_mov_b32 s21, 491520
buffer_load_dwordx4 v[62:65], v202, s[8:11], s21 offen nt
s_mov_b32 s20, 524288
buffer_load_dwordx4 v[66:69], v202, s[8:11], s20 offen nt
s_mov_b32 s21, 557056
buffer_load_dwordx4 v[70:73], v202, s[8:11], s21 offen nt
s_mov_b32 s20, 589824
buffer_load_dwordx4 v[74:77], v202, s[8:11], s20 offen nt
s_mov_b32 s21, 622592
buffer_load_dwordx4 v[78:81], v202, s[8:11], s21 offen nt
s_mov_b32 s20, 655360
buffer_load_dwordx4 v[82:85], v202, s[8:11], s20 offen nt
s_mov_b32 s21, 688128
buffer_load_dwordx4 v[86:89], v202, s[8:11], s21 offen nt
s_mov_b32 s20, 720896
buffer_load_dwordx4 v[90:93], v202, s[8:11], s20 offen nt
s_mov_b32 s21, 753664
buffer_load_dwordx4 v[94:97], v202, s[8:11], s21 offen nt
s_mov_b32 s20, 786432
buffer_load_dwordx4 v[98:101], v202, s[8:11], s20 offen nt
s_mov_b32 s21, 819200
buffer_load_dwordx4 v[102:105], v202, s[8:11], s21 offen nt
s_mov_b32 s20, 851968
buffer_load_dwordx4 v[106:109], v202, s[8:11], s20 offen nt
s_mov_b32 s21, 884736
buffer_load_dwordx4 v[110:113], v202, s[8:11], s21 offen nt
s_mov_b32 s20, 917504
buffer_load_dwordx4 v[114:117], v202, s[8:11], s20 offen nt
s_mov_b32 s21, 950272
buffer_load_dwordx4 v[118:121], v202, s[8:11], s21 offen nt
s_mov_b32 s20, 983040
buffer_load_dwordx4 v[122:125], v202, s[8:11], s20 offen nt
s_mov_b32 s21, 1015808
buffer_load_dwordx4 v[126:129], v202, s[8:11], s21 offen nt
s_lshl_b32 s20, s15, 13
s_add_u32 s20, s20, 65536
v_bfe_u32 v1, v0, 4, 2
v_lshlrev_b32 v202, 8, v1
v_bfe_u32 v1, v0, 0, 4
v_lshl_add_u32 v202, v1, 4, v202
v_add_u32 v202, s20, v202
v_bfe_u32 v1, v0, 4, 2
v_lshlrev_b32 v1, 6, v1
v_xor_b32 v202, v202, v1
s_lshr_b32 s21, s15, 2
s_lshl_b32 s20, s21, 15
s_lshl_b32 s22, s12, 6
s_add_u32 s20, s20, s22
s_add_u32 s20, s20, 65536
v_bfe_u32 v1, v0, 4, 2
v_lshlrev_b32 v203, 11, v1
v_bfe_u32 v1, v0, 2, 2
v_lshl_add_u32 v203, v1, 8, v203
v_bfe_u32 v1, v0, 0, 2
v_lshl_add_u32 v203, v1, 4, v203
v_add_u32 v203, s20, v203
v_bfe_u32 v1, v0, 2, 2
v_lshlrev_b32 v1, 6, v1
v_xor_b32 v203, v203, v1
s_lshl_b32 s22, s12, 10
s_add_u32 s22, s22, 4194304
v_bfe_u32 v1, v0, 0, 6
v_lshlrev_b32 v205, 4, v1
v_add_u32 v205, s22, v205
s_branch kvJ_103
kvV_102:
s_load_dwordx2 s[8:9], s[0:1], 80
s_mov_b32 s10, 8388608
s_mov_b32 s11, 0x20000
s_waitcnt lgkmcnt(0)
s_lshl_b32 s22, s15, 20
s_lshl_b32 s21, s32, 8
s_add_u32 s22, s22, s21
v_bfe_u32 v1, v0, 4, 2
v_lshlrev_b32 v202, 13, v1
v_bfe_u32 v1, v0, 0, 4
v_lshl_add_u32 v202, v1, 4, v202
v_add_u32 v202, s22, v202
s_mov_b32 s20, 0
buffer_load_dwordx4 v[2:5], v202, s[8:11], s20 offen nt
s_mov_b32 s21, 32768
buffer_load_dwordx4 v[6:9], v202, s[8:11], s21 offen nt
s_mov_b32 s20, 65536
buffer_load_dwordx4 v[10:13], v202, s[8:11], s20 offen nt
s_mov_b32 s21, 98304
buffer_load_dwordx4 v[14:17], v202, s[8:11], s21 offen nt
s_mov_b32 s20, 131072
buffer_load_dwordx4 v[18:21], v202, s[8:11], s20 offen nt
s_mov_b32 s21, 163840
buffer_load_dwordx4 v[22:25], v202, s[8:11], s21 offen nt
s_mov_b32 s20, 196608
buffer_load_dwordx4 v[26:29], v202, s[8:11], s20 offen nt
s_mov_b32 s21, 229376
buffer_load_dwordx4 v[30:33], v202, s[8:11], s21 offen nt
s_mov_b32 s20, 262144
buffer_load_dwordx4 v[34:37], v202, s[8:11], s20 offen nt
s_mov_b32 s21, 294912
buffer_load_dwordx4 v[38:41], v202, s[8:11], s21 offen nt
s_mov_b32 s20, 327680
buffer_load_dwordx4 v[42:45], v202, s[8:11], s20 offen nt
s_mov_b32 s21, 360448
buffer_load_dwordx4 v[46:49], v202, s[8:11], s21 offen nt
s_mov_b32 s20, 393216
buffer_load_dwordx4 v[50:53], v202, s[8:11], s20 offen nt
s_mov_b32 s21, 425984
buffer_load_dwordx4 v[54:57], v202, s[8:11], s21 offen nt
s_mov_b32 s20, 458752
buffer_load_dwordx4 v[58:61], v202, s[8:11], s20 offen nt
s_mov_b32 s21, 491520
buffer_load_dwordx4 v[62:65], v202, s[8:11], s21 offen nt
s_mov_b32 s20, 524288
buffer_load_dwordx4 v[66:69], v202, s[8:11], s20 offen nt
s_mov_b32 s21, 557056
buffer_load_dwordx4 v[70:73], v202, s[8:11], s21 offen nt
s_mov_b32 s20, 589824
buffer_load_dwordx4 v[74:77], v202, s[8:11], s20 offen nt
s_mov_b32 s21, 622592
buffer_load_dwordx4 v[78:81], v202, s[8:11], s21 offen nt
s_mov_b32 s20, 655360
buffer_load_dwordx4 v[82:85], v202, s[8:11], s20 offen nt
s_mov_b32 s21, 688128
buffer_load_dwordx4 v[86:89], v202, s[8:11], s21 offen nt
s_mov_b32 s20, 720896
buffer_load_dwordx4 v[90:93], v202, s[8:11], s20 offen nt
s_mov_b32 s21, 753664
buffer_load_dwordx4 v[94:97], v202, s[8:11], s21 offen nt
s_mov_b32 s20, 786432
buffer_load_dwordx4 v[98:101], v202, s[8:11], s20 offen nt
s_mov_b32 s21, 819200
buffer_load_dwordx4 v[102:105], v202, s[8:11], s21 offen nt
s_mov_b32 s20, 851968
buffer_load_dwordx4 v[106:109], v202, s[8:11], s20 offen nt
s_mov_b32 s21, 884736
buffer_load_dwordx4 v[110:113], v202, s[8:11], s21 offen nt
s_mov_b32 s20, 917504
buffer_load_dwordx4 v[114:117], v202, s[8:11], s20 offen nt
s_mov_b32 s21, 950272
buffer_load_dwordx4 v[118:121], v202, s[8:11], s21 offen nt
s_mov_b32 s20, 983040
buffer_load_dwordx4 v[122:125], v202, s[8:11], s20 offen nt
s_mov_b32 s21, 1015808
buffer_load_dwordx4 v[126:129], v202, s[8:11], s21 offen nt
s_lshl_b32 s20, s15, 13
s_add_u32 s20, s20, 65536
v_bfe_u32 v1, v0, 4, 2
v_lshlrev_b32 v202, 8, v1
v_bfe_u32 v1, v0, 0, 4
v_lshl_add_u32 v202, v1, 4, v202
v_add_u32 v202, s20, v202
v_bfe_u32 v1, v0, 4, 2
v_lshlrev_b32 v1, 6, v1
v_xor_b32 v202, v202, v1
s_lshr_b32 s21, s15, 2
s_lshl_b32 s20, s21, 15
s_lshl_b32 s22, s12, 6
s_add_u32 s20, s20, s22
s_add_u32 s20, s20, 65536
v_bfe_u32 v1, v0, 4, 2
v_lshlrev_b32 v203, 11, v1
v_bfe_u32 v1, v0, 2, 2
v_lshl_add_u32 v203, v1, 8, v203
v_bfe_u32 v1, v0, 0, 2
v_lshl_add_u32 v203, v1, 4, v203
v_add_u32 v203, s20, v203
v_bfe_u32 v1, v0, 2, 2
v_lshlrev_b32 v1, 6, v1
v_xor_b32 v203, v203, v1
s_lshl_b32 s22, s12, 11
s_add_u32 s22, s22, 37748736
v_bfe_u32 v1, v0, 0, 6
v_lshlrev_b32 v205, 4, v1
v_add_u32 v205, s22, v205
kvJ_103:
s_lshl_b32 s42, s32, 20
s_add_u32 s42, s42, 8192
s_and_b32 s21, s32, 1
s_lshl_b32 s21, s21, 14
s_xor_b32 s42, s42, s21
s_and_b32 s21, s32, 2
s_lshl_b32 s21, s21, 12
s_xor_b32 s42, s42, s21
s_lshl_b32 s43, s32, 8
s_lshl_b32 s21, s33, 7
s_add_u32 s43, s43, s21
s_add_u32 s43, s43, 3932160
s_lshl_b32 s20, s12, 12
s_add_u32 s20, s20, 131072
v_lshlrev_b32 v204, 4, v0
v_add_u32 v204, s20, v204
v_mov_b32 v1, 2147483632
v_cmp_ne_u32 vcc, 0, v0
s_nop 1
v_cndmask_b32 v206, 0, v1, vcc
s_cmp_eq_u32 s12, 0
s_cselect_b32 s20, 0, 2147483632
v_or_b32 v206, s20, v206
s_and_b32 s20, s14, 15
s_lshl_b32 s21, s20, 12
s_lshl_b32 s22, s12, 10
s_add_u32 s21, s21, s22
v_lshlrev_b32 v207, 6, v0
v_add_u32 v207, s21, v207
v_mov_b32 v1, 2147483632
v_cmp_gt_u32 vcc, 16, v0
s_nop 1
v_cndmask_b32 v207, v1, v207, vcc
s_load_dwordx2 s[36:37], s[0:1], 0
s_mov_b32 s38, 4194304
s_mov_b32 s39, 0x20000
s_waitcnt lgkmcnt(0)
s_and_b32 s20, s13, 3
s_lshr_b32 s22, s14, 1
s_and_b32 s23, s14, 1
s_lshl_b32 s24, s15, 19
s_lshl_b32 s21, s22, 8
s_add_u32 s24, s24, s21
s_lshl_b32 s21, s20, 6
s_add_u32 s24, s24, s21
s_lshl_b32 s21, s23, 5
s_add_u32 s24, s24, s21
v_bfe_u32 v1, v0, 1, 5
v_lshlrev_b32 v249, 14, v1
v_bfe_u32 v1, v0, 0, 1
v_lshl_add_u32 v249, v1, 4, v249
v_add_u32 v249, s24, v249
s_mov_b32 s22, 65536
buffer_load_dword v248, v207, s[48:51], s22 offen
s_mov_b32 s22, 131072
buffer_load_dword v248, v207, s[48:51], s22 offen
s_mov_b32 s22, 196608
buffer_load_dword v248, v207, s[48:51], s22 offen
v_and_b32 v1, 7, v0
v_lshlrev_b32 v1, 5, v1
buffer_load_dwordx2 v[240:241], v1, s[28:31], 0 offen sc1
s_cmp_eq_u32 s33, 1
s_cbranch_scc1 kvm_108
s_waitcnt vmcnt(35)
ds_write_b128 v202, v[2:5] offset:0
s_waitcnt vmcnt(34)
ds_write_b128 v202, v[6:9] offset:1024
s_waitcnt vmcnt(33)
ds_write_b128 v202, v[10:13] offset:2048
s_waitcnt vmcnt(32)
ds_write_b128 v202, v[14:17] offset:3072
s_waitcnt vmcnt(31)
ds_write_b128 v202, v[18:21] offset:4096
s_waitcnt vmcnt(30)
ds_write_b128 v202, v[22:25] offset:5120
s_waitcnt vmcnt(29)
ds_write_b128 v202, v[26:29] offset:6144
s_waitcnt vmcnt(28)
ds_write_b128 v202, v[30:33] offset:7168
s_waitcnt lgkmcnt(0)
s_barrier
ds_read_b64_tr_b16 v[2:3], v203 offset:0
ds_read_b64_tr_b16 v[4:5], v203 offset:1024
ds_read_b64_tr_b16 v[6:7], v203 offset:8
ds_read_b64_tr_b16 v[8:9], v203 offset:1032
ds_read_b64_tr_b16 v[10:11], v203 offset:8192
ds_read_b64_tr_b16 v[12:13], v203 offset:9216
ds_read_b64_tr_b16 v[14:15], v203 offset:8200
ds_read_b64_tr_b16 v[16:17], v203 offset:9224
ds_read_b64_tr_b16 v[18:19], v203 offset:16384
ds_read_b64_tr_b16 v[20:21], v203 offset:17408
ds_read_b64_tr_b16 v[22:23], v203 offset:16392
ds_read_b64_tr_b16 v[24:25], v203 offset:17416
s_waitcnt lgkmcnt(8)
ds_read_b64_tr_b16 v[26:27], v203 offset:24576
ds_read_b64_tr_b16 v[28:29], v203 offset:25600
ds_read_b64_tr_b16 v[30:31], v203 offset:24584
ds_read_b64_tr_b16 v[32:33], v203 offset:25608
s_waitcnt lgkmcnt(0)
s_barrier
ds_read_b128 v[186:189], v251 offset:0
ds_read_b128 v[190:193], v251 offset:2048
ds_read_b128 v[194:197], v251 offset:8192
ds_read_b128 v[198:201], v251 offset:10240
ds_read_b128 v[146:149], v251 offset:16384
ds_read_b128 v[150:153], v251 offset:18432
ds_read_b128 v[154:157], v251 offset:24576
ds_read_b128 v[158:161], v251 offset:26624
s_waitcnt lgkmcnt(7)
v_mfma_f32_16x16x32_bf16 v[130:133], v[2:5], v[186:189], 0
v_mfma_f32_16x16x32_bf16 v[134:137], v[6:9], v[186:189], 0
s_waitcnt lgkmcnt(6)
v_mfma_f32_16x16x32_bf16 v[138:141], v[2:5], v[190:193], 0
v_mfma_f32_16x16x32_bf16 v[142:145], v[6:9], v[190:193], 0
s_waitcnt lgkmcnt(5)
v_mfma_f32_16x16x32_bf16 v[130:133], v[10:13], v[194:197], v[130:133]
v_mfma_f32_16x16x32_bf16 v[134:137], v[14:17], v[194:197], v[134:137]
s_waitcnt lgkmcnt(4)
v_mfma_f32_16x16x32_bf16 v[138:141], v[10:13], v[198:201], v[138:141]
v_mfma_f32_16x16x32_bf16 v[142:145], v[14:17], v[198:201], v[142:145]
s_waitcnt lgkmcnt(3)
v_mfma_f32_16x16x32_bf16 v[130:133], v[18:21], v[146:149], v[130:133]
v_mfma_f32_16x16x32_bf16 v[134:137], v[22:25], v[146:149], v[134:137]
s_waitcnt lgkmcnt(2)
v_mfma_f32_16x16x32_bf16 v[138:141], v[18:21], v[150:153], v[138:141]
v_mfma_f32_16x16x32_bf16 v[142:145], v[22:25], v[150:153], v[142:145]
s_waitcnt lgkmcnt(1)
v_mfma_f32_16x16x32_bf16 v[130:133], v[26:29], v[154:157], v[130:133]
v_mfma_f32_16x16x32_bf16 v[134:137], v[30:33], v[154:157], v[134:137]
s_waitcnt lgkmcnt(0)
v_mfma_f32_16x16x32_bf16 v[138:141], v[26:29], v[158:161], v[138:141]
v_mfma_f32_16x16x32_bf16 v[142:145], v[30:33], v[158:161], v[142:145]
s_waitcnt vmcnt(27)
ds_write_b128 v202, v[34:37] offset:0
s_waitcnt vmcnt(26)
ds_write_b128 v202, v[38:41] offset:1024
s_waitcnt vmcnt(25)
ds_write_b128 v202, v[42:45] offset:2048
s_waitcnt vmcnt(24)
ds_write_b128 v202, v[46:49] offset:3072
s_waitcnt vmcnt(23)
ds_write_b128 v202, v[50:53] offset:4096
s_waitcnt vmcnt(22)
ds_write_b128 v202, v[54:57] offset:5120
s_waitcnt vmcnt(21)
ds_write_b128 v202, v[58:61] offset:6144
s_waitcnt vmcnt(20)
ds_write_b128 v202, v[62:65] offset:7168
s_waitcnt lgkmcnt(0)
s_barrier
ds_read_b64_tr_b16 v[34:35], v203 offset:0
ds_read_b64_tr_b16 v[36:37], v203 offset:1024
ds_read_b64_tr_b16 v[38:39], v203 offset:8
ds_read_b64_tr_b16 v[40:41], v203 offset:1032
ds_read_b64_tr_b16 v[42:43], v203 offset:8192
ds_read_b64_tr_b16 v[44:45], v203 offset:9216
ds_read_b64_tr_b16 v[46:47], v203 offset:8200
ds_read_b64_tr_b16 v[48:49], v203 offset:9224
ds_read_b64_tr_b16 v[50:51], v203 offset:16384
ds_read_b64_tr_b16 v[52:53], v203 offset:17408
ds_read_b64_tr_b16 v[54:55], v203 offset:16392
ds_read_b64_tr_b16 v[56:57], v203 offset:17416
s_waitcnt lgkmcnt(8)
ds_read_b64_tr_b16 v[58:59], v203 offset:24576
ds_read_b64_tr_b16 v[60:61], v203 offset:25600
ds_read_b64_tr_b16 v[62:63], v203 offset:24584
ds_read_b64_tr_b16 v[64:65], v203 offset:25608
s_waitcnt lgkmcnt(0)
s_barrier
ds_read_b128 v[186:189], v252 offset:0
ds_read_b128 v[190:193], v252 offset:2048
ds_read_b128 v[194:197], v252 offset:8192
ds_read_b128 v[198:201], v252 offset:10240
ds_read_b128 v[146:149], v252 offset:16384
ds_read_b128 v[150:153], v252 offset:18432
ds_read_b128 v[154:157], v252 offset:24576
ds_read_b128 v[158:161], v252 offset:26624
s_waitcnt lgkmcnt(7)
v_mfma_f32_16x16x32_bf16 v[130:133], v[34:37], v[186:189], v[130:133]
v_mfma_f32_16x16x32_bf16 v[134:137], v[38:41], v[186:189], v[134:137]
s_waitcnt lgkmcnt(6)
v_mfma_f32_16x16x32_bf16 v[138:141], v[34:37], v[190:193], v[138:141]
v_mfma_f32_16x16x32_bf16 v[142:145], v[38:41], v[190:193], v[142:145]
s_waitcnt lgkmcnt(5)
v_mfma_f32_16x16x32_bf16 v[130:133], v[42:45], v[194:197], v[130:133]
v_mfma_f32_16x16x32_bf16 v[134:137], v[46:49], v[194:197], v[134:137]
s_waitcnt lgkmcnt(4)
v_mfma_f32_16x16x32_bf16 v[138:141], v[42:45], v[198:201], v[138:141]
v_mfma_f32_16x16x32_bf16 v[142:145], v[46:49], v[198:201], v[142:145]
s_waitcnt lgkmcnt(3)
v_mfma_f32_16x16x32_bf16 v[130:133], v[50:53], v[146:149], v[130:133]
v_mfma_f32_16x16x32_bf16 v[134:137], v[54:57], v[146:149], v[134:137]
s_waitcnt lgkmcnt(2)
v_mfma_f32_16x16x32_bf16 v[138:141], v[50:53], v[150:153], v[138:141]
v_mfma_f32_16x16x32_bf16 v[142:145], v[54:57], v[150:153], v[142:145]
s_waitcnt lgkmcnt(1)
v_mfma_f32_16x16x32_bf16 v[130:133], v[58:61], v[154:157], v[130:133]
v_mfma_f32_16x16x32_bf16 v[134:137], v[62:65], v[154:157], v[134:137]
s_waitcnt lgkmcnt(0)
v_mfma_f32_16x16x32_bf16 v[138:141], v[58:61], v[158:161], v[138:141]
v_mfma_f32_16x16x32_bf16 v[142:145], v[62:65], v[158:161], v[142:145]
s_waitcnt vmcnt(19)
ds_write_b128 v202, v[66:69] offset:0
s_waitcnt vmcnt(18)
ds_write_b128 v202, v[70:73] offset:1024
s_waitcnt vmcnt(17)
ds_write_b128 v202, v[74:77] offset:2048
s_waitcnt vmcnt(16)
ds_write_b128 v202, v[78:81] offset:3072
s_waitcnt vmcnt(15)
ds_write_b128 v202, v[82:85] offset:4096
s_waitcnt vmcnt(14)
ds_write_b128 v202, v[86:89] offset:5120
s_waitcnt vmcnt(13)
ds_write_b128 v202, v[90:93] offset:6144
s_waitcnt vmcnt(12)
ds_write_b128 v202, v[94:97] offset:7168
s_waitcnt lgkmcnt(0)
s_barrier
ds_read_b64_tr_b16 v[66:67], v203 offset:0
ds_read_b64_tr_b16 v[68:69], v203 offset:1024
ds_read_b64_tr_b16 v[70:71], v203 offset:8
ds_read_b64_tr_b16 v[72:73], v203 offset:1032
ds_read_b64_tr_b16 v[74:75], v203 offset:8192
ds_read_b64_tr_b16 v[76:77], v203 offset:9216
ds_read_b64_tr_b16 v[78:79], v203 offset:8200
ds_read_b64_tr_b16 v[80:81], v203 offset:9224
ds_read_b64_tr_b16 v[82:83], v203 offset:16384
ds_read_b64_tr_b16 v[84:85], v203 offset:17408
ds_read_b64_tr_b16 v[86:87], v203 offset:16392
ds_read_b64_tr_b16 v[88:89], v203 offset:17416
s_waitcnt lgkmcnt(8)
ds_read_b64_tr_b16 v[90:91], v203 offset:24576
ds_read_b64_tr_b16 v[92:93], v203 offset:25600
ds_read_b64_tr_b16 v[94:95], v203 offset:24584
ds_read_b64_tr_b16 v[96:97], v203 offset:25608
s_waitcnt lgkmcnt(0)
s_barrier
ds_read_b128 v[186:189], v251 offset:4096
ds_read_b128 v[190:193], v251 offset:6144
ds_read_b128 v[194:197], v251 offset:12288
ds_read_b128 v[198:201], v251 offset:14336
ds_read_b128 v[146:149], v251 offset:20480
ds_read_b128 v[150:153], v251 offset:22528
ds_read_b128 v[154:157], v251 offset:28672
ds_read_b128 v[158:161], v251 offset:30720
s_waitcnt lgkmcnt(7)
v_mfma_f32_16x16x32_bf16 v[130:133], v[66:69], v[186:189], v[130:133]
v_mfma_f32_16x16x32_bf16 v[134:137], v[70:73], v[186:189], v[134:137]
s_waitcnt lgkmcnt(6)
v_mfma_f32_16x16x32_bf16 v[138:141], v[66:69], v[190:193], v[138:141]
v_mfma_f32_16x16x32_bf16 v[142:145], v[70:73], v[190:193], v[142:145]
s_waitcnt lgkmcnt(5)
v_mfma_f32_16x16x32_bf16 v[130:133], v[74:77], v[194:197], v[130:133]
v_mfma_f32_16x16x32_bf16 v[134:137], v[78:81], v[194:197], v[134:137]
s_waitcnt lgkmcnt(4)
v_mfma_f32_16x16x32_bf16 v[138:141], v[74:77], v[198:201], v[138:141]
v_mfma_f32_16x16x32_bf16 v[142:145], v[78:81], v[198:201], v[142:145]
s_waitcnt lgkmcnt(3)
v_mfma_f32_16x16x32_bf16 v[130:133], v[82:85], v[146:149], v[130:133]
v_mfma_f32_16x16x32_bf16 v[134:137], v[86:89], v[146:149], v[134:137]
s_waitcnt lgkmcnt(2)
v_mfma_f32_16x16x32_bf16 v[138:141], v[82:85], v[150:153], v[138:141]
v_mfma_f32_16x16x32_bf16 v[142:145], v[86:89], v[150:153], v[142:145]
s_waitcnt lgkmcnt(1)
v_mfma_f32_16x16x32_bf16 v[130:133], v[90:93], v[154:157], v[130:133]
v_mfma_f32_16x16x32_bf16 v[134:137], v[94:97], v[154:157], v[134:137]
s_waitcnt lgkmcnt(0)
v_mfma_f32_16x16x32_bf16 v[138:141], v[90:93], v[158:161], v[138:141]
v_mfma_f32_16x16x32_bf16 v[142:145], v[94:97], v[158:161], v[142:145]
s_waitcnt vmcnt(11)
ds_write_b128 v202, v[98:101] offset:0
s_waitcnt vmcnt(10)
ds_write_b128 v202, v[102:105] offset:1024
s_waitcnt vmcnt(9)
ds_write_b128 v202, v[106:109] offset:2048
s_waitcnt vmcnt(8)
ds_write_b128 v202, v[110:113] offset:3072
s_waitcnt vmcnt(7)
ds_write_b128 v202, v[114:117] offset:4096
s_waitcnt vmcnt(6)
ds_write_b128 v202, v[118:121] offset:5120
s_waitcnt vmcnt(5)
ds_write_b128 v202, v[122:125] offset:6144
s_waitcnt vmcnt(4)
ds_write_b128 v202, v[126:129] offset:7168
s_waitcnt lgkmcnt(0)
s_barrier
ds_read_b64_tr_b16 v[98:99], v203 offset:0
ds_read_b64_tr_b16 v[100:101], v203 offset:1024
ds_read_b64_tr_b16 v[102:103], v203 offset:8
ds_read_b64_tr_b16 v[104:105], v203 offset:1032
ds_read_b64_tr_b16 v[106:107], v203 offset:8192
ds_read_b64_tr_b16 v[108:109], v203 offset:9216
ds_read_b64_tr_b16 v[110:111], v203 offset:8200
ds_read_b64_tr_b16 v[112:113], v203 offset:9224
ds_read_b64_tr_b16 v[114:115], v203 offset:16384
ds_read_b64_tr_b16 v[116:117], v203 offset:17408
ds_read_b64_tr_b16 v[118:119], v203 offset:16392
ds_read_b64_tr_b16 v[120:121], v203 offset:17416
s_waitcnt lgkmcnt(8)
ds_read_b64_tr_b16 v[122:123], v203 offset:24576
ds_read_b64_tr_b16 v[124:125], v203 offset:25600
ds_read_b64_tr_b16 v[126:127], v203 offset:24584
ds_read_b64_tr_b16 v[128:129], v203 offset:25608
s_waitcnt lgkmcnt(0)
s_barrier
ds_read_b128 v[186:189], v252 offset:4096
ds_read_b128 v[190:193], v252 offset:6144
ds_read_b128 v[194:197], v252 offset:12288
ds_read_b128 v[198:201], v252 offset:14336
ds_read_b128 v[146:149], v252 offset:20480
ds_read_b128 v[150:153], v252 offset:22528
ds_read_b128 v[154:157], v252 offset:28672
ds_read_b128 v[158:161], v252 offset:30720
s_waitcnt lgkmcnt(7)
v_mfma_f32_16x16x32_bf16 v[130:133], v[98:101], v[186:189], v[130:133]
v_mfma_f32_16x16x32_bf16 v[134:137], v[102:105], v[186:189], v[134:137]
s_waitcnt lgkmcnt(6)
v_mfma_f32_16x16x32_bf16 v[138:141], v[98:101], v[190:193], v[138:141]
v_mfma_f32_16x16x32_bf16 v[142:145], v[102:105], v[190:193], v[142:145]
s_waitcnt lgkmcnt(5)
v_mfma_f32_16x16x32_bf16 v[130:133], v[106:109], v[194:197], v[130:133]
v_mfma_f32_16x16x32_bf16 v[134:137], v[110:113], v[194:197], v[134:137]
s_waitcnt lgkmcnt(4)
v_mfma_f32_16x16x32_bf16 v[138:141], v[106:109], v[198:201], v[138:141]
v_mfma_f32_16x16x32_bf16 v[142:145], v[110:113], v[198:201], v[142:145]
s_waitcnt lgkmcnt(3)
v_mfma_f32_16x16x32_bf16 v[130:133], v[114:117], v[146:149], v[130:133]
v_mfma_f32_16x16x32_bf16 v[134:137], v[118:121], v[146:149], v[134:137]
s_waitcnt lgkmcnt(2)
v_mfma_f32_16x16x32_bf16 v[138:141], v[114:117], v[150:153], v[138:141]
v_mfma_f32_16x16x32_bf16 v[142:145], v[118:121], v[150:153], v[142:145]
s_waitcnt lgkmcnt(1)
v_mfma_f32_16x16x32_bf16 v[130:133], v[122:125], v[154:157], v[130:133]
v_mfma_f32_16x16x32_bf16 v[134:137], v[126:129], v[154:157], v[134:137]
s_waitcnt lgkmcnt(0)
v_mfma_f32_16x16x32_bf16 v[138:141], v[122:125], v[158:161], v[138:141]
v_mfma_f32_16x16x32_bf16 v[142:145], v[126:129], v[158:161], v[142:145]
s_nop 0
s_cmp_lg_u32 s16, 0
s_cbranch_scc1 rdy_109
v_and_b32 v1, 7, v0
v_lshlrev_b32 v1, 5, v1
s_branch rdy_113
rdy_110:
buffer_load_dwordx2 v[240:241], v1, s[28:31], 0 offen sc1
rdy_113:
s_mov_b32 s20, 0
s_waitcnt vmcnt(0)
v_readlane_b32 s21, v241, 0
s_nop 0
s_lshr_b32 s21, s21, 8
s_add_u32 s20, s20, s21
v_readlane_b32 s21, v241, 1
s_nop 0
s_lshr_b32 s21, s21, 8
s_add_u32 s20, s20, s21
v_readlane_b32 s21, v241, 2
s_nop 0
s_lshr_b32 s21, s21, 8
s_add_u32 s20, s20, s21
v_readlane_b32 s21, v241, 3
s_nop 0
s_lshr_b32 s21, s21, 8
s_add_u32 s20, s20, s21
v_readlane_b32 s21, v241, 4
s_nop 0
s_lshr_b32 s21, s21, 8
s_add_u32 s20, s20, s21
v_readlane_b32 s21, v241, 5
s_nop 0
s_lshr_b32 s21, s21, 8
s_add_u32 s20, s20, s21
v_readlane_b32 s21, v241, 6
s_nop 0
s_lshr_b32 s21, s21, 8
s_add_u32 s20, s20, s21
v_readlane_b32 s21, v241, 7
s_nop 0
s_lshr_b32 s21, s21, 8
s_add_u32 s20, s20, s21
s_and_b32 s21, s20, 0xfff
s_cmp_ge_u32 s21, 256
s_cbranch_scc1 rdy_111
s_add_u32 s19, s19, 1
s_cmp_gt_u32 s19, 1048576
s_cbranch_scc1 L_end
s_sleep 8
s_branch rdy_110
rdy_111:
s_lshr_b32 s20, s20, 12
s_cmp_gt_u32 s20, 16
s_cselect_b32 s17, 8192, 0
v_and_b32 v241, 0xfffff, v241
v_cmp_ne_u32 vcc, -1, v240
s_cbranch_vccnz L_restart
v_cmp_ne_u32 vcc, 0x2000, v241
s_cbranch_vccnz L_restart
rdy_109:
s_xor_b32 s42, s42, s17
s_xor_b32 s43, s43, s17
s_nop 7
v_xor_b32 v251, 0x10000, v251
v_xor_b32 v252, 0x10000, v252
s_cmp_eq_u32 s40, 1
s_cbranch_scc1 kv01_105
s_branch kv00_104
kvm_108:
s_waitcnt vmcnt(35)
ds_write_b128 v202, v[2:5] offset:0
s_waitcnt vmcnt(34)
ds_write_b128 v202, v[6:9] offset:1024
s_waitcnt vmcnt(33)
ds_write_b128 v202, v[10:13] offset:2048
s_waitcnt vmcnt(32)
ds_write_b128 v202, v[14:17] offset:3072
s_waitcnt vmcnt(31)
ds_write_b128 v202, v[18:21] offset:4096
s_waitcnt vmcnt(30)
ds_write_b128 v202, v[22:25] offset:5120
s_waitcnt vmcnt(29)
ds_write_b128 v202, v[26:29] offset:6144
s_waitcnt vmcnt(28)
ds_write_b128 v202, v[30:33] offset:7168
s_waitcnt lgkmcnt(0)
s_barrier
ds_read_b64_tr_b16 v[2:3], v203 offset:0
ds_read_b64_tr_b16 v[4:5], v203 offset:1024
ds_read_b64_tr_b16 v[6:7], v203 offset:8
ds_read_b64_tr_b16 v[8:9], v203 offset:1032
ds_read_b64_tr_b16 v[10:11], v203 offset:8192
ds_read_b64_tr_b16 v[12:13], v203 offset:9216
ds_read_b64_tr_b16 v[14:15], v203 offset:8200
ds_read_b64_tr_b16 v[16:17], v203 offset:9224
ds_read_b64_tr_b16 v[18:19], v203 offset:16384
ds_read_b64_tr_b16 v[20:21], v203 offset:17408
ds_read_b64_tr_b16 v[22:23], v203 offset:16392
ds_read_b64_tr_b16 v[24:25], v203 offset:17416
s_waitcnt lgkmcnt(8)
ds_read_b64_tr_b16 v[26:27], v203 offset:24576
ds_read_b64_tr_b16 v[28:29], v203 offset:25600
ds_read_b64_tr_b16 v[30:31], v203 offset:24584
ds_read_b64_tr_b16 v[32:33], v203 offset:25608
s_waitcnt lgkmcnt(0)
s_barrier
ds_read_b128 v[186:189], v251 offset:0
ds_read_b128 v[190:193], v251 offset:2048
ds_read_b128 v[194:197], v251 offset:8192
ds_read_b128 v[198:201], v251 offset:10240
ds_read_b128 v[146:149], v251 offset:16384
ds_read_b128 v[150:153], v251 offset:18432
ds_read_b128 v[154:157], v251 offset:24576
ds_read_b128 v[158:161], v251 offset:26624
s_waitcnt lgkmcnt(7)
v_mfma_f32_16x16x32_bf16 v[130:133], v[186:189], v[2:5], 0
v_mfma_f32_16x16x32_bf16 v[138:141], v[186:189], v[6:9], 0
s_waitcnt lgkmcnt(6)
v_mfma_f32_16x16x32_bf16 v[134:137], v[190:193], v[2:5], 0
v_mfma_f32_16x16x32_bf16 v[142:145], v[190:193], v[6:9], 0
s_waitcnt lgkmcnt(5)
v_mfma_f32_16x16x32_bf16 v[130:133], v[194:197], v[10:13], v[130:133]
v_mfma_f32_16x16x32_bf16 v[138:141], v[194:197], v[14:17], v[138:141]
s_waitcnt lgkmcnt(4)
v_mfma_f32_16x16x32_bf16 v[134:137], v[198:201], v[10:13], v[134:137]
v_mfma_f32_16x16x32_bf16 v[142:145], v[198:201], v[14:17], v[142:145]
s_waitcnt lgkmcnt(3)
v_mfma_f32_16x16x32_bf16 v[130:133], v[146:149], v[18:21], v[130:133]
v_mfma_f32_16x16x32_bf16 v[138:141], v[146:149], v[22:25], v[138:141]
s_waitcnt lgkmcnt(2)
v_mfma_f32_16x16x32_bf16 v[134:137], v[150:153], v[18:21], v[134:137]
v_mfma_f32_16x16x32_bf16 v[142:145], v[150:153], v[22:25], v[142:145]
s_waitcnt lgkmcnt(1)
v_mfma_f32_16x16x32_bf16 v[130:133], v[154:157], v[26:29], v[130:133]
v_mfma_f32_16x16x32_bf16 v[138:141], v[154:157], v[30:33], v[138:141]
s_waitcnt lgkmcnt(0)
v_mfma_f32_16x16x32_bf16 v[134:137], v[158:161], v[26:29], v[134:137]
v_mfma_f32_16x16x32_bf16 v[142:145], v[158:161], v[30:33], v[142:145]
s_waitcnt vmcnt(27)
ds_write_b128 v202, v[34:37] offset:0
s_waitcnt vmcnt(26)
ds_write_b128 v202, v[38:41] offset:1024
s_waitcnt vmcnt(25)
ds_write_b128 v202, v[42:45] offset:2048
s_waitcnt vmcnt(24)
ds_write_b128 v202, v[46:49] offset:3072
s_waitcnt vmcnt(23)
ds_write_b128 v202, v[50:53] offset:4096
s_waitcnt vmcnt(22)
ds_write_b128 v202, v[54:57] offset:5120
s_waitcnt vmcnt(21)
ds_write_b128 v202, v[58:61] offset:6144
s_waitcnt vmcnt(20)
ds_write_b128 v202, v[62:65] offset:7168
s_waitcnt lgkmcnt(0)
s_barrier
ds_read_b64_tr_b16 v[34:35], v203 offset:0
ds_read_b64_tr_b16 v[36:37], v203 offset:1024
ds_read_b64_tr_b16 v[38:39], v203 offset:8
ds_read_b64_tr_b16 v[40:41], v203 offset:1032
ds_read_b64_tr_b16 v[42:43], v203 offset:8192
ds_read_b64_tr_b16 v[44:45], v203 offset:9216
ds_read_b64_tr_b16 v[46:47], v203 offset:8200
ds_read_b64_tr_b16 v[48:49], v203 offset:9224
ds_read_b64_tr_b16 v[50:51], v203 offset:16384
ds_read_b64_tr_b16 v[52:53], v203 offset:17408
ds_read_b64_tr_b16 v[54:55], v203 offset:16392
ds_read_b64_tr_b16 v[56:57], v203 offset:17416
s_waitcnt lgkmcnt(8)
ds_read_b64_tr_b16 v[58:59], v203 offset:24576
ds_read_b64_tr_b16 v[60:61], v203 offset:25600
ds_read_b64_tr_b16 v[62:63], v203 offset:24584
ds_read_b64_tr_b16 v[64:65], v203 offset:25608
s_waitcnt lgkmcnt(0)
s_barrier
ds_read_b128 v[186:189], v252 offset:0
ds_read_b128 v[190:193], v252 offset:2048
ds_read_b128 v[194:197], v252 offset:8192
ds_read_b128 v[198:201], v252 offset:10240
ds_read_b128 v[146:149], v252 offset:16384
ds_read_b128 v[150:153], v252 offset:18432
ds_read_b128 v[154:157], v252 offset:24576
ds_read_b128 v[158:161], v252 offset:26624
s_waitcnt lgkmcnt(7)
v_mfma_f32_16x16x32_bf16 v[130:133], v[186:189], v[34:37], v[130:133]
v_mfma_f32_16x16x32_bf16 v[138:141], v[186:189], v[38:41], v[138:141]
s_waitcnt lgkmcnt(6)
v_mfma_f32_16x16x32_bf16 v[134:137], v[190:193], v[34:37], v[134:137]
v_mfma_f32_16x16x32_bf16 v[142:145], v[190:193], v[38:41], v[142:145]
s_waitcnt lgkmcnt(5)
v_mfma_f32_16x16x32_bf16 v[130:133], v[194:197], v[42:45], v[130:133]
v_mfma_f32_16x16x32_bf16 v[138:141], v[194:197], v[46:49], v[138:141]
s_waitcnt lgkmcnt(4)
v_mfma_f32_16x16x32_bf16 v[134:137], v[198:201], v[42:45], v[134:137]
v_mfma_f32_16x16x32_bf16 v[142:145], v[198:201], v[46:49], v[142:145]
s_waitcnt lgkmcnt(3)
v_mfma_f32_16x16x32_bf16 v[130:133], v[146:149], v[50:53], v[130:133]
v_mfma_f32_16x16x32_bf16 v[138:141], v[146:149], v[54:57], v[138:141]
s_waitcnt lgkmcnt(2)
v_mfma_f32_16x16x32_bf16 v[134:137], v[150:153], v[50:53], v[134:137]
v_mfma_f32_16x16x32_bf16 v[142:145], v[150:153], v[54:57], v[142:145]
s_waitcnt lgkmcnt(1)
v_mfma_f32_16x16x32_bf16 v[130:133], v[154:157], v[58:61], v[130:133]
v_mfma_f32_16x16x32_bf16 v[138:141], v[154:157], v[62:65], v[138:141]
s_waitcnt lgkmcnt(0)
v_mfma_f32_16x16x32_bf16 v[134:137], v[158:161], v[58:61], v[134:137]
v_mfma_f32_16x16x32_bf16 v[142:145], v[158:161], v[62:65], v[142:145]
s_waitcnt vmcnt(19)
ds_write_b128 v202, v[66:69] offset:0
s_waitcnt vmcnt(18)
ds_write_b128 v202, v[70:73] offset:1024
s_waitcnt vmcnt(17)
ds_write_b128 v202, v[74:77] offset:2048
s_waitcnt vmcnt(16)
ds_write_b128 v202, v[78:81] offset:3072
s_waitcnt vmcnt(15)
ds_write_b128 v202, v[82:85] offset:4096
s_waitcnt vmcnt(14)
ds_write_b128 v202, v[86:89] offset:5120
s_waitcnt vmcnt(13)
ds_write_b128 v202, v[90:93] offset:6144
s_waitcnt vmcnt(12)
ds_write_b128 v202, v[94:97] offset:7168
s_waitcnt lgkmcnt(0)
s_barrier
ds_read_b64_tr_b16 v[66:67], v203 offset:0
ds_read_b64_tr_b16 v[68:69], v203 offset:1024
ds_read_b64_tr_b16 v[70:71], v203 offset:8
ds_read_b64_tr_b16 v[72:73], v203 offset:1032
ds_read_b64_tr_b16 v[74:75], v203 offset:8192
ds_read_b64_tr_b16 v[76:77], v203 offset:9216
ds_read_b64_tr_b16 v[78:79], v203 offset:8200
ds_read_b64_tr_b16 v[80:81], v203 offset:9224
ds_read_b64_tr_b16 v[82:83], v203 offset:16384
ds_read_b64_tr_b16 v[84:85], v203 offset:17408
ds_read_b64_tr_b16 v[86:87], v203 offset:16392
ds_read_b64_tr_b16 v[88:89], v203 offset:17416
s_waitcnt lgkmcnt(8)
ds_read_b64_tr_b16 v[90:91], v203 offset:24576
ds_read_b64_tr_b16 v[92:93], v203 offset:25600
ds_read_b64_tr_b16 v[94:95], v203 offset:24584
ds_read_b64_tr_b16 v[96:97], v203 offset:25608
s_waitcnt lgkmcnt(0)
s_barrier
ds_read_b128 v[186:189], v251 offset:4096
ds_read_b128 v[190:193], v251 offset:6144
ds_read_b128 v[194:197], v251 offset:12288
ds_read_b128 v[198:201], v251 offset:14336
ds_read_b128 v[146:149], v251 offset:20480
ds_read_b128 v[150:153], v251 offset:22528
ds_read_b128 v[154:157], v251 offset:28672
ds_read_b128 v[158:161], v251 offset:30720
s_waitcnt lgkmcnt(7)
v_mfma_f32_16x16x32_bf16 v[130:133], v[186:189], v[66:69], v[130:133]
v_mfma_f32_16x16x32_bf16 v[138:141], v[186:189], v[70:73], v[138:141]
s_waitcnt lgkmcnt(6)
v_mfma_f32_16x16x32_bf16 v[134:137], v[190:193], v[66:69], v[134:137]
v_mfma_f32_16x16x32_bf16 v[142:145], v[190:193], v[70:73], v[142:145]
s_waitcnt lgkmcnt(5)
v_mfma_f32_16x16x32_bf16 v[130:133], v[194:197], v[74:77], v[130:133]
v_mfma_f32_16x16x32_bf16 v[138:141], v[194:197], v[78:81], v[138:141]
s_waitcnt lgkmcnt(4)
v_mfma_f32_16x16x32_bf16 v[134:137], v[198:201], v[74:77], v[134:137]
v_mfma_f32_16x16x32_bf16 v[142:145], v[198:201], v[78:81], v[142:145]
s_waitcnt lgkmcnt(3)
v_mfma_f32_16x16x32_bf16 v[130:133], v[146:149], v[82:85], v[130:133]
v_mfma_f32_16x16x32_bf16 v[138:141], v[146:149], v[86:89], v[138:141]
s_waitcnt lgkmcnt(2)
v_mfma_f32_16x16x32_bf16 v[134:137], v[150:153], v[82:85], v[134:137]
v_mfma_f32_16x16x32_bf16 v[142:145], v[150:153], v[86:89], v[142:145]
s_waitcnt lgkmcnt(1)
v_mfma_f32_16x16x32_bf16 v[130:133], v[154:157], v[90:93], v[130:133]
v_mfma_f32_16x16x32_bf16 v[138:141], v[154:157], v[94:97], v[138:141]
s_waitcnt lgkmcnt(0)
v_mfma_f32_16x16x32_bf16 v[134:137], v[158:161], v[90:93], v[134:137]
v_mfma_f32_16x16x32_bf16 v[142:145], v[158:161], v[94:97], v[142:145]
s_waitcnt vmcnt(11)
ds_write_b128 v202, v[98:101] offset:0
s_waitcnt vmcnt(10)
ds_write_b128 v202, v[102:105] offset:1024
s_waitcnt vmcnt(9)
ds_write_b128 v202, v[106:109] offset:2048
s_waitcnt vmcnt(8)
ds_write_b128 v202, v[110:113] offset:3072
s_waitcnt vmcnt(7)
ds_write_b128 v202, v[114:117] offset:4096
s_waitcnt vmcnt(6)
ds_write_b128 v202, v[118:121] offset:5120
s_waitcnt vmcnt(5)
ds_write_b128 v202, v[122:125] offset:6144
s_waitcnt vmcnt(4)
ds_write_b128 v202, v[126:129] offset:7168
s_waitcnt lgkmcnt(0)
s_barrier
ds_read_b64_tr_b16 v[98:99], v203 offset:0
ds_read_b64_tr_b16 v[100:101], v203 offset:1024
ds_read_b64_tr_b16 v[102:103], v203 offset:8
ds_read_b64_tr_b16 v[104:105], v203 offset:1032
ds_read_b64_tr_b16 v[106:107], v203 offset:8192
ds_read_b64_tr_b16 v[108:109], v203 offset:9216
ds_read_b64_tr_b16 v[110:111], v203 offset:8200
ds_read_b64_tr_b16 v[112:113], v203 offset:9224
ds_read_b64_tr_b16 v[114:115], v203 offset:16384
ds_read_b64_tr_b16 v[116:117], v203 offset:17408
ds_read_b64_tr_b16 v[118:119], v203 offset:16392
ds_read_b64_tr_b16 v[120:121], v203 offset:17416
s_waitcnt lgkmcnt(8)
ds_read_b64_tr_b16 v[122:123], v203 offset:24576
ds_read_b64_tr_b16 v[124:125], v203 offset:25600
ds_read_b64_tr_b16 v[126:127], v203 offset:24584
ds_read_b64_tr_b16 v[128:129], v203 offset:25608
s_waitcnt lgkmcnt(0)
s_barrier
ds_read_b128 v[186:189], v252 offset:4096
ds_read_b128 v[190:193], v252 offset:6144
ds_read_b128 v[194:197], v252 offset:12288
ds_read_b128 v[198:201], v252 offset:14336
ds_read_b128 v[146:149], v252 offset:20480
ds_read_b128 v[150:153], v252 offset:22528
ds_read_b128 v[154:157], v252 offset:28672
ds_read_b128 v[158:161], v252 offset:30720
s_waitcnt lgkmcnt(7)
v_mfma_f32_16x16x32_bf16 v[130:133], v[186:189], v[98:101], v[130:133]
v_mfma_f32_16x16x32_bf16 v[138:141], v[186:189], v[102:105], v[138:141]
s_waitcnt lgkmcnt(6)
v_mfma_f32_16x16x32_bf16 v[134:137], v[190:193], v[98:101], v[134:137]
v_mfma_f32_16x16x32_bf16 v[142:145], v[190:193], v[102:105], v[142:145]
s_waitcnt lgkmcnt(5)
v_mfma_f32_16x16x32_bf16 v[130:133], v[194:197], v[106:109], v[130:133]
v_mfma_f32_16x16x32_bf16 v[138:141], v[194:197], v[110:113], v[138:141]
s_waitcnt lgkmcnt(4)
v_mfma_f32_16x16x32_bf16 v[134:137], v[198:201], v[106:109], v[134:137]
v_mfma_f32_16x16x32_bf16 v[142:145], v[198:201], v[110:113], v[142:145]
s_waitcnt lgkmcnt(3)
v_mfma_f32_16x16x32_bf16 v[130:133], v[146:149], v[114:117], v[130:133]
v_mfma_f32_16x16x32_bf16 v[138:141], v[146:149], v[118:121], v[138:141]
s_waitcnt lgkmcnt(2)
v_mfma_f32_16x16x32_bf16 v[134:137], v[150:153], v[114:117], v[134:137]
v_mfma_f32_16x16x32_bf16 v[142:145], v[150:153], v[118:121], v[142:145]
s_waitcnt lgkmcnt(1)
v_mfma_f32_16x16x32_bf16 v[130:133], v[154:157], v[122:125], v[130:133]
v_mfma_f32_16x16x32_bf16 v[138:141], v[154:157], v[126:129], v[138:141]
s_waitcnt lgkmcnt(0)
v_mfma_f32_16x16x32_bf16 v[134:137], v[158:161], v[122:125], v[134:137]
v_mfma_f32_16x16x32_bf16 v[142:145], v[158:161], v[126:129], v[142:145]
s_nop 0
s_cmp_lg_u32 s16, 0
s_cbranch_scc1 rdy_114
v_and_b32 v1, 7, v0
v_lshlrev_b32 v1, 5, v1
s_branch rdy_118
rdy_115:
buffer_load_dwordx2 v[240:241], v1, s[28:31], 0 offen sc1
rdy_118:
s_mov_b32 s20, 0
s_waitcnt vmcnt(0)
v_readlane_b32 s21, v241, 0
s_nop 0
s_lshr_b32 s21, s21, 8
s_add_u32 s20, s20, s21
v_readlane_b32 s21, v241, 1
s_nop 0
s_lshr_b32 s21, s21, 8
s_add_u32 s20, s20, s21
v_readlane_b32 s21, v241, 2
s_nop 0
s_lshr_b32 s21, s21, 8
s_add_u32 s20, s20, s21
v_readlane_b32 s21, v241, 3
s_nop 0
s_lshr_b32 s21, s21, 8
s_add_u32 s20, s20, s21
v_readlane_b32 s21, v241, 4
s_nop 0
s_lshr_b32 s21, s21, 8
s_add_u32 s20, s20, s21
v_readlane_b32 s21, v241, 5
s_nop 0
s_lshr_b32 s21, s21, 8
s_add_u32 s20, s20, s21
v_readlane_b32 s21, v241, 6
s_nop 0
s_lshr_b32 s21, s21, 8
s_add_u32 s20, s20, s21
v_readlane_b32 s21, v241, 7
s_nop 0
s_lshr_b32 s21, s21, 8
s_add_u32 s20, s20, s21
s_and_b32 s21, s20, 0xfff
s_cmp_ge_u32 s21, 256
s_cbranch_scc1 rdy_116
s_add_u32 s19, s19, 1
s_cmp_gt_u32 s19, 1048576
s_cbranch_scc1 L_end
s_sleep 8
s_branch rdy_115
rdy_116:
s_lshr_b32 s20, s20, 12
s_cmp_gt_u32 s20, 16
s_cselect_b32 s17, 8192, 0
v_and_b32 v241, 0xfffff, v241
v_cmp_ne_u32 vcc, -1, v240
s_cbranch_vccnz L_restart
v_cmp_ne_u32 vcc, 0x2000, v241
s_cbranch_vccnz L_restart
rdy_114:
s_xor_b32 s42, s42, s17
s_xor_b32 s43, s43, s17
s_nop 7
v_xor_b32 v251, 0x10000, v251
v_xor_b32 v252, 0x10000, v252
s_cmp_eq_u32 s40, 1
s_cbranch_scc1 kv11_107
s_branch kv10_106
kv00_104:
v_mov_b32 v170, v130
v_mov_b32 v171, v131
v_mov_b32 v172, v132
v_mov_b32 v173, v133
v_mov_b32 v174, v134
v_mov_b32 v175, v135
v_mov_b32 v176, v136
v_mov_b32 v177, v137
v_mov_b32 v178, v138
v_mov_b32 v179, v139
v_mov_b32 v180, v140
v_mov_b32 v181, v141
v_mov_b32 v182, v142
v_mov_b32 v183, v143
v_mov_b32 v184, v144
v_mov_b32 v185, v145
s_mov_b32 s18, 1
s_barrier
ds_read_b128 v[186:189], v204 offset:0
ds_read_b128 v[190:193], v204 offset:1024
ds_read_b128 v[194:197], v204 offset:2048
ds_read_b128 v[198:201], v204 offset:3072
v_xor_b32 v204, 0x4000, v204
s_waitcnt lgkmcnt(0)
v_add_f32 v170, v170, v186
v_add_f32 v171, v171, v187
v_add_f32 v172, v172, v188
v_add_f32 v173, v173, v189
v_add_f32 v174, v174, v190
v_add_f32 v175, v175, v191
v_add_f32 v176, v176, v192
v_add_f32 v177, v177, v193
v_add_f32 v178, v178, v194
v_add_f32 v179, v179, v195
v_add_f32 v180, v180, v196
v_add_f32 v181, v181, v197
v_add_f32 v182, v182, v198
v_add_f32 v183, v183, v199
v_add_f32 v184, v184, v200
v_add_f32 v185, v185, v201
v_cvt_pk_bf16_f32 v240, v170, v171
v_cvt_pk_bf16_f32 v241, v172, v173
v_cvt_pk_bf16_f32 v242, v174, v175
v_cvt_pk_bf16_f32 v243, v176, v177
v_cvt_pk_bf16_f32 v244, v178, v179
v_cvt_pk_bf16_f32 v245, v180, v181
v_cvt_pk_bf16_f32 v246, v182, v183
v_cvt_pk_bf16_f32 v247, v184, v185
s_sub_u32 s22, s18, 1
s_lshl_b32 s22, s22, 14
s_xor_b32 s22, s22, s42
buffer_store_dwordx4 v[240:243], v205, s[4:7], s22 offen sc1
s_add_u32 s22, s22, 4096
buffer_store_dwordx4 v[244:247], v205, s[4:7], s22 offen sc1
s_waitcnt vmcnt(0)
s_barrier
s_sub_u32 s22, s18, 0
v_mov_b32 v1, s22
buffer_store_dword v1, v206, s[4:7], s43 offen sc1
s_nop 0
s_waitcnt vmcnt(63) lgkmcnt(0)
s_barrier
s_setprio 2
ds_read_b128 v[146:149], v251 offset:0
ds_read_b128 v[150:153], v251 offset:2048
ds_read_b128 v[154:157], v252 offset:0
ds_read_b128 v[158:161], v252 offset:2048
ds_read_b128 v[162:165], v251 offset:4096
ds_read_b128 v[166:169], v251 offset:6144
s_waitcnt lgkmcnt(5)
v_mfma_f32_16x16x32_bf16 v[130:133], v[2:5], v[146:149], 0
v_mfma_f32_16x16x32_bf16 v[134:137], v[6:9], v[146:149], 0
ds_read_b128 v[146:149], v252 offset:4096
s_waitcnt lgkmcnt(5)
v_mfma_f32_16x16x32_bf16 v[138:141], v[2:5], v[150:153], 0
v_mfma_f32_16x16x32_bf16 v[142:145], v[6:9], v[150:153], 0
ds_read_b128 v[150:153], v252 offset:6144
s_waitcnt lgkmcnt(5)
v_mfma_f32_16x16x32_bf16 v[130:133], v[34:37], v[154:157], v[130:133]
v_mfma_f32_16x16x32_bf16 v[134:137], v[38:41], v[154:157], v[134:137]
ds_read_b128 v[154:157], v251 offset:8192
s_waitcnt lgkmcnt(5)
v_mfma_f32_16x16x32_bf16 v[138:141], v[34:37], v[158:161], v[138:141]
v_mfma_f32_16x16x32_bf16 v[142:145], v[38:41], v[158:161], v[142:145]
ds_read_b128 v[158:161], v251 offset:10240
s_waitcnt lgkmcnt(5)
v_mfma_f32_16x16x32_bf16 v[130:133], v[66:69], v[162:165], v[130:133]
v_mfma_f32_16x16x32_bf16 v[134:137], v[70:73], v[162:165], v[134:137]
ds_read_b128 v[162:165], v252 offset:8192
s_waitcnt lgkmcnt(5)
v_mfma_f32_16x16x32_bf16 v[138:141], v[66:69], v[166:169], v[138:141]
v_mfma_f32_16x16x32_bf16 v[142:145], v[70:73], v[166:169], v[142:145]
ds_read_b128 v[166:169], v252 offset:10240
s_waitcnt lgkmcnt(5)
v_mfma_f32_16x16x32_bf16 v[130:133], v[98:101], v[146:149], v[130:133]
v_mfma_f32_16x16x32_bf16 v[134:137], v[102:105], v[146:149], v[134:137]
ds_read_b128 v[146:149], v251 offset:12288
s_waitcnt lgkmcnt(5)
v_mfma_f32_16x16x32_bf16 v[138:141], v[98:101], v[150:153], v[138:141]
v_mfma_f32_16x16x32_bf16 v[142:145], v[102:105], v[150:153], v[142:145]
ds_read_b128 v[150:153], v251 offset:14336
s_waitcnt lgkmcnt(5)
v_mfma_f32_16x16x32_bf16 v[130:133], v[10:13], v[154:157], v[130:133]
v_mfma_f32_16x16x32_bf16 v[134:137], v[14:17], v[154:157], v[134:137]
ds_read_b128 v[154:157], v252 offset:12288
s_waitcnt lgkmcnt(5)
v_mfma_f32_16x16x32_bf16 v[138:141], v[10:13], v[158:161], v[138:141]
v_mfma_f32_16x16x32_bf16 v[142:145], v[14:17], v[158:161], v[142:145]
ds_read_b128 v[158:161], v252 offset:14336
s_waitcnt lgkmcnt(5)
v_mfma_f32_16x16x32_bf16 v[130:133], v[42:45], v[162:165], v[130:133]
v_mfma_f32_16x16x32_bf16 v[134:137], v[46:49], v[162:165], v[134:137]
ds_read_b128 v[162:165], v251 offset:16384
s_waitcnt lgkmcnt(5)
v_mfma_f32_16x16x32_bf16 v[138:141], v[42:45], v[166:169], v[138:141]
v_mfma_f32_16x16x32_bf16 v[142:145], v[46:49], v[166:169], v[142:145]
ds_read_b128 v[166:169], v251 offset:18432
s_waitcnt lgkmcnt(5)
v_mfma_f32_16x16x32_bf16 v[130:133], v[74:77], v[146:149], v[130:133]
v_mfma_f32_16x16x32_bf16 v[134:137], v[78:81], v[146:149], v[134:137]
ds_read_b128 v[146:149], v252 offset:16384
s_waitcnt lgkmcnt(5)
v_mfma_f32_16x16x32_bf16 v[138:141], v[74:77], v[150:153], v[138:141]
v_mfma_f32_16x16x32_bf16 v[142:145], v[78:81], v[150:153], v[142:145]
ds_read_b128 v[150:153], v252 offset:18432
s_waitcnt lgkmcnt(5)
v_mfma_f32_16x16x32_bf16 v[130:133], v[106:109], v[154:157], v[130:133]
v_mfma_f32_16x16x32_bf16 v[134:137], v[110:113], v[154:157], v[134:137]
ds_read_b128 v[154:157], v251 offset:20480
s_waitcnt lgkmcnt(5)
v_mfma_f32_16x16x32_bf16 v[138:141], v[106:109], v[158:161], v[138:141]
v_mfma_f32_16x16x32_bf16 v[142:145], v[110:113], v[158:161], v[142:145]
ds_read_b128 v[158:161], v251 offset:22528
s_waitcnt lgkmcnt(5)
v_mfma_f32_16x16x32_bf16 v[130:133], v[18:21], v[162:165], v[130:133]
v_mfma_f32_16x16x32_bf16 v[134:137], v[22:25], v[162:165], v[134:137]
ds_read_b128 v[162:165], v252 offset:20480
s_waitcnt lgkmcnt(5)
v_mfma_f32_16x16x32_bf16 v[138:141], v[18:21], v[166:169], v[138:141]
v_mfma_f32_16x16x32_bf16 v[142:145], v[22:25], v[166:169], v[142:145]
ds_read_b128 v[166:169], v252 offset:22528
s_waitcnt lgkmcnt(5)
v_mfma_f32_16x16x32_bf16 v[130:133], v[50:53], v[146:149], v[130:133]
v_mfma_f32_16x16x32_bf16 v[134:137], v[54:57], v[146:149], v[134:137]
ds_read_b128 v[146:149], v251 offset:24576
s_waitcnt lgkmcnt(5)
v_mfma_f32_16x16x32_bf16 v[138:141], v[50:53], v[150:153], v[138:141]
v_mfma_f32_16x16x32_bf16 v[142:145], v[54:57], v[150:153], v[142:145]
ds_read_b128 v[150:153], v251 offset:26624
s_waitcnt lgkmcnt(5)
v_mfma_f32_16x16x32_bf16 v[130:133], v[82:85], v[154:157], v[130:133]
v_mfma_f32_16x16x32_bf16 v[134:137], v[86:89], v[154:157], v[134:137]
ds_read_b128 v[154:157], v252 offset:24576
s_waitcnt lgkmcnt(5)
v_mfma_f32_16x16x32_bf16 v[138:141], v[82:85], v[158:161], v[138:141]
v_mfma_f32_16x16x32_bf16 v[142:145], v[86:89], v[158:161], v[142:145]
ds_read_b128 v[158:161], v252 offset:26624
s_waitcnt lgkmcnt(5)
v_mfma_f32_16x16x32_bf16 v[130:133], v[114:117], v[162:165], v[130:133]
v_mfma_f32_16x16x32_bf16 v[134:137], v[118:121], v[162:165], v[134:137]
ds_read_b128 v[162:165], v251 offset:28672
s_waitcnt lgkmcnt(5)
v_mfma_f32_16x16x32_bf16 v[138:141], v[114:117], v[166:169], v[138:141]
v_mfma_f32_16x16x32_bf16 v[142:145], v[118:121], v[166:169], v[142:145]
ds_read_b128 v[166:169], v251 offset:30720
s_waitcnt lgkmcnt(5)
v_mfma_f32_16x16x32_bf16 v[130:133], v[26:29], v[146:149], v[130:133]
v_mfma_f32_16x16x32_bf16 v[134:137], v[30:33], v[146:149], v[134:137]
ds_read_b128 v[146:149], v252 offset:28672
s_waitcnt lgkmcnt(5)
v_mfma_f32_16x16x32_bf16 v[138:141], v[26:29], v[150:153], v[138:141]
v_mfma_f32_16x16x32_bf16 v[142:145], v[30:33], v[150:153], v[142:145]
ds_read_b128 v[150:153], v252 offset:30720
s_waitcnt lgkmcnt(5)
v_mfma_f32_16x16x32_bf16 v[130:133], v[58:61], v[154:157], v[130:133]
v_mfma_f32_16x16x32_bf16 v[134:137], v[62:65], v[154:157], v[134:137]
s_waitcnt lgkmcnt(4)
v_mfma_f32_16x16x32_bf16 v[138:141], v[58:61], v[158:161], v[138:141]
v_mfma_f32_16x16x32_bf16 v[142:145], v[62:65], v[158:161], v[142:145]
s_waitcnt lgkmcnt(3)
v_mfma_f32_16x16x32_bf16 v[130:133], v[90:93], v[162:165], v[130:133]
v_mfma_f32_16x16x32_bf16 v[134:137], v[94:97], v[162:165], v[134:137]
s_waitcnt lgkmcnt(2)
v_mfma_f32_16x16x32_bf16 v[138:141], v[90:93], v[166:169], v[138:141]
v_mfma_f32_16x16x32_bf16 v[142:145], v[94:97], v[166:169], v[142:145]
s_waitcnt lgkmcnt(1)
v_mfma_f32_16x16x32_bf16 v[130:133], v[122:125], v[146:149], v[130:133]
v_mfma_f32_16x16x32_bf16 v[134:137], v[126:129], v[146:149], v[134:137]
s_waitcnt lgkmcnt(0)
v_mfma_f32_16x16x32_bf16 v[138:141], v[122:125], v[150:153], v[138:141]
v_mfma_f32_16x16x32_bf16 v[142:145], v[126:129], v[150:153], v[142:145]
s_setprio 0
v_xor_b32 v251, 0x10000, v251
v_xor_b32 v252, 0x10000, v252
s_barrier
s_nop 7
v_mov_b32 v170, v130
v_mov_b32 v171, v131
v_mov_b32 v172, v132
v_mov_b32 v173, v133
v_mov_b32 v174, v134
v_mov_b32 v175, v135
v_mov_b32 v176, v136
v_mov_b32 v177, v137
v_mov_b32 v178, v138
v_mov_b32 v179, v139
v_mov_b32 v180, v140
v_mov_b32 v181, v141
v_mov_b32 v182, v142
v_mov_b32 v183, v143
v_mov_b32 v184, v144
v_mov_b32 v185, v145
s_add_u32 s22, s18, 3
s_lshl_b32 s22, s22, 16
buffer_load_dword v248, v207, s[48:51], s22 offen
s_add_u32 s18, s18, 1
kvl_120:
s_waitcnt vmcnt(63) lgkmcnt(0)
s_barrier
ds_read_b128 v[186:189], v204 offset:0
ds_read_b128 v[190:193], v204 offset:1024
ds_read_b128 v[194:197], v204 offset:2048
ds_read_b128 v[198:201], v204 offset:3072
v_xor_b32 v204, 0x4000, v204
s_waitcnt lgkmcnt(0)
v_add_f32 v170, v170, v186
v_add_f32 v171, v171, v187
v_add_f32 v172, v172, v188
v_add_f32 v173, v173, v189
v_add_f32 v174, v174, v190
v_add_f32 v175, v175, v191
v_add_f32 v176, v176, v192
v_add_f32 v177, v177, v193
v_add_f32 v178, v178, v194
v_add_f32 v179, v179, v195
v_add_f32 v180, v180, v196
v_add_f32 v181, v181, v197
v_add_f32 v182, v182, v198
v_add_f32 v183, v183, v199
v_add_f32 v184, v184, v200
v_add_f32 v185, v185, v201
v_cvt_pk_bf16_f32 v240, v170, v171
v_cvt_pk_bf16_f32 v241, v172, v173
v_cvt_pk_bf16_f32 v242, v174, v175
v_cvt_pk_bf16_f32 v243, v176, v177
v_cvt_pk_bf16_f32 v244, v178, v179
v_cvt_pk_bf16_f32 v245, v180, v181
v_cvt_pk_bf16_f32 v246, v182, v183
v_cvt_pk_bf16_f32 v247, v184, v185
s_sub_u32 s22, s18, 1
s_lshl_b32 s22, s22, 14
s_xor_b32 s22, s22, s42
buffer_store_dwordx4 v[240:243], v205, s[4:7], s22 offen sc1
s_add_u32 s22, s22, 4096
buffer_store_dwordx4 v[244:247], v205, s[4:7], s22 offen sc1
s_setprio 2
ds_read_b128 v[146:149], v251 offset:0
ds_read_b128 v[150:153], v251 offset:2048
ds_read_b128 v[154:157], v252 offset:0
ds_read_b128 v[158:161], v252 offset:2048
ds_read_b128 v[162:165], v251 offset:4096
ds_read_b128 v[166:169], v251 offset:6144
s_waitcnt lgkmcnt(5)
v_mfma_f32_16x16x32_bf16 v[130:133], v[2:5], v[146:149], 0
v_mfma_f32_16x16x32_bf16 v[134:137], v[6:9], v[146:149], 0
ds_read_b128 v[146:149], v252 offset:4096
s_waitcnt lgkmcnt(5)
v_mfma_f32_16x16x32_bf16 v[138:141], v[2:5], v[150:153], 0
v_mfma_f32_16x16x32_bf16 v[142:145], v[6:9], v[150:153], 0
ds_read_b128 v[150:153], v252 offset:6144
s_waitcnt lgkmcnt(5)
v_mfma_f32_16x16x32_bf16 v[130:133], v[34:37], v[154:157], v[130:133]
v_mfma_f32_16x16x32_bf16 v[134:137], v[38:41], v[154:157], v[134:137]
ds_read_b128 v[154:157], v251 offset:8192
s_waitcnt lgkmcnt(5)
v_mfma_f32_16x16x32_bf16 v[138:141], v[34:37], v[158:161], v[138:141]
v_mfma_f32_16x16x32_bf16 v[142:145], v[38:41], v[158:161], v[142:145]
ds_read_b128 v[158:161], v251 offset:10240
s_waitcnt lgkmcnt(5)
v_mfma_f32_16x16x32_bf16 v[130:133], v[66:69], v[162:165], v[130:133]
v_mfma_f32_16x16x32_bf16 v[134:137], v[70:73], v[162:165], v[134:137]
ds_read_b128 v[162:165], v252 offset:8192
s_waitcnt lgkmcnt(5)
v_mfma_f32_16x16x32_bf16 v[138:141], v[66:69], v[166:169], v[138:141]
v_mfma_f32_16x16x32_bf16 v[142:145], v[70:73], v[166:169], v[142:145]
ds_read_b128 v[166:169], v252 offset:10240
s_waitcnt lgkmcnt(5)
v_mfma_f32_16x16x32_bf16 v[130:133], v[98:101], v[146:149], v[130:133]
v_mfma_f32_16x16x32_bf16 v[134:137], v[102:105], v[146:149], v[134:137]
ds_read_b128 v[146:149], v251 offset:12288
s_waitcnt lgkmcnt(5)
v_mfma_f32_16x16x32_bf16 v[138:141], v[98:101], v[150:153], v[138:141]
v_mfma_f32_16x16x32_bf16 v[142:145], v[102:105], v[150:153], v[142:145]
ds_read_b128 v[150:153], v251 offset:14336
s_waitcnt lgkmcnt(5)
v_mfma_f32_16x16x32_bf16 v[130:133], v[10:13], v[154:157], v[130:133]
v_mfma_f32_16x16x32_bf16 v[134:137], v[14:17], v[154:157], v[134:137]
ds_read_b128 v[154:157], v252 offset:12288
s_waitcnt lgkmcnt(5)
v_mfma_f32_16x16x32_bf16 v[138:141], v[10:13], v[158:161], v[138:141]
v_mfma_f32_16x16x32_bf16 v[142:145], v[14:17], v[158:161], v[142:145]
ds_read_b128 v[158:161], v252 offset:14336
s_waitcnt lgkmcnt(5)
v_mfma_f32_16x16x32_bf16 v[130:133], v[42:45], v[162:165], v[130:133]
v_mfma_f32_16x16x32_bf16 v[134:137], v[46:49], v[162:165], v[134:137]
ds_read_b128 v[162:165], v251 offset:16384
s_waitcnt lgkmcnt(5)
v_mfma_f32_16x16x32_bf16 v[138:141], v[42:45], v[166:169], v[138:141]
v_mfma_f32_16x16x32_bf16 v[142:145], v[46:49], v[166:169], v[142:145]
ds_read_b128 v[166:169], v251 offset:18432
s_waitcnt lgkmcnt(5)
v_mfma_f32_16x16x32_bf16 v[130:133], v[74:77], v[146:149], v[130:133]
v_mfma_f32_16x16x32_bf16 v[134:137], v[78:81], v[146:149], v[134:137]
ds_read_b128 v[146:149], v252 offset:16384
s_waitcnt lgkmcnt(5)
v_mfma_f32_16x16x32_bf16 v[138:141], v[74:77], v[150:153], v[138:141]
v_mfma_f32_16x16x32_bf16 v[142:145], v[78:81], v[150:153], v[142:145]
ds_read_b128 v[150:153], v252 offset:18432
s_waitcnt lgkmcnt(5)
v_mfma_f32_16x16x32_bf16 v[130:133], v[106:109], v[154:157], v[130:133]
v_mfma_f32_16x16x32_bf16 v[134:137], v[110:113], v[154:157], v[134:137]
ds_read_b128 v[154:157], v251 offset:20480
s_waitcnt lgkmcnt(5)
v_mfma_f32_16x16x32_bf16 v[138:141], v[106:109], v[158:161], v[138:141]
v_mfma_f32_16x16x32_bf16 v[142:145], v[110:113], v[158:161], v[142:145]
ds_read_b128 v[158:161], v251 offset:22528
s_waitcnt lgkmcnt(5)
v_mfma_f32_16x16x32_bf16 v[130:133], v[18:21], v[162:165], v[130:133]
v_mfma_f32_16x16x32_bf16 v[134:137], v[22:25], v[162:165], v[134:137]
ds_read_b128 v[162:165], v252 offset:20480
s_waitcnt lgkmcnt(5)
v_mfma_f32_16x16x32_bf16 v[138:141], v[18:21], v[166:169], v[138:141]
v_mfma_f32_16x16x32_bf16 v[142:145], v[22:25], v[166:169], v[142:145]
ds_read_b128 v[166:169], v252 offset:22528
s_waitcnt lgkmcnt(5)
v_mfma_f32_16x16x32_bf16 v[130:133], v[50:53], v[146:149], v[130:133]
v_mfma_f32_16x16x32_bf16 v[134:137], v[54:57], v[146:149], v[134:137]
ds_read_b128 v[146:149], v251 offset:24576
s_waitcnt lgkmcnt(5)
v_mfma_f32_16x16x32_bf16 v[138:141], v[50:53], v[150:153], v[138:141]
v_mfma_f32_16x16x32_bf16 v[142:145], v[54:57], v[150:153], v[142:145]
ds_read_b128 v[150:153], v251 offset:26624
s_waitcnt lgkmcnt(5)
v_mfma_f32_16x16x32_bf16 v[130:133], v[82:85], v[154:157], v[130:133]
v_mfma_f32_16x16x32_bf16 v[134:137], v[86:89], v[154:157], v[134:137]
ds_read_b128 v[154:157], v252 offset:24576
s_waitcnt lgkmcnt(5)
v_mfma_f32_16x16x32_bf16 v[138:141], v[82:85], v[158:161], v[138:141]
v_mfma_f32_16x16x32_bf16 v[142:145], v[86:89], v[158:161], v[142:145]
ds_read_b128 v[158:161], v252 offset:26624
s_waitcnt lgkmcnt(5)
v_mfma_f32_16x16x32_bf16 v[130:133], v[114:117], v[162:165], v[130:133]
v_mfma_f32_16x16x32_bf16 v[134:137], v[118:121], v[162:165], v[134:137]
ds_read_b128 v[162:165], v251 offset:28672
s_waitcnt lgkmcnt(5)
v_mfma_f32_16x16x32_bf16 v[138:141], v[114:117], v[166:169], v[138:141]
v_mfma_f32_16x16x32_bf16 v[142:145], v[118:121], v[166:169], v[142:145]
ds_read_b128 v[166:169], v251 offset:30720
s_waitcnt lgkmcnt(5)
v_mfma_f32_16x16x32_bf16 v[130:133], v[26:29], v[146:149], v[130:133]
v_mfma_f32_16x16x32_bf16 v[134:137], v[30:33], v[146:149], v[134:137]
ds_read_b128 v[146:149], v252 offset:28672
s_waitcnt lgkmcnt(5)
v_mfma_f32_16x16x32_bf16 v[138:141], v[26:29], v[150:153], v[138:141]
v_mfma_f32_16x16x32_bf16 v[142:145], v[30:33], v[150:153], v[142:145]
ds_read_b128 v[150:153], v252 offset:30720
s_waitcnt lgkmcnt(5)
v_mfma_f32_16x16x32_bf16 v[130:133], v[58:61], v[154:157], v[130:133]
v_mfma_f32_16x16x32_bf16 v[134:137], v[62:65], v[154:157], v[134:137]
s_waitcnt lgkmcnt(4)
v_mfma_f32_16x16x32_bf16 v[138:141], v[58:61], v[158:161], v[138:141]
v_mfma_f32_16x16x32_bf16 v[142:145], v[62:65], v[158:161], v[142:145]
s_waitcnt lgkmcnt(3)
v_mfma_f32_16x16x32_bf16 v[130:133], v[90:93], v[162:165], v[130:133]
v_mfma_f32_16x16x32_bf16 v[134:137], v[94:97], v[162:165], v[134:137]
s_waitcnt lgkmcnt(2)
v_mfma_f32_16x16x32_bf16 v[138:141], v[90:93], v[166:169], v[138:141]
v_mfma_f32_16x16x32_bf16 v[142:145], v[94:97], v[166:169], v[142:145]
s_waitcnt lgkmcnt(1)
v_mfma_f32_16x16x32_bf16 v[130:133], v[122:125], v[146:149], v[130:133]
v_mfma_f32_16x16x32_bf16 v[134:137], v[126:129], v[146:149], v[134:137]
s_waitcnt lgkmcnt(0)
v_mfma_f32_16x16x32_bf16 v[138:141], v[122:125], v[150:153], v[138:141]
v_mfma_f32_16x16x32_bf16 v[142:145], v[126:129], v[150:153], v[142:145]
s_setprio 0
v_xor_b32 v251, 0x10000, v251
v_xor_b32 v252, 0x10000, v252
s_waitcnt vmcnt(0)
s_barrier
s_sub_u32 s22, s18, 0
v_mov_b32 v1, s22
buffer_store_dword v1, v206, s[4:7], s43 offen sc1
s_nop 7
v_mov_b32 v170, v130
v_mov_b32 v171, v131
v_mov_b32 v172, v132
v_mov_b32 v173, v133
v_mov_b32 v174, v134
v_mov_b32 v175, v135
v_mov_b32 v176, v136
v_mov_b32 v177, v137
v_mov_b32 v178, v138
v_mov_b32 v179, v139
v_mov_b32 v180, v140
v_mov_b32 v181, v141
v_mov_b32 v182, v142
v_mov_b32 v183, v143
v_mov_b32 v184, v144
v_mov_b32 v185, v145
s_add_u32 s22, s18, 3
s_lshl_b32 s22, s22, 16
buffer_load_dword v248, v207, s[48:51], s22 offen
s_add_u32 s18, s18, 1
s_cmp_lt_u32 s18, 14
s_cbranch_scc1 kvl_120
kvl_119:
s_waitcnt vmcnt(4) lgkmcnt(0)
s_barrier
ds_read_b128 v[186:189], v204 offset:0
ds_read_b128 v[190:193], v204 offset:1024
ds_read_b128 v[194:197], v204 offset:2048
ds_read_b128 v[198:201], v204 offset:3072
v_xor_b32 v204, 0x4000, v204
s_setprio 2
ds_read_b128 v[146:149], v251 offset:0
ds_read_b128 v[150:153], v251 offset:2048
ds_read_b128 v[154:157], v252 offset:0
ds_read_b128 v[158:161], v252 offset:2048
ds_read_b128 v[162:165], v251 offset:4096
ds_read_b128 v[166:169], v251 offset:6144
s_waitcnt lgkmcnt(5)
v_mfma_f32_16x16x32_bf16 v[130:133], v[2:5], v[146:149], 0
v_mfma_f32_16x16x32_bf16 v[134:137], v[6:9], v[146:149], 0
ds_read_b128 v[146:149], v252 offset:4096
s_waitcnt lgkmcnt(5)
v_mfma_f32_16x16x32_bf16 v[138:141], v[2:5], v[150:153], 0
v_mfma_f32_16x16x32_bf16 v[142:145], v[6:9], v[150:153], 0
ds_read_b128 v[150:153], v252 offset:6144
s_waitcnt lgkmcnt(5)
v_mfma_f32_16x16x32_bf16 v[130:133], v[34:37], v[154:157], v[130:133]
v_mfma_f32_16x16x32_bf16 v[134:137], v[38:41], v[154:157], v[134:137]
ds_read_b128 v[154:157], v251 offset:8192
s_waitcnt lgkmcnt(5)
v_mfma_f32_16x16x32_bf16 v[138:141], v[34:37], v[158:161], v[138:141]
v_mfma_f32_16x16x32_bf16 v[142:145], v[38:41], v[158:161], v[142:145]
ds_read_b128 v[158:161], v251 offset:10240
s_waitcnt lgkmcnt(5)
v_mfma_f32_16x16x32_bf16 v[130:133], v[66:69], v[162:165], v[130:133]
v_mfma_f32_16x16x32_bf16 v[134:137], v[70:73], v[162:165], v[134:137]
ds_read_b128 v[162:165], v252 offset:8192
s_waitcnt lgkmcnt(5)
v_mfma_f32_16x16x32_bf16 v[138:141], v[66:69], v[166:169], v[138:141]
v_mfma_f32_16x16x32_bf16 v[142:145], v[70:73], v[166:169], v[142:145]
ds_read_b128 v[166:169], v252 offset:10240
s_waitcnt lgkmcnt(5)
v_mfma_f32_16x16x32_bf16 v[130:133], v[98:101], v[146:149], v[130:133]
v_mfma_f32_16x16x32_bf16 v[134:137], v[102:105], v[146:149], v[134:137]
ds_read_b128 v[146:149], v251 offset:12288
s_waitcnt lgkmcnt(5)
v_mfma_f32_16x16x32_bf16 v[138:141], v[98:101], v[150:153], v[138:141]
v_mfma_f32_16x16x32_bf16 v[142:145], v[102:105], v[150:153], v[142:145]
ds_read_b128 v[150:153], v251 offset:14336
s_waitcnt lgkmcnt(5)
v_mfma_f32_16x16x32_bf16 v[130:133], v[10:13], v[154:157], v[130:133]
v_mfma_f32_16x16x32_bf16 v[134:137], v[14:17], v[154:157], v[134:137]
ds_read_b128 v[154:157], v252 offset:12288
s_waitcnt lgkmcnt(5)
v_mfma_f32_16x16x32_bf16 v[138:141], v[10:13], v[158:161], v[138:141]
v_mfma_f32_16x16x32_bf16 v[142:145], v[14:17], v[158:161], v[142:145]
ds_read_b128 v[158:161], v252 offset:14336
s_waitcnt lgkmcnt(5)
v_mfma_f32_16x16x32_bf16 v[130:133], v[42:45], v[162:165], v[130:133]
v_mfma_f32_16x16x32_bf16 v[134:137], v[46:49], v[162:165], v[134:137]
ds_read_b128 v[162:165], v251 offset:16384
s_waitcnt lgkmcnt(5)
v_mfma_f32_16x16x32_bf16 v[138:141], v[42:45], v[166:169], v[138:141]
v_mfma_f32_16x16x32_bf16 v[142:145], v[46:49], v[166:169], v[142:145]
ds_read_b128 v[166:169], v251 offset:18432
s_waitcnt lgkmcnt(5)
v_mfma_f32_16x16x32_bf16 v[130:133], v[74:77], v[146:149], v[130:133]
v_mfma_f32_16x16x32_bf16 v[134:137], v[78:81], v[146:149], v[134:137]
ds_read_b128 v[146:149], v252 offset:16384
s_waitcnt lgkmcnt(5)
v_mfma_f32_16x16x32_bf16 v[138:141], v[74:77], v[150:153], v[138:141]
v_mfma_f32_16x16x32_bf16 v[142:145], v[78:81], v[150:153], v[142:145]
ds_read_b128 v[150:153], v252 offset:18432
s_waitcnt lgkmcnt(5)
v_mfma_f32_16x16x32_bf16 v[130:133], v[106:109], v[154:157], v[130:133]
v_mfma_f32_16x16x32_bf16 v[134:137], v[110:113], v[154:157], v[134:137]
ds_read_b128 v[154:157], v251 offset:20480
s_waitcnt lgkmcnt(5)
v_mfma_f32_16x16x32_bf16 v[138:141], v[106:109], v[158:161], v[138:141]
v_mfma_f32_16x16x32_bf16 v[142:145], v[110:113], v[158:161], v[142:145]
ds_read_b128 v[158:161], v251 offset:22528
s_waitcnt lgkmcnt(5)
v_mfma_f32_16x16x32_bf16 v[130:133], v[18:21], v[162:165], v[130:133]
v_mfma_f32_16x16x32_bf16 v[134:137], v[22:25], v[162:165], v[134:137]
ds_read_b128 v[162:165], v252 offset:20480
s_waitcnt lgkmcnt(5)
v_mfma_f32_16x16x32_bf16 v[138:141], v[18:21], v[166:169], v[138:141]
v_mfma_f32_16x16x32_bf16 v[142:145], v[22:25], v[166:169], v[142:145]
ds_read_b128 v[166:169], v252 offset:22528
s_waitcnt lgkmcnt(5)
v_mfma_f32_16x16x32_bf16 v[130:133], v[50:53], v[146:149], v[130:133]
v_mfma_f32_16x16x32_bf16 v[134:137], v[54:57], v[146:149], v[134:137]
ds_read_b128 v[146:149], v251 offset:24576
s_waitcnt lgkmcnt(5)
v_mfma_f32_16x16x32_bf16 v[138:141], v[50:53], v[150:153], v[138:141]
v_mfma_f32_16x16x32_bf16 v[142:145], v[54:57], v[150:153], v[142:145]
ds_read_b128 v[150:153], v251 offset:26624
s_waitcnt lgkmcnt(5)
v_mfma_f32_16x16x32_bf16 v[130:133], v[82:85], v[154:157], v[130:133]
v_mfma_f32_16x16x32_bf16 v[134:137], v[86:89], v[154:157], v[134:137]
ds_read_b128 v[154:157], v252 offset:24576
s_waitcnt lgkmcnt(5)
v_mfma_f32_16x16x32_bf16 v[138:141], v[82:85], v[158:161], v[138:141]
v_mfma_f32_16x16x32_bf16 v[142:145], v[86:89], v[158:161], v[142:145]
ds_read_b128 v[158:161], v252 offset:26624
s_waitcnt lgkmcnt(5)
v_mfma_f32_16x16x32_bf16 v[130:133], v[114:117], v[162:165], v[130:133]
v_mfma_f32_16x16x32_bf16 v[134:137], v[118:121], v[162:165], v[134:137]
ds_read_b128 v[162:165], v251 offset:28672
s_waitcnt lgkmcnt(5)
v_mfma_f32_16x16x32_bf16 v[138:141], v[114:117], v[166:169], v[138:141]
v_mfma_f32_16x16x32_bf16 v[142:145], v[118:121], v[166:169], v[142:145]
ds_read_b128 v[166:169], v251 offset:30720
s_waitcnt lgkmcnt(5)
v_mfma_f32_16x16x32_bf16 v[130:133], v[26:29], v[146:149], v[130:133]
v_mfma_f32_16x16x32_bf16 v[134:137], v[30:33], v[146:149], v[134:137]
ds_read_b128 v[146:149], v252 offset:28672
s_waitcnt lgkmcnt(5)
v_mfma_f32_16x16x32_bf16 v[138:141], v[26:29], v[150:153], v[138:141]
v_mfma_f32_16x16x32_bf16 v[142:145], v[30:33], v[150:153], v[142:145]
ds_read_b128 v[150:153], v252 offset:30720
s_waitcnt lgkmcnt(5)
v_mfma_f32_16x16x32_bf16 v[130:133], v[58:61], v[154:157], v[130:133]
v_mfma_f32_16x16x32_bf16 v[134:137], v[62:65], v[154:157], v[134:137]
s_waitcnt lgkmcnt(4)
v_mfma_f32_16x16x32_bf16 v[138:141], v[58:61], v[158:161], v[138:141]
v_mfma_f32_16x16x32_bf16 v[142:145], v[62:65], v[158:161], v[142:145]
s_waitcnt lgkmcnt(3)
v_mfma_f32_16x16x32_bf16 v[130:133], v[90:93], v[162:165], v[130:133]
v_mfma_f32_16x16x32_bf16 v[134:137], v[94:97], v[162:165], v[134:137]
s_waitcnt lgkmcnt(2)
v_mfma_f32_16x16x32_bf16 v[138:141], v[90:93], v[166:169], v[138:141]
v_mfma_f32_16x16x32_bf16 v[142:145], v[94:97], v[166:169], v[142:145]
s_waitcnt lgkmcnt(1)
v_mfma_f32_16x16x32_bf16 v[130:133], v[122:125], v[146:149], v[130:133]
v_mfma_f32_16x16x32_bf16 v[134:137], v[126:129], v[146:149], v[134:137]
s_waitcnt lgkmcnt(0)
v_mfma_f32_16x16x32_bf16 v[138:141], v[122:125], v[150:153], v[138:141]
v_mfma_f32_16x16x32_bf16 v[142:145], v[126:129], v[150:153], v[142:145]
s_setprio 0
v_xor_b32 v251, 0x10000, v251
v_xor_b32 v252, 0x10000, v252
v_add_f32 v170, v170, v186
v_add_f32 v171, v171, v187
v_add_f32 v172, v172, v188
v_add_f32 v173, v173, v189
v_add_f32 v174, v174, v190
v_add_f32 v175, v175, v191
v_add_f32 v176, v176, v192
v_add_f32 v177, v177, v193
v_add_f32 v178, v178, v194
v_add_f32 v179, v179, v195
v_add_f32 v180, v180, v196
v_add_f32 v181, v181, v197
v_add_f32 v182, v182, v198
v_add_f32 v183, v183, v199
v_add_f32 v184, v184, v200
v_add_f32 v185, v185, v201
v_cvt_pk_bf16_f32 v240, v170, v171
v_cvt_pk_bf16_f32 v241, v172, v173
v_cvt_pk_bf16_f32 v242, v174, v175
v_cvt_pk_bf16_f32 v243, v176, v177
v_cvt_pk_bf16_f32 v244, v178, v179
v_cvt_pk_bf16_f32 v245, v180, v181
v_cvt_pk_bf16_f32 v246, v182, v183
v_cvt_pk_bf16_f32 v247, v184, v185
s_sub_u32 s22, s18, 1
s_lshl_b32 s22, s22, 14
s_xor_b32 s22, s22, s42
buffer_store_dwordx4 v[240:243], v205, s[4:7], s22 offen sc1
s_add_u32 s22, s22, 4096
buffer_store_dwordx4 v[244:247], v205, s[4:7], s22 offen sc1
s_sub_u32 s22, s18, 2
s_max_u32 s22, s22, 13
v_mov_b32 v1, s22
buffer_store_dword v1, v206, s[4:7], s43 offen sc1
v_mov_b32 v170, v130
v_mov_b32 v171, v131
v_mov_b32 v172, v132
v_mov_b32 v173, v133
v_mov_b32 v174, v134
v_mov_b32 v175, v135
v_mov_b32 v176, v136
v_mov_b32 v177, v137
v_mov_b32 v178, v138
v_mov_b32 v179, v139
v_mov_b32 v180, v140
v_mov_b32 v181, v141
v_mov_b32 v182, v142
v_mov_b32 v183, v143
v_mov_b32 v184, v144
v_mov_b32 v185, v145
s_add_u32 s22, s18, 3
s_lshl_b32 s22, s22, 16
buffer_load_dword v248, v207, s[48:51], s22 offen
s_and_b32 s22, s18, 35
s_xor_b32 s22, s22, s12
s_cmp_eq_u32 s22, 32
s_cbranch_scc1 kq_121
kq_122:
s_add_u32 s18, s18, 1
s_cmp_lt_u32 s18, 64
s_cbranch_scc1 kvl_119
s_barrier
ds_read_b128 v[186:189], v204 offset:0
ds_read_b128 v[190:193], v204 offset:1024
ds_read_b128 v[194:197], v204 offset:2048
ds_read_b128 v[198:201], v204 offset:3072
v_xor_b32 v204, 0x4000, v204
s_waitcnt lgkmcnt(0)
v_add_f32 v170, v170, v186
v_add_f32 v171, v171, v187
v_add_f32 v172, v172, v188
v_add_f32 v173, v173, v189
v_add_f32 v174, v174, v190
v_add_f32 v175, v175, v191
v_add_f32 v176, v176, v192
v_add_f32 v177, v177, v193
v_add_f32 v178, v178, v194
v_add_f32 v179, v179, v195
v_add_f32 v180, v180, v196
v_add_f32 v181, v181, v197
v_add_f32 v182, v182, v198
v_add_f32 v183, v183, v199
v_add_f32 v184, v184, v200
v_add_f32 v185, v185, v201
v_cvt_pk_bf16_f32 v240, v170, v171
v_cvt_pk_bf16_f32 v241, v172, v173
v_cvt_pk_bf16_f32 v242, v174, v175
v_cvt_pk_bf16_f32 v243, v176, v177
v_cvt_pk_bf16_f32 v244, v178, v179
v_cvt_pk_bf16_f32 v245, v180, v181
v_cvt_pk_bf16_f32 v246, v182, v183
v_cvt_pk_bf16_f32 v247, v184, v185
s_sub_u32 s22, s18, 1
s_lshl_b32 s22, s22, 14
s_xor_b32 s22, s22, s42
buffer_store_dwordx4 v[240:243], v205, s[4:7], s22 offen sc1
s_add_u32 s22, s22, 4096
buffer_store_dwordx4 v[244:247], v205, s[4:7], s22 offen sc1
s_waitcnt vmcnt(0)
s_barrier
s_sub_u32 s22, s18, 0
v_mov_b32 v1, s22
buffer_store_dword v1, v206, s[4:7], s43 offen sc1
s_branch L_conv
kv01_105:
ds_write_b128 v204, v[130:133] offset:0
ds_write_b128 v204, v[134:137] offset:1024
ds_write_b128 v204, v[138:141] offset:2048
ds_write_b128 v204, v[142:145] offset:3072
v_xor_b32 v204, 0x4000, v204
s_waitcnt lgkmcnt(0)
s_barrier
s_mov_b32 s44, 1
s_xor_b32 s41, s41, 0x10000
s_lshl_b32 s20, s44, 16
s_add_u32 s21, s52, s41
s_xor_b32 s21, s21, 0x8000
s_add_u32 m0, s21, 0
s_nop 0
buffer_load_dwordx4 v253, s[48:51], s20 offen offset:0 lds
s_add_u32 m0, s21, 3968
s_nop 0
buffer_load_dwordx4 v253, s[48:51], s20 offen offset:128 lds
s_add_u32 m0, s21, 7936
s_nop 0
buffer_load_dwordx4 v253, s[48:51], s20 offen offset:256 lds
s_add_u32 m0, s21, 11904
s_nop 0
buffer_load_dwordx4 v253, s[48:51], s20 offen offset:384 lds
s_add_u32 m0, s21, 15872
s_nop 0
buffer_load_dwordx4 v253, s[48:51], s20 offen offset:512 lds
s_add_u32 m0, s21, 19840
s_nop 0
buffer_load_dwordx4 v253, s[48:51], s20 offen offset:640 lds
s_add_u32 m0, s21, 23808
s_nop 0
buffer_load_dwordx4 v253, s[48:51], s20 offen offset:768 lds
s_add_u32 m0, s21, 27776
s_nop 0
buffer_load_dwordx4 v253, s[48:51], s20 offen offset:896 lds
s_lshl_b32 s20, s44, 16
s_add_u32 s21, s52, s41
s_add_u32 m0, s21, 0
s_nop 0
buffer_load_dwordx4 v250, s[48:51], s20 offen offset:0 lds
s_add_u32 m0, s21, 3968
s_nop 0
buffer_load_dwordx4 v250, s[48:51], s20 offen offset:128 lds
s_add_u32 m0, s21, 7936
s_nop 0
buffer_load_dwordx4 v250, s[48:51], s20 offen offset:256 lds
s_add_u32 m0, s21, 11904
s_nop 0
buffer_load_dwordx4 v250, s[48:51], s20 offen offset:384 lds
s_add_u32 m0, s21, 15872
s_nop 0
buffer_load_dwordx4 v250, s[48:51], s20 offen offset:512 lds
s_add_u32 m0, s21, 19840
s_nop 0
buffer_load_dwordx4 v250, s[48:51], s20 offen offset:640 lds
s_add_u32 m0, s21, 23808
s_nop 0
buffer_load_dwordx4 v250, s[48:51], s20 offen offset:768 lds
s_add_u32 m0, s21, 27776
s_nop 0
buffer_load_dwordx4 v250, s[48:51], s20 offen offset:896 lds
s_mov_b32 s18, 1
s_barrier
kvl_124:
s_waitcnt vmcnt(0) lgkmcnt(0)
s_barrier
s_add_u32 s44, s18, 1
s_min_u32 s44, s44, 63
s_xor_b32 s41, s41, 0x10000
s_lshl_b32 s20, s44, 16
s_add_u32 s21, s52, s41
s_xor_b32 s21, s21, 0x8000
s_add_u32 m0, s21, 0
s_nop 0
buffer_load_dwordx4 v253, s[48:51], s20 offen offset:0 lds
s_add_u32 m0, s21, 3968
s_nop 0
buffer_load_dwordx4 v253, s[48:51], s20 offen offset:128 lds
s_add_u32 m0, s21, 7936
s_nop 0
buffer_load_dwordx4 v253, s[48:51], s20 offen offset:256 lds
s_add_u32 m0, s21, 11904
s_nop 0
buffer_load_dwordx4 v253, s[48:51], s20 offen offset:384 lds
s_add_u32 m0, s21, 15872
s_nop 0
buffer_load_dwordx4 v253, s[48:51], s20 offen offset:512 lds
s_add_u32 m0, s21, 19840
s_nop 0
buffer_load_dwordx4 v253, s[48:51], s20 offen offset:640 lds
s_add_u32 m0, s21, 23808
s_nop 0
buffer_load_dwordx4 v253, s[48:51], s20 offen offset:768 lds
s_add_u32 m0, s21, 27776
s_nop 0
buffer_load_dwordx4 v253, s[48:51], s20 offen offset:896 lds
s_lshl_b32 s20, s44, 16
s_add_u32 s21, s52, s41
s_add_u32 m0, s21, 0
s_nop 0
buffer_load_dwordx4 v250, s[48:51], s20 offen offset:0 lds
s_add_u32 m0, s21, 3968
s_nop 0
buffer_load_dwordx4 v250, s[48:51], s20 offen offset:128 lds
s_add_u32 m0, s21, 7936
s_nop 0
buffer_load_dwordx4 v250, s[48:51], s20 offen offset:256 lds
s_add_u32 m0, s21, 11904
s_nop 0
buffer_load_dwordx4 v250, s[48:51], s20 offen offset:384 lds
s_add_u32 m0, s21, 15872
s_nop 0
buffer_load_dwordx4 v250, s[48:51], s20 offen offset:512 lds
s_add_u32 m0, s21, 19840
s_nop 0
buffer_load_dwordx4 v250, s[48:51], s20 offen offset:640 lds
s_add_u32 m0, s21, 23808
s_nop 0
buffer_load_dwordx4 v250, s[48:51], s20 offen offset:768 lds
s_add_u32 m0, s21, 27776
s_nop 0
buffer_load_dwordx4 v250, s[48:51], s20 offen offset:896 lds
s_barrier
s_setprio 1
ds_read_b128 v[146:149], v251 offset:0
ds_read_b128 v[150:153], v251 offset:2048
ds_read_b128 v[154:157], v252 offset:0
ds_read_b128 v[158:161], v252 offset:2048
ds_read_b128 v[162:165], v251 offset:4096
ds_read_b128 v[166:169], v251 offset:6144
s_waitcnt lgkmcnt(5)
v_mfma_f32_16x16x32_bf16 v[130:133], v[2:5], v[146:149], 0
v_mfma_f32_16x16x32_bf16 v[134:137], v[6:9], v[146:149], 0
ds_read_b128 v[146:149], v252 offset:4096
s_waitcnt lgkmcnt(5)
v_mfma_f32_16x16x32_bf16 v[138:141], v[2:5], v[150:153], 0
v_mfma_f32_16x16x32_bf16 v[142:145], v[6:9], v[150:153], 0
ds_read_b128 v[150:153], v252 offset:6144
s_waitcnt lgkmcnt(5)
v_mfma_f32_16x16x32_bf16 v[130:133], v[34:37], v[154:157], v[130:133]
v_mfma_f32_16x16x32_bf16 v[134:137], v[38:41], v[154:157], v[134:137]
ds_read_b128 v[154:157], v251 offset:8192
s_waitcnt lgkmcnt(5)
v_mfma_f32_16x16x32_bf16 v[138:141], v[34:37], v[158:161], v[138:141]
v_mfma_f32_16x16x32_bf16 v[142:145], v[38:41], v[158:161], v[142:145]
ds_read_b128 v[158:161], v251 offset:10240
s_waitcnt lgkmcnt(5)
v_mfma_f32_16x16x32_bf16 v[130:133], v[66:69], v[162:165], v[130:133]
v_mfma_f32_16x16x32_bf16 v[134:137], v[70:73], v[162:165], v[134:137]
ds_read_b128 v[162:165], v252 offset:8192
s_waitcnt lgkmcnt(5)
v_mfma_f32_16x16x32_bf16 v[138:141], v[66:69], v[166:169], v[138:141]
v_mfma_f32_16x16x32_bf16 v[142:145], v[70:73], v[166:169], v[142:145]
ds_read_b128 v[166:169], v252 offset:10240
s_waitcnt lgkmcnt(5)
v_mfma_f32_16x16x32_bf16 v[130:133], v[98:101], v[146:149], v[130:133]
v_mfma_f32_16x16x32_bf16 v[134:137], v[102:105], v[146:149], v[134:137]
ds_read_b128 v[146:149], v251 offset:12288
s_waitcnt lgkmcnt(5)
v_mfma_f32_16x16x32_bf16 v[138:141], v[98:101], v[150:153], v[138:141]
v_mfma_f32_16x16x32_bf16 v[142:145], v[102:105], v[150:153], v[142:145]
ds_read_b128 v[150:153], v251 offset:14336
s_waitcnt lgkmcnt(5)
v_mfma_f32_16x16x32_bf16 v[130:133], v[10:13], v[154:157], v[130:133]
v_mfma_f32_16x16x32_bf16 v[134:137], v[14:17], v[154:157], v[134:137]
ds_read_b128 v[154:157], v252 offset:12288
s_waitcnt lgkmcnt(5)
v_mfma_f32_16x16x32_bf16 v[138:141], v[10:13], v[158:161], v[138:141]
v_mfma_f32_16x16x32_bf16 v[142:145], v[14:17], v[158:161], v[142:145]
ds_read_b128 v[158:161], v252 offset:14336
s_waitcnt lgkmcnt(5)
v_mfma_f32_16x16x32_bf16 v[130:133], v[42:45], v[162:165], v[130:133]
v_mfma_f32_16x16x32_bf16 v[134:137], v[46:49], v[162:165], v[134:137]
ds_read_b128 v[162:165], v251 offset:16384
s_waitcnt lgkmcnt(5)
v_mfma_f32_16x16x32_bf16 v[138:141], v[42:45], v[166:169], v[138:141]
v_mfma_f32_16x16x32_bf16 v[142:145], v[46:49], v[166:169], v[142:145]
ds_read_b128 v[166:169], v251 offset:18432
s_waitcnt lgkmcnt(5)
v_mfma_f32_16x16x32_bf16 v[130:133], v[74:77], v[146:149], v[130:133]
v_mfma_f32_16x16x32_bf16 v[134:137], v[78:81], v[146:149], v[134:137]
ds_read_b128 v[146:149], v252 offset:16384
s_waitcnt lgkmcnt(5)
v_mfma_f32_16x16x32_bf16 v[138:141], v[74:77], v[150:153], v[138:141]
v_mfma_f32_16x16x32_bf16 v[142:145], v[78:81], v[150:153], v[142:145]
ds_read_b128 v[150:153], v252 offset:18432
s_waitcnt lgkmcnt(5)
v_mfma_f32_16x16x32_bf16 v[130:133], v[106:109], v[154:157], v[130:133]
v_mfma_f32_16x16x32_bf16 v[134:137], v[110:113], v[154:157], v[134:137]
ds_read_b128 v[154:157], v251 offset:20480
s_waitcnt lgkmcnt(5)
v_mfma_f32_16x16x32_bf16 v[138:141], v[106:109], v[158:161], v[138:141]
v_mfma_f32_16x16x32_bf16 v[142:145], v[110:113], v[158:161], v[142:145]
ds_read_b128 v[158:161], v251 offset:22528
s_waitcnt lgkmcnt(5)
v_mfma_f32_16x16x32_bf16 v[130:133], v[18:21], v[162:165], v[130:133]
v_mfma_f32_16x16x32_bf16 v[134:137], v[22:25], v[162:165], v[134:137]
ds_read_b128 v[162:165], v252 offset:20480
s_waitcnt lgkmcnt(5)
v_mfma_f32_16x16x32_bf16 v[138:141], v[18:21], v[166:169], v[138:141]
v_mfma_f32_16x16x32_bf16 v[142:145], v[22:25], v[166:169], v[142:145]
ds_read_b128 v[166:169], v252 offset:22528
s_waitcnt lgkmcnt(5)
v_mfma_f32_16x16x32_bf16 v[130:133], v[50:53], v[146:149], v[130:133]
v_mfma_f32_16x16x32_bf16 v[134:137], v[54:57], v[146:149], v[134:137]
ds_read_b128 v[146:149], v251 offset:24576
s_waitcnt lgkmcnt(5)
v_mfma_f32_16x16x32_bf16 v[138:141], v[50:53], v[150:153], v[138:141]
v_mfma_f32_16x16x32_bf16 v[142:145], v[54:57], v[150:153], v[142:145]
ds_read_b128 v[150:153], v251 offset:26624
s_waitcnt lgkmcnt(5)
v_mfma_f32_16x16x32_bf16 v[130:133], v[82:85], v[154:157], v[130:133]
v_mfma_f32_16x16x32_bf16 v[134:137], v[86:89], v[154:157], v[134:137]
ds_read_b128 v[154:157], v252 offset:24576
s_waitcnt lgkmcnt(5)
v_mfma_f32_16x16x32_bf16 v[138:141], v[82:85], v[158:161], v[138:141]
v_mfma_f32_16x16x32_bf16 v[142:145], v[86:89], v[158:161], v[142:145]
ds_read_b128 v[158:161], v252 offset:26624
s_waitcnt lgkmcnt(5)
v_mfma_f32_16x16x32_bf16 v[130:133], v[114:117], v[162:165], v[130:133]
v_mfma_f32_16x16x32_bf16 v[134:137], v[118:121], v[162:165], v[134:137]
ds_read_b128 v[162:165], v251 offset:28672
s_waitcnt lgkmcnt(5)
v_mfma_f32_16x16x32_bf16 v[138:141], v[114:117], v[166:169], v[138:141]
v_mfma_f32_16x16x32_bf16 v[142:145], v[118:121], v[166:169], v[142:145]
ds_read_b128 v[166:169], v251 offset:30720
s_waitcnt lgkmcnt(5)
v_mfma_f32_16x16x32_bf16 v[130:133], v[26:29], v[146:149], v[130:133]
v_mfma_f32_16x16x32_bf16 v[134:137], v[30:33], v[146:149], v[134:137]
ds_read_b128 v[146:149], v252 offset:28672
s_waitcnt lgkmcnt(5)
v_mfma_f32_16x16x32_bf16 v[138:141], v[26:29], v[150:153], v[138:141]
v_mfma_f32_16x16x32_bf16 v[142:145], v[30:33], v[150:153], v[142:145]
ds_read_b128 v[150:153], v252 offset:30720
s_waitcnt lgkmcnt(5)
v_mfma_f32_16x16x32_bf16 v[130:133], v[58:61], v[154:157], v[130:133]
v_mfma_f32_16x16x32_bf16 v[134:137], v[62:65], v[154:157], v[134:137]
s_waitcnt lgkmcnt(4)
v_mfma_f32_16x16x32_bf16 v[138:141], v[58:61], v[158:161], v[138:141]
v_mfma_f32_16x16x32_bf16 v[142:145], v[62:65], v[158:161], v[142:145]
s_waitcnt lgkmcnt(3)
v_mfma_f32_16x16x32_bf16 v[130:133], v[90:93], v[162:165], v[130:133]
v_mfma_f32_16x16x32_bf16 v[134:137], v[94:97], v[162:165], v[134:137]
s_waitcnt lgkmcnt(2)
v_mfma_f32_16x16x32_bf16 v[138:141], v[90:93], v[166:169], v[138:141]
v_mfma_f32_16x16x32_bf16 v[142:145], v[94:97], v[166:169], v[142:145]
s_waitcnt lgkmcnt(1)
v_mfma_f32_16x16x32_bf16 v[130:133], v[122:125], v[146:149], v[130:133]
v_mfma_f32_16x16x32_bf16 v[134:137], v[126:129], v[146:149], v[134:137]
s_waitcnt lgkmcnt(0)
v_mfma_f32_16x16x32_bf16 v[138:141], v[122:125], v[150:153], v[138:141]
v_mfma_f32_16x16x32_bf16 v[142:145], v[126:129], v[150:153], v[142:145]
s_setprio 0
v_xor_b32 v251, 0x10000, v251
v_xor_b32 v252, 0x10000, v252
s_nop 7
ds_write_b128 v204, v[130:133] offset:0
ds_write_b128 v204, v[134:137] offset:1024
ds_write_b128 v204, v[138:141] offset:2048
ds_write_b128 v204, v[142:145] offset:3072
v_xor_b32 v204, 0x4000, v204
s_add_u32 s18, s18, 1
s_cmp_lt_u32 s18, 14
s_cbranch_scc1 kvl_124
kvl_123:
s_waitcnt vmcnt(0) lgkmcnt(0)
s_barrier
s_add_u32 s44, s18, 1
s_min_u32 s44, s44, 63
s_xor_b32 s41, s41, 0x10000
s_lshl_b32 s20, s44, 16
s_add_u32 s21, s52, s41
s_xor_b32 s21, s21, 0x8000
s_add_u32 m0, s21, 0
s_nop 0
buffer_load_dwordx4 v253, s[48:51], s20 offen offset:0 lds
s_add_u32 m0, s21, 3968
s_nop 0
buffer_load_dwordx4 v253, s[48:51], s20 offen offset:128 lds
s_add_u32 m0, s21, 7936
s_nop 0
buffer_load_dwordx4 v253, s[48:51], s20 offen offset:256 lds
s_add_u32 m0, s21, 11904
s_nop 0
buffer_load_dwordx4 v253, s[48:51], s20 offen offset:384 lds
s_add_u32 m0, s21, 15872
s_nop 0
buffer_load_dwordx4 v253, s[48:51], s20 offen offset:512 lds
s_add_u32 m0, s21, 19840
s_nop 0
buffer_load_dwordx4 v253, s[48:51], s20 offen offset:640 lds
s_add_u32 m0, s21, 23808
s_nop 0
buffer_load_dwordx4 v253, s[48:51], s20 offen offset:768 lds
s_add_u32 m0, s21, 27776
s_nop 0
buffer_load_dwordx4 v253, s[48:51], s20 offen offset:896 lds
s_lshl_b32 s20, s44, 16
s_add_u32 s21, s52, s41
s_add_u32 m0, s21, 0
s_nop 0
buffer_load_dwordx4 v250, s[48:51], s20 offen offset:0 lds
s_add_u32 m0, s21, 3968
s_nop 0
buffer_load_dwordx4 v250, s[48:51], s20 offen offset:128 lds
s_add_u32 m0, s21, 7936
s_nop 0
buffer_load_dwordx4 v250, s[48:51], s20 offen offset:256 lds
s_add_u32 m0, s21, 11904
s_nop 0
buffer_load_dwordx4 v250, s[48:51], s20 offen offset:384 lds
s_add_u32 m0, s21, 15872
s_nop 0
buffer_load_dwordx4 v250, s[48:51], s20 offen offset:512 lds
s_add_u32 m0, s21, 19840
s_nop 0
buffer_load_dwordx4 v250, s[48:51], s20 offen offset:640 lds
s_add_u32 m0, s21, 23808
s_nop 0
buffer_load_dwordx4 v250, s[48:51], s20 offen offset:768 lds
s_add_u32 m0, s21, 27776
s_nop 0
buffer_load_dwordx4 v250, s[48:51], s20 offen offset:896 lds
s_and_b32 s22, s18, 35
s_xor_b32 s22, s22, s12
s_cmp_eq_u32 s22, 32
s_cbranch_scc1 kq_125
kq_126:
s_setprio 1
ds_read_b128 v[146:149], v251 offset:0
ds_read_b128 v[150:153], v251 offset:2048
ds_read_b128 v[154:157], v252 offset:0
ds_read_b128 v[158:161], v252 offset:2048
ds_read_b128 v[162:165], v251 offset:4096
ds_read_b128 v[166:169], v251 offset:6144
s_waitcnt lgkmcnt(5)
v_mfma_f32_16x16x32_bf16 v[130:133], v[2:5], v[146:149], 0
v_mfma_f32_16x16x32_bf16 v[134:137], v[6:9], v[146:149], 0
ds_read_b128 v[146:149], v252 offset:4096
s_waitcnt lgkmcnt(5)
v_mfma_f32_16x16x32_bf16 v[138:141], v[2:5], v[150:153], 0
v_mfma_f32_16x16x32_bf16 v[142:145], v[6:9], v[150:153], 0
ds_read_b128 v[150:153], v252 offset:6144
s_waitcnt lgkmcnt(5)
v_mfma_f32_16x16x32_bf16 v[130:133], v[34:37], v[154:157], v[130:133]
v_mfma_f32_16x16x32_bf16 v[134:137], v[38:41], v[154:157], v[134:137]
ds_read_b128 v[154:157], v251 offset:8192
s_waitcnt lgkmcnt(5)
v_mfma_f32_16x16x32_bf16 v[138:141], v[34:37], v[158:161], v[138:141]
v_mfma_f32_16x16x32_bf16 v[142:145], v[38:41], v[158:161], v[142:145]
ds_read_b128 v[158:161], v251 offset:10240
s_waitcnt lgkmcnt(5)
v_mfma_f32_16x16x32_bf16 v[130:133], v[66:69], v[162:165], v[130:133]
v_mfma_f32_16x16x32_bf16 v[134:137], v[70:73], v[162:165], v[134:137]
ds_read_b128 v[162:165], v252 offset:8192
s_waitcnt lgkmcnt(5)
v_mfma_f32_16x16x32_bf16 v[138:141], v[66:69], v[166:169], v[138:141]
v_mfma_f32_16x16x32_bf16 v[142:145], v[70:73], v[166:169], v[142:145]
ds_read_b128 v[166:169], v252 offset:10240
s_waitcnt lgkmcnt(5)
v_mfma_f32_16x16x32_bf16 v[130:133], v[98:101], v[146:149], v[130:133]
v_mfma_f32_16x16x32_bf16 v[134:137], v[102:105], v[146:149], v[134:137]
ds_read_b128 v[146:149], v251 offset:12288
s_waitcnt lgkmcnt(5)
v_mfma_f32_16x16x32_bf16 v[138:141], v[98:101], v[150:153], v[138:141]
v_mfma_f32_16x16x32_bf16 v[142:145], v[102:105], v[150:153], v[142:145]
ds_read_b128 v[150:153], v251 offset:14336
s_waitcnt lgkmcnt(5)
v_mfma_f32_16x16x32_bf16 v[130:133], v[10:13], v[154:157], v[130:133]
v_mfma_f32_16x16x32_bf16 v[134:137], v[14:17], v[154:157], v[134:137]
ds_read_b128 v[154:157], v252 offset:12288
s_waitcnt lgkmcnt(5)
v_mfma_f32_16x16x32_bf16 v[138:141], v[10:13], v[158:161], v[138:141]
v_mfma_f32_16x16x32_bf16 v[142:145], v[14:17], v[158:161], v[142:145]
ds_read_b128 v[158:161], v252 offset:14336
s_waitcnt lgkmcnt(5)
v_mfma_f32_16x16x32_bf16 v[130:133], v[42:45], v[162:165], v[130:133]
v_mfma_f32_16x16x32_bf16 v[134:137], v[46:49], v[162:165], v[134:137]
ds_read_b128 v[162:165], v251 offset:16384
s_waitcnt lgkmcnt(5)
v_mfma_f32_16x16x32_bf16 v[138:141], v[42:45], v[166:169], v[138:141]
v_mfma_f32_16x16x32_bf16 v[142:145], v[46:49], v[166:169], v[142:145]
ds_read_b128 v[166:169], v251 offset:18432
s_waitcnt lgkmcnt(5)
v_mfma_f32_16x16x32_bf16 v[130:133], v[74:77], v[146:149], v[130:133]
v_mfma_f32_16x16x32_bf16 v[134:137], v[78:81], v[146:149], v[134:137]
ds_read_b128 v[146:149], v252 offset:16384
s_waitcnt lgkmcnt(5)
v_mfma_f32_16x16x32_bf16 v[138:141], v[74:77], v[150:153], v[138:141]
v_mfma_f32_16x16x32_bf16 v[142:145], v[78:81], v[150:153], v[142:145]
ds_read_b128 v[150:153], v252 offset:18432
s_waitcnt lgkmcnt(5)
v_mfma_f32_16x16x32_bf16 v[130:133], v[106:109], v[154:157], v[130:133]
v_mfma_f32_16x16x32_bf16 v[134:137], v[110:113], v[154:157], v[134:137]
ds_read_b128 v[154:157], v251 offset:20480
s_waitcnt lgkmcnt(5)
v_mfma_f32_16x16x32_bf16 v[138:141], v[106:109], v[158:161], v[138:141]
v_mfma_f32_16x16x32_bf16 v[142:145], v[110:113], v[158:161], v[142:145]
ds_read_b128 v[158:161], v251 offset:22528
s_waitcnt lgkmcnt(5)
v_mfma_f32_16x16x32_bf16 v[130:133], v[18:21], v[162:165], v[130:133]
v_mfma_f32_16x16x32_bf16 v[134:137], v[22:25], v[162:165], v[134:137]
ds_read_b128 v[162:165], v252 offset:20480
s_waitcnt lgkmcnt(5)
v_mfma_f32_16x16x32_bf16 v[138:141], v[18:21], v[166:169], v[138:141]
v_mfma_f32_16x16x32_bf16 v[142:145], v[22:25], v[166:169], v[142:145]
ds_read_b128 v[166:169], v252 offset:22528
s_waitcnt lgkmcnt(5)
v_mfma_f32_16x16x32_bf16 v[130:133], v[50:53], v[146:149], v[130:133]
v_mfma_f32_16x16x32_bf16 v[134:137], v[54:57], v[146:149], v[134:137]
ds_read_b128 v[146:149], v251 offset:24576
s_waitcnt lgkmcnt(5)
v_mfma_f32_16x16x32_bf16 v[138:141], v[50:53], v[150:153], v[138:141]
v_mfma_f32_16x16x32_bf16 v[142:145], v[54:57], v[150:153], v[142:145]
ds_read_b128 v[150:153], v251 offset:26624
s_waitcnt lgkmcnt(5)
v_mfma_f32_16x16x32_bf16 v[130:133], v[82:85], v[154:157], v[130:133]
v_mfma_f32_16x16x32_bf16 v[134:137], v[86:89], v[154:157], v[134:137]
ds_read_b128 v[154:157], v252 offset:24576
s_waitcnt lgkmcnt(5)
v_mfma_f32_16x16x32_bf16 v[138:141], v[82:85], v[158:161], v[138:141]
v_mfma_f32_16x16x32_bf16 v[142:145], v[86:89], v[158:161], v[142:145]
ds_read_b128 v[158:161], v252 offset:26624
s_waitcnt lgkmcnt(5)
v_mfma_f32_16x16x32_bf16 v[130:133], v[114:117], v[162:165], v[130:133]
v_mfma_f32_16x16x32_bf16 v[134:137], v[118:121], v[162:165], v[134:137]
ds_read_b128 v[162:165], v251 offset:28672
s_waitcnt lgkmcnt(5)
v_mfma_f32_16x16x32_bf16 v[138:141], v[114:117], v[166:169], v[138:141]
v_mfma_f32_16x16x32_bf16 v[142:145], v[118:121], v[166:169], v[142:145]
ds_read_b128 v[166:169], v251 offset:30720
s_waitcnt lgkmcnt(5)
v_mfma_f32_16x16x32_bf16 v[130:133], v[26:29], v[146:149], v[130:133]
v_mfma_f32_16x16x32_bf16 v[134:137], v[30:33], v[146:149], v[134:137]
ds_read_b128 v[146:149], v252 offset:28672
s_waitcnt lgkmcnt(5)
v_mfma_f32_16x16x32_bf16 v[138:141], v[26:29], v[150:153], v[138:141]
v_mfma_f32_16x16x32_bf16 v[142:145], v[30:33], v[150:153], v[142:145]
ds_read_b128 v[150:153], v252 offset:30720
s_waitcnt lgkmcnt(5)
v_mfma_f32_16x16x32_bf16 v[130:133], v[58:61], v[154:157], v[130:133]
v_mfma_f32_16x16x32_bf16 v[134:137], v[62:65], v[154:157], v[134:137]
s_waitcnt lgkmcnt(4)
v_mfma_f32_16x16x32_bf16 v[138:141], v[58:61], v[158:161], v[138:141]
v_mfma_f32_16x16x32_bf16 v[142:145], v[62:65], v[158:161], v[142:145]
s_waitcnt lgkmcnt(3)
v_mfma_f32_16x16x32_bf16 v[130:133], v[90:93], v[162:165], v[130:133]
v_mfma_f32_16x16x32_bf16 v[134:137], v[94:97], v[162:165], v[134:137]
s_waitcnt lgkmcnt(2)
v_mfma_f32_16x16x32_bf16 v[138:141], v[90:93], v[166:169], v[138:141]
v_mfma_f32_16x16x32_bf16 v[142:145], v[94:97], v[166:169], v[142:145]
s_waitcnt lgkmcnt(1)
v_mfma_f32_16x16x32_bf16 v[130:133], v[122:125], v[146:149], v[130:133]
v_mfma_f32_16x16x32_bf16 v[134:137], v[126:129], v[146:149], v[134:137]
s_waitcnt lgkmcnt(0)
v_mfma_f32_16x16x32_bf16 v[138:141], v[122:125], v[150:153], v[138:141]
v_mfma_f32_16x16x32_bf16 v[142:145], v[126:129], v[150:153], v[142:145]
s_setprio 0
v_xor_b32 v251, 0x10000, v251
v_xor_b32 v252, 0x10000, v252
s_nop 7
ds_write_b128 v204, v[130:133] offset:0
ds_write_b128 v204, v[134:137] offset:1024
ds_write_b128 v204, v[138:141] offset:2048
ds_write_b128 v204, v[142:145] offset:3072
v_xor_b32 v204, 0x4000, v204
s_add_u32 s18, s18, 1
s_cmp_lt_u32 s18, 64
s_cbranch_scc1 kvl_123
s_waitcnt vmcnt(0) lgkmcnt(0)
s_barrier
s_barrier
s_branch L_conv
kv10_106:
v_mov_b32 v170, v130
v_mov_b32 v171, v131
v_mov_b32 v172, v132
v_mov_b32 v173, v133
v_mov_b32 v174, v134
v_mov_b32 v175, v135
v_mov_b32 v176, v136
v_mov_b32 v177, v137
v_mov_b32 v178, v138
v_mov_b32 v179, v139
v_mov_b32 v180, v140
v_mov_b32 v181, v141
v_mov_b32 v182, v142
v_mov_b32 v183, v143
v_mov_b32 v184, v144
v_mov_b32 v185, v145
s_mov_b32 s18, 1
s_barrier
ds_read_b128 v[186:189], v204 offset:0
ds_read_b128 v[190:193], v204 offset:1024
ds_read_b128 v[194:197], v204 offset:2048
ds_read_b128 v[198:201], v204 offset:3072
v_xor_b32 v204, 0x4000, v204
s_waitcnt lgkmcnt(0)
v_add_f32 v170, v170, v186
v_add_f32 v171, v171, v187
v_add_f32 v172, v172, v188
v_add_f32 v173, v173, v189
v_add_f32 v174, v174, v190
v_add_f32 v175, v175, v191
v_add_f32 v176, v176, v192
v_add_f32 v177, v177, v193
v_add_f32 v178, v178, v194
v_add_f32 v179, v179, v195
v_add_f32 v180, v180, v196
v_add_f32 v181, v181, v197
v_add_f32 v182, v182, v198
v_add_f32 v183, v183, v199
v_add_f32 v184, v184, v200
v_add_f32 v185, v185, v201
v_cvt_pk_bf16_f32 v240, v170, v171
v_cvt_pk_bf16_f32 v241, v172, v173
v_cvt_pk_bf16_f32 v242, v174, v175
v_cvt_pk_bf16_f32 v243, v176, v177
v_cvt_pk_bf16_f32 v244, v178, v179
v_cvt_pk_bf16_f32 v245, v180, v181
v_cvt_pk_bf16_f32 v246, v182, v183
v_cvt_pk_bf16_f32 v247, v184, v185
s_sub_u32 s22, s18, 1
s_lshl_b32 s22, s22, 14
s_xor_b32 s22, s22, s42
buffer_store_dwordx4 v[240:243], v205, s[4:7], s22 offen sc1
s_add_u32 s22, s22, 1024
buffer_store_dwordx4 v[244:247], v205, s[4:7], s22 offen sc1
s_waitcnt vmcnt(0)
s_barrier
s_sub_u32 s22, s18, 0
v_mov_b32 v1, s22
buffer_store_dword v1, v206, s[4:7], s43 offen sc1
s_nop 0
s_waitcnt vmcnt(63) lgkmcnt(0)
s_barrier
s_setprio 2
ds_read_b128 v[146:149], v251 offset:0
ds_read_b128 v[150:153], v251 offset:2048
ds_read_b128 v[154:157], v252 offset:0
ds_read_b128 v[158:161], v252 offset:2048
ds_read_b128 v[162:165], v251 offset:4096
ds_read_b128 v[166:169], v251 offset:6144
s_waitcnt lgkmcnt(5)
v_mfma_f32_16x16x32_bf16 v[130:133], v[146:149], v[2:5], 0
v_mfma_f32_16x16x32_bf16 v[138:141], v[146:149], v[6:9], 0
ds_read_b128 v[146:149], v252 offset:4096
s_waitcnt lgkmcnt(5)
v_mfma_f32_16x16x32_bf16 v[134:137], v[150:153], v[2:5], 0
v_mfma_f32_16x16x32_bf16 v[142:145], v[150:153], v[6:9], 0
ds_read_b128 v[150:153], v252 offset:6144
s_waitcnt lgkmcnt(5)
v_mfma_f32_16x16x32_bf16 v[130:133], v[154:157], v[34:37], v[130:133]
v_mfma_f32_16x16x32_bf16 v[138:141], v[154:157], v[38:41], v[138:141]
ds_read_b128 v[154:157], v251 offset:8192
s_waitcnt lgkmcnt(5)
v_mfma_f32_16x16x32_bf16 v[134:137], v[158:161], v[34:37], v[134:137]
v_mfma_f32_16x16x32_bf16 v[142:145], v[158:161], v[38:41], v[142:145]
ds_read_b128 v[158:161], v251 offset:10240
s_waitcnt lgkmcnt(5)
v_mfma_f32_16x16x32_bf16 v[130:133], v[162:165], v[66:69], v[130:133]
v_mfma_f32_16x16x32_bf16 v[138:141], v[162:165], v[70:73], v[138:141]
ds_read_b128 v[162:165], v252 offset:8192
s_waitcnt lgkmcnt(5)
v_mfma_f32_16x16x32_bf16 v[134:137], v[166:169], v[66:69], v[134:137]
v_mfma_f32_16x16x32_bf16 v[142:145], v[166:169], v[70:73], v[142:145]
ds_read_b128 v[166:169], v252 offset:10240
s_waitcnt lgkmcnt(5)
v_mfma_f32_16x16x32_bf16 v[130:133], v[146:149], v[98:101], v[130:133]
v_mfma_f32_16x16x32_bf16 v[138:141], v[146:149], v[102:105], v[138:141]
ds_read_b128 v[146:149], v251 offset:12288
s_waitcnt lgkmcnt(5)
v_mfma_f32_16x16x32_bf16 v[134:137], v[150:153], v[98:101], v[134:137]
v_mfma_f32_16x16x32_bf16 v[142:145], v[150:153], v[102:105], v[142:145]
ds_read_b128 v[150:153], v251 offset:14336
s_waitcnt lgkmcnt(5)
v_mfma_f32_16x16x32_bf16 v[130:133], v[154:157], v[10:13], v[130:133]
v_mfma_f32_16x16x32_bf16 v[138:141], v[154:157], v[14:17], v[138:141]
ds_read_b128 v[154:157], v252 offset:12288
s_waitcnt lgkmcnt(5)
v_mfma_f32_16x16x32_bf16 v[134:137], v[158:161], v[10:13], v[134:137]
v_mfma_f32_16x16x32_bf16 v[142:145], v[158:161], v[14:17], v[142:145]
ds_read_b128 v[158:161], v252 offset:14336
s_waitcnt lgkmcnt(5)
v_mfma_f32_16x16x32_bf16 v[130:133], v[162:165], v[42:45], v[130:133]
v_mfma_f32_16x16x32_bf16 v[138:141], v[162:165], v[46:49], v[138:141]
ds_read_b128 v[162:165], v251 offset:16384
s_waitcnt lgkmcnt(5)
v_mfma_f32_16x16x32_bf16 v[134:137], v[166:169], v[42:45], v[134:137]
v_mfma_f32_16x16x32_bf16 v[142:145], v[166:169], v[46:49], v[142:145]
ds_read_b128 v[166:169], v251 offset:18432
s_waitcnt lgkmcnt(5)
v_mfma_f32_16x16x32_bf16 v[130:133], v[146:149], v[74:77], v[130:133]
v_mfma_f32_16x16x32_bf16 v[138:141], v[146:149], v[78:81], v[138:141]
ds_read_b128 v[146:149], v252 offset:16384
s_waitcnt lgkmcnt(5)
v_mfma_f32_16x16x32_bf16 v[134:137], v[150:153], v[74:77], v[134:137]
v_mfma_f32_16x16x32_bf16 v[142:145], v[150:153], v[78:81], v[142:145]
ds_read_b128 v[150:153], v252 offset:18432
s_waitcnt lgkmcnt(5)
v_mfma_f32_16x16x32_bf16 v[130:133], v[154:157], v[106:109], v[130:133]
v_mfma_f32_16x16x32_bf16 v[138:141], v[154:157], v[110:113], v[138:141]
ds_read_b128 v[154:157], v251 offset:20480
s_waitcnt lgkmcnt(5)
v_mfma_f32_16x16x32_bf16 v[134:137], v[158:161], v[106:109], v[134:137]
v_mfma_f32_16x16x32_bf16 v[142:145], v[158:161], v[110:113], v[142:145]
ds_read_b128 v[158:161], v251 offset:22528
s_waitcnt lgkmcnt(5)
v_mfma_f32_16x16x32_bf16 v[130:133], v[162:165], v[18:21], v[130:133]
v_mfma_f32_16x16x32_bf16 v[138:141], v[162:165], v[22:25], v[138:141]
ds_read_b128 v[162:165], v252 offset:20480
s_waitcnt lgkmcnt(5)
v_mfma_f32_16x16x32_bf16 v[134:137], v[166:169], v[18:21], v[134:137]
v_mfma_f32_16x16x32_bf16 v[142:145], v[166:169], v[22:25], v[142:145]
ds_read_b128 v[166:169], v252 offset:22528
s_waitcnt lgkmcnt(5)
v_mfma_f32_16x16x32_bf16 v[130:133], v[146:149], v[50:53], v[130:133]
v_mfma_f32_16x16x32_bf16 v[138:141], v[146:149], v[54:57], v[138:141]
ds_read_b128 v[146:149], v251 offset:24576
s_waitcnt lgkmcnt(5)
v_mfma_f32_16x16x32_bf16 v[134:137], v[150:153], v[50:53], v[134:137]
v_mfma_f32_16x16x32_bf16 v[142:145], v[150:153], v[54:57], v[142:145]
ds_read_b128 v[150:153], v251 offset:26624
s_waitcnt lgkmcnt(5)
v_mfma_f32_16x16x32_bf16 v[130:133], v[154:157], v[82:85], v[130:133]
v_mfma_f32_16x16x32_bf16 v[138:141], v[154:157], v[86:89], v[138:141]
ds_read_b128 v[154:157], v252 offset:24576
s_waitcnt lgkmcnt(5)
v_mfma_f32_16x16x32_bf16 v[134:137], v[158:161], v[82:85], v[134:137]
v_mfma_f32_16x16x32_bf16 v[142:145], v[158:161], v[86:89], v[142:145]
ds_read_b128 v[158:161], v252 offset:26624
s_waitcnt lgkmcnt(5)
v_mfma_f32_16x16x32_bf16 v[130:133], v[162:165], v[114:117], v[130:133]
v_mfma_f32_16x16x32_bf16 v[138:141], v[162:165], v[118:121], v[138:141]
ds_read_b128 v[162:165], v251 offset:28672
s_waitcnt lgkmcnt(5)
v_mfma_f32_16x16x32_bf16 v[134:137], v[166:169], v[114:117], v[134:137]
v_mfma_f32_16x16x32_bf16 v[142:145], v[166:169], v[118:121], v[142:145]
ds_read_b128 v[166:169], v251 offset:30720
s_waitcnt lgkmcnt(5)
v_mfma_f32_16x16x32_bf16 v[130:133], v[146:149], v[26:29], v[130:133]
v_mfma_f32_16x16x32_bf16 v[138:141], v[146:149], v[30:33], v[138:141]
ds_read_b128 v[146:149], v252 offset:28672
s_waitcnt lgkmcnt(5)
v_mfma_f32_16x16x32_bf16 v[134:137], v[150:153], v[26:29], v[134:137]
v_mfma_f32_16x16x32_bf16 v[142:145], v[150:153], v[30:33], v[142:145]
ds_read_b128 v[150:153], v252 offset:30720
s_waitcnt lgkmcnt(5)
v_mfma_f32_16x16x32_bf16 v[130:133], v[154:157], v[58:61], v[130:133]
v_mfma_f32_16x16x32_bf16 v[138:141], v[154:157], v[62:65], v[138:141]
s_waitcnt lgkmcnt(4)
v_mfma_f32_16x16x32_bf16 v[134:137], v[158:161], v[58:61], v[134:137]
v_mfma_f32_16x16x32_bf16 v[142:145], v[158:161], v[62:65], v[142:145]
s_waitcnt lgkmcnt(3)
v_mfma_f32_16x16x32_bf16 v[130:133], v[162:165], v[90:93], v[130:133]
v_mfma_f32_16x16x32_bf16 v[138:141], v[162:165], v[94:97], v[138:141]
s_waitcnt lgkmcnt(2)
v_mfma_f32_16x16x32_bf16 v[134:137], v[166:169], v[90:93], v[134:137]
v_mfma_f32_16x16x32_bf16 v[142:145], v[166:169], v[94:97], v[142:145]
s_waitcnt lgkmcnt(1)
v_mfma_f32_16x16x32_bf16 v[130:133], v[146:149], v[122:125], v[130:133]
v_mfma_f32_16x16x32_bf16 v[138:141], v[146:149], v[126:129], v[138:141]
s_waitcnt lgkmcnt(0)
v_mfma_f32_16x16x32_bf16 v[134:137], v[150:153], v[122:125], v[134:137]
v_mfma_f32_16x16x32_bf16 v[142:145], v[150:153], v[126:129], v[142:145]
s_setprio 0
v_xor_b32 v251, 0x10000, v251
v_xor_b32 v252, 0x10000, v252
s_barrier
s_nop 7
v_mov_b32 v170, v130
v_mov_b32 v171, v131
v_mov_b32 v172, v132
v_mov_b32 v173, v133
v_mov_b32 v174, v134
v_mov_b32 v175, v135
v_mov_b32 v176, v136
v_mov_b32 v177, v137
v_mov_b32 v178, v138
v_mov_b32 v179, v139
v_mov_b32 v180, v140
v_mov_b32 v181, v141
v_mov_b32 v182, v142
v_mov_b32 v183, v143
v_mov_b32 v184, v144
v_mov_b32 v185, v145
s_add_u32 s22, s18, 3
s_lshl_b32 s22, s22, 16
buffer_load_dword v248, v207, s[48:51], s22 offen
s_add_u32 s18, s18, 1
kvl_128:
s_waitcnt vmcnt(63) lgkmcnt(0)
s_barrier
ds_read_b128 v[186:189], v204 offset:0
ds_read_b128 v[190:193], v204 offset:1024
ds_read_b128 v[194:197], v204 offset:2048
ds_read_b128 v[198:201], v204 offset:3072
v_xor_b32 v204, 0x4000, v204
s_waitcnt lgkmcnt(0)
v_add_f32 v170, v170, v186
v_add_f32 v171, v171, v187
v_add_f32 v172, v172, v188
v_add_f32 v173, v173, v189
v_add_f32 v174, v174, v190
v_add_f32 v175, v175, v191
v_add_f32 v176, v176, v192
v_add_f32 v177, v177, v193
v_add_f32 v178, v178, v194
v_add_f32 v179, v179, v195
v_add_f32 v180, v180, v196
v_add_f32 v181, v181, v197
v_add_f32 v182, v182, v198
v_add_f32 v183, v183, v199
v_add_f32 v184, v184, v200
v_add_f32 v185, v185, v201
v_cvt_pk_bf16_f32 v240, v170, v171
v_cvt_pk_bf16_f32 v241, v172, v173
v_cvt_pk_bf16_f32 v242, v174, v175
v_cvt_pk_bf16_f32 v243, v176, v177
v_cvt_pk_bf16_f32 v244, v178, v179
v_cvt_pk_bf16_f32 v245, v180, v181
v_cvt_pk_bf16_f32 v246, v182, v183
v_cvt_pk_bf16_f32 v247, v184, v185
s_sub_u32 s22, s18, 1
s_lshl_b32 s22, s22, 14
s_xor_b32 s22, s22, s42
buffer_store_dwordx4 v[240:243], v205, s[4:7], s22 offen sc1
s_add_u32 s22, s22, 1024
buffer_store_dwordx4 v[244:247], v205, s[4:7], s22 offen sc1
s_setprio 2
ds_read_b128 v[146:149], v251 offset:0
ds_read_b128 v[150:153], v251 offset:2048
ds_read_b128 v[154:157], v252 offset:0
ds_read_b128 v[158:161], v252 offset:2048
ds_read_b128 v[162:165], v251 offset:4096
ds_read_b128 v[166:169], v251 offset:6144
s_waitcnt lgkmcnt(5)
v_mfma_f32_16x16x32_bf16 v[130:133], v[146:149], v[2:5], 0
v_mfma_f32_16x16x32_bf16 v[138:141], v[146:149], v[6:9], 0
ds_read_b128 v[146:149], v252 offset:4096
s_waitcnt lgkmcnt(5)
v_mfma_f32_16x16x32_bf16 v[134:137], v[150:153], v[2:5], 0
v_mfma_f32_16x16x32_bf16 v[142:145], v[150:153], v[6:9], 0
ds_read_b128 v[150:153], v252 offset:6144
s_waitcnt lgkmcnt(5)
v_mfma_f32_16x16x32_bf16 v[130:133], v[154:157], v[34:37], v[130:133]
v_mfma_f32_16x16x32_bf16 v[138:141], v[154:157], v[38:41], v[138:141]
ds_read_b128 v[154:157], v251 offset:8192
s_waitcnt lgkmcnt(5)
v_mfma_f32_16x16x32_bf16 v[134:137], v[158:161], v[34:37], v[134:137]
v_mfma_f32_16x16x32_bf16 v[142:145], v[158:161], v[38:41], v[142:145]
ds_read_b128 v[158:161], v251 offset:10240
s_waitcnt lgkmcnt(5)
v_mfma_f32_16x16x32_bf16 v[130:133], v[162:165], v[66:69], v[130:133]
v_mfma_f32_16x16x32_bf16 v[138:141], v[162:165], v[70:73], v[138:141]
ds_read_b128 v[162:165], v252 offset:8192
s_waitcnt lgkmcnt(5)
v_mfma_f32_16x16x32_bf16 v[134:137], v[166:169], v[66:69], v[134:137]
v_mfma_f32_16x16x32_bf16 v[142:145], v[166:169], v[70:73], v[142:145]
ds_read_b128 v[166:169], v252 offset:10240
s_waitcnt lgkmcnt(5)
v_mfma_f32_16x16x32_bf16 v[130:133], v[146:149], v[98:101], v[130:133]
v_mfma_f32_16x16x32_bf16 v[138:141], v[146:149], v[102:105], v[138:141]
ds_read_b128 v[146:149], v251 offset:12288
s_waitcnt lgkmcnt(5)
v_mfma_f32_16x16x32_bf16 v[134:137], v[150:153], v[98:101], v[134:137]
v_mfma_f32_16x16x32_bf16 v[142:145], v[150:153], v[102:105], v[142:145]
ds_read_b128 v[150:153], v251 offset:14336
s_waitcnt lgkmcnt(5)
v_mfma_f32_16x16x32_bf16 v[130:133], v[154:157], v[10:13], v[130:133]
v_mfma_f32_16x16x32_bf16 v[138:141], v[154:157], v[14:17], v[138:141]
ds_read_b128 v[154:157], v252 offset:12288
s_waitcnt lgkmcnt(5)
v_mfma_f32_16x16x32_bf16 v[134:137], v[158:161], v[10:13], v[134:137]
v_mfma_f32_16x16x32_bf16 v[142:145], v[158:161], v[14:17], v[142:145]
ds_read_b128 v[158:161], v252 offset:14336
s_waitcnt lgkmcnt(5)
v_mfma_f32_16x16x32_bf16 v[130:133], v[162:165], v[42:45], v[130:133]
v_mfma_f32_16x16x32_bf16 v[138:141], v[162:165], v[46:49], v[138:141]
ds_read_b128 v[162:165], v251 offset:16384
s_waitcnt lgkmcnt(5)
v_mfma_f32_16x16x32_bf16 v[134:137], v[166:169], v[42:45], v[134:137]
v_mfma_f32_16x16x32_bf16 v[142:145], v[166:169], v[46:49], v[142:145]
ds_read_b128 v[166:169], v251 offset:18432
s_waitcnt lgkmcnt(5)
v_mfma_f32_16x16x32_bf16 v[130:133], v[146:149], v[74:77], v[130:133]
v_mfma_f32_16x16x32_bf16 v[138:141], v[146:149], v[78:81], v[138:141]
ds_read_b128 v[146:149], v252 offset:16384
s_waitcnt lgkmcnt(5)
v_mfma_f32_16x16x32_bf16 v[134:137], v[150:153], v[74:77], v[134:137]
v_mfma_f32_16x16x32_bf16 v[142:145], v[150:153], v[78:81], v[142:145]
ds_read_b128 v[150:153], v252 offset:18432
s_waitcnt lgkmcnt(5)
v_mfma_f32_16x16x32_bf16 v[130:133], v[154:157], v[106:109], v[130:133]
v_mfma_f32_16x16x32_bf16 v[138:141], v[154:157], v[110:113], v[138:141]
ds_read_b128 v[154:157], v251 offset:20480
s_waitcnt lgkmcnt(5)
v_mfma_f32_16x16x32_bf16 v[134:137], v[158:161], v[106:109], v[134:137]
v_mfma_f32_16x16x32_bf16 v[142:145], v[158:161], v[110:113], v[142:145]
ds_read_b128 v[158:161], v251 offset:22528
s_waitcnt lgkmcnt(5)
v_mfma_f32_16x16x32_bf16 v[130:133], v[162:165], v[18:21], v[130:133]
v_mfma_f32_16x16x32_bf16 v[138:141], v[162:165], v[22:25], v[138:141]
ds_read_b128 v[162:165], v252 offset:20480
s_waitcnt lgkmcnt(5)
v_mfma_f32_16x16x32_bf16 v[134:137], v[166:169], v[18:21], v[134:137]
v_mfma_f32_16x16x32_bf16 v[142:145], v[166:169], v[22:25], v[142:145]
ds_read_b128 v[166:169], v252 offset:22528
s_waitcnt lgkmcnt(5)
v_mfma_f32_16x16x32_bf16 v[130:133], v[146:149], v[50:53], v[130:133]
v_mfma_f32_16x16x32_bf16 v[138:141], v[146:149], v[54:57], v[138:141]
ds_read_b128 v[146:149], v251 offset:24576
s_waitcnt lgkmcnt(5)
v_mfma_f32_16x16x32_bf16 v[134:137], v[150:153], v[50:53], v[134:137]
v_mfma_f32_16x16x32_bf16 v[142:145], v[150:153], v[54:57], v[142:145]
ds_read_b128 v[150:153], v251 offset:26624
s_waitcnt lgkmcnt(5)
v_mfma_f32_16x16x32_bf16 v[130:133], v[154:157], v[82:85], v[130:133]
v_mfma_f32_16x16x32_bf16 v[138:141], v[154:157], v[86:89], v[138:141]
ds_read_b128 v[154:157], v252 offset:24576
s_waitcnt lgkmcnt(5)
v_mfma_f32_16x16x32_bf16 v[134:137], v[158:161], v[82:85], v[134:137]
v_mfma_f32_16x16x32_bf16 v[142:145], v[158:161], v[86:89], v[142:145]
ds_read_b128 v[158:161], v252 offset:26624
s_waitcnt lgkmcnt(5)
v_mfma_f32_16x16x32_bf16 v[130:133], v[162:165], v[114:117], v[130:133]
v_mfma_f32_16x16x32_bf16 v[138:141], v[162:165], v[118:121], v[138:141]
ds_read_b128 v[162:165], v251 offset:28672
s_waitcnt lgkmcnt(5)
v_mfma_f32_16x16x32_bf16 v[134:137], v[166:169], v[114:117], v[134:137]
v_mfma_f32_16x16x32_bf16 v[142:145], v[166:169], v[118:121], v[142:145]
ds_read_b128 v[166:169], v251 offset:30720
s_waitcnt lgkmcnt(5)
v_mfma_f32_16x16x32_bf16 v[130:133], v[146:149], v[26:29], v[130:133]
v_mfma_f32_16x16x32_bf16 v[138:141], v[146:149], v[30:33], v[138:141]
ds_read_b128 v[146:149], v252 offset:28672
s_waitcnt lgkmcnt(5)
v_mfma_f32_16x16x32_bf16 v[134:137], v[150:153], v[26:29], v[134:137]
v_mfma_f32_16x16x32_bf16 v[142:145], v[150:153], v[30:33], v[142:145]
ds_read_b128 v[150:153], v252 offset:30720
s_waitcnt lgkmcnt(5)
v_mfma_f32_16x16x32_bf16 v[130:133], v[154:157], v[58:61], v[130:133]
v_mfma_f32_16x16x32_bf16 v[138:141], v[154:157], v[62:65], v[138:141]
s_waitcnt lgkmcnt(4)
v_mfma_f32_16x16x32_bf16 v[134:137], v[158:161], v[58:61], v[134:137]
v_mfma_f32_16x16x32_bf16 v[142:145], v[158:161], v[62:65], v[142:145]
s_waitcnt lgkmcnt(3)
v_mfma_f32_16x16x32_bf16 v[130:133], v[162:165], v[90:93], v[130:133]
v_mfma_f32_16x16x32_bf16 v[138:141], v[162:165], v[94:97], v[138:141]
s_waitcnt lgkmcnt(2)
v_mfma_f32_16x16x32_bf16 v[134:137], v[166:169], v[90:93], v[134:137]
v_mfma_f32_16x16x32_bf16 v[142:145], v[166:169], v[94:97], v[142:145]
s_waitcnt lgkmcnt(1)
v_mfma_f32_16x16x32_bf16 v[130:133], v[146:149], v[122:125], v[130:133]
v_mfma_f32_16x16x32_bf16 v[138:141], v[146:149], v[126:129], v[138:141]
s_waitcnt lgkmcnt(0)
v_mfma_f32_16x16x32_bf16 v[134:137], v[150:153], v[122:125], v[134:137]
v_mfma_f32_16x16x32_bf16 v[142:145], v[150:153], v[126:129], v[142:145]
s_setprio 0
v_xor_b32 v251, 0x10000, v251
v_xor_b32 v252, 0x10000, v252
s_waitcnt vmcnt(0)
s_barrier
s_sub_u32 s22, s18, 0
v_mov_b32 v1, s22
buffer_store_dword v1, v206, s[4:7], s43 offen sc1
s_nop 7
v_mov_b32 v170, v130
v_mov_b32 v171, v131
v_mov_b32 v172, v132
v_mov_b32 v173, v133
v_mov_b32 v174, v134
v_mov_b32 v175, v135
v_mov_b32 v176, v136
v_mov_b32 v177, v137
v_mov_b32 v178, v138
v_mov_b32 v179, v139
v_mov_b32 v180, v140
v_mov_b32 v181, v141
v_mov_b32 v182, v142
v_mov_b32 v183, v143
v_mov_b32 v184, v144
v_mov_b32 v185, v145
s_add_u32 s22, s18, 3
s_lshl_b32 s22, s22, 16
buffer_load_dword v248, v207, s[48:51], s22 offen
s_add_u32 s18, s18, 1
s_cmp_lt_u32 s18, 14
s_cbranch_scc1 kvl_128
kvl_127:
s_waitcnt vmcnt(4) lgkmcnt(0)
s_barrier
ds_read_b128 v[186:189], v204 offset:0
ds_read_b128 v[190:193], v204 offset:1024
ds_read_b128 v[194:197], v204 offset:2048
ds_read_b128 v[198:201], v204 offset:3072
v_xor_b32 v204, 0x4000, v204
s_setprio 2
ds_read_b128 v[146:149], v251 offset:0
ds_read_b128 v[150:153], v251 offset:2048
ds_read_b128 v[154:157], v252 offset:0
ds_read_b128 v[158:161], v252 offset:2048
ds_read_b128 v[162:165], v251 offset:4096
ds_read_b128 v[166:169], v251 offset:6144
s_waitcnt lgkmcnt(5)
v_mfma_f32_16x16x32_bf16 v[130:133], v[146:149], v[2:5], 0
v_mfma_f32_16x16x32_bf16 v[138:141], v[146:149], v[6:9], 0
ds_read_b128 v[146:149], v252 offset:4096
s_waitcnt lgkmcnt(5)
v_mfma_f32_16x16x32_bf16 v[134:137], v[150:153], v[2:5], 0
v_mfma_f32_16x16x32_bf16 v[142:145], v[150:153], v[6:9], 0
ds_read_b128 v[150:153], v252 offset:6144
s_waitcnt lgkmcnt(5)
v_mfma_f32_16x16x32_bf16 v[130:133], v[154:157], v[34:37], v[130:133]
v_mfma_f32_16x16x32_bf16 v[138:141], v[154:157], v[38:41], v[138:141]
ds_read_b128 v[154:157], v251 offset:8192
s_waitcnt lgkmcnt(5)
v_mfma_f32_16x16x32_bf16 v[134:137], v[158:161], v[34:37], v[134:137]
v_mfma_f32_16x16x32_bf16 v[142:145], v[158:161], v[38:41], v[142:145]
ds_read_b128 v[158:161], v251 offset:10240
s_waitcnt lgkmcnt(5)
v_mfma_f32_16x16x32_bf16 v[130:133], v[162:165], v[66:69], v[130:133]
v_mfma_f32_16x16x32_bf16 v[138:141], v[162:165], v[70:73], v[138:141]
ds_read_b128 v[162:165], v252 offset:8192
s_waitcnt lgkmcnt(5)
v_mfma_f32_16x16x32_bf16 v[134:137], v[166:169], v[66:69], v[134:137]
v_mfma_f32_16x16x32_bf16 v[142:145], v[166:169], v[70:73], v[142:145]
ds_read_b128 v[166:169], v252 offset:10240
s_waitcnt lgkmcnt(5)
v_mfma_f32_16x16x32_bf16 v[130:133], v[146:149], v[98:101], v[130:133]
v_mfma_f32_16x16x32_bf16 v[138:141], v[146:149], v[102:105], v[138:141]
ds_read_b128 v[146:149], v251 offset:12288
s_waitcnt lgkmcnt(5)
v_mfma_f32_16x16x32_bf16 v[134:137], v[150:153], v[98:101], v[134:137]
v_mfma_f32_16x16x32_bf16 v[142:145], v[150:153], v[102:105], v[142:145]
ds_read_b128 v[150:153], v251 offset:14336
s_waitcnt lgkmcnt(5)
v_mfma_f32_16x16x32_bf16 v[130:133], v[154:157], v[10:13], v[130:133]
v_mfma_f32_16x16x32_bf16 v[138:141], v[154:157], v[14:17], v[138:141]
ds_read_b128 v[154:157], v252 offset:12288
s_waitcnt lgkmcnt(5)
v_mfma_f32_16x16x32_bf16 v[134:137], v[158:161], v[10:13], v[134:137]
v_mfma_f32_16x16x32_bf16 v[142:145], v[158:161], v[14:17], v[142:145]
ds_read_b128 v[158:161], v252 offset:14336
s_waitcnt lgkmcnt(5)
v_mfma_f32_16x16x32_bf16 v[130:133], v[162:165], v[42:45], v[130:133]
v_mfma_f32_16x16x32_bf16 v[138:141], v[162:165], v[46:49], v[138:141]
ds_read_b128 v[162:165], v251 offset:16384
s_waitcnt lgkmcnt(5)
v_mfma_f32_16x16x32_bf16 v[134:137], v[166:169], v[42:45], v[134:137]
v_mfma_f32_16x16x32_bf16 v[142:145], v[166:169], v[46:49], v[142:145]
ds_read_b128 v[166:169], v251 offset:18432
s_waitcnt lgkmcnt(5)
v_mfma_f32_16x16x32_bf16 v[130:133], v[146:149], v[74:77], v[130:133]
v_mfma_f32_16x16x32_bf16 v[138:141], v[146:149], v[78:81], v[138:141]
ds_read_b128 v[146:149], v252 offset:16384
s_waitcnt lgkmcnt(5)
v_mfma_f32_16x16x32_bf16 v[134:137], v[150:153], v[74:77], v[134:137]
v_mfma_f32_16x16x32_bf16 v[142:145], v[150:153], v[78:81], v[142:145]
ds_read_b128 v[150:153], v252 offset:18432
s_waitcnt lgkmcnt(5)
v_mfma_f32_16x16x32_bf16 v[130:133], v[154:157], v[106:109], v[130:133]
v_mfma_f32_16x16x32_bf16 v[138:141], v[154:157], v[110:113], v[138:141]
ds_read_b128 v[154:157], v251 offset:20480
s_waitcnt lgkmcnt(5)
v_mfma_f32_16x16x32_bf16 v[134:137], v[158:161], v[106:109], v[134:137]
v_mfma_f32_16x16x32_bf16 v[142:145], v[158:161], v[110:113], v[142:145]
ds_read_b128 v[158:161], v251 offset:22528
s_waitcnt lgkmcnt(5)
v_mfma_f32_16x16x32_bf16 v[130:133], v[162:165], v[18:21], v[130:133]
v_mfma_f32_16x16x32_bf16 v[138:141], v[162:165], v[22:25], v[138:141]
ds_read_b128 v[162:165], v252 offset:20480
s_waitcnt lgkmcnt(5)
v_mfma_f32_16x16x32_bf16 v[134:137], v[166:169], v[18:21], v[134:137]
v_mfma_f32_16x16x32_bf16 v[142:145], v[166:169], v[22:25], v[142:145]
ds_read_b128 v[166:169], v252 offset:22528
s_waitcnt lgkmcnt(5)
v_mfma_f32_16x16x32_bf16 v[130:133], v[146:149], v[50:53], v[130:133]
v_mfma_f32_16x16x32_bf16 v[138:141], v[146:149], v[54:57], v[138:141]
ds_read_b128 v[146:149], v251 offset:24576
s_waitcnt lgkmcnt(5)
v_mfma_f32_16x16x32_bf16 v[134:137], v[150:153], v[50:53], v[134:137]
v_mfma_f32_16x16x32_bf16 v[142:145], v[150:153], v[54:57], v[142:145]
ds_read_b128 v[150:153], v251 offset:26624
s_waitcnt lgkmcnt(5)
v_mfma_f32_16x16x32_bf16 v[130:133], v[154:157], v[82:85], v[130:133]
v_mfma_f32_16x16x32_bf16 v[138:141], v[154:157], v[86:89], v[138:141]
ds_read_b128 v[154:157], v252 offset:24576
s_waitcnt lgkmcnt(5)
v_mfma_f32_16x16x32_bf16 v[134:137], v[158:161], v[82:85], v[134:137]
v_mfma_f32_16x16x32_bf16 v[142:145], v[158:161], v[86:89], v[142:145]
ds_read_b128 v[158:161], v252 offset:26624
s_waitcnt lgkmcnt(5)
v_mfma_f32_16x16x32_bf16 v[130:133], v[162:165], v[114:117], v[130:133]
v_mfma_f32_16x16x32_bf16 v[138:141], v[162:165], v[118:121], v[138:141]
ds_read_b128 v[162:165], v251 offset:28672
s_waitcnt lgkmcnt(5)
v_mfma_f32_16x16x32_bf16 v[134:137], v[166:169], v[114:117], v[134:137]
v_mfma_f32_16x16x32_bf16 v[142:145], v[166:169], v[118:121], v[142:145]
ds_read_b128 v[166:169], v251 offset:30720
s_waitcnt lgkmcnt(5)
v_mfma_f32_16x16x32_bf16 v[130:133], v[146:149], v[26:29], v[130:133]
v_mfma_f32_16x16x32_bf16 v[138:141], v[146:149], v[30:33], v[138:141]
ds_read_b128 v[146:149], v252 offset:28672
s_waitcnt lgkmcnt(5)
v_mfma_f32_16x16x32_bf16 v[134:137], v[150:153], v[26:29], v[134:137]
v_mfma_f32_16x16x32_bf16 v[142:145], v[150:153], v[30:33], v[142:145]
ds_read_b128 v[150:153], v252 offset:30720
s_waitcnt lgkmcnt(5)
v_mfma_f32_16x16x32_bf16 v[130:133], v[154:157], v[58:61], v[130:133]
v_mfma_f32_16x16x32_bf16 v[138:141], v[154:157], v[62:65], v[138:141]
s_waitcnt lgkmcnt(4)
v_mfma_f32_16x16x32_bf16 v[134:137], v[158:161], v[58:61], v[134:137]
v_mfma_f32_16x16x32_bf16 v[142:145], v[158:161], v[62:65], v[142:145]
s_waitcnt lgkmcnt(3)
v_mfma_f32_16x16x32_bf16 v[130:133], v[162:165], v[90:93], v[130:133]
v_mfma_f32_16x16x32_bf16 v[138:141], v[162:165], v[94:97], v[138:141]
s_waitcnt lgkmcnt(2)
v_mfma_f32_16x16x32_bf16 v[134:137], v[166:169], v[90:93], v[134:137]
v_mfma_f32_16x16x32_bf16 v[142:145], v[166:169], v[94:97], v[142:145]
s_waitcnt lgkmcnt(1)
v_mfma_f32_16x16x32_bf16 v[130:133], v[146:149], v[122:125], v[130:133]
v_mfma_f32_16x16x32_bf16 v[138:141], v[146:149], v[126:129], v[138:141]
s_waitcnt lgkmcnt(0)
v_mfma_f32_16x16x32_bf16 v[134:137], v[150:153], v[122:125], v[134:137]
v_mfma_f32_16x16x32_bf16 v[142:145], v[150:153], v[126:129], v[142:145]
s_setprio 0
v_xor_b32 v251, 0x10000, v251
v_xor_b32 v252, 0x10000, v252
v_add_f32 v170, v170, v186
v_add_f32 v171, v171, v187
v_add_f32 v172, v172, v188
v_add_f32 v173, v173, v189
v_add_f32 v174, v174, v190
v_add_f32 v175, v175, v191
v_add_f32 v176, v176, v192
v_add_f32 v177, v177, v193
v_add_f32 v178, v178, v194
v_add_f32 v179, v179, v195
v_add_f32 v180, v180, v196
v_add_f32 v181, v181, v197
v_add_f32 v182, v182, v198
v_add_f32 v183, v183, v199
v_add_f32 v184, v184, v200
v_add_f32 v185, v185, v201
v_cvt_pk_bf16_f32 v240, v170, v171
v_cvt_pk_bf16_f32 v241, v172, v173
v_cvt_pk_bf16_f32 v242, v174, v175
v_cvt_pk_bf16_f32 v243, v176, v177
v_cvt_pk_bf16_f32 v244, v178, v179
v_cvt_pk_bf16_f32 v245, v180, v181
v_cvt_pk_bf16_f32 v246, v182, v183
v_cvt_pk_bf16_f32 v247, v184, v185
s_sub_u32 s22, s18, 1
s_lshl_b32 s22, s22, 14
s_xor_b32 s22, s22, s42
buffer_store_dwordx4 v[240:243], v205, s[4:7], s22 offen sc1
s_add_u32 s22, s22, 1024
buffer_store_dwordx4 v[244:247], v205, s[4:7], s22 offen sc1
s_sub_u32 s22, s18, 2
s_max_u32 s22, s22, 13
v_mov_b32 v1, s22
buffer_store_dword v1, v206, s[4:7], s43 offen sc1
v_mov_b32 v170, v130
v_mov_b32 v171, v131
v_mov_b32 v172, v132
v_mov_b32 v173, v133
v_mov_b32 v174, v134
v_mov_b32 v175, v135
v_mov_b32 v176, v136
v_mov_b32 v177, v137
v_mov_b32 v178, v138
v_mov_b32 v179, v139
v_mov_b32 v180, v140
v_mov_b32 v181, v141
v_mov_b32 v182, v142
v_mov_b32 v183, v143
v_mov_b32 v184, v144
v_mov_b32 v185, v145
s_add_u32 s22, s18, 3
s_lshl_b32 s22, s22, 16
buffer_load_dword v248, v207, s[48:51], s22 offen
s_and_b32 s22, s18, 35
s_xor_b32 s22, s22, s12
s_cmp_eq_u32 s22, 32
s_cbranch_scc1 kq_129
kq_130:
s_add_u32 s18, s18, 1
s_cmp_lt_u32 s18, 64
s_cbranch_scc1 kvl_127
s_barrier
ds_read_b128 v[186:189], v204 offset:0
ds_read_b128 v[190:193], v204 offset:1024
ds_read_b128 v[194:197], v204 offset:2048
ds_read_b128 v[198:201], v204 offset:3072
v_xor_b32 v204, 0x4000, v204
s_waitcnt lgkmcnt(0)
v_add_f32 v170, v170, v186
v_add_f32 v171, v171, v187
v_add_f32 v172, v172, v188
v_add_f32 v173, v173, v189
v_add_f32 v174, v174, v190
v_add_f32 v175, v175, v191
v_add_f32 v176, v176, v192
v_add_f32 v177, v177, v193
v_add_f32 v178, v178, v194
v_add_f32 v179, v179, v195
v_add_f32 v180, v180, v196
v_add_f32 v181, v181, v197
v_add_f32 v182, v182, v198
v_add_f32 v183, v183, v199
v_add_f32 v184, v184, v200
v_add_f32 v185, v185, v201
v_cvt_pk_bf16_f32 v240, v170, v171
v_cvt_pk_bf16_f32 v241, v172, v173
v_cvt_pk_bf16_f32 v242, v174, v175
v_cvt_pk_bf16_f32 v243, v176, v177
v_cvt_pk_bf16_f32 v244, v178, v179
v_cvt_pk_bf16_f32 v245, v180, v181
v_cvt_pk_bf16_f32 v246, v182, v183
v_cvt_pk_bf16_f32 v247, v184, v185
s_sub_u32 s22, s18, 1
s_lshl_b32 s22, s22, 14
s_xor_b32 s22, s22, s42
buffer_store_dwordx4 v[240:243], v205, s[4:7], s22 offen sc1
s_add_u32 s22, s22, 1024
buffer_store_dwordx4 v[244:247], v205, s[4:7], s22 offen sc1
s_waitcnt vmcnt(0)
s_barrier
s_sub_u32 s22, s18, 0
v_mov_b32 v1, s22
buffer_store_dword v1, v206, s[4:7], s43 offen sc1
s_branch L_conv
kv11_107:
ds_write_b128 v204, v[130:133] offset:0
ds_write_b128 v204, v[134:137] offset:1024
ds_write_b128 v204, v[138:141] offset:2048
ds_write_b128 v204, v[142:145] offset:3072
v_xor_b32 v204, 0x4000, v204
s_waitcnt lgkmcnt(0)
s_barrier
s_mov_b32 s44, 1
s_xor_b32 s41, s41, 0x10000
s_lshl_b32 s20, s44, 16
s_add_u32 s21, s52, s41
s_xor_b32 s21, s21, 0x8000
s_add_u32 m0, s21, 0
s_nop 0
buffer_load_dwordx4 v253, s[48:51], s20 offen offset:0 lds
s_add_u32 m0, s21, 3968
s_nop 0
buffer_load_dwordx4 v253, s[48:51], s20 offen offset:128 lds
s_add_u32 m0, s21, 7936
s_nop 0
buffer_load_dwordx4 v253, s[48:51], s20 offen offset:256 lds
s_add_u32 m0, s21, 11904
s_nop 0
buffer_load_dwordx4 v253, s[48:51], s20 offen offset:384 lds
s_add_u32 m0, s21, 15872
s_nop 0
buffer_load_dwordx4 v253, s[48:51], s20 offen offset:512 lds
s_add_u32 m0, s21, 19840
s_nop 0
buffer_load_dwordx4 v253, s[48:51], s20 offen offset:640 lds
s_add_u32 m0, s21, 23808
s_nop 0
buffer_load_dwordx4 v253, s[48:51], s20 offen offset:768 lds
s_add_u32 m0, s21, 27776
s_nop 0
buffer_load_dwordx4 v253, s[48:51], s20 offen offset:896 lds
s_lshl_b32 s20, s44, 16
s_add_u32 s21, s52, s41
s_add_u32 m0, s21, 0
s_nop 0
buffer_load_dwordx4 v250, s[48:51], s20 offen offset:0 lds
s_add_u32 m0, s21, 3968
s_nop 0
buffer_load_dwordx4 v250, s[48:51], s20 offen offset:128 lds
s_add_u32 m0, s21, 7936
s_nop 0
buffer_load_dwordx4 v250, s[48:51], s20 offen offset:256 lds
s_add_u32 m0, s21, 11904
s_nop 0
buffer_load_dwordx4 v250, s[48:51], s20 offen offset:384 lds
s_add_u32 m0, s21, 15872
s_nop 0
buffer_load_dwordx4 v250, s[48:51], s20 offen offset:512 lds
s_add_u32 m0, s21, 19840
s_nop 0
buffer_load_dwordx4 v250, s[48:51], s20 offen offset:640 lds
s_add_u32 m0, s21, 23808
s_nop 0
buffer_load_dwordx4 v250, s[48:51], s20 offen offset:768 lds
s_add_u32 m0, s21, 27776
s_nop 0
buffer_load_dwordx4 v250, s[48:51], s20 offen offset:896 lds
s_mov_b32 s18, 1
s_barrier
kvl_132:
s_waitcnt vmcnt(0) lgkmcnt(0)
s_barrier
s_add_u32 s44, s18, 1
s_min_u32 s44, s44, 63
s_xor_b32 s41, s41, 0x10000
s_lshl_b32 s20, s44, 16
s_add_u32 s21, s52, s41
s_xor_b32 s21, s21, 0x8000
s_add_u32 m0, s21, 0
s_nop 0
buffer_load_dwordx4 v253, s[48:51], s20 offen offset:0 lds
s_add_u32 m0, s21, 3968
s_nop 0
buffer_load_dwordx4 v253, s[48:51], s20 offen offset:128 lds
s_add_u32 m0, s21, 7936
s_nop 0
buffer_load_dwordx4 v253, s[48:51], s20 offen offset:256 lds
s_add_u32 m0, s21, 11904
s_nop 0
buffer_load_dwordx4 v253, s[48:51], s20 offen offset:384 lds
s_add_u32 m0, s21, 15872
s_nop 0
buffer_load_dwordx4 v253, s[48:51], s20 offen offset:512 lds
s_add_u32 m0, s21, 19840
s_nop 0
buffer_load_dwordx4 v253, s[48:51], s20 offen offset:640 lds
s_add_u32 m0, s21, 23808
s_nop 0
buffer_load_dwordx4 v253, s[48:51], s20 offen offset:768 lds
s_add_u32 m0, s21, 27776
s_nop 0
buffer_load_dwordx4 v253, s[48:51], s20 offen offset:896 lds
s_lshl_b32 s20, s44, 16
s_add_u32 s21, s52, s41
s_add_u32 m0, s21, 0
s_nop 0
buffer_load_dwordx4 v250, s[48:51], s20 offen offset:0 lds
s_add_u32 m0, s21, 3968
s_nop 0
buffer_load_dwordx4 v250, s[48:51], s20 offen offset:128 lds
s_add_u32 m0, s21, 7936
s_nop 0
buffer_load_dwordx4 v250, s[48:51], s20 offen offset:256 lds
s_add_u32 m0, s21, 11904
s_nop 0
buffer_load_dwordx4 v250, s[48:51], s20 offen offset:384 lds
s_add_u32 m0, s21, 15872
s_nop 0
buffer_load_dwordx4 v250, s[48:51], s20 offen offset:512 lds
s_add_u32 m0, s21, 19840
s_nop 0
buffer_load_dwordx4 v250, s[48:51], s20 offen offset:640 lds
s_add_u32 m0, s21, 23808
s_nop 0
buffer_load_dwordx4 v250, s[48:51], s20 offen offset:768 lds
s_add_u32 m0, s21, 27776
s_nop 0
buffer_load_dwordx4 v250, s[48:51], s20 offen offset:896 lds
s_barrier
s_setprio 1
ds_read_b128 v[146:149], v251 offset:0
ds_read_b128 v[150:153], v251 offset:2048
ds_read_b128 v[154:157], v252 offset:0
ds_read_b128 v[158:161], v252 offset:2048
ds_read_b128 v[162:165], v251 offset:4096
ds_read_b128 v[166:169], v251 offset:6144
s_waitcnt lgkmcnt(5)
v_mfma_f32_16x16x32_bf16 v[130:133], v[146:149], v[2:5], 0
v_mfma_f32_16x16x32_bf16 v[138:141], v[146:149], v[6:9], 0
ds_read_b128 v[146:149], v252 offset:4096
s_waitcnt lgkmcnt(5)
v_mfma_f32_16x16x32_bf16 v[134:137], v[150:153], v[2:5], 0
v_mfma_f32_16x16x32_bf16 v[142:145], v[150:153], v[6:9], 0
ds_read_b128 v[150:153], v252 offset:6144
s_waitcnt lgkmcnt(5)
v_mfma_f32_16x16x32_bf16 v[130:133], v[154:157], v[34:37], v[130:133]
v_mfma_f32_16x16x32_bf16 v[138:141], v[154:157], v[38:41], v[138:141]
ds_read_b128 v[154:157], v251 offset:8192
s_waitcnt lgkmcnt(5)
v_mfma_f32_16x16x32_bf16 v[134:137], v[158:161], v[34:37], v[134:137]
v_mfma_f32_16x16x32_bf16 v[142:145], v[158:161], v[38:41], v[142:145]
ds_read_b128 v[158:161], v251 offset:10240
s_waitcnt lgkmcnt(5)
v_mfma_f32_16x16x32_bf16 v[130:133], v[162:165], v[66:69], v[130:133]
v_mfma_f32_16x16x32_bf16 v[138:141], v[162:165], v[70:73], v[138:141]
ds_read_b128 v[162:165], v252 offset:8192
s_waitcnt lgkmcnt(5)
v_mfma_f32_16x16x32_bf16 v[134:137], v[166:169], v[66:69], v[134:137]
v_mfma_f32_16x16x32_bf16 v[142:145], v[166:169], v[70:73], v[142:145]
ds_read_b128 v[166:169], v252 offset:10240
s_waitcnt lgkmcnt(5)
v_mfma_f32_16x16x32_bf16 v[130:133], v[146:149], v[98:101], v[130:133]
v_mfma_f32_16x16x32_bf16 v[138:141], v[146:149], v[102:105], v[138:141]
ds_read_b128 v[146:149], v251 offset:12288
s_waitcnt lgkmcnt(5)
v_mfma_f32_16x16x32_bf16 v[134:137], v[150:153], v[98:101], v[134:137]
v_mfma_f32_16x16x32_bf16 v[142:145], v[150:153], v[102:105], v[142:145]
ds_read_b128 v[150:153], v251 offset:14336
s_waitcnt lgkmcnt(5)
v_mfma_f32_16x16x32_bf16 v[130:133], v[154:157], v[10:13], v[130:133]
v_mfma_f32_16x16x32_bf16 v[138:141], v[154:157], v[14:17], v[138:141]
ds_read_b128 v[154:157], v252 offset:12288
s_waitcnt lgkmcnt(5)
v_mfma_f32_16x16x32_bf16 v[134:137], v[158:161], v[10:13], v[134:137]
v_mfma_f32_16x16x32_bf16 v[142:145], v[158:161], v[14:17], v[142:145]
ds_read_b128 v[158:161], v252 offset:14336
s_waitcnt lgkmcnt(5)
v_mfma_f32_16x16x32_bf16 v[130:133], v[162:165], v[42:45], v[130:133]
v_mfma_f32_16x16x32_bf16 v[138:141], v[162:165], v[46:49], v[138:141]
ds_read_b128 v[162:165], v251 offset:16384
s_waitcnt lgkmcnt(5)
v_mfma_f32_16x16x32_bf16 v[134:137], v[166:169], v[42:45], v[134:137]
v_mfma_f32_16x16x32_bf16 v[142:145], v[166:169], v[46:49], v[142:145]
ds_read_b128 v[166:169], v251 offset:18432
s_waitcnt lgkmcnt(5)
v_mfma_f32_16x16x32_bf16 v[130:133], v[146:149], v[74:77], v[130:133]
v_mfma_f32_16x16x32_bf16 v[138:141], v[146:149], v[78:81], v[138:141]
ds_read_b128 v[146:149], v252 offset:16384
s_waitcnt lgkmcnt(5)
v_mfma_f32_16x16x32_bf16 v[134:137], v[150:153], v[74:77], v[134:137]
v_mfma_f32_16x16x32_bf16 v[142:145], v[150:153], v[78:81], v[142:145]
ds_read_b128 v[150:153], v252 offset:18432
s_waitcnt lgkmcnt(5)
v_mfma_f32_16x16x32_bf16 v[130:133], v[154:157], v[106:109], v[130:133]
v_mfma_f32_16x16x32_bf16 v[138:141], v[154:157], v[110:113], v[138:141]
ds_read_b128 v[154:157], v251 offset:20480
s_waitcnt lgkmcnt(5)
v_mfma_f32_16x16x32_bf16 v[134:137], v[158:161], v[106:109], v[134:137]
v_mfma_f32_16x16x32_bf16 v[142:145], v[158:161], v[110:113], v[142:145]
ds_read_b128 v[158:161], v251 offset:22528
s_waitcnt lgkmcnt(5)
v_mfma_f32_16x16x32_bf16 v[130:133], v[162:165], v[18:21], v[130:133]
v_mfma_f32_16x16x32_bf16 v[138:141], v[162:165], v[22:25], v[138:141]
ds_read_b128 v[162:165], v252 offset:20480
s_waitcnt lgkmcnt(5)
v_mfma_f32_16x16x32_bf16 v[134:137], v[166:169], v[18:21], v[134:137]
v_mfma_f32_16x16x32_bf16 v[142:145], v[166:169], v[22:25], v[142:145]
ds_read_b128 v[166:169], v252 offset:22528
s_waitcnt lgkmcnt(5)
v_mfma_f32_16x16x32_bf16 v[130:133], v[146:149], v[50:53], v[130:133]
v_mfma_f32_16x16x32_bf16 v[138:141], v[146:149], v[54:57], v[138:141]
ds_read_b128 v[146:149], v251 offset:24576
s_waitcnt lgkmcnt(5)
v_mfma_f32_16x16x32_bf16 v[134:137], v[150:153], v[50:53], v[134:137]
v_mfma_f32_16x16x32_bf16 v[142:145], v[150:153], v[54:57], v[142:145]
ds_read_b128 v[150:153], v251 offset:26624
s_waitcnt lgkmcnt(5)
v_mfma_f32_16x16x32_bf16 v[130:133], v[154:157], v[82:85], v[130:133]
v_mfma_f32_16x16x32_bf16 v[138:141], v[154:157], v[86:89], v[138:141]
ds_read_b128 v[154:157], v252 offset:24576
s_waitcnt lgkmcnt(5)
v_mfma_f32_16x16x32_bf16 v[134:137], v[158:161], v[82:85], v[134:137]
v_mfma_f32_16x16x32_bf16 v[142:145], v[158:161], v[86:89], v[142:145]
ds_read_b128 v[158:161], v252 offset:26624
s_waitcnt lgkmcnt(5)
v_mfma_f32_16x16x32_bf16 v[130:133], v[162:165], v[114:117], v[130:133]
v_mfma_f32_16x16x32_bf16 v[138:141], v[162:165], v[118:121], v[138:141]
ds_read_b128 v[162:165], v251 offset:28672
s_waitcnt lgkmcnt(5)
v_mfma_f32_16x16x32_bf16 v[134:137], v[166:169], v[114:117], v[134:137]
v_mfma_f32_16x16x32_bf16 v[142:145], v[166:169], v[118:121], v[142:145]
ds_read_b128 v[166:169], v251 offset:30720
s_waitcnt lgkmcnt(5)
v_mfma_f32_16x16x32_bf16 v[130:133], v[146:149], v[26:29], v[130:133]
v_mfma_f32_16x16x32_bf16 v[138:141], v[146:149], v[30:33], v[138:141]
ds_read_b128 v[146:149], v252 offset:28672
s_waitcnt lgkmcnt(5)
v_mfma_f32_16x16x32_bf16 v[134:137], v[150:153], v[26:29], v[134:137]
v_mfma_f32_16x16x32_bf16 v[142:145], v[150:153], v[30:33], v[142:145]
ds_read_b128 v[150:153], v252 offset:30720
s_waitcnt lgkmcnt(5)
v_mfma_f32_16x16x32_bf16 v[130:133], v[154:157], v[58:61], v[130:133]
v_mfma_f32_16x16x32_bf16 v[138:141], v[154:157], v[62:65], v[138:141]
s_waitcnt lgkmcnt(4)
v_mfma_f32_16x16x32_bf16 v[134:137], v[158:161], v[58:61], v[134:137]
v_mfma_f32_16x16x32_bf16 v[142:145], v[158:161], v[62:65], v[142:145]
s_waitcnt lgkmcnt(3)
v_mfma_f32_16x16x32_bf16 v[130:133], v[162:165], v[90:93], v[130:133]
v_mfma_f32_16x16x32_bf16 v[138:141], v[162:165], v[94:97], v[138:141]
s_waitcnt lgkmcnt(2)
v_mfma_f32_16x16x32_bf16 v[134:137], v[166:169], v[90:93], v[134:137]
v_mfma_f32_16x16x32_bf16 v[142:145], v[166:169], v[94:97], v[142:145]
s_waitcnt lgkmcnt(1)
v_mfma_f32_16x16x32_bf16 v[130:133], v[146:149], v[122:125], v[130:133]
v_mfma_f32_16x16x32_bf16 v[138:141], v[146:149], v[126:129], v[138:141]
s_waitcnt lgkmcnt(0)
v_mfma_f32_16x16x32_bf16 v[134:137], v[150:153], v[122:125], v[134:137]
v_mfma_f32_16x16x32_bf16 v[142:145], v[150:153], v[126:129], v[142:145]
s_setprio 0
v_xor_b32 v251, 0x10000, v251
v_xor_b32 v252, 0x10000, v252
s_nop 7
ds_write_b128 v204, v[130:133] offset:0
ds_write_b128 v204, v[134:137] offset:1024
ds_write_b128 v204, v[138:141] offset:2048
ds_write_b128 v204, v[142:145] offset:3072
v_xor_b32 v204, 0x4000, v204
s_add_u32 s18, s18, 1
s_cmp_lt_u32 s18, 14
s_cbranch_scc1 kvl_132
kvl_131:
s_waitcnt vmcnt(0) lgkmcnt(0)
s_barrier
s_add_u32 s44, s18, 1
s_min_u32 s44, s44, 63
s_xor_b32 s41, s41, 0x10000
s_lshl_b32 s20, s44, 16
s_add_u32 s21, s52, s41
s_xor_b32 s21, s21, 0x8000
s_add_u32 m0, s21, 0
s_nop 0
buffer_load_dwordx4 v253, s[48:51], s20 offen offset:0 lds
s_add_u32 m0, s21, 3968
s_nop 0
buffer_load_dwordx4 v253, s[48:51], s20 offen offset:128 lds
s_add_u32 m0, s21, 7936
s_nop 0
buffer_load_dwordx4 v253, s[48:51], s20 offen offset:256 lds
s_add_u32 m0, s21, 11904
s_nop 0
buffer_load_dwordx4 v253, s[48:51], s20 offen offset:384 lds
s_add_u32 m0, s21, 15872
s_nop 0
buffer_load_dwordx4 v253, s[48:51], s20 offen offset:512 lds
s_add_u32 m0, s21, 19840
s_nop 0
buffer_load_dwordx4 v253, s[48:51], s20 offen offset:640 lds
s_add_u32 m0, s21, 23808
s_nop 0
buffer_load_dwordx4 v253, s[48:51], s20 offen offset:768 lds
s_add_u32 m0, s21, 27776
s_nop 0
buffer_load_dwordx4 v253, s[48:51], s20 offen offset:896 lds
s_lshl_b32 s20, s44, 16
s_add_u32 s21, s52, s41
s_add_u32 m0, s21, 0
s_nop 0
buffer_load_dwordx4 v250, s[48:51], s20 offen offset:0 lds
s_add_u32 m0, s21, 3968
s_nop 0
buffer_load_dwordx4 v250, s[48:51], s20 offen offset:128 lds
s_add_u32 m0, s21, 7936
s_nop 0
buffer_load_dwordx4 v250, s[48:51], s20 offen offset:256 lds
s_add_u32 m0, s21, 11904
s_nop 0
buffer_load_dwordx4 v250, s[48:51], s20 offen offset:384 lds
s_add_u32 m0, s21, 15872
s_nop 0
buffer_load_dwordx4 v250, s[48:51], s20 offen offset:512 lds
s_add_u32 m0, s21, 19840
s_nop 0
buffer_load_dwordx4 v250, s[48:51], s20 offen offset:640 lds
s_add_u32 m0, s21, 23808
s_nop 0
buffer_load_dwordx4 v250, s[48:51], s20 offen offset:768 lds
s_add_u32 m0, s21, 27776
s_nop 0
buffer_load_dwordx4 v250, s[48:51], s20 offen offset:896 lds
s_and_b32 s22, s18, 35
s_xor_b32 s22, s22, s12
s_cmp_eq_u32 s22, 32
s_cbranch_scc1 kq_133
kq_134:
s_setprio 1
ds_read_b128 v[146:149], v251 offset:0
ds_read_b128 v[150:153], v251 offset:2048
ds_read_b128 v[154:157], v252 offset:0
ds_read_b128 v[158:161], v252 offset:2048
ds_read_b128 v[162:165], v251 offset:4096
ds_read_b128 v[166:169], v251 offset:6144
s_waitcnt lgkmcnt(5)
v_mfma_f32_16x16x32_bf16 v[130:133], v[146:149], v[2:5], 0
v_mfma_f32_16x16x32_bf16 v[138:141], v[146:149], v[6:9], 0
ds_read_b128 v[146:149], v252 offset:4096
s_waitcnt lgkmcnt(5)
v_mfma_f32_16x16x32_bf16 v[134:137], v[150:153], v[2:5], 0
v_mfma_f32_16x16x32_bf16 v[142:145], v[150:153], v[6:9], 0
ds_read_b128 v[150:153], v252 offset:6144
s_waitcnt lgkmcnt(5)
v_mfma_f32_16x16x32_bf16 v[130:133], v[154:157], v[34:37], v[130:133]
v_mfma_f32_16x16x32_bf16 v[138:141], v[154:157], v[38:41], v[138:141]
ds_read_b128 v[154:157], v251 offset:8192
s_waitcnt lgkmcnt(5)
v_mfma_f32_16x16x32_bf16 v[134:137], v[158:161], v[34:37], v[134:137]
v_mfma_f32_16x16x32_bf16 v[142:145], v[158:161], v[38:41], v[142:145]
ds_read_b128 v[158:161], v251 offset:10240
s_waitcnt lgkmcnt(5)
v_mfma_f32_16x16x32_bf16 v[130:133], v[162:165], v[66:69], v[130:133]
v_mfma_f32_16x16x32_bf16 v[138:141], v[162:165], v[70:73], v[138:141]
ds_read_b128 v[162:165], v252 offset:8192
s_waitcnt lgkmcnt(5)
v_mfma_f32_16x16x32_bf16 v[134:137], v[166:169], v[66:69], v[134:137]
v_mfma_f32_16x16x32_bf16 v[142:145], v[166:169], v[70:73], v[142:145]
ds_read_b128 v[166:169], v252 offset:10240
s_waitcnt lgkmcnt(5)
v_mfma_f32_16x16x32_bf16 v[130:133], v[146:149], v[98:101], v[130:133]
v_mfma_f32_16x16x32_bf16 v[138:141], v[146:149], v[102:105], v[138:141]
ds_read_b128 v[146:149], v251 offset:12288
s_waitcnt lgkmcnt(5)
v_mfma_f32_16x16x32_bf16 v[134:137], v[150:153], v[98:101], v[134:137]
v_mfma_f32_16x16x32_bf16 v[142:145], v[150:153], v[102:105], v[142:145]
ds_read_b128 v[150:153], v251 offset:14336
s_waitcnt lgkmcnt(5)
v_mfma_f32_16x16x32_bf16 v[130:133], v[154:157], v[10:13], v[130:133]
v_mfma_f32_16x16x32_bf16 v[138:141], v[154:157], v[14:17], v[138:141]
ds_read_b128 v[154:157], v252 offset:12288
s_waitcnt lgkmcnt(5)
v_mfma_f32_16x16x32_bf16 v[134:137], v[158:161], v[10:13], v[134:137]
v_mfma_f32_16x16x32_bf16 v[142:145], v[158:161], v[14:17], v[142:145]
ds_read_b128 v[158:161], v252 offset:14336
s_waitcnt lgkmcnt(5)
v_mfma_f32_16x16x32_bf16 v[130:133], v[162:165], v[42:45], v[130:133]
v_mfma_f32_16x16x32_bf16 v[138:141], v[162:165], v[46:49], v[138:141]
ds_read_b128 v[162:165], v251 offset:16384
s_waitcnt lgkmcnt(5)
v_mfma_f32_16x16x32_bf16 v[134:137], v[166:169], v[42:45], v[134:137]
v_mfma_f32_16x16x32_bf16 v[142:145], v[166:169], v[46:49], v[142:145]
ds_read_b128 v[166:169], v251 offset:18432
s_waitcnt lgkmcnt(5)
v_mfma_f32_16x16x32_bf16 v[130:133], v[146:149], v[74:77], v[130:133]
v_mfma_f32_16x16x32_bf16 v[138:141], v[146:149], v[78:81], v[138:141]
ds_read_b128 v[146:149], v252 offset:16384
s_waitcnt lgkmcnt(5)
v_mfma_f32_16x16x32_bf16 v[134:137], v[150:153], v[74:77], v[134:137]
v_mfma_f32_16x16x32_bf16 v[142:145], v[150:153], v[78:81], v[142:145]
ds_read_b128 v[150:153], v252 offset:18432
s_waitcnt lgkmcnt(5)
v_mfma_f32_16x16x32_bf16 v[130:133], v[154:157], v[106:109], v[130:133]
v_mfma_f32_16x16x32_bf16 v[138:141], v[154:157], v[110:113], v[138:141]
ds_read_b128 v[154:157], v251 offset:20480
s_waitcnt lgkmcnt(5)
v_mfma_f32_16x16x32_bf16 v[134:137], v[158:161], v[106:109], v[134:137]
v_mfma_f32_16x16x32_bf16 v[142:145], v[158:161], v[110:113], v[142:145]
ds_read_b128 v[158:161], v251 offset:22528
s_waitcnt lgkmcnt(5)
v_mfma_f32_16x16x32_bf16 v[130:133], v[162:165], v[18:21], v[130:133]
v_mfma_f32_16x16x32_bf16 v[138:141], v[162:165], v[22:25], v[138:141]
ds_read_b128 v[162:165], v252 offset:20480
s_waitcnt lgkmcnt(5)
v_mfma_f32_16x16x32_bf16 v[134:137], v[166:169], v[18:21], v[134:137]
v_mfma_f32_16x16x32_bf16 v[142:145], v[166:169], v[22:25], v[142:145]
ds_read_b128 v[166:169], v252 offset:22528
s_waitcnt lgkmcnt(5)
v_mfma_f32_16x16x32_bf16 v[130:133], v[146:149], v[50:53], v[130:133]
v_mfma_f32_16x16x32_bf16 v[138:141], v[146:149], v[54:57], v[138:141]
ds_read_b128 v[146:149], v251 offset:24576
s_waitcnt lgkmcnt(5)
v_mfma_f32_16x16x32_bf16 v[134:137], v[150:153], v[50:53], v[134:137]
v_mfma_f32_16x16x32_bf16 v[142:145], v[150:153], v[54:57], v[142:145]
ds_read_b128 v[150:153], v251 offset:26624
s_waitcnt lgkmcnt(5)
v_mfma_f32_16x16x32_bf16 v[130:133], v[154:157], v[82:85], v[130:133]
v_mfma_f32_16x16x32_bf16 v[138:141], v[154:157], v[86:89], v[138:141]
ds_read_b128 v[154:157], v252 offset:24576
s_waitcnt lgkmcnt(5)
v_mfma_f32_16x16x32_bf16 v[134:137], v[158:161], v[82:85], v[134:137]
v_mfma_f32_16x16x32_bf16 v[142:145], v[158:161], v[86:89], v[142:145]
ds_read_b128 v[158:161], v252 offset:26624
s_waitcnt lgkmcnt(5)
v_mfma_f32_16x16x32_bf16 v[130:133], v[162:165], v[114:117], v[130:133]
v_mfma_f32_16x16x32_bf16 v[138:141], v[162:165], v[118:121], v[138:141]
ds_read_b128 v[162:165], v251 offset:28672
s_waitcnt lgkmcnt(5)
v_mfma_f32_16x16x32_bf16 v[134:137], v[166:169], v[114:117], v[134:137]
v_mfma_f32_16x16x32_bf16 v[142:145], v[166:169], v[118:121], v[142:145]
ds_read_b128 v[166:169], v251 offset:30720
s_waitcnt lgkmcnt(5)
v_mfma_f32_16x16x32_bf16 v[130:133], v[146:149], v[26:29], v[130:133]
v_mfma_f32_16x16x32_bf16 v[138:141], v[146:149], v[30:33], v[138:141]
ds_read_b128 v[146:149], v252 offset:28672
s_waitcnt lgkmcnt(5)
v_mfma_f32_16x16x32_bf16 v[134:137], v[150:153], v[26:29], v[134:137]
v_mfma_f32_16x16x32_bf16 v[142:145], v[150:153], v[30:33], v[142:145]
ds_read_b128 v[150:153], v252 offset:30720
s_waitcnt lgkmcnt(5)
v_mfma_f32_16x16x32_bf16 v[130:133], v[154:157], v[58:61], v[130:133]
v_mfma_f32_16x16x32_bf16 v[138:141], v[154:157], v[62:65], v[138:141]
s_waitcnt lgkmcnt(4)
v_mfma_f32_16x16x32_bf16 v[134:137], v[158:161], v[58:61], v[134:137]
v_mfma_f32_16x16x32_bf16 v[142:145], v[158:161], v[62:65], v[142:145]
s_waitcnt lgkmcnt(3)
v_mfma_f32_16x16x32_bf16 v[130:133], v[162:165], v[90:93], v[130:133]
v_mfma_f32_16x16x32_bf16 v[138:141], v[162:165], v[94:97], v[138:141]
s_waitcnt lgkmcnt(2)
v_mfma_f32_16x16x32_bf16 v[134:137], v[166:169], v[90:93], v[134:137]
v_mfma_f32_16x16x32_bf16 v[142:145], v[166:169], v[94:97], v[142:145]
s_waitcnt lgkmcnt(1)
v_mfma_f32_16x16x32_bf16 v[130:133], v[146:149], v[122:125], v[130:133]
v_mfma_f32_16x16x32_bf16 v[138:141], v[146:149], v[126:129], v[138:141]
s_waitcnt lgkmcnt(0)
v_mfma_f32_16x16x32_bf16 v[134:137], v[150:153], v[122:125], v[134:137]
v_mfma_f32_16x16x32_bf16 v[142:145], v[150:153], v[126:129], v[142:145]
s_setprio 0
v_xor_b32 v251, 0x10000, v251
v_xor_b32 v252, 0x10000, v252
s_nop 7
ds_write_b128 v204, v[130:133] offset:0
ds_write_b128 v204, v[134:137] offset:1024
ds_write_b128 v204, v[138:141] offset:2048
ds_write_b128 v204, v[142:145] offset:3072
v_xor_b32 v204, 0x4000, v204
s_add_u32 s18, s18, 1
s_cmp_lt_u32 s18, 64
s_cbranch_scc1 kvl_131
s_waitcnt vmcnt(0) lgkmcnt(0)
s_barrier
s_barrier
s_branch L_conv
kq_121:
s_bfe_u32 s22, s18, 0x30002
s_lshl_b32 s23, s22, 11
s_cmp_lg_u32 s22, 0
s_cbranch_scc1 kq_121_0
buffer_load_dwordx4 v[208:211], v249, s[36:39], s23 offen nt
s_branch kq_122
kq_121_0:
s_cmp_lg_u32 s22, 1
s_cbranch_scc1 kq_121_1
buffer_load_dwordx4 v[212:215], v249, s[36:39], s23 offen nt
s_branch kq_122
kq_121_1:
s_cmp_lg_u32 s22, 2
s_cbranch_scc1 kq_121_2
buffer_load_dwordx4 v[216:219], v249, s[36:39], s23 offen nt
s_branch kq_122
kq_121_2:
s_cmp_lg_u32 s22, 3
s_cbranch_scc1 kq_121_3
buffer_load_dwordx4 v[220:223], v249, s[36:39], s23 offen nt
s_branch kq_122
kq_121_3:
s_cmp_lg_u32 s22, 4
s_cbranch_scc1 kq_121_4
buffer_load_dwordx4 v[224:227], v249, s[36:39], s23 offen nt
s_branch kq_122
kq_121_4:
s_cmp_lg_u32 s22, 5
s_cbranch_scc1 kq_121_5
buffer_load_dwordx4 v[228:231], v249, s[36:39], s23 offen nt
s_branch kq_122
kq_121_5:
s_cmp_lg_u32 s22, 6
s_cbranch_scc1 kq_121_6
buffer_load_dwordx4 v[232:235], v249, s[36:39], s23 offen nt
s_branch kq_122
kq_121_6:
buffer_load_dwordx4 v[236:239], v249, s[36:39], s23 offen nt
s_branch kq_122
kq_125:
s_bfe_u32 s22, s18, 0x30002
s_lshl_b32 s23, s22, 11
s_cmp_lg_u32 s22, 0
s_cbranch_scc1 kq_125_0
buffer_load_dwordx4 v[208:211], v249, s[36:39], s23 offen nt
s_branch kq_126
kq_125_0:
s_cmp_lg_u32 s22, 1
s_cbranch_scc1 kq_125_1
buffer_load_dwordx4 v[212:215], v249, s[36:39], s23 offen nt
s_branch kq_126
kq_125_1:
s_cmp_lg_u32 s22, 2
s_cbranch_scc1 kq_125_2
buffer_load_dwordx4 v[216:219], v249, s[36:39], s23 offen nt
s_branch kq_126
kq_125_2:
s_cmp_lg_u32 s22, 3
s_cbranch_scc1 kq_125_3
buffer_load_dwordx4 v[220:223], v249, s[36:39], s23 offen nt
s_branch kq_126
kq_125_3:
s_cmp_lg_u32 s22, 4
s_cbranch_scc1 kq_125_4
buffer_load_dwordx4 v[224:227], v249, s[36:39], s23 offen nt
s_branch kq_126
kq_125_4:
s_cmp_lg_u32 s22, 5
s_cbranch_scc1 kq_125_5
buffer_load_dwordx4 v[228:231], v249, s[36:39], s23 offen nt
s_branch kq_126
kq_125_5:
s_cmp_lg_u32 s22, 6
s_cbranch_scc1 kq_125_6
buffer_load_dwordx4 v[232:235], v249, s[36:39], s23 offen nt
s_branch kq_126
kq_125_6:
buffer_load_dwordx4 v[236:239], v249, s[36:39], s23 offen nt
s_branch kq_126
kq_129:
s_bfe_u32 s22, s18, 0x30002
s_lshl_b32 s23, s22, 11
s_cmp_lg_u32 s22, 0
s_cbranch_scc1 kq_129_0
buffer_load_dwordx4 v[208:211], v249, s[36:39], s23 offen nt
s_branch kq_130
kq_129_0:
s_cmp_lg_u32 s22, 1
s_cbranch_scc1 kq_129_1
buffer_load_dwordx4 v[212:215], v249, s[36:39], s23 offen nt
s_branch kq_130
kq_129_1:
s_cmp_lg_u32 s22, 2
s_cbranch_scc1 kq_129_2
buffer_load_dwordx4 v[216:219], v249, s[36:39], s23 offen nt
s_branch kq_130
kq_129_2:
s_cmp_lg_u32 s22, 3
s_cbranch_scc1 kq_129_3
buffer_load_dwordx4 v[220:223], v249, s[36:39], s23 offen nt
s_branch kq_130
kq_129_3:
s_cmp_lg_u32 s22, 4
s_cbranch_scc1 kq_129_4
buffer_load_dwordx4 v[224:227], v249, s[36:39], s23 offen nt
s_branch kq_130
kq_129_4:
s_cmp_lg_u32 s22, 5
s_cbranch_scc1 kq_129_5
buffer_load_dwordx4 v[228:231], v249, s[36:39], s23 offen nt
s_branch kq_130
kq_129_5:
s_cmp_lg_u32 s22, 6
s_cbranch_scc1 kq_129_6
buffer_load_dwordx4 v[232:235], v249, s[36:39], s23 offen nt
s_branch kq_130
kq_129_6:
buffer_load_dwordx4 v[236:239], v249, s[36:39], s23 offen nt
s_branch kq_130
kq_133:
s_bfe_u32 s22, s18, 0x30002
s_lshl_b32 s23, s22, 11
s_cmp_lg_u32 s22, 0
s_cbranch_scc1 kq_133_0
buffer_load_dwordx4 v[208:211], v249, s[36:39], s23 offen nt
s_branch kq_134
kq_133_0:
s_cmp_lg_u32 s22, 1
s_cbranch_scc1 kq_133_1
buffer_load_dwordx4 v[212:215], v249, s[36:39], s23 offen nt
s_branch kq_134
kq_133_1:
s_cmp_lg_u32 s22, 2
s_cbranch_scc1 kq_133_2
buffer_load_dwordx4 v[216:219], v249, s[36:39], s23 offen nt
s_branch kq_134
kq_133_2:
s_cmp_lg_u32 s22, 3
s_cbranch_scc1 kq_133_3
buffer_load_dwordx4 v[220:223], v249, s[36:39], s23 offen nt
s_branch kq_134
kq_133_3:
s_cmp_lg_u32 s22, 4
s_cbranch_scc1 kq_133_4
buffer_load_dwordx4 v[224:227], v249, s[36:39], s23 offen nt
s_branch kq_134
kq_133_4:
s_cmp_lg_u32 s22, 5
s_cbranch_scc1 kq_133_5
buffer_load_dwordx4 v[228:231], v249, s[36:39], s23 offen nt
s_branch kq_134
kq_133_5:
s_cmp_lg_u32 s22, 6
s_cbranch_scc1 kq_133_6
buffer_load_dwordx4 v[232:235], v249, s[36:39], s23 offen nt
s_branch kq_134
kq_133_6:
buffer_load_dwordx4 v[236:239], v249, s[36:39], s23 offen nt
s_branch kq_134
L_conv:
s_mov_b64 exec, -1
s_setprio 0
s_sub_u32 s20, s13, 4
s_lshr_b32 s22, s14, 1
s_and_b32 s23, s14, 1
s_lshl_b32 s32, s22, 3
s_lshl_b32 s21, s20, 1
s_add_u32 s32, s32, s21
s_add_u32 s32, s32, s23
s_mov_b32 s62, 0xffff0000
s_lshl_b32 s20, s15, 19
s_lshl_b32 s21, s32, 5
s_add_u32 s20, s20, s21
v_bfe_u32 v250, v0, 1, 5
v_lshlrev_b32 v248, 14, v250
v_bfe_u32 v250, v0, 0, 1
v_lshl_add_u32 v248, v250, 4, v248
v_add_u32 v248, s20, v248
s_lshl_b32 s20, s15, 9
s_add_u32 s20, s20, 512
v_bfe_u32 v250, v0, 1, 5
v_lshlrev_b32 v249, 4, v250
v_add_u32 v249, s20, v249
v_and_b32 v250, 1, v0
v_mul_u32_u24 v250, 74240, v250
v_add_u32 v249, v249, v250
s_xor_b32 s20, s17, 3940352
v_and_b32 v250, 31, v0
v_lshlrev_b32 v250, 7, v250
cvp_135:
s_add_u32 s19, s19, 1
s_cmp_gt_u32 s19, 1048576
s_cbranch_scc1 L_end
buffer_load_dword v251, v250, s[4:7], s20 offen sc1
s_waitcnt vmcnt(0)
v_cmp_eq_u32 vcc, 0, v251
s_cbranch_vccnz cvp_135
s_barrier
s_bfe_u32 s21, s32, 0x10003
s_lshl_b32 s20, s32, 18
s_lshl_b32 s22, s15, 14
s_add_u32 s20, s20, s22
s_lshl_b32 s22, s21, 13
s_add_u32 s20, s20, s22
s_add_u32 s20, s20, 138412032
s_xor_b32 s20, s20, s17
s_xor_b32 s20, s20, 0x2000
s_mul_i32 s21, s15, 9280
v_lshlrev_b32 v251, 4, v0
s_mov_b32 s63, s20
s_mov_b32 s64, s21
v_mov_b32 v255, v251
s_add_u32 s22, s63, 0
s_add_u32 m0, s64, 512
s_nop 0
buffer_load_dwordx4 v255, s[4:7], s22 offen offset:0 sc1 lds
s_add_u32 s22, s63, 0
s_add_u32 m0, s64, 512
s_nop 0
buffer_load_dwordx4 v255, s[4:7], s22 offen offset:1024 sc1 lds
s_add_u32 s22, s63, 0
s_add_u32 m0, s64, 512
s_nop 0
buffer_load_dwordx4 v255, s[4:7], s22 offen offset:2048 sc1 lds
s_add_u32 s22, s63, 0
s_add_u32 m0, s64, 512
s_nop 0
buffer_load_dwordx4 v255, s[4:7], s22 offen offset:3072 sc1 lds
s_add_u32 s22, s63, 4096
s_add_u32 m0, s64, 5152
s_nop 0
buffer_load_dwordx4 v255, s[4:7], s22 offen offset:0 sc1 lds
s_add_u32 s22, s63, 4096
s_add_u32 m0, s64, 5152
s_nop 0
buffer_load_dwordx4 v255, s[4:7], s22 offen offset:1024 sc1 lds
s_add_u32 s22, s63, 4096
s_add_u32 m0, s64, 5152
s_nop 0
buffer_load_dwordx4 v255, s[4:7], s22 offen offset:2048 sc1 lds
s_add_u32 s22, s63, 4096
s_add_u32 m0, s64, 5152
s_nop 0
buffer_load_dwordx4 v255, s[4:7], s22 offen offset:3072 sc1 lds
v_mov_b32 v2, 0
v_mov_b32 v3, 0
v_mov_b32 v4, 0
v_mov_b32 v5, 0
v_lshrrev_b32 v250, 4, v0
s_lshl_b32 s20, s15, 2
v_add_u32 v250, s20, v250
v_mul_u32_u24 v250, 4640, v250
v_and_b32 v252, 15, v0
v_lshl_add_u32 v250, v252, 5, v250
ds_write_b128 v250, v[2:5]
ds_write_b128 v250, v[2:5] offset:16
s_waitcnt lgkmcnt(0)
s_load_dwordx2 s[8:9], s[0:1], 40
s_mov_b32 s10, 2048
s_mov_b32 s11, 0x20000
s_waitcnt lgkmcnt(0)
s_lshl_b32 s20, s32, 5
v_bfe_u32 v250, v0, 0, 1
v_lshlrev_b32 v253, 4, v250
v_add_u32 v253, s20, v253
buffer_load_dwordx4 v[240:243], v253, s[8:11], 0 offen
s_load_dwordx2 s[8:9], s[0:1], 32
s_mov_b32 s10, 4194304
s_mov_b32 s11, 0x20000
s_waitcnt lgkmcnt(0)
v_and_b32 v250, 15, v0
v_lshrrev_b32 v251, 4, v0
v_lshlrev_b32 v251, 2, v251
v_sub_u32 v250, v250, v251
v_lshlrev_b32 v253, 2, v250
v_add_u32 v253, 52, v253
v_mov_b32 v251, 2147483632
v_add_u32 v244, -64, v253
v_cmp_gt_i32 vcc, 3, v250
s_nop 1
v_cndmask_b32 v244, v244, v251, vcc
v_add_u32 v245, -60, v253
v_cmp_gt_i32 vcc, 2, v250
s_nop 1
v_cndmask_b32 v245, v245, v251, vcc
v_add_u32 v246, -56, v253
v_cmp_gt_i32 vcc, 1, v250
s_nop 1
v_cndmask_b32 v246, v246, v251, vcc
v_add_u32 v247, -52, v253
v_cmp_gt_i32 vcc, 0, v250
s_nop 1
v_cndmask_b32 v247, v247, v251, vcc
s_mul_i32 s20, s15, 9280
s_add_u32 s20, s20, 64
v_bfe_u32 v250, v0, 0, 3
v_lshlrev_b32 v252, 6, v250
v_bfe_u32 v250, v0, 4, 2
v_lshl_add_u32 v252, v250, 4, v252
v_add_u32 v252, s20, v252
v_bfe_u32 v250, v0, 3, 1
v_lshl_add_u32 v254, v250, 3, v252
v_mul_u32_u24 v250, 4640, v250
v_add_u32 v252, v252, v250
s_lshl_b32 s60, s32, 16
s_lshl_b32 s20, s15, 12
s_add_u32 s60, s60, s20
s_mov_b32 s61, 0
buffer_load_dword v2, v244, s[8:11], s60 offen
buffer_load_dword v3, v245, s[8:11], s60 offen
buffer_load_dword v4, v246, s[8:11], s60 offen
buffer_load_dword v5, v247, s[8:11], s60 offen
buffer_load_dwordx4 v[6:9], v253, s[8:11], s60 offen offset:448 nt
buffer_load_dwordx4 v[10:13], v253, s[8:11], s60 offen offset:960 nt
buffer_load_dwordx4 v[14:17], v253, s[8:11], s60 offen offset:1472 nt
buffer_load_dwordx4 v[18:21], v253, s[8:11], s60 offen offset:1984 nt
buffer_load_dwordx4 v[22:25], v253, s[8:11], s60 offen offset:2496 nt
buffer_load_dwordx4 v[26:29], v253, s[8:11], s60 offen offset:3008 nt
buffer_load_dwordx4 v[30:33], v253, s[8:11], s60 offen offset:3520 nt
s_waitcnt vmcnt(0) lgkmcnt(0)
s_barrier
cvl_136:
ds_read_b128 v[66:69], v252 offset:448
ds_read_b128 v[70:73], v252 offset:960
ds_read_b128 v[74:77], v252 offset:1472
ds_read_b128 v[78:81], v252 offset:1984
ds_read_b128 v[82:85], v252 offset:2496
ds_read_b128 v[86:89], v252 offset:3008
ds_read_b128 v[90:93], v252 offset:3520
ds_read_b128 v[94:97], v252 offset:4032
s_waitcnt vmcnt(0) lgkmcnt(0)
v_mfma_f32_16x16x32_bf16 v[130:133], v[2:5], v[66:69], 0
buffer_load_dwordx4 v[34:37], v253, s[8:11], s60 offen offset:0 nt
v_mfma_f32_16x16x32_bf16 v[134:137], v[2:5], v[70:73], 0
buffer_load_dwordx4 v[38:41], v253, s[8:11], s60 offen offset:512 nt
v_mfma_f32_16x16x32_bf16 v[138:141], v[2:5], v[74:77], 0
buffer_load_dwordx4 v[42:45], v253, s[8:11], s60 offen offset:1024 nt
v_mfma_f32_16x16x32_bf16 v[142:145], v[2:5], v[78:81], 0
buffer_load_dwordx4 v[46:49], v253, s[8:11], s60 offen offset:1536 nt
v_mfma_f32_16x16x32_bf16 v[146:149], v[2:5], v[82:85], 0
buffer_load_dwordx4 v[50:53], v253, s[8:11], s60 offen offset:2048 nt
v_mfma_f32_16x16x32_bf16 v[150:153], v[2:5], v[86:89], 0
buffer_load_dwordx4 v[54:57], v253, s[8:11], s60 offen offset:2560 nt
v_mfma_f32_16x16x32_bf16 v[154:157], v[2:5], v[90:93], 0
buffer_load_dwordx4 v[58:61], v253, s[8:11], s60 offen offset:3072 nt
v_mfma_f32_16x16x32_bf16 v[158:161], v[2:5], v[94:97], 0
buffer_load_dwordx4 v[62:65], v253, s[8:11], s60 offen offset:3584 nt
v_mfma_f32_16x16x32_bf16 v[134:137], v[6:9], v[66:69], v[134:137]
s_cmp_lg_u32 s61, 0
s_cbranch_scc1 cq_137
s_add_u32 s22, s63, 131072
s_add_u32 m0, s64, 74752
s_nop 0
buffer_load_dwordx4 v255, s[4:7], s22 offen offset:0 sc1 lds
s_add_u32 s22, s63, 131072
s_add_u32 m0, s64, 74752
s_nop 0
buffer_load_dwordx4 v255, s[4:7], s22 offen offset:1024 sc1 lds
cq_137:
v_mfma_f32_16x16x32_bf16 v[138:141], v[6:9], v[70:73], v[138:141]
v_mfma_f32_16x16x32_bf16 v[142:145], v[6:9], v[74:77], v[142:145]
ds_read_b128 v[98:101], v252 offset:384
v_mfma_f32_16x16x32_bf16 v[146:149], v[6:9], v[78:81], v[146:149]
v_mfma_f32_16x16x32_bf16 v[150:153], v[6:9], v[82:85], v[150:153]
ds_read_b128 v[102:105], v252 offset:896
v_mfma_f32_16x16x32_bf16 v[154:157], v[6:9], v[86:89], v[154:157]
v_mfma_f32_16x16x32_bf16 v[158:161], v[6:9], v[90:93], v[158:161]
ds_read_b128 v[106:109], v252 offset:1408
v_mfma_f32_16x16x32_bf16 v[138:141], v[10:13], v[66:69], v[138:141]
v_mfma_f32_16x16x32_bf16 v[142:145], v[10:13], v[70:73], v[142:145]
ds_read_b128 v[110:113], v252 offset:1920
v_mfma_f32_16x16x32_bf16 v[146:149], v[10:13], v[74:77], v[146:149]
v_mfma_f32_16x16x32_bf16 v[150:153], v[10:13], v[78:81], v[150:153]
ds_read_b128 v[114:117], v252 offset:2432
v_mfma_f32_16x16x32_bf16 v[154:157], v[10:13], v[82:85], v[154:157]
v_mfma_f32_16x16x32_bf16 v[158:161], v[10:13], v[86:89], v[158:161]
ds_read_b128 v[118:121], v252 offset:2944
v_mfma_f32_16x16x32_bf16 v[142:145], v[14:17], v[66:69], v[142:145]
v_mfma_f32_16x16x32_bf16 v[146:149], v[14:17], v[70:73], v[146:149]
ds_read_b128 v[122:125], v252 offset:3456
v_mfma_f32_16x16x32_bf16 v[150:153], v[14:17], v[74:77], v[150:153]
v_mfma_f32_16x16x32_bf16 v[154:157], v[14:17], v[78:81], v[154:157]
ds_read_b128 v[126:129], v252 offset:3968
v_mfma_f32_16x16x32_bf16 v[158:161], v[14:17], v[82:85], v[158:161]
v_mfma_f32_16x16x32_bf16 v[146:149], v[18:21], v[66:69], v[146:149]
v_mfma_f32_16x16x32_bf16 v[150:153], v[18:21], v[70:73], v[150:153]
v_mfma_f32_16x16x32_bf16 v[154:157], v[18:21], v[74:77], v[154:157]
v_mfma_f32_16x16x32_bf16 v[158:161], v[18:21], v[78:81], v[158:161]
v_mfma_f32_16x16x32_bf16 v[150:153], v[22:25], v[66:69], v[150:153]
v_mfma_f32_16x16x32_bf16 v[154:157], v[22:25], v[70:73], v[154:157]
v_mfma_f32_16x16x32_bf16 v[158:161], v[22:25], v[74:77], v[158:161]
v_mfma_f32_16x16x32_bf16 v[154:157], v[26:29], v[66:69], v[154:157]
v_mfma_f32_16x16x32_bf16 v[158:161], v[26:29], v[70:73], v[158:161]
v_mfma_f32_16x16x32_bf16 v[158:161], v[30:33], v[66:69], v[158:161]
s_waitcnt vmcnt(0) lgkmcnt(0)
v_mfma_f32_16x16x32_bf16 v[130:133], v[34:37], v[98:101], v[130:133]
buffer_load_dwordx4 v[2:5], v253, s[8:11], s60 offen offset:64 nt
v_mfma_f32_16x16x32_bf16 v[134:137], v[34:37], v[102:105], v[134:137]
buffer_load_dwordx4 v[6:9], v253, s[8:11], s60 offen offset:576 nt
v_mfma_f32_16x16x32_bf16 v[138:141], v[34:37], v[106:109], v[138:141]
buffer_load_dwordx4 v[10:13], v253, s[8:11], s60 offen offset:1088 nt
v_mfma_f32_16x16x32_bf16 v[142:145], v[34:37], v[110:113], v[142:145]
buffer_load_dwordx4 v[14:17], v253, s[8:11], s60 offen offset:1600 nt
v_mfma_f32_16x16x32_bf16 v[146:149], v[34:37], v[114:117], v[146:149]
buffer_load_dwordx4 v[18:21], v253, s[8:11], s60 offen offset:2112 nt
v_mfma_f32_16x16x32_bf16 v[150:153], v[34:37], v[118:121], v[150:153]
buffer_load_dwordx4 v[22:25], v253, s[8:11], s60 offen offset:2624 nt
v_mfma_f32_16x16x32_bf16 v[154:157], v[34:37], v[122:125], v[154:157]
buffer_load_dwordx4 v[26:29], v253, s[8:11], s60 offen offset:3136 nt
v_mfma_f32_16x16x32_bf16 v[158:161], v[34:37], v[126:129], v[158:161]
buffer_load_dwordx4 v[30:33], v253, s[8:11], s60 offen offset:3648 nt
v_mfma_f32_16x16x32_bf16 v[134:137], v[38:41], v[98:101], v[134:137]
s_cmp_lg_u32 s61, 0
s_cbranch_scc1 cq_138
s_add_u32 s22, s63, 131072
s_add_u32 m0, s64, 74752
s_nop 0
buffer_load_dwordx4 v255, s[4:7], s22 offen offset:2048 sc1 lds
cq_138:
v_mfma_f32_16x16x32_bf16 v[138:141], v[38:41], v[102:105], v[138:141]
v_mfma_f32_16x16x32_bf16 v[142:145], v[38:41], v[106:109], v[142:145]
ds_read_b128 v[66:69], v252 offset:320
v_mfma_f32_16x16x32_bf16 v[146:149], v[38:41], v[110:113], v[146:149]
v_mfma_f32_16x16x32_bf16 v[150:153], v[38:41], v[114:117], v[150:153]
ds_read_b128 v[70:73], v252 offset:832
v_mfma_f32_16x16x32_bf16 v[154:157], v[38:41], v[118:121], v[154:157]
v_mfma_f32_16x16x32_bf16 v[158:161], v[38:41], v[122:125], v[158:161]
ds_read_b128 v[74:77], v252 offset:1344
v_mfma_f32_16x16x32_bf16 v[138:141], v[42:45], v[98:101], v[138:141]
v_mfma_f32_16x16x32_bf16 v[142:145], v[42:45], v[102:105], v[142:145]
ds_read_b128 v[78:81], v252 offset:1856
v_mfma_f32_16x16x32_bf16 v[146:149], v[42:45], v[106:109], v[146:149]
v_mfma_f32_16x16x32_bf16 v[150:153], v[42:45], v[110:113], v[150:153]
ds_read_b128 v[82:85], v252 offset:2368
v_mfma_f32_16x16x32_bf16 v[154:157], v[42:45], v[114:117], v[154:157]
v_mfma_f32_16x16x32_bf16 v[158:161], v[42:45], v[118:121], v[158:161]
ds_read_b128 v[86:89], v252 offset:2880
v_mfma_f32_16x16x32_bf16 v[142:145], v[46:49], v[98:101], v[142:145]
v_mfma_f32_16x16x32_bf16 v[146:149], v[46:49], v[102:105], v[146:149]
ds_read_b128 v[90:93], v252 offset:3392
v_mfma_f32_16x16x32_bf16 v[150:153], v[46:49], v[106:109], v[150:153]
v_mfma_f32_16x16x32_bf16 v[154:157], v[46:49], v[110:113], v[154:157]
ds_read_b128 v[94:97], v252 offset:3904
v_mfma_f32_16x16x32_bf16 v[158:161], v[46:49], v[114:117], v[158:161]
v_mfma_f32_16x16x32_bf16 v[146:149], v[50:53], v[98:101], v[146:149]
v_mfma_f32_16x16x32_bf16 v[150:153], v[50:53], v[102:105], v[150:153]
v_mfma_f32_16x16x32_bf16 v[154:157], v[50:53], v[106:109], v[154:157]
v_mfma_f32_16x16x32_bf16 v[158:161], v[50:53], v[110:113], v[158:161]
v_mfma_f32_16x16x32_bf16 v[150:153], v[54:57], v[98:101], v[150:153]
v_mfma_f32_16x16x32_bf16 v[154:157], v[54:57], v[102:105], v[154:157]
v_mfma_f32_16x16x32_bf16 v[158:161], v[54:57], v[106:109], v[158:161]
v_mfma_f32_16x16x32_bf16 v[154:157], v[58:61], v[98:101], v[154:157]
v_mfma_f32_16x16x32_bf16 v[158:161], v[58:61], v[102:105], v[158:161]
v_mfma_f32_16x16x32_bf16 v[158:161], v[62:65], v[98:101], v[158:161]
s_waitcnt vmcnt(0) lgkmcnt(0)
v_mfma_f32_16x16x32_bf16 v[130:133], v[2:5], v[66:69], v[130:133]
buffer_load_dwordx4 v[34:37], v253, s[8:11], s60 offen offset:128 nt
v_mfma_f32_16x16x32_bf16 v[134:137], v[2:5], v[70:73], v[134:137]
buffer_load_dwordx4 v[38:41], v253, s[8:11], s60 offen offset:640 nt
v_mfma_f32_16x16x32_bf16 v[138:141], v[2:5], v[74:77], v[138:141]
buffer_load_dwordx4 v[42:45], v253, s[8:11], s60 offen offset:1152 nt
v_mfma_f32_16x16x32_bf16 v[142:145], v[2:5], v[78:81], v[142:145]
buffer_load_dwordx4 v[46:49], v253, s[8:11], s60 offen offset:1664 nt
v_mfma_f32_16x16x32_bf16 v[146:149], v[2:5], v[82:85], v[146:149]
buffer_load_dwordx4 v[50:53], v253, s[8:11], s60 offen offset:2176 nt
v_mfma_f32_16x16x32_bf16 v[150:153], v[2:5], v[86:89], v[150:153]
buffer_load_dwordx4 v[54:57], v253, s[8:11], s60 offen offset:2688 nt
v_mfma_f32_16x16x32_bf16 v[154:157], v[2:5], v[90:93], v[154:157]
buffer_load_dwordx4 v[58:61], v253, s[8:11], s60 offen offset:3200 nt
v_mfma_f32_16x16x32_bf16 v[158:161], v[2:5], v[94:97], v[158:161]
buffer_load_dwordx4 v[62:65], v253, s[8:11], s60 offen offset:3712 nt
v_mfma_f32_16x16x32_bf16 v[134:137], v[6:9], v[66:69], v[134:137]
s_cmp_lg_u32 s61, 0
s_cbranch_scc1 cq_139
s_add_u32 s22, s63, 131072
s_add_u32 m0, s64, 74752
s_nop 0
buffer_load_dwordx4 v255, s[4:7], s22 offen offset:3072 sc1 lds
cq_139:
v_mfma_f32_16x16x32_bf16 v[138:141], v[6:9], v[70:73], v[138:141]
v_mfma_f32_16x16x32_bf16 v[142:145], v[6:9], v[74:77], v[142:145]
ds_read_b128 v[98:101], v252 offset:256
v_mfma_f32_16x16x32_bf16 v[146:149], v[6:9], v[78:81], v[146:149]
v_mfma_f32_16x16x32_bf16 v[150:153], v[6:9], v[82:85], v[150:153]
ds_read_b128 v[102:105], v252 offset:768
v_mfma_f32_16x16x32_bf16 v[154:157], v[6:9], v[86:89], v[154:157]
v_mfma_f32_16x16x32_bf16 v[158:161], v[6:9], v[90:93], v[158:161]
ds_read_b128 v[106:109], v252 offset:1280
v_mfma_f32_16x16x32_bf16 v[138:141], v[10:13], v[66:69], v[138:141]
v_mfma_f32_16x16x32_bf16 v[142:145], v[10:13], v[70:73], v[142:145]
ds_read_b128 v[110:113], v252 offset:1792
v_mfma_f32_16x16x32_bf16 v[146:149], v[10:13], v[74:77], v[146:149]
v_mfma_f32_16x16x32_bf16 v[150:153], v[10:13], v[78:81], v[150:153]
ds_read_b128 v[114:117], v252 offset:2304
v_mfma_f32_16x16x32_bf16 v[154:157], v[10:13], v[82:85], v[154:157]
v_mfma_f32_16x16x32_bf16 v[158:161], v[10:13], v[86:89], v[158:161]
ds_read_b128 v[118:121], v252 offset:2816
v_mfma_f32_16x16x32_bf16 v[142:145], v[14:17], v[66:69], v[142:145]
v_mfma_f32_16x16x32_bf16 v[146:149], v[14:17], v[70:73], v[146:149]
ds_read_b128 v[122:125], v252 offset:3328
v_mfma_f32_16x16x32_bf16 v[150:153], v[14:17], v[74:77], v[150:153]
v_mfma_f32_16x16x32_bf16 v[154:157], v[14:17], v[78:81], v[154:157]
ds_read_b128 v[126:129], v252 offset:3840
v_mfma_f32_16x16x32_bf16 v[158:161], v[14:17], v[82:85], v[158:161]
v_mfma_f32_16x16x32_bf16 v[146:149], v[18:21], v[66:69], v[146:149]
v_mfma_f32_16x16x32_bf16 v[150:153], v[18:21], v[70:73], v[150:153]
v_mfma_f32_16x16x32_bf16 v[154:157], v[18:21], v[74:77], v[154:157]
v_mfma_f32_16x16x32_bf16 v[158:161], v[18:21], v[78:81], v[158:161]
v_mfma_f32_16x16x32_bf16 v[150:153], v[22:25], v[66:69], v[150:153]
v_mfma_f32_16x16x32_bf16 v[154:157], v[22:25], v[70:73], v[154:157]
v_mfma_f32_16x16x32_bf16 v[158:161], v[22:25], v[74:77], v[158:161]
v_mfma_f32_16x16x32_bf16 v[154:157], v[26:29], v[66:69], v[154:157]
v_mfma_f32_16x16x32_bf16 v[158:161], v[26:29], v[70:73], v[158:161]
v_mfma_f32_16x16x32_bf16 v[158:161], v[30:33], v[66:69], v[158:161]
s_waitcnt vmcnt(0) lgkmcnt(0)
v_mfma_f32_16x16x32_bf16 v[130:133], v[34:37], v[98:101], v[130:133]
buffer_load_dwordx4 v[2:5], v253, s[8:11], s60 offen offset:192 nt
v_mfma_f32_16x16x32_bf16 v[134:137], v[34:37], v[102:105], v[134:137]
buffer_load_dwordx4 v[6:9], v253, s[8:11], s60 offen offset:704 nt
v_mfma_f32_16x16x32_bf16 v[138:141], v[34:37], v[106:109], v[138:141]
buffer_load_dwordx4 v[10:13], v253, s[8:11], s60 offen offset:1216 nt
v_mfma_f32_16x16x32_bf16 v[142:145], v[34:37], v[110:113], v[142:145]
buffer_load_dwordx4 v[14:17], v253, s[8:11], s60 offen offset:1728 nt
v_mfma_f32_16x16x32_bf16 v[146:149], v[34:37], v[114:117], v[146:149]
buffer_load_dwordx4 v[18:21], v253, s[8:11], s60 offen offset:2240 nt
v_mfma_f32_16x16x32_bf16 v[150:153], v[34:37], v[118:121], v[150:153]
buffer_load_dwordx4 v[22:25], v253, s[8:11], s60 offen offset:2752 nt
v_mfma_f32_16x16x32_bf16 v[154:157], v[34:37], v[122:125], v[154:157]
buffer_load_dwordx4 v[26:29], v253, s[8:11], s60 offen offset:3264 nt
v_mfma_f32_16x16x32_bf16 v[158:161], v[34:37], v[126:129], v[158:161]
buffer_load_dwordx4 v[30:33], v253, s[8:11], s60 offen offset:3776 nt
v_mfma_f32_16x16x32_bf16 v[134:137], v[38:41], v[98:101], v[134:137]
s_cmp_lg_u32 s61, 0
s_cbranch_scc1 cq_140
s_add_u32 s22, s63, 135168
s_add_u32 m0, s64, 79392
s_nop 0
buffer_load_dwordx4 v255, s[4:7], s22 offen offset:0 sc1 lds
cq_140:
v_mfma_f32_16x16x32_bf16 v[138:141], v[38:41], v[102:105], v[138:141]
v_mfma_f32_16x16x32_bf16 v[142:145], v[38:41], v[106:109], v[142:145]
ds_read_b128 v[66:69], v252 offset:192
v_mfma_f32_16x16x32_bf16 v[146:149], v[38:41], v[110:113], v[146:149]
v_mfma_f32_16x16x32_bf16 v[150:153], v[38:41], v[114:117], v[150:153]
ds_read_b128 v[70:73], v252 offset:704
v_mfma_f32_16x16x32_bf16 v[154:157], v[38:41], v[118:121], v[154:157]
v_mfma_f32_16x16x32_bf16 v[158:161], v[38:41], v[122:125], v[158:161]
ds_read_b128 v[74:77], v252 offset:1216
v_mfma_f32_16x16x32_bf16 v[138:141], v[42:45], v[98:101], v[138:141]
v_mfma_f32_16x16x32_bf16 v[142:145], v[42:45], v[102:105], v[142:145]
ds_read_b128 v[78:81], v252 offset:1728
v_mfma_f32_16x16x32_bf16 v[146:149], v[42:45], v[106:109], v[146:149]
v_mfma_f32_16x16x32_bf16 v[150:153], v[42:45], v[110:113], v[150:153]
ds_read_b128 v[82:85], v252 offset:2240
v_mfma_f32_16x16x32_bf16 v[154:157], v[42:45], v[114:117], v[154:157]
v_mfma_f32_16x16x32_bf16 v[158:161], v[42:45], v[118:121], v[158:161]
ds_read_b128 v[86:89], v252 offset:2752
v_mfma_f32_16x16x32_bf16 v[142:145], v[46:49], v[98:101], v[142:145]
v_mfma_f32_16x16x32_bf16 v[146:149], v[46:49], v[102:105], v[146:149]
ds_read_b128 v[90:93], v252 offset:3264
v_mfma_f32_16x16x32_bf16 v[150:153], v[46:49], v[106:109], v[150:153]
v_mfma_f32_16x16x32_bf16 v[154:157], v[46:49], v[110:113], v[154:157]
ds_read_b128 v[94:97], v252 offset:3776
v_mfma_f32_16x16x32_bf16 v[158:161], v[46:49], v[114:117], v[158:161]
v_mfma_f32_16x16x32_bf16 v[146:149], v[50:53], v[98:101], v[146:149]
v_mfma_f32_16x16x32_bf16 v[150:153], v[50:53], v[102:105], v[150:153]
v_mfma_f32_16x16x32_bf16 v[154:157], v[50:53], v[106:109], v[154:157]
v_mfma_f32_16x16x32_bf16 v[158:161], v[50:53], v[110:113], v[158:161]
v_mfma_f32_16x16x32_bf16 v[150:153], v[54:57], v[98:101], v[150:153]
v_mfma_f32_16x16x32_bf16 v[154:157], v[54:57], v[102:105], v[154:157]
v_mfma_f32_16x16x32_bf16 v[158:161], v[54:57], v[106:109], v[158:161]
v_mfma_f32_16x16x32_bf16 v[154:157], v[58:61], v[98:101], v[154:157]
v_mfma_f32_16x16x32_bf16 v[158:161], v[58:61], v[102:105], v[158:161]
v_mfma_f32_16x16x32_bf16 v[158:161], v[62:65], v[98:101], v[158:161]
s_waitcnt vmcnt(0) lgkmcnt(0)
v_mfma_f32_16x16x32_bf16 v[130:133], v[2:5], v[66:69], v[130:133]
buffer_load_dwordx4 v[34:37], v253, s[8:11], s60 offen offset:256 nt
v_mfma_f32_16x16x32_bf16 v[134:137], v[2:5], v[70:73], v[134:137]
buffer_load_dwordx4 v[38:41], v253, s[8:11], s60 offen offset:768 nt
v_mfma_f32_16x16x32_bf16 v[138:141], v[2:5], v[74:77], v[138:141]
buffer_load_dwordx4 v[42:45], v253, s[8:11], s60 offen offset:1280 nt
v_mfma_f32_16x16x32_bf16 v[142:145], v[2:5], v[78:81], v[142:145]
buffer_load_dwordx4 v[46:49], v253, s[8:11], s60 offen offset:1792 nt
v_mfma_f32_16x16x32_bf16 v[146:149], v[2:5], v[82:85], v[146:149]
buffer_load_dwordx4 v[50:53], v253, s[8:11], s60 offen offset:2304 nt
v_mfma_f32_16x16x32_bf16 v[150:153], v[2:5], v[86:89], v[150:153]
buffer_load_dwordx4 v[54:57], v253, s[8:11], s60 offen offset:2816 nt
v_mfma_f32_16x16x32_bf16 v[154:157], v[2:5], v[90:93], v[154:157]
buffer_load_dwordx4 v[58:61], v253, s[8:11], s60 offen offset:3328 nt
v_mfma_f32_16x16x32_bf16 v[158:161], v[2:5], v[94:97], v[158:161]
buffer_load_dwordx4 v[62:65], v253, s[8:11], s60 offen offset:3840 nt
v_mfma_f32_16x16x32_bf16 v[134:137], v[6:9], v[66:69], v[134:137]
s_cmp_lg_u32 s61, 0
s_cbranch_scc1 cq_141
s_add_u32 s22, s63, 135168
s_add_u32 m0, s64, 79392
s_nop 0
buffer_load_dwordx4 v255, s[4:7], s22 offen offset:1024 sc1 lds
cq_141:
v_mfma_f32_16x16x32_bf16 v[138:141], v[6:9], v[70:73], v[138:141]
v_mfma_f32_16x16x32_bf16 v[142:145], v[6:9], v[74:77], v[142:145]
ds_read_b128 v[98:101], v252 offset:128
v_mfma_f32_16x16x32_bf16 v[146:149], v[6:9], v[78:81], v[146:149]
v_mfma_f32_16x16x32_bf16 v[150:153], v[6:9], v[82:85], v[150:153]
ds_read_b128 v[102:105], v252 offset:640
v_mfma_f32_16x16x32_bf16 v[154:157], v[6:9], v[86:89], v[154:157]
v_mfma_f32_16x16x32_bf16 v[158:161], v[6:9], v[90:93], v[158:161]
ds_read_b128 v[106:109], v252 offset:1152
v_mfma_f32_16x16x32_bf16 v[138:141], v[10:13], v[66:69], v[138:141]
v_mfma_f32_16x16x32_bf16 v[142:145], v[10:13], v[70:73], v[142:145]
ds_read_b128 v[110:113], v252 offset:1664
v_mfma_f32_16x16x32_bf16 v[146:149], v[10:13], v[74:77], v[146:149]
v_mfma_f32_16x16x32_bf16 v[150:153], v[10:13], v[78:81], v[150:153]
ds_read_b128 v[114:117], v252 offset:2176
v_mfma_f32_16x16x32_bf16 v[154:157], v[10:13], v[82:85], v[154:157]
v_mfma_f32_16x16x32_bf16 v[158:161], v[10:13], v[86:89], v[158:161]
ds_read_b128 v[118:121], v252 offset:2688
v_mfma_f32_16x16x32_bf16 v[142:145], v[14:17], v[66:69], v[142:145]
v_mfma_f32_16x16x32_bf16 v[146:149], v[14:17], v[70:73], v[146:149]
ds_read_b128 v[122:125], v252 offset:3200
v_mfma_f32_16x16x32_bf16 v[150:153], v[14:17], v[74:77], v[150:153]
v_mfma_f32_16x16x32_bf16 v[154:157], v[14:17], v[78:81], v[154:157]
ds_read_b128 v[126:129], v252 offset:3712
v_mfma_f32_16x16x32_bf16 v[158:161], v[14:17], v[82:85], v[158:161]
v_mfma_f32_16x16x32_bf16 v[146:149], v[18:21], v[66:69], v[146:149]
v_mfma_f32_16x16x32_bf16 v[150:153], v[18:21], v[70:73], v[150:153]
v_mfma_f32_16x16x32_bf16 v[154:157], v[18:21], v[74:77], v[154:157]
v_mfma_f32_16x16x32_bf16 v[158:161], v[18:21], v[78:81], v[158:161]
v_mfma_f32_16x16x32_bf16 v[150:153], v[22:25], v[66:69], v[150:153]
v_mfma_f32_16x16x32_bf16 v[154:157], v[22:25], v[70:73], v[154:157]
v_mfma_f32_16x16x32_bf16 v[158:161], v[22:25], v[74:77], v[158:161]
v_mfma_f32_16x16x32_bf16 v[154:157], v[26:29], v[66:69], v[154:157]
v_mfma_f32_16x16x32_bf16 v[158:161], v[26:29], v[70:73], v[158:161]
v_mfma_f32_16x16x32_bf16 v[158:161], v[30:33], v[66:69], v[158:161]
s_waitcnt vmcnt(0) lgkmcnt(0)
v_mfma_f32_16x16x32_bf16 v[130:133], v[34:37], v[98:101], v[130:133]
buffer_load_dwordx4 v[2:5], v253, s[8:11], s60 offen offset:320 nt
v_mfma_f32_16x16x32_bf16 v[134:137], v[34:37], v[102:105], v[134:137]
buffer_load_dwordx4 v[6:9], v253, s[8:11], s60 offen offset:832 nt
v_mfma_f32_16x16x32_bf16 v[138:141], v[34:37], v[106:109], v[138:141]
buffer_load_dwordx4 v[10:13], v253, s[8:11], s60 offen offset:1344 nt
v_mfma_f32_16x16x32_bf16 v[142:145], v[34:37], v[110:113], v[142:145]
buffer_load_dwordx4 v[14:17], v253, s[8:11], s60 offen offset:1856 nt
v_mfma_f32_16x16x32_bf16 v[146:149], v[34:37], v[114:117], v[146:149]
buffer_load_dwordx4 v[18:21], v253, s[8:11], s60 offen offset:2368 nt
v_mfma_f32_16x16x32_bf16 v[150:153], v[34:37], v[118:121], v[150:153]
buffer_load_dwordx4 v[22:25], v253, s[8:11], s60 offen offset:2880 nt
v_mfma_f32_16x16x32_bf16 v[154:157], v[34:37], v[122:125], v[154:157]
buffer_load_dwordx4 v[26:29], v253, s[8:11], s60 offen offset:3392 nt
v_mfma_f32_16x16x32_bf16 v[158:161], v[34:37], v[126:129], v[158:161]
buffer_load_dwordx4 v[30:33], v253, s[8:11], s60 offen offset:3904 nt
v_mfma_f32_16x16x32_bf16 v[134:137], v[38:41], v[98:101], v[134:137]
s_cmp_lg_u32 s61, 0
s_cbranch_scc1 cq_142
s_add_u32 s22, s63, 135168
s_add_u32 m0, s64, 79392
s_nop 0
buffer_load_dwordx4 v255, s[4:7], s22 offen offset:2048 sc1 lds
cq_142:
v_mfma_f32_16x16x32_bf16 v[138:141], v[38:41], v[102:105], v[138:141]
v_mfma_f32_16x16x32_bf16 v[142:145], v[38:41], v[106:109], v[142:145]
ds_read_b128 v[66:69], v252 offset:64
v_mfma_f32_16x16x32_bf16 v[146:149], v[38:41], v[110:113], v[146:149]
v_mfma_f32_16x16x32_bf16 v[150:153], v[38:41], v[114:117], v[150:153]
ds_read_b128 v[70:73], v252 offset:576
v_mfma_f32_16x16x32_bf16 v[154:157], v[38:41], v[118:121], v[154:157]
v_mfma_f32_16x16x32_bf16 v[158:161], v[38:41], v[122:125], v[158:161]
ds_read_b128 v[74:77], v252 offset:1088
v_mfma_f32_16x16x32_bf16 v[138:141], v[42:45], v[98:101], v[138:141]
v_mfma_f32_16x16x32_bf16 v[142:145], v[42:45], v[102:105], v[142:145]
ds_read_b128 v[78:81], v252 offset:1600
v_mfma_f32_16x16x32_bf16 v[146:149], v[42:45], v[106:109], v[146:149]
v_mfma_f32_16x16x32_bf16 v[150:153], v[42:45], v[110:113], v[150:153]
ds_read_b128 v[82:85], v252 offset:2112
v_mfma_f32_16x16x32_bf16 v[154:157], v[42:45], v[114:117], v[154:157]
v_mfma_f32_16x16x32_bf16 v[158:161], v[42:45], v[118:121], v[158:161]
ds_read_b128 v[86:89], v252 offset:2624
v_mfma_f32_16x16x32_bf16 v[142:145], v[46:49], v[98:101], v[142:145]
v_mfma_f32_16x16x32_bf16 v[146:149], v[46:49], v[102:105], v[146:149]
ds_read_b128 v[90:93], v252 offset:3136
v_mfma_f32_16x16x32_bf16 v[150:153], v[46:49], v[106:109], v[150:153]
v_mfma_f32_16x16x32_bf16 v[154:157], v[46:49], v[110:113], v[154:157]
ds_read_b128 v[94:97], v252 offset:3648
v_mfma_f32_16x16x32_bf16 v[158:161], v[46:49], v[114:117], v[158:161]
v_mfma_f32_16x16x32_bf16 v[146:149], v[50:53], v[98:101], v[146:149]
v_mfma_f32_16x16x32_bf16 v[150:153], v[50:53], v[102:105], v[150:153]
v_mfma_f32_16x16x32_bf16 v[154:157], v[50:53], v[106:109], v[154:157]
v_mfma_f32_16x16x32_bf16 v[158:161], v[50:53], v[110:113], v[158:161]
v_mfma_f32_16x16x32_bf16 v[150:153], v[54:57], v[98:101], v[150:153]
v_mfma_f32_16x16x32_bf16 v[154:157], v[54:57], v[102:105], v[154:157]
v_mfma_f32_16x16x32_bf16 v[158:161], v[54:57], v[106:109], v[158:161]
v_mfma_f32_16x16x32_bf16 v[154:157], v[58:61], v[98:101], v[154:157]
v_mfma_f32_16x16x32_bf16 v[158:161], v[58:61], v[102:105], v[158:161]
v_mfma_f32_16x16x32_bf16 v[158:161], v[62:65], v[98:101], v[158:161]
s_waitcnt vmcnt(0) lgkmcnt(0)
v_mfma_f32_16x16x32_bf16 v[130:133], v[2:5], v[66:69], v[130:133]
buffer_load_dwordx4 v[34:37], v253, s[8:11], s60 offen offset:384 nt
v_mfma_f32_16x16x32_bf16 v[134:137], v[2:5], v[70:73], v[134:137]
buffer_load_dwordx4 v[38:41], v253, s[8:11], s60 offen offset:896 nt
v_mfma_f32_16x16x32_bf16 v[138:141], v[2:5], v[74:77], v[138:141]
buffer_load_dwordx4 v[42:45], v253, s[8:11], s60 offen offset:1408 nt
v_mfma_f32_16x16x32_bf16 v[142:145], v[2:5], v[78:81], v[142:145]
buffer_load_dwordx4 v[46:49], v253, s[8:11], s60 offen offset:1920 nt
v_mfma_f32_16x16x32_bf16 v[146:149], v[2:5], v[82:85], v[146:149]
buffer_load_dwordx4 v[50:53], v253, s[8:11], s60 offen offset:2432 nt
v_mfma_f32_16x16x32_bf16 v[150:153], v[2:5], v[86:89], v[150:153]
buffer_load_dwordx4 v[54:57], v253, s[8:11], s60 offen offset:2944 nt
v_mfma_f32_16x16x32_bf16 v[154:157], v[2:5], v[90:93], v[154:157]
buffer_load_dwordx4 v[58:61], v253, s[8:11], s60 offen offset:3456 nt
v_mfma_f32_16x16x32_bf16 v[158:161], v[2:5], v[94:97], v[158:161]
buffer_load_dwordx4 v[62:65], v253, s[8:11], s60 offen offset:3968 nt
v_mfma_f32_16x16x32_bf16 v[134:137], v[6:9], v[66:69], v[134:137]
s_cmp_lg_u32 s61, 0
s_cbranch_scc1 cq_143
s_add_u32 s22, s63, 135168
s_add_u32 m0, s64, 79392
s_nop 0
buffer_load_dwordx4 v255, s[4:7], s22 offen offset:3072 sc1 lds
cq_143:
v_mfma_f32_16x16x32_bf16 v[138:141], v[6:9], v[70:73], v[138:141]
v_mfma_f32_16x16x32_bf16 v[142:145], v[6:9], v[74:77], v[142:145]
ds_read_b128 v[98:101], v252 offset:0
v_mfma_f32_16x16x32_bf16 v[146:149], v[6:9], v[78:81], v[146:149]
v_mfma_f32_16x16x32_bf16 v[150:153], v[6:9], v[82:85], v[150:153]
ds_read_b128 v[102:105], v252 offset:512
v_mfma_f32_16x16x32_bf16 v[154:157], v[6:9], v[86:89], v[154:157]
v_mfma_f32_16x16x32_bf16 v[158:161], v[6:9], v[90:93], v[158:161]
ds_read_b128 v[106:109], v252 offset:1024
v_mfma_f32_16x16x32_bf16 v[138:141], v[10:13], v[66:69], v[138:141]
v_mfma_f32_16x16x32_bf16 v[142:145], v[10:13], v[70:73], v[142:145]
ds_read_b128 v[110:113], v252 offset:1536
v_mfma_f32_16x16x32_bf16 v[146:149], v[10:13], v[74:77], v[146:149]
v_mfma_f32_16x16x32_bf16 v[150:153], v[10:13], v[78:81], v[150:153]
ds_read_b128 v[114:117], v252 offset:2048
v_mfma_f32_16x16x32_bf16 v[154:157], v[10:13], v[82:85], v[154:157]
v_mfma_f32_16x16x32_bf16 v[158:161], v[10:13], v[86:89], v[158:161]
ds_read_b128 v[118:121], v252 offset:2560
v_mfma_f32_16x16x32_bf16 v[142:145], v[14:17], v[66:69], v[142:145]
v_mfma_f32_16x16x32_bf16 v[146:149], v[14:17], v[70:73], v[146:149]
ds_read_b128 v[122:125], v252 offset:3072
v_mfma_f32_16x16x32_bf16 v[150:153], v[14:17], v[74:77], v[150:153]
v_mfma_f32_16x16x32_bf16 v[154:157], v[14:17], v[78:81], v[154:157]
ds_read_b128 v[126:129], v252 offset:3584
v_mfma_f32_16x16x32_bf16 v[158:161], v[14:17], v[82:85], v[158:161]
v_mfma_f32_16x16x32_bf16 v[146:149], v[18:21], v[66:69], v[146:149]
v_mfma_f32_16x16x32_bf16 v[150:153], v[18:21], v[70:73], v[150:153]
v_mfma_f32_16x16x32_bf16 v[154:157], v[18:21], v[74:77], v[154:157]
v_mfma_f32_16x16x32_bf16 v[158:161], v[18:21], v[78:81], v[158:161]
v_mfma_f32_16x16x32_bf16 v[150:153], v[22:25], v[66:69], v[150:153]
v_mfma_f32_16x16x32_bf16 v[154:157], v[22:25], v[70:73], v[154:157]
v_mfma_f32_16x16x32_bf16 v[158:161], v[22:25], v[74:77], v[158:161]
v_mfma_f32_16x16x32_bf16 v[154:157], v[26:29], v[66:69], v[154:157]
v_mfma_f32_16x16x32_bf16 v[158:161], v[26:29], v[70:73], v[158:161]
v_mfma_f32_16x16x32_bf16 v[158:161], v[30:33], v[66:69], v[158:161]
s_waitcnt vmcnt(0) lgkmcnt(0)
v_mfma_f32_16x16x32_bf16 v[130:133], v[34:37], v[98:101], v[130:133]
s_add_u32 s60, s60, 0x8000
buffer_load_dword v2, v244, s[8:11], s60 offen
buffer_load_dword v3, v245, s[8:11], s60 offen
buffer_load_dword v4, v246, s[8:11], s60 offen
buffer_load_dword v5, v247, s[8:11], s60 offen
v_mfma_f32_16x16x32_bf16 v[134:137], v[34:37], v[102:105], v[134:137]
buffer_load_dwordx4 v[6:9], v253, s[8:11], s60 offen offset:448 nt
v_mfma_f32_16x16x32_bf16 v[138:141], v[34:37], v[106:109], v[138:141]
buffer_load_dwordx4 v[10:13], v253, s[8:11], s60 offen offset:960 nt
v_mfma_f32_16x16x32_bf16 v[142:145], v[34:37], v[110:113], v[142:145]
buffer_load_dwordx4 v[14:17], v253, s[8:11], s60 offen offset:1472 nt
v_mfma_f32_16x16x32_bf16 v[146:149], v[34:37], v[114:117], v[146:149]
buffer_load_dwordx4 v[18:21], v253, s[8:11], s60 offen offset:1984 nt
v_mfma_f32_16x16x32_bf16 v[150:153], v[34:37], v[118:121], v[150:153]
buffer_load_dwordx4 v[22:25], v253, s[8:11], s60 offen offset:2496 nt
v_mfma_f32_16x16x32_bf16 v[154:157], v[34:37], v[122:125], v[154:157]
buffer_load_dwordx4 v[26:29], v253, s[8:11], s60 offen offset:3008 nt
v_mfma_f32_16x16x32_bf16 v[158:161], v[34:37], v[126:129], v[158:161]
buffer_load_dwordx4 v[30:33], v253, s[8:11], s60 offen offset:3520 nt
v_mfma_f32_16x16x32_bf16 v[134:137], v[38:41], v[98:101], v[134:137]
v_mfma_f32_16x16x32_bf16 v[138:141], v[38:41], v[102:105], v[138:141]
v_mfma_f32_16x16x32_bf16 v[142:145], v[38:41], v[106:109], v[142:145]
v_mfma_f32_16x16x32_bf16 v[146:149], v[38:41], v[110:113], v[146:149]
v_mfma_f32_16x16x32_bf16 v[150:153], v[38:41], v[114:117], v[150:153]
v_mfma_f32_16x16x32_bf16 v[154:157], v[38:41], v[118:121], v[154:157]
v_mfma_f32_16x16x32_bf16 v[158:161], v[38:41], v[122:125], v[158:161]
v_mfma_f32_16x16x32_bf16 v[138:141], v[42:45], v[98:101], v[138:141]
v_mfma_f32_16x16x32_bf16 v[142:145], v[42:45], v[102:105], v[142:145]
v_mfma_f32_16x16x32_bf16 v[146:149], v[42:45], v[106:109], v[146:149]
v_mfma_f32_16x16x32_bf16 v[150:153], v[42:45], v[110:113], v[150:153]
v_mfma_f32_16x16x32_bf16 v[154:157], v[42:45], v[114:117], v[154:157]
v_mfma_f32_16x16x32_bf16 v[158:161], v[42:45], v[118:121], v[158:161]
v_mfma_f32_16x16x32_bf16 v[142:145], v[46:49], v[98:101], v[142:145]
v_mfma_f32_16x16x32_bf16 v[146:149], v[46:49], v[102:105], v[146:149]
v_mfma_f32_16x16x32_bf16 v[150:153], v[46:49], v[106:109], v[150:153]
v_mfma_f32_16x16x32_bf16 v[154:157], v[46:49], v[110:113], v[154:157]
v_mfma_f32_16x16x32_bf16 v[158:161], v[46:49], v[114:117], v[158:161]
v_mfma_f32_16x16x32_bf16 v[146:149], v[50:53], v[98:101], v[146:149]
v_mfma_f32_16x16x32_bf16 v[150:153], v[50:53], v[102:105], v[150:153]
v_mfma_f32_16x16x32_bf16 v[154:157], v[50:53], v[106:109], v[154:157]
v_mfma_f32_16x16x32_bf16 v[158:161], v[50:53], v[110:113], v[158:161]
v_mfma_f32_16x16x32_bf16 v[150:153], v[54:57], v[98:101], v[150:153]
v_mfma_f32_16x16x32_bf16 v[154:157], v[54:57], v[102:105], v[154:157]
v_mfma_f32_16x16x32_bf16 v[158:161], v[54:57], v[106:109], v[158:161]
v_mfma_f32_16x16x32_bf16 v[154:157], v[58:61], v[98:101], v[154:157]
v_mfma_f32_16x16x32_bf16 v[158:161], v[58:61], v[102:105], v[158:161]
v_mfma_f32_16x16x32_bf16 v[158:161], v[62:65], v[98:101], v[158:161]
s_nop 7
v_cvt_pk_bf16_f32 v162, v130, v131
v_cvt_pk_bf16_f32 v163, v132, v133
ds_write_b64 v254, v[162:163] offset:448
v_cvt_pk_bf16_f32 v164, v134, v135
v_cvt_pk_bf16_f32 v165, v136, v137
ds_write_b64 v254, v[164:165] offset:960
v_cvt_pk_bf16_f32 v162, v138, v139
v_cvt_pk_bf16_f32 v163, v140, v141
ds_write_b64 v254, v[162:163] offset:1472
v_cvt_pk_bf16_f32 v164, v142, v143
v_cvt_pk_bf16_f32 v165, v144, v145
ds_write_b64 v254, v[164:165] offset:1984
v_cvt_pk_bf16_f32 v162, v146, v147
v_cvt_pk_bf16_f32 v163, v148, v149
ds_write_b64 v254, v[162:163] offset:2496
v_cvt_pk_bf16_f32 v164, v150, v151
v_cvt_pk_bf16_f32 v165, v152, v153
ds_write_b64 v254, v[164:165] offset:3008
v_cvt_pk_bf16_f32 v162, v154, v155
v_cvt_pk_bf16_f32 v163, v156, v157
ds_write_b64 v254, v[162:163] offset:3520
v_cvt_pk_bf16_f32 v164, v158, v159
v_cvt_pk_bf16_f32 v165, v160, v161
ds_write_b64 v254, v[164:165] offset:4032
v_add_u32 v252, 74240, v252
v_add_u32 v254, 74240, v254
s_waitcnt lgkmcnt(4)
s_add_u32 s61, s61, 1
s_cmp_lt_u32 s61, 2
s_cbranch_scc1 cvl_136
s_waitcnt vmcnt(0)
s_add_u32 s18, s33, 62
s_and_b32 s33, s13, 3
s_and_b32 s51, s14, 7
s_add_u32 s44, s15, s14
s_and_b32 s44, s44, 7
s_lshl_b32 s20, s33, 3
s_add_u32 s44, s44, s20
s_lshr_b32 s49, s15, 2
s_load_dwordx2 s[8:9], s[0:1], 88
s_mov_b32 s10, 8388608
s_mov_b32 s11, 0x20000
s_waitcnt lgkmcnt(0)
s_lshl_b32 s22, s44, 18
s_lshl_b32 s21, s51, 8
s_add_u32 s22, s22, s21
v_bfe_u32 v2, v0, 4, 2
v_lshlrev_b32 v1, 11, v2
v_bfe_u32 v2, v0, 0, 4
v_lshl_add_u32 v1, v2, 4, v1
v_add_u32 v1, s22, v1
s_mov_b32 s20, 0
buffer_load_dwordx4 v[2:5], v1, s[8:11], s20 offen
s_mov_b32 s21, 8192
buffer_load_dwordx4 v[6:9], v1, s[8:11], s21 offen
s_mov_b32 s20, 16384
buffer_load_dwordx4 v[10:13], v1, s[8:11], s20 offen
s_mov_b32 s21, 24576
buffer_load_dwordx4 v[14:17], v1, s[8:11], s21 offen
s_mov_b32 s20, 32768
buffer_load_dwordx4 v[18:21], v1, s[8:11], s20 offen
s_mov_b32 s21, 40960
buffer_load_dwordx4 v[22:25], v1, s[8:11], s21 offen
s_mov_b32 s20, 49152
buffer_load_dwordx4 v[26:29], v1, s[8:11], s20 offen
s_mov_b32 s21, 57344
buffer_load_dwordx4 v[30:33], v1, s[8:11], s21 offen
s_mov_b32 s20, 65536
buffer_load_dwordx4 v[34:37], v1, s[8:11], s20 offen
s_mov_b32 s21, 73728
buffer_load_dwordx4 v[38:41], v1, s[8:11], s21 offen
s_mov_b32 s20, 81920
buffer_load_dwordx4 v[42:45], v1, s[8:11], s20 offen
s_mov_b32 s21, 90112
buffer_load_dwordx4 v[46:49], v1, s[8:11], s21 offen
s_mov_b32 s20, 98304
buffer_load_dwordx4 v[50:53], v1, s[8:11], s20 offen
s_mov_b32 s21, 106496
buffer_load_dwordx4 v[54:57], v1, s[8:11], s21 offen
s_mov_b32 s20, 114688
buffer_load_dwordx4 v[58:61], v1, s[8:11], s20 offen
s_mov_b32 s21, 122880
buffer_load_dwordx4 v[62:65], v1, s[8:11], s21 offen
s_mov_b32 s20, 131072
buffer_load_dwordx4 v[66:69], v1, s[8:11], s20 offen
s_mov_b32 s21, 139264
buffer_load_dwordx4 v[70:73], v1, s[8:11], s21 offen
s_mov_b32 s20, 147456
buffer_load_dwordx4 v[74:77], v1, s[8:11], s20 offen
s_mov_b32 s21, 155648
buffer_load_dwordx4 v[78:81], v1, s[8:11], s21 offen
s_mov_b32 s20, 163840
buffer_load_dwordx4 v[82:85], v1, s[8:11], s20 offen
s_mov_b32 s21, 172032
buffer_load_dwordx4 v[86:89], v1, s[8:11], s21 offen
s_mov_b32 s20, 180224
buffer_load_dwordx4 v[90:93], v1, s[8:11], s20 offen
s_mov_b32 s21, 188416
buffer_load_dwordx4 v[94:97], v1, s[8:11], s21 offen
s_mov_b32 s20, 196608
buffer_load_dwordx4 v[98:101], v1, s[8:11], s20 offen
s_mov_b32 s21, 204800
buffer_load_dwordx4 v[102:105], v1, s[8:11], s21 offen
s_mov_b32 s20, 212992
buffer_load_dwordx4 v[106:109], v1, s[8:11], s20 offen
s_mov_b32 s21, 221184
buffer_load_dwordx4 v[110:113], v1, s[8:11], s21 offen
s_mov_b32 s20, 229376
buffer_load_dwordx4 v[114:117], v1, s[8:11], s20 offen
s_mov_b32 s21, 237568
buffer_load_dwordx4 v[118:121], v1, s[8:11], s21 offen
s_mov_b32 s20, 245760
buffer_load_dwordx4 v[122:125], v1, s[8:11], s20 offen
s_mov_b32 s21, 253952
buffer_load_dwordx4 v[126:129], v1, s[8:11], s21 offen
s_load_dwordx2 s[56:57], s[0:1], 104
s_mov_b32 s58, 8388608
s_mov_b32 s59, 0x20000
s_waitcnt lgkmcnt(0)
s_lshl_b32 s20, s15, 20
s_lshl_b32 s21, s32, 5
s_add_u32 s20, s20, s21
v_bfe_u32 v250, v0, 1, 5
v_lshlrev_b32 v248, 15, v250
v_bfe_u32 v250, v0, 0, 1
v_lshl_add_u32 v248, v250, 4, v248
v_add_u32 v248, s20, v248
v_add_u32 v250, 64960, v249
s_waitcnt lgkmcnt(0)
s_barrier
ds_read_b128 v[130:133], v249 offset:0
ds_read_b128 v[146:149], v249 offset:4640
ds_read_b128 v[134:137], v249 offset:9280
ds_read_b128 v[150:153], v249 offset:13920
ds_read_b128 v[138:141], v249 offset:18560
ds_read_b128 v[154:157], v249 offset:23200
ds_read_b128 v[142:145], v249 offset:27840
ds_read_b128 v[158:161], v249 offset:32480
s_waitcnt lgkmcnt(0)
v_lshlrev_b32 v178, 16, v240
v_lshlrev_b32 v162, 16, v130
v_and_b32 v179, s62, v149
v_lshlrev_b32 v180, 16, v208
v_fmac_f32 v162, v179, v178
v_mul_f32 v162, v162, v180
v_lshlrev_b32 v163, 16, v132
v_lshlrev_b32 v179, 16, v149
v_lshlrev_b32 v180, 16, v212
v_fmac_f32 v163, v179, v178
v_mul_f32 v163, v163, v180
v_and_b32 v164, s62, v130
v_and_b32 v179, s62, v148
v_lshlrev_b32 v180, 16, v216
v_fmac_f32 v164, v179, v178
v_mul_f32 v164, v164, v180
v_and_b32 v165, s62, v132
v_lshlrev_b32 v179, 16, v148
v_lshlrev_b32 v180, 16, v220
v_fmac_f32 v165, v179, v178
v_mul_f32 v165, v165, v180
v_lshlrev_b32 v166, 16, v131
v_and_b32 v179, s62, v147
v_lshlrev_b32 v180, 16, v224
v_fmac_f32 v166, v179, v178
v_mul_f32 v166, v166, v180
v_lshlrev_b32 v167, 16, v133
v_lshlrev_b32 v179, 16, v147
v_lshlrev_b32 v180, 16, v228
v_fmac_f32 v167, v179, v178
v_mul_f32 v167, v167, v180
v_and_b32 v168, s62, v131
v_and_b32 v179, s62, v146
v_lshlrev_b32 v180, 16, v232
v_fmac_f32 v168, v179, v178
v_mul_f32 v168, v168, v180
v_and_b32 v169, s62, v133
v_lshlrev_b32 v179, 16, v146
v_lshlrev_b32 v180, 16, v236
v_fmac_f32 v169, v179, v178
v_mul_f32 v169, v169, v180
v_and_b32 v178, s62, v240
v_lshlrev_b32 v170, 16, v134
v_and_b32 v179, s62, v153
v_and_b32 v180, s62, v208
v_fmac_f32 v170, v179, v178
v_mul_f32 v170, v170, v180
v_lshlrev_b32 v171, 16, v136
v_lshlrev_b32 v179, 16, v153
v_and_b32 v180, s62, v212
v_fmac_f32 v171, v179, v178
v_mul_f32 v171, v171, v180
v_and_b32 v172, s62, v134
v_and_b32 v179, s62, v152
v_and_b32 v180, s62, v216
v_fmac_f32 v172, v179, v178
v_mul_f32 v172, v172, v180
v_and_b32 v173, s62, v136
v_lshlrev_b32 v179, 16, v152
v_and_b32 v180, s62, v220
v_fmac_f32 v173, v179, v178
v_mul_f32 v173, v173, v180
v_lshlrev_b32 v174, 16, v135
v_and_b32 v179, s62, v151
v_and_b32 v180, s62, v224
v_fmac_f32 v174, v179, v178
v_mul_f32 v174, v174, v180
v_lshlrev_b32 v175, 16, v137
v_lshlrev_b32 v179, 16, v151
v_and_b32 v180, s62, v228
v_fmac_f32 v175, v179, v178
v_mul_f32 v175, v175, v180
v_and_b32 v176, s62, v135
v_and_b32 v179, s62, v150
v_and_b32 v180, s62, v232
v_fmac_f32 v176, v179, v178
v_mul_f32 v176, v176, v180
v_and_b32 v177, s62, v137
v_lshlrev_b32 v179, 16, v150
v_and_b32 v180, s62, v236
v_fmac_f32 v177, v179, v178
v_mul_f32 v177, v177, v180
v_cvt_pk_bf16_f32 v208, v162, v170
v_cvt_pk_bf16_f32 v212, v163, v171
v_cvt_pk_bf16_f32 v216, v164, v172
v_cvt_pk_bf16_f32 v220, v165, v173
v_cvt_pk_bf16_f32 v224, v166, v174
v_cvt_pk_bf16_f32 v228, v167, v175
v_cvt_pk_bf16_f32 v232, v168, v176
v_cvt_pk_bf16_f32 v236, v169, v177
v_lshlrev_b32 v178, 16, v241
v_lshlrev_b32 v162, 16, v138
v_and_b32 v179, s62, v157
v_lshlrev_b32 v180, 16, v209
v_fmac_f32 v162, v179, v178
v_mul_f32 v162, v162, v180
v_lshlrev_b32 v163, 16, v140
v_lshlrev_b32 v179, 16, v157
v_lshlrev_b32 v180, 16, v213
v_fmac_f32 v163, v179, v178
v_mul_f32 v163, v163, v180
v_and_b32 v164, s62, v138
v_and_b32 v179, s62, v156
v_lshlrev_b32 v180, 16, v217
v_fmac_f32 v164, v179, v178
v_mul_f32 v164, v164, v180
v_and_b32 v165, s62, v140
v_lshlrev_b32 v179, 16, v156
v_lshlrev_b32 v180, 16, v221
v_fmac_f32 v165, v179, v178
v_mul_f32 v165, v165, v180
v_lshlrev_b32 v166, 16, v139
v_and_b32 v179, s62, v155
v_lshlrev_b32 v180, 16, v225
v_fmac_f32 v166, v179, v178
v_mul_f32 v166, v166, v180
v_lshlrev_b32 v167, 16, v141
v_lshlrev_b32 v179, 16, v155
v_lshlrev_b32 v180, 16, v229
v_fmac_f32 v167, v179, v178
v_mul_f32 v167, v167, v180
v_and_b32 v168, s62, v139
v_and_b32 v179, s62, v154
v_lshlrev_b32 v180, 16, v233
v_fmac_f32 v168, v179, v178
v_mul_f32 v168, v168, v180
v_and_b32 v169, s62, v141
v_lshlrev_b32 v179, 16, v154
v_lshlrev_b32 v180, 16, v237
v_fmac_f32 v169, v179, v178
v_mul_f32 v169, v169, v180
v_and_b32 v178, s62, v241
v_lshlrev_b32 v170, 16, v142
v_and_b32 v179, s62, v161
v_and_b32 v180, s62, v209
v_fmac_f32 v170, v179, v178
v_mul_f32 v170, v170, v180
v_lshlrev_b32 v171, 16, v144
v_lshlrev_b32 v179, 16, v161
v_and_b32 v180, s62, v213
v_fmac_f32 v171, v179, v178
v_mul_f32 v171, v171, v180
v_and_b32 v172, s62, v142
v_and_b32 v179, s62, v160
v_and_b32 v180, s62, v217
v_fmac_f32 v172, v179, v178
v_mul_f32 v172, v172, v180
v_and_b32 v173, s62, v144
v_lshlrev_b32 v179, 16, v160
v_and_b32 v180, s62, v221
v_fmac_f32 v173, v179, v178
v_mul_f32 v173, v173, v180
v_lshlrev_b32 v174, 16, v143
v_and_b32 v179, s62, v159
v_and_b32 v180, s62, v225
v_fmac_f32 v174, v179, v178
v_mul_f32 v174, v174, v180
v_lshlrev_b32 v175, 16, v145
v_lshlrev_b32 v179, 16, v159
v_and_b32 v180, s62, v229
v_fmac_f32 v175, v179, v178
v_mul_f32 v175, v175, v180
v_and_b32 v176, s62, v143
v_and_b32 v179, s62, v158
v_and_b32 v180, s62, v233
v_fmac_f32 v176, v179, v178
v_mul_f32 v176, v176, v180
v_and_b32 v177, s62, v145
v_lshlrev_b32 v179, 16, v158
v_and_b32 v180, s62, v237
v_fmac_f32 v177, v179, v178
v_mul_f32 v177, v177, v180
v_cvt_pk_bf16_f32 v209, v162, v170
v_cvt_pk_bf16_f32 v213, v163, v171
v_cvt_pk_bf16_f32 v217, v164, v172
v_cvt_pk_bf16_f32 v221, v165, v173
v_cvt_pk_bf16_f32 v225, v166, v174
v_cvt_pk_bf16_f32 v229, v167, v175
v_cvt_pk_bf16_f32 v233, v168, v176
v_cvt_pk_bf16_f32 v237, v169, v177
ds_read_b128 v[130:133], v249 offset:37120
ds_read_b128 v[146:149], v249 offset:41760
ds_read_b128 v[134:137], v249 offset:46400
ds_read_b128 v[150:153], v249 offset:51040
ds_read_b128 v[138:141], v249 offset:55680
ds_read_b128 v[154:157], v249 offset:60320
ds_read_b128 v[142:145], v250 offset:0
ds_read_b128 v[158:161], v250 offset:4640
s_waitcnt lgkmcnt(0)
v_lshlrev_b32 v178, 16, v242
v_lshlrev_b32 v162, 16, v130
v_and_b32 v179, s62, v149
v_lshlrev_b32 v180, 16, v210
v_fmac_f32 v162, v179, v178
v_mul_f32 v162, v162, v180
v_lshlrev_b32 v163, 16, v132
v_lshlrev_b32 v179, 16, v149
v_lshlrev_b32 v180, 16, v214
v_fmac_f32 v163, v179, v178
v_mul_f32 v163, v163, v180
v_and_b32 v164, s62, v130
v_and_b32 v179, s62, v148
v_lshlrev_b32 v180, 16, v218
v_fmac_f32 v164, v179, v178
v_mul_f32 v164, v164, v180
v_and_b32 v165, s62, v132
v_lshlrev_b32 v179, 16, v148
v_lshlrev_b32 v180, 16, v222
v_fmac_f32 v165, v179, v178
v_mul_f32 v165, v165, v180
v_lshlrev_b32 v166, 16, v131
v_and_b32 v179, s62, v147
v_lshlrev_b32 v180, 16, v226
v_fmac_f32 v166, v179, v178
v_mul_f32 v166, v166, v180
v_lshlrev_b32 v167, 16, v133
v_lshlrev_b32 v179, 16, v147
v_lshlrev_b32 v180, 16, v230
v_fmac_f32 v167, v179, v178
v_mul_f32 v167, v167, v180
v_and_b32 v168, s62, v131
v_and_b32 v179, s62, v146
v_lshlrev_b32 v180, 16, v234
v_fmac_f32 v168, v179, v178
v_mul_f32 v168, v168, v180
v_and_b32 v169, s62, v133
v_lshlrev_b32 v179, 16, v146
v_lshlrev_b32 v180, 16, v238
v_fmac_f32 v169, v179, v178
v_mul_f32 v169, v169, v180
v_and_b32 v178, s62, v242
v_lshlrev_b32 v170, 16, v134
v_and_b32 v179, s62, v153
v_and_b32 v180, s62, v210
v_fmac_f32 v170, v179, v178
v_mul_f32 v170, v170, v180
v_lshlrev_b32 v171, 16, v136
v_lshlrev_b32 v179, 16, v153
v_and_b32 v180, s62, v214
v_fmac_f32 v171, v179, v178
v_mul_f32 v171, v171, v180
v_and_b32 v172, s62, v134
v_and_b32 v179, s62, v152
v_and_b32 v180, s62, v218
v_fmac_f32 v172, v179, v178
v_mul_f32 v172, v172, v180
v_and_b32 v173, s62, v136
v_lshlrev_b32 v179, 16, v152
v_and_b32 v180, s62, v222
v_fmac_f32 v173, v179, v178
v_mul_f32 v173, v173, v180
v_lshlrev_b32 v174, 16, v135
v_and_b32 v179, s62, v151
v_and_b32 v180, s62, v226
v_fmac_f32 v174, v179, v178
v_mul_f32 v174, v174, v180
v_lshlrev_b32 v175, 16, v137
v_lshlrev_b32 v179, 16, v151
v_and_b32 v180, s62, v230
v_fmac_f32 v175, v179, v178
v_mul_f32 v175, v175, v180
v_and_b32 v176, s62, v135
v_and_b32 v179, s62, v150
v_and_b32 v180, s62, v234
v_fmac_f32 v176, v179, v178
v_mul_f32 v176, v176, v180
v_and_b32 v177, s62, v137
v_lshlrev_b32 v179, 16, v150
v_and_b32 v180, s62, v238
v_fmac_f32 v177, v179, v178
v_mul_f32 v177, v177, v180
v_cvt_pk_bf16_f32 v210, v162, v170
v_cvt_pk_bf16_f32 v214, v163, v171
v_cvt_pk_bf16_f32 v218, v164, v172
v_cvt_pk_bf16_f32 v222, v165, v173
v_cvt_pk_bf16_f32 v226, v166, v174
v_cvt_pk_bf16_f32 v230, v167, v175
v_cvt_pk_bf16_f32 v234, v168, v176
v_cvt_pk_bf16_f32 v238, v169, v177
v_lshlrev_b32 v178, 16, v243
v_lshlrev_b32 v162, 16, v138
v_and_b32 v179, s62, v157
v_lshlrev_b32 v180, 16, v211
v_fmac_f32 v162, v179, v178
v_mul_f32 v162, v162, v180
v_lshlrev_b32 v163, 16, v140
v_lshlrev_b32 v179, 16, v157
v_lshlrev_b32 v180, 16, v215
v_fmac_f32 v163, v179, v178
v_mul_f32 v163, v163, v180
v_and_b32 v164, s62, v138
v_and_b32 v179, s62, v156
v_lshlrev_b32 v180, 16, v219
v_fmac_f32 v164, v179, v178
v_mul_f32 v164, v164, v180
v_and_b32 v165, s62, v140
v_lshlrev_b32 v179, 16, v156
v_lshlrev_b32 v180, 16, v223
v_fmac_f32 v165, v179, v178
v_mul_f32 v165, v165, v180
v_lshlrev_b32 v166, 16, v139
v_and_b32 v179, s62, v155
v_lshlrev_b32 v180, 16, v227
v_fmac_f32 v166, v179, v178
v_mul_f32 v166, v166, v180
v_lshlrev_b32 v167, 16, v141
v_lshlrev_b32 v179, 16, v155
v_lshlrev_b32 v180, 16, v231
v_fmac_f32 v167, v179, v178
v_mul_f32 v167, v167, v180
v_and_b32 v168, s62, v139
v_and_b32 v179, s62, v154
v_lshlrev_b32 v180, 16, v235
v_fmac_f32 v168, v179, v178
v_mul_f32 v168, v168, v180
v_and_b32 v169, s62, v141
v_lshlrev_b32 v179, 16, v154
v_lshlrev_b32 v180, 16, v239
v_fmac_f32 v169, v179, v178
v_mul_f32 v169, v169, v180
v_and_b32 v178, s62, v243
v_lshlrev_b32 v170, 16, v142
v_and_b32 v179, s62, v161
v_and_b32 v180, s62, v211
v_fmac_f32 v170, v179, v178
v_mul_f32 v170, v170, v180
v_lshlrev_b32 v171, 16, v144
v_lshlrev_b32 v179, 16, v161
v_and_b32 v180, s62, v215
v_fmac_f32 v171, v179, v178
v_mul_f32 v171, v171, v180
v_and_b32 v172, s62, v142
v_and_b32 v179, s62, v160
v_and_b32 v180, s62, v219
v_fmac_f32 v172, v179, v178
v_mul_f32 v172, v172, v180
v_and_b32 v173, s62, v144
v_lshlrev_b32 v179, 16, v160
v_and_b32 v180, s62, v223
v_fmac_f32 v173, v179, v178
v_mul_f32 v173, v173, v180
v_lshlrev_b32 v174, 16, v143
v_and_b32 v179, s62, v159
v_and_b32 v180, s62, v227
v_fmac_f32 v174, v179, v178
v_mul_f32 v174, v174, v180
v_lshlrev_b32 v175, 16, v145
v_lshlrev_b32 v179, 16, v159
v_and_b32 v180, s62, v231
v_fmac_f32 v175, v179, v178
v_mul_f32 v175, v175, v180
v_and_b32 v176, s62, v143
v_and_b32 v179, s62, v158
v_and_b32 v180, s62, v235
v_fmac_f32 v176, v179, v178
v_mul_f32 v176, v176, v180
v_and_b32 v177, s62, v145
v_lshlrev_b32 v179, 16, v158
v_and_b32 v180, s62, v239
v_fmac_f32 v177, v179, v178
v_mul_f32 v177, v177, v180
v_cvt_pk_bf16_f32 v211, v162, v170
v_cvt_pk_bf16_f32 v215, v163, v171
v_cvt_pk_bf16_f32 v219, v164, v172
v_cvt_pk_bf16_f32 v223, v165, v173
v_cvt_pk_bf16_f32 v227, v166, v174
v_cvt_pk_bf16_f32 v231, v167, v175
v_cvt_pk_bf16_f32 v235, v168, v176
v_cvt_pk_bf16_f32 v239, v169, v177
s_mov_b32 s20, 0
buffer_store_dwordx4 v[208:211], v248, s[56:59], s20 offen nt
s_mov_b32 s21, 4096
buffer_store_dwordx4 v[212:215], v248, s[56:59], s21 offen nt
s_mov_b32 s20, 8192
buffer_store_dwordx4 v[216:219], v248, s[56:59], s20 offen nt
s_mov_b32 s21, 12288
buffer_store_dwordx4 v[220:223], v248, s[56:59], s21 offen nt
s_mov_b32 s20, 16384
buffer_store_dwordx4 v[224:227], v248, s[56:59], s20 offen nt
s_mov_b32 s21, 20480
buffer_store_dwordx4 v[228:231], v248, s[56:59], s21 offen nt
s_mov_b32 s20, 24576
buffer_store_dwordx4 v[232:235], v248, s[56:59], s20 offen nt
s_mov_b32 s21, 28672
buffer_store_dwordx4 v[236:239], v248, s[56:59], s21 offen nt
s_waitcnt vmcnt(0)
s_branch L_help
L_help:
s_mov_b64 exec, -1
s_barrier
s_mov_b32 s32, s51
s_branch L_oent
L_chain:
s_lshr_b32 s34, s14, 3
s_lshl_b32 s20, s13, 2
s_add_u32 s34, s34, s20
s_and_b32 s35, s14, 7
s_lshr_b32 s36, s35, 2
s_lshl_b32 s20, s34, 1
s_add_u32 s36, s36, s20
s_and_b32 s37, s35, 3
s_mov_b32 s18, 0
s_mov_b32 s19, 0
s_mov_b32 s43, 0
s_lshr_b32 s21, s12, 1
s_lshl_b32 s22, s34, 1
s_add_u32 s22, s22, s21
s_lshl_b32 s44, s22, 20
s_add_u32 s44, s44, 4202496
s_and_b32 s20, s22, 1
s_lshl_b32 s20, s20, 14
s_xor_b32 s44, s44, s20
s_and_b32 s20, s22, 2
s_lshl_b32 s20, s20, 12
s_xor_b32 s44, s44, s20
s_and_b32 s21, s12, 1
s_mul_i32 s21, s21, 33554432
s_add_u32 s44, s44, s21
s_lshl_b32 s45, s34, 9
s_lshl_b32 s20, s12, 7
s_add_u32 s45, s45, s20
s_add_u32 s45, s45, 3932160
s_cmp_ge_u32 s15, 4
s_cbranch_scc1 chainA_144
s_bfe_u32 s51, s35, 0x10001
s_lshl_b32 s20, s51, 3
s_add_u32 s10, s0, s20
s_addc_u32 s11, s1, 0
s_load_dwordx2 s[8:9], s[10:11], 64
s_and_b32 s22, s35, 1
s_lshl_b32 s20, s12, 21
s_lshl_b32 s21, s36, 8
s_add_u32 s20, s20, s21
s_lshl_b32 s21, s22, 7
s_add_u32 s20, s20, s21
v_bfe_u32 v248, v0, 3, 3
v_lshlrev_b32 v242, 13, v248
v_bfe_u32 v248, v0, 0, 3
v_lshl_add_u32 v242, v248, 4, v242
v_add_u32 v242, s20, v242
s_load_dwordx2 s[24:25], s[0:1], 80
s_mov_b32 s26, 8388608
s_mov_b32 s27, 0x20000
s_waitcnt lgkmcnt(0)
s_mov_b32 s10, 8388608
s_mov_b32 s11, 0x20000
s_lshl_b32 s20, s12, 21
s_lshl_b32 s21, s36, 8
s_add_u32 s20, s20, s21
s_lshl_b32 s21, s37, 6
s_add_u32 s20, s20, s21
s_xor_b32 s20, s20, 256
v_bfe_u32 v248, v0, 2, 4
v_lshlrev_b32 v243, 13, v248
v_bfe_u32 v248, v0, 0, 2
v_lshl_add_u32 v243, v248, 4, v243
v_add_u32 v243, s20, v243
s_mov_b32 s20, 0
buffer_load_dwordx4 v[2:5], v242, s[8:11], s20 offen nt
buffer_load_dwordx4 v[130:133], v243, s[24:27], s20 offen
s_mov_b32 s21, 65536
buffer_load_dwordx4 v[6:9], v242, s[8:11], s21 offen nt
s_mov_b32 s20, 131072
buffer_load_dwordx4 v[34:37], v242, s[8:11], s20 offen nt
buffer_load_dwordx4 v[134:137], v243, s[24:27], s20 offen
s_mov_b32 s21, 196608
buffer_load_dwordx4 v[38:41], v242, s[8:11], s21 offen nt
s_mov_b32 s20, 262144
buffer_load_dwordx4 v[66:69], v242, s[8:11], s20 offen nt
buffer_load_dwordx4 v[162:165], v243, s[24:27], s20 offen
s_mov_b32 s21, 327680
buffer_load_dwordx4 v[70:73], v242, s[8:11], s21 offen nt
s_mov_b32 s20, 393216
buffer_load_dwordx4 v[98:101], v242, s[8:11], s20 offen nt
buffer_load_dwordx4 v[166:169], v243, s[24:27], s20 offen
s_mov_b32 s21, 458752
buffer_load_dwordx4 v[102:105], v242, s[8:11], s21 offen nt
s_mov_b32 s20, 524288
buffer_load_dwordx4 v[10:13], v242, s[8:11], s20 offen nt
buffer_load_dwordx4 v[138:141], v243, s[24:27], s20 offen
s_mov_b32 s21, 589824
buffer_load_dwordx4 v[14:17], v242, s[8:11], s21 offen nt
s_mov_b32 s20, 655360
buffer_load_dwordx4 v[42:45], v242, s[8:11], s20 offen nt
buffer_load_dwordx4 v[142:145], v243, s[24:27], s20 offen
s_mov_b32 s21, 720896
buffer_load_dwordx4 v[46:49], v242, s[8:11], s21 offen nt
s_mov_b32 s20, 786432
buffer_load_dwordx4 v[74:77], v242, s[8:11], s20 offen nt
buffer_load_dwordx4 v[170:173], v243, s[24:27], s20 offen
s_mov_b32 s21, 851968
buffer_load_dwordx4 v[78:81], v242, s[8:11], s21 offen nt
s_mov_b32 s20, 917504
buffer_load_dwordx4 v[106:109], v242, s[8:11], s20 offen nt
buffer_load_dwordx4 v[174:177], v243, s[24:27], s20 offen
s_mov_b32 s21, 983040
buffer_load_dwordx4 v[110:113], v242, s[8:11], s21 offen nt
s_mov_b32 s20, 1048576
buffer_load_dwordx4 v[18:21], v242, s[8:11], s20 offen nt
buffer_load_dwordx4 v[146:149], v243, s[24:27], s20 offen
s_mov_b32 s21, 1114112
buffer_load_dwordx4 v[22:25], v242, s[8:11], s21 offen nt
s_mov_b32 s20, 1179648
buffer_load_dwordx4 v[50:53], v242, s[8:11], s20 offen nt
buffer_load_dwordx4 v[150:153], v243, s[24:27], s20 offen
s_mov_b32 s21, 1245184
buffer_load_dwordx4 v[54:57], v242, s[8:11], s21 offen nt
s_mov_b32 s20, 1310720
buffer_load_dwordx4 v[82:85], v242, s[8:11], s20 offen nt
buffer_load_dwordx4 v[178:181], v243, s[24:27], s20 offen
s_mov_b32 s21, 1376256
buffer_load_dwordx4 v[86:89], v242, s[8:11], s21 offen nt
s_mov_b32 s20, 1441792
buffer_load_dwordx4 v[114:117], v242, s[8:11], s20 offen nt
buffer_load_dwordx4 v[182:185], v243, s[24:27], s20 offen
s_mov_b32 s21, 1507328
buffer_load_dwordx4 v[118:121], v242, s[8:11], s21 offen nt
s_mov_b32 s20, 1572864
buffer_load_dwordx4 v[26:29], v242, s[8:11], s20 offen nt
buffer_load_dwordx4 v[154:157], v243, s[24:27], s20 offen
s_mov_b32 s21, 1638400
buffer_load_dwordx4 v[30:33], v242, s[8:11], s21 offen nt
s_mov_b32 s20, 1703936
buffer_load_dwordx4 v[58:61], v242, s[8:11], s20 offen nt
buffer_load_dwordx4 v[158:161], v243, s[24:27], s20 offen
s_mov_b32 s21, 1769472
buffer_load_dwordx4 v[62:65], v242, s[8:11], s21 offen nt
s_mov_b32 s20, 1835008
buffer_load_dwordx4 v[90:93], v242, s[8:11], s20 offen nt
buffer_load_dwordx4 v[186:189], v243, s[24:27], s20 offen
s_mov_b32 s21, 1900544
buffer_load_dwordx4 v[94:97], v242, s[8:11], s21 offen nt
s_mov_b32 s20, 1966080
buffer_load_dwordx4 v[122:125], v242, s[8:11], s20 offen nt
buffer_load_dwordx4 v[190:193], v243, s[24:27], s20 offen
s_mov_b32 s21, 2031616
buffer_load_dwordx4 v[126:129], v242, s[8:11], s21 offen nt
v_mov_b32 v240, 0x4444
v_and_b32 v248, 8, v0
v_cmp_ne_u32 vcc, 0, v248
v_mov_b32 v248, 0xeeee
s_nop 0
v_cndmask_b32 v240, v240, v248, vcc
v_and_b32 v248, 15, v0
v_mov_b32 v234, 0
v_mov_b32 v247, 0x3f80
v_cmp_eq_u32 vcc, 0, v248
s_nop 1
v_cndmask_b32 v234, v234, v247, vcc
v_mov_b32 v247, 0x3f800000
v_cmp_eq_u32 vcc, 1, v248
s_nop 1
v_cndmask_b32 v234, v234, v247, vcc
v_mov_b32 v235, 0
v_mov_b32 v247, 0x3f80
v_cmp_eq_u32 vcc, 2, v248
s_nop 1
v_cndmask_b32 v235, v235, v247, vcc
v_mov_b32 v247, 0x3f800000
v_cmp_eq_u32 vcc, 3, v248
s_nop 1
v_cndmask_b32 v235, v235, v247, vcc
v_mov_b32 v236, 0
v_mov_b32 v247, 0x3f80
v_cmp_eq_u32 vcc, 4, v248
s_nop 1
v_cndmask_b32 v236, v236, v247, vcc
v_mov_b32 v247, 0x3f800000
v_cmp_eq_u32 vcc, 5, v248
s_nop 1
v_cndmask_b32 v236, v236, v247, vcc
v_mov_b32 v237, 0
v_mov_b32 v247, 0x3f80
v_cmp_eq_u32 vcc, 6, v248
s_nop 1
v_cndmask_b32 v237, v237, v247, vcc
v_mov_b32 v247, 0x3f800000
v_cmp_eq_u32 vcc, 7, v248
s_nop 1
v_cndmask_b32 v237, v237, v247, vcc
s_lshl_b32 s47, s13, 14
s_lshl_b32 s20, s12, 12
s_add_u32 s47, s47, s20
s_add_u32 s47, s47, 2097152
v_lshlrev_b32 v241, 4, v0
s_lshr_b32 s21, s12, 1
s_and_b32 s22, s12, 1
s_lshl_b32 s20, s21, 10
s_lshl_b32 s23, s22, 8
s_add_u32 s20, s20, s23
v_bfe_u32 v248, v0, 4, 2
v_lshlrev_b32 v243, 11, v248
v_bfe_u32 v248, v0, 4, 2
v_lshl_add_u32 v243, v248, 10, v243
v_bfe_u32 v248, v0, 0, 4
v_lshl_add_u32 v243, v248, 4, v243
v_add_u32 v243, s20, v243
s_and_b32 s23, s35, 1
s_lshl_b32 s23, s23, 1
s_add_u32 s23, s23, s21
s_and_b32 s24, s36, 1
s_lshl_b32 s20, s36, 12
s_lshl_b32 s25, s23, 10
s_add_u32 s20, s20, s25
s_lshl_b32 s25, s51, 7
s_add_u32 s20, s20, s25
s_lshl_b32 s25, s22, 6
s_add_u32 s20, s20, s25
v_bfe_u32 v248, v0, 4, 2
v_lshlrev_b32 v244, 8, v248
v_bfe_u32 v248, v0, 0, 2
v_lshl_add_u32 v244, v248, 4, v244
v_bfe_u32 v248, v0, 2, 1
v_lshl_add_u32 v244, v248, 3, v244
v_add_u32 v244, s20, v244
v_and_b32 v248, 8, v0
v_cmp_ne_u32 vcc, 0, v248
v_mov_b32 v248, 2147483632
s_nop 0
v_cndmask_b32 v244, v244, v248, vcc
s_lshl_b32 s42, s34, 21
s_lshl_b32 s25, s24, 12
s_add_u32 s42, s42, s25
s_lshl_b32 s25, s23, 9
s_add_u32 s42, s42, s25
s_lshl_b32 s25, s22, 6
s_add_u32 s42, s42, s25
s_add_u32 s42, s42, 104857600
s_and_b32 s25, s34, 3
s_lshl_b32 s25, s25, 13
s_xor_b32 s42, s42, s25
v_bfe_u32 v248, v0, 4, 2
v_lshlrev_b32 v252, 7, v248
v_bfe_u32 v248, v0, 0, 2
v_lshl_add_u32 v252, v248, 4, v252
v_bfe_u32 v248, v0, 2, 1
v_lshl_add_u32 v252, v248, 3, v252
v_and_b32 v248, 8, v0
v_cmp_ne_u32 vcc, 0, v248
v_mov_b32 v248, 2147483632
s_nop 0
v_cndmask_b32 v252, v252, v248, vcc
s_lshl_b32 s52, s34, 21
s_lshl_b32 s25, s24, 12
s_add_u32 s52, s52, s25
s_lshl_b32 s25, s37, 9
s_add_u32 s52, s52, s25
s_lshl_b32 s25, s22, 8
s_add_u32 s52, s52, s25
s_add_u32 s52, s52, 104859648
s_and_b32 s25, s34, 3
s_lshl_b32 s25, s25, 13
s_xor_b32 s52, s52, s25
s_xor_b32 s52, s52, 0x1000
v_bfe_u32 v248, v0, 0, 4
v_lshlrev_b32 v246, 4, v248
v_bfe_u32 v248, v0, 4, 1
v_lshl_add_u32 v246, v248, 3, v246
v_and_b32 v248, 32, v0
v_cmp_ne_u32 vcc, 0, v248
v_mov_b32 v248, 2147483632
s_nop 0
v_cndmask_b32 v246, v246, v248, vcc
s_lshl_b32 s46, s36, 11
s_lshl_b32 s21, s37, 9
s_add_u32 s46, s46, s21
s_lshl_b32 s21, s22, 8
s_add_u32 s46, s46, s21
s_add_u32 s46, s46, 2883584
s_xor_b32 s46, s46, 0x800
v_mov_b32 v248, 2147483632
v_cmp_ne_u32 vcc, 0, v0
s_nop 1
v_cndmask_b32 v247, 0, v248, vcc
s_lshl_b32 s48, s36, 12
s_lshl_b32 s20, s37, 10
s_add_u32 s48, s48, s20
s_add_u32 s48, s48, 2359296
s_and_b32 s21, s12, 1
s_lshl_b32 s20, s35, 16
s_lshl_b32 s22, s21, 15
s_add_u32 s20, s20, s22
s_lshl_b32 s22, s34, 7
s_add_u32 s20, s20, s22
v_bfe_u32 v248, v0, 5, 1
v_lshlrev_b32 v245, 14, v248
v_bfe_u32 v248, v0, 3, 2
v_lshl_add_u32 v245, v248, 11, v245
v_bfe_u32 v248, v0, 0, 3
v_lshl_add_u32 v245, v248, 4, v245
v_add_u32 v245, s20, v245
s_cmp_lg_u32 s12, 1
s_cbranch_scc1 rs_145
s_lshl_b32 s20, s36, 11
s_lshl_b32 s22, s37, 9
s_add_u32 s20, s20, s22
s_add_u32 s20, s20, 2883584
s_lshl_b32 s21, s13, 14
s_lshl_b32 s22, s14, 9
s_add_u32 s21, s21, s22
s_add_u32 s21, s21, 2096640
v_add_u32 v245, s20, v241
v_add_u32 v248, s21, v241
v_cmp_gt_u32 vcc, 32, v0
s_nop 1
v_cndmask_b32 v245, v248, v245, vcc
rs_145:
s_lshl_b32 s49, s12, 13
s_add_u32 s49, s49, 16384
v_and_b32 v248, 7, v0
v_lshlrev_b32 v248, 5, v248
buffer_load_dwordx2 v[194:195], v248, s[28:31], 0 offen sc1
s_lshl_b32 s20, s12, 13
s_add_u32 s20, s20, 49152
v_add_u32 v242, s20, v241
v_bfe_u32 v248, v0, 5, 1
v_lshlrev_b32 v1, 11, v248
v_bfe_u32 v248, v0, 4, 1
v_lshl_add_u32 v1, v248, 9, v1
v_bfe_u32 v248, v0, 2, 1
v_lshl_add_u32 v1, v248, 7, v1
v_bfe_u32 v248, v0, 3, 1
v_lshl_add_u32 v1, v248, 10, v1
v_bfe_u32 v248, v0, 0, 2
v_lshl_add_u32 v1, v248, 4, v1
v_add_u32 v1, s20, v1
v_bfe_u32 v248, v0, 5, 1
v_lshlrev_b32 v238, 10, v248
v_bfe_u32 v248, v0, 4, 1
v_lshl_add_u32 v238, v248, 8, v238
v_bfe_u32 v248, v0, 2, 1
v_lshl_add_u32 v238, v248, 6, v238
v_bfe_u32 v248, v0, 3, 1
v_lshl_add_u32 v238, v248, 9, v238
v_bfe_u32 v248, v0, 0, 2
v_lshl_add_u32 v238, v248, 4, v238
v_add_u32 v238, s20, v238
s_waitcnt vmcnt(37)
ds_write_b128 v242, v[2:5] offset:0
ds_write_b128 v242, v[6:9] offset:1024
ds_write_b128 v242, v[34:37] offset:2048
ds_write_b128 v242, v[38:41] offset:3072
ds_write_b128 v242, v[66:69] offset:4096
ds_write_b128 v242, v[70:73] offset:5120
ds_write_b128 v242, v[98:101] offset:6144
ds_write_b128 v242, v[102:105] offset:7168
s_waitcnt lgkmcnt(4)
ds_read_b64_tr_b16 v[2:3], v1 offset:0
ds_read_b64_tr_b16 v[4:5], v1 offset:256
ds_read_b64_tr_b16 v[6:7], v1 offset:4096
ds_read_b64_tr_b16 v[8:9], v1 offset:4352
ds_read_b64_tr_b16 v[34:35], v1 offset:8
ds_read_b64_tr_b16 v[36:37], v1 offset:264
ds_read_b64_tr_b16 v[38:39], v1 offset:4104
ds_read_b64_tr_b16 v[40:41], v1 offset:4360
s_waitcnt lgkmcnt(4)
ds_read_b64_tr_b16 v[66:67], v1 offset:64
ds_read_b64_tr_b16 v[68:69], v1 offset:320
ds_read_b64_tr_b16 v[70:71], v1 offset:4160
ds_read_b64_tr_b16 v[72:73], v1 offset:4416
ds_read_b64_tr_b16 v[98:99], v1 offset:72
ds_read_b64_tr_b16 v[100:101], v1 offset:328
ds_read_b64_tr_b16 v[102:103], v1 offset:4168
ds_read_b64_tr_b16 v[104:105], v1 offset:4424
s_waitcnt lgkmcnt(2)
ds_write_b128 v242, v[130:133] offset:0
ds_write_b128 v242, v[134:137] offset:1024
ds_write_b128 v242, v[162:165] offset:2048
ds_write_b128 v242, v[166:169] offset:3072
ds_read_b64_tr_b16 v[130:131], v238 offset:0
ds_read_b64_tr_b16 v[132:133], v238 offset:128
ds_read_b64_tr_b16 v[134:135], v238 offset:2048
ds_read_b64_tr_b16 v[136:137], v238 offset:2176
ds_read_b64_tr_b16 v[162:163], v238 offset:8
ds_read_b64_tr_b16 v[164:165], v238 offset:136
ds_read_b64_tr_b16 v[166:167], v238 offset:2056
ds_read_b64_tr_b16 v[168:169], v238 offset:2184
s_waitcnt lgkmcnt(4)
s_waitcnt vmcnt(25)
ds_write_b128 v242, v[10:13] offset:0
ds_write_b128 v242, v[14:17] offset:1024
ds_write_b128 v242, v[42:45] offset:2048
ds_write_b128 v242, v[46:49] offset:3072
ds_write_b128 v242, v[74:77] offset:4096
ds_write_b128 v242, v[78:81] offset:5120
ds_write_b128 v242, v[106:109] offset:6144
ds_write_b128 v242, v[110:113] offset:7168
s_waitcnt lgkmcnt(4)
ds_read_b64_tr_b16 v[10:11], v1 offset:0
ds_read_b64_tr_b16 v[12:13], v1 offset:256
ds_read_b64_tr_b16 v[14:15], v1 offset:4096
ds_read_b64_tr_b16 v[16:17], v1 offset:4352
ds_read_b64_tr_b16 v[42:43], v1 offset:8
ds_read_b64_tr_b16 v[44:45], v1 offset:264
ds_read_b64_tr_b16 v[46:47], v1 offset:4104
ds_read_b64_tr_b16 v[48:49], v1 offset:4360
s_waitcnt lgkmcnt(4)
ds_read_b64_tr_b16 v[74:75], v1 offset:64
ds_read_b64_tr_b16 v[76:77], v1 offset:320
ds_read_b64_tr_b16 v[78:79], v1 offset:4160
ds_read_b64_tr_b16 v[80:81], v1 offset:4416
ds_read_b64_tr_b16 v[106:107], v1 offset:72
ds_read_b64_tr_b16 v[108:109], v1 offset:328
ds_read_b64_tr_b16 v[110:111], v1 offset:4168
ds_read_b64_tr_b16 v[112:113], v1 offset:4424
s_waitcnt lgkmcnt(2)
ds_write_b128 v242, v[138:141] offset:0
ds_write_b128 v242, v[142:145] offset:1024
ds_write_b128 v242, v[170:173] offset:2048
ds_write_b128 v242, v[174:177] offset:3072
ds_read_b64_tr_b16 v[138:139], v238 offset:0
ds_read_b64_tr_b16 v[140:141], v238 offset:128
ds_read_b64_tr_b16 v[142:143], v238 offset:2048
ds_read_b64_tr_b16 v[144:145], v238 offset:2176
ds_read_b64_tr_b16 v[170:171], v238 offset:8
ds_read_b64_tr_b16 v[172:173], v238 offset:136
ds_read_b64_tr_b16 v[174:175], v238 offset:2056
ds_read_b64_tr_b16 v[176:177], v238 offset:2184
s_waitcnt lgkmcnt(4)
s_waitcnt vmcnt(13)
ds_write_b128 v242, v[18:21] offset:0
ds_write_b128 v242, v[22:25] offset:1024
ds_write_b128 v242, v[50:53] offset:2048
ds_write_b128 v242, v[54:57] offset:3072
ds_write_b128 v242, v[82:85] offset:4096
ds_write_b128 v242, v[86:89] offset:5120
ds_write_b128 v242, v[114:117] offset:6144
ds_write_b128 v242, v[118:121] offset:7168
s_waitcnt lgkmcnt(4)
ds_read_b64_tr_b16 v[18:19], v1 offset:0
ds_read_b64_tr_b16 v[20:21], v1 offset:256
ds_read_b64_tr_b16 v[22:23], v1 offset:4096
ds_read_b64_tr_b16 v[24:25], v1 offset:4352
ds_read_b64_tr_b16 v[50:51], v1 offset:8
ds_read_b64_tr_b16 v[52:53], v1 offset:264
ds_read_b64_tr_b16 v[54:55], v1 offset:4104
ds_read_b64_tr_b16 v[56:57], v1 offset:4360
s_waitcnt lgkmcnt(4)
ds_read_b64_tr_b16 v[82:83], v1 offset:64
ds_read_b64_tr_b16 v[84:85], v1 offset:320
ds_read_b64_tr_b16 v[86:87], v1 offset:4160
ds_read_b64_tr_b16 v[88:89], v1 offset:4416
ds_read_b64_tr_b16 v[114:115], v1 offset:72
ds_read_b64_tr_b16 v[116:117], v1 offset:328
ds_read_b64_tr_b16 v[118:119], v1 offset:4168
ds_read_b64_tr_b16 v[120:121], v1 offset:4424
s_waitcnt lgkmcnt(2)
ds_write_b128 v242, v[146:149] offset:0
ds_write_b128 v242, v[150:153] offset:1024
ds_write_b128 v242, v[178:181] offset:2048
ds_write_b128 v242, v[182:185] offset:3072
ds_read_b64_tr_b16 v[146:147], v238 offset:0
ds_read_b64_tr_b16 v[148:149], v238 offset:128
ds_read_b64_tr_b16 v[150:151], v238 offset:2048
ds_read_b64_tr_b16 v[152:153], v238 offset:2176
ds_read_b64_tr_b16 v[178:179], v238 offset:8
ds_read_b64_tr_b16 v[180:181], v238 offset:136
ds_read_b64_tr_b16 v[182:183], v238 offset:2056
ds_read_b64_tr_b16 v[184:185], v238 offset:2184
s_waitcnt lgkmcnt(4)
s_waitcnt vmcnt(1)
ds_write_b128 v242, v[26:29] offset:0
ds_write_b128 v242, v[30:33] offset:1024
ds_write_b128 v242, v[58:61] offset:2048
ds_write_b128 v242, v[62:65] offset:3072
ds_write_b128 v242, v[90:93] offset:4096
ds_write_b128 v242, v[94:97] offset:5120
ds_write_b128 v242, v[122:125] offset:6144
ds_write_b128 v242, v[126:129] offset:7168
s_waitcnt lgkmcnt(4)
ds_read_b64_tr_b16 v[26:27], v1 offset:0
ds_read_b64_tr_b16 v[28:29], v1 offset:256
ds_read_b64_tr_b16 v[30:31], v1 offset:4096
ds_read_b64_tr_b16 v[32:33], v1 offset:4352
ds_read_b64_tr_b16 v[58:59], v1 offset:8
ds_read_b64_tr_b16 v[60:61], v1 offset:264
ds_read_b64_tr_b16 v[62:63], v1 offset:4104
ds_read_b64_tr_b16 v[64:65], v1 offset:4360
s_waitcnt lgkmcnt(4)
ds_read_b64_tr_b16 v[90:91], v1 offset:64
ds_read_b64_tr_b16 v[92:93], v1 offset:320
ds_read_b64_tr_b16 v[94:95], v1 offset:4160
ds_read_b64_tr_b16 v[96:97], v1 offset:4416
ds_read_b64_tr_b16 v[122:123], v1 offset:72
ds_read_b64_tr_b16 v[124:125], v1 offset:328
ds_read_b64_tr_b16 v[126:127], v1 offset:4168
ds_read_b64_tr_b16 v[128:129], v1 offset:4424
s_waitcnt lgkmcnt(2)
ds_write_b128 v242, v[154:157] offset:0
ds_write_b128 v242, v[158:161] offset:1024
ds_write_b128 v242, v[186:189] offset:2048
ds_write_b128 v242, v[190:193] offset:3072
ds_read_b64_tr_b16 v[154:155], v238 offset:0
ds_read_b64_tr_b16 v[156:157], v238 offset:128
ds_read_b64_tr_b16 v[158:159], v238 offset:2048
ds_read_b64_tr_b16 v[160:161], v238 offset:2176
ds_read_b64_tr_b16 v[186:187], v238 offset:8
ds_read_b64_tr_b16 v[188:189], v238 offset:136
ds_read_b64_tr_b16 v[190:191], v238 offset:2056
ds_read_b64_tr_b16 v[192:193], v238 offset:2184
s_waitcnt lgkmcnt(4)
s_waitcnt lgkmcnt(0)
s_waitcnt vmcnt(0)
s_barrier
s_mul_i32 s20, s12, 3072
v_add_u32 v242, s20, v241
v_mov_b32 v210, 0
v_mov_b32 v211, 0
v_mov_b32 v212, 0
v_mov_b32 v213, 0
v_mov_b32 v214, 0
v_mov_b32 v215, 0
v_mov_b32 v216, 0
v_mov_b32 v217, 0
v_mov_b32 v218, 0
v_mov_b32 v219, 0
v_mov_b32 v220, 0
v_mov_b32 v221, 0
v_mov_b32 v222, 0
v_mov_b32 v223, 0
v_mov_b32 v224, 0
v_mov_b32 v225, 0
v_mov_b32 v226, 0
v_mov_b32 v227, 0
v_mov_b32 v228, 0
v_mov_b32 v229, 0
v_mov_b32 v230, 0
v_mov_b32 v231, 0
v_mov_b32 v232, 0
v_mov_b32 v233, 0
s_cmp_lg_u32 s16, 0
s_cbranch_scc1 rdy_146
v_and_b32 v248, 7, v0
v_lshlrev_b32 v248, 5, v248
s_branch rdy_150
rdy_147:
buffer_load_dwordx2 v[194:195], v248, s[28:31], 0 offen sc1
rdy_150:
s_mov_b32 s20, 0
s_waitcnt vmcnt(0)
v_readlane_b32 s21, v195, 0
s_nop 0
s_lshr_b32 s21, s21, 8
s_add_u32 s20, s20, s21
v_readlane_b32 s21, v195, 1
s_nop 0
s_lshr_b32 s21, s21, 8
s_add_u32 s20, s20, s21
v_readlane_b32 s21, v195, 2
s_nop 0
s_lshr_b32 s21, s21, 8
s_add_u32 s20, s20, s21
v_readlane_b32 s21, v195, 3
s_nop 0
s_lshr_b32 s21, s21, 8
s_add_u32 s20, s20, s21
v_readlane_b32 s21, v195, 4
s_nop 0
s_lshr_b32 s21, s21, 8
s_add_u32 s20, s20, s21
v_readlane_b32 s21, v195, 5
s_nop 0
s_lshr_b32 s21, s21, 8
s_add_u32 s20, s20, s21
v_readlane_b32 s21, v195, 6
s_nop 0
s_lshr_b32 s21, s21, 8
s_add_u32 s20, s20, s21
v_readlane_b32 s21, v195, 7
s_nop 0
s_lshr_b32 s21, s21, 8
s_add_u32 s20, s20, s21
s_and_b32 s21, s20, 0xfff
s_cmp_ge_u32 s21, 256
s_cbranch_scc1 rdy_148
s_add_u32 s19, s19, 1
s_cmp_gt_u32 s19, 1048576
s_cbranch_scc1 L_end
s_sleep 8
s_branch rdy_147
rdy_148:
s_lshr_b32 s20, s20, 12
s_cmp_gt_u32 s20, 16
s_cselect_b32 s17, 8192, 0
v_and_b32 v195, 0xfffff, v195
v_cmp_ne_u32 vcc, -1, v194
s_cbranch_vccnz L_restart
v_cmp_ne_u32 vcc, 0x2000, v195
s_cbranch_vccnz L_restart
rdy_146:
s_xor_b32 s44, s44, s17
s_xor_b32 s42, s42, s17
s_xor_b32 s52, s52, s17
s_xor_b32 s45, s45, s17
v_mov_b32 v194, -1
v_mov_b32 v195, -1
v_mov_b32 v196, -1
v_mov_b32 v197, -1
s_cmp_ge_u32 s12, 2
s_cbranch_scc1 qw_152
s_cmp_eq_u32 s12, 0
s_cbranch_scc1 qw_151
s_mov_b32 s20, 0
buffer_load_dwordx4 v[198:201], v245, s[4:7], s20 offen sc1
s_mov_b32 s20, 65536
buffer_load_dwordx4 v[198:201], v245, s[4:7], s20 offen sc1
s_mov_b32 s20, 131072
buffer_load_dwordx4 v[198:201], v245, s[4:7], s20 offen sc1
s_mov_b32 s20, 196608
buffer_load_dwordx4 v[198:201], v245, s[4:7], s20 offen sc1
s_branch qw_152
qw_151:
s_add_u32 s20, s48, 0
buffer_load_dwordx4 v[198:201], v241, s[4:7], s20 offen sc1
s_add_u32 s20, s48, 131072
buffer_load_dwordx4 v[198:201], v241, s[4:7], s20 offen sc1
s_add_u32 s20, s48, 262144
buffer_load_dwordx4 v[198:201], v241, s[4:7], s20 offen sc1
s_add_u32 s20, s48, 393216
buffer_load_dwordx4 v[198:201], v241, s[4:7], s20 offen sc1
qw_152:
buffer_load_dword v1, v247, s[4:7], s45 offen sc1
s_and_b32 s20, s18, 3
s_lshl_b32 s38, s20, 16
s_add_u32 s40, s38, s46
s_add_u32 s38, s38, s47
s_lshl_b32 s39, s20, 17
s_add_u32 s39, s39, 2359296
s_xor_b32 s50, s20, 2
s_waitcnt vmcnt(0)
v_readfirstlane_b32 s43, v1
s_cmp_lg_u32 s16, 0
s_cbranch_scc1 qslow_153
s_branch qloop_154
.p2align 6
s_nop 0
s_nop 0
s_nop 0
s_nop 0
qloop_154:
s_setprio 2
s_barrier
buffer_load_dwordx4 v[194:197], v241, s[4:7], s38 offen offset:0 sc1
s_nop 15
buffer_load_dwordx4 v[198:201], v241, s[4:7], s38 offen offset:1024 sc1
s_nop 15
buffer_load_dwordx4 v[202:205], v241, s[4:7], s38 offen offset:2048 sc1
s_nop 15
buffer_load_dwordx4 v[206:209], v241, s[4:7], s38 offen offset:3072 sc1
s_waitcnt vmcnt(3)
v_cmp_eq_u32 vcc, -1, v197
s_cbranch_vccnz qF15_0_0_156
qB15_0_0_157:
v_smfmac_f32_16x16x64_bf16 v[210:213], v[194:197], v[2:9], v240
v_smfmac_f32_16x16x64_bf16 v[214:217], v[194:197], v[34:41], v240
v_smfmac_f32_16x16x64_bf16 v[218:221], v[194:197], v[66:73], v240
s_waitcnt vmcnt(2)
v_cmp_eq_u32 vcc, -1, v201
v_smfmac_f32_16x16x64_bf16 v[222:225], v[194:197], v[98:105], v240
s_cbranch_vccnz qF14_1_0_158
qB14_1_0_159:
v_smfmac_f32_16x16x64_bf16 v[210:213], v[198:201], v[10:17], v240
v_smfmac_f32_16x16x64_bf16 v[214:217], v[198:201], v[42:49], v240
v_smfmac_f32_16x16x64_bf16 v[218:221], v[198:201], v[74:81], v240
s_waitcnt vmcnt(1)
v_cmp_eq_u32 vcc, -1, v205
v_smfmac_f32_16x16x64_bf16 v[222:225], v[198:201], v[106:113], v240
s_cbranch_vccnz qF12_2_0_160
qB12_2_0_161:
v_smfmac_f32_16x16x64_bf16 v[210:213], v[202:205], v[18:25], v240
v_smfmac_f32_16x16x64_bf16 v[214:217], v[202:205], v[50:57], v240
v_smfmac_f32_16x16x64_bf16 v[218:221], v[202:205], v[82:89], v240
s_waitcnt vmcnt(0)
v_cmp_eq_u32 vcc, -1, v209
v_smfmac_f32_16x16x64_bf16 v[222:225], v[202:205], v[114:121], v240
s_cbranch_vccnz qF8_3_0_162
qB8_3_0_163:
v_smfmac_f32_16x16x64_bf16 v[210:213], v[206:209], v[26:33], v240
v_smfmac_f32_16x16x64_bf16 v[214:217], v[206:209], v[58:65], v240
v_smfmac_f32_16x16x64_bf16 v[218:221], v[206:209], v[90:97], v240
v_smfmac_f32_16x16x64_bf16 v[222:225], v[206:209], v[122:129], v240
v_cvt_pk_bf16_f32 v210, v210, v211
v_cvt_pk_bf16_f32 v211, v212, v213
v_smfmac_f32_16x16x64_bf16 v[226:229], v[194:197], v[130:137], v240
v_cvt_pk_bf16_f32 v212, v214, v215
v_cvt_pk_bf16_f32 v213, v216, v217
ds_write_b128 v242, v[210:213] offset:0
qdone_155:
v_cvt_pk_bf16_f32 v218, v218, v219
v_cvt_pk_bf16_f32 v219, v220, v221
v_cvt_pk_bf16_f32 v220, v222, v223
v_cvt_pk_bf16_f32 v221, v224, v225
ds_write_b128 v242, v[218:221] offset:1024
v_smfmac_f32_16x16x64_bf16 v[230:233], v[194:197], v[162:169], v240
v_smfmac_f32_16x16x64_bf16 v[226:229], v[198:201], v[138:145], v240
v_smfmac_f32_16x16x64_bf16 v[230:233], v[198:201], v[170:177], v240
s_waitcnt lgkmcnt(0)
s_barrier
ds_read_b128 v[218:221], v243
ds_read_b128 v[222:225], v243 offset:512
v_smfmac_f32_16x16x64_bf16 v[226:229], v[202:205], v[146:153], v240
v_smfmac_f32_16x16x64_bf16 v[230:233], v[202:205], v[178:185], v240
v_smfmac_f32_16x16x64_bf16 v[226:229], v[206:209], v[154:161], v240
v_smfmac_f32_16x16x64_bf16 v[230:233], v[206:209], v[186:193], v240
s_waitcnt lgkmcnt(1)
v_mfma_f32_16x16x32_bf16 v[214:217], v[218:221], v[234:237], 0
s_waitcnt lgkmcnt(0)
v_mfma_f32_16x16x32_bf16 v[214:217], v[222:225], v[234:237], v[214:217]
s_nop 2
v_cvt_pk_bf16_f32 v226, v226, v227
v_cvt_pk_bf16_f32 v227, v228, v229
v_cvt_pk_bf16_f32 v228, v230, v231
v_cvt_pk_bf16_f32 v229, v232, v233
ds_write_b128 v242, v[226:229] offset:2048
v_cvt_pk_bf16_f32 v238, v214, v215
v_cvt_pk_bf16_f32 v239, v216, v217
v_min_u32 v239, -2, v239
buffer_store_dwordx2 v[238:239], v244, s[4:7], s39 offen
s_cmp_ge_u32 s12, 2
s_waitcnt lgkmcnt(0)
s_barrier
s_cbranch_scc1 qnv_220
ds_read_b128 v[218:221], v243 offset:2048
ds_read_b128 v[222:225], v243 offset:2560
s_waitcnt lgkmcnt(1)
v_mfma_f32_16x16x32_bf16 v[214:217], v[234:237], v[218:221], 0
s_waitcnt lgkmcnt(0)
v_mfma_f32_16x16x32_bf16 v[214:217], v[234:237], v[222:225], v[214:217]
s_nop 7
v_cvt_pk_bf16_f32 v250, v214, v215
v_cvt_pk_bf16_f32 v251, v216, v217
v_min_u32 v250, -2, v250
v_min_u32 v251, -2, v251
buffer_store_dwordx2 v[250:251], v246, s[4:7], s40 offen
qnv_220:
v_min_u32 v238, -2, v238
s_add_u32 s18, s18, 1
s_cmp_ge_u32 s18, 64
s_cbranch_scc1 qlast_221
s_setprio 0
v_mov_b32 v210, 0
v_mov_b32 v211, 0
v_mov_b32 v212, 0
v_mov_b32 v213, 0
v_mov_b32 v214, 0
v_mov_b32 v215, 0
v_mov_b32 v216, 0
v_mov_b32 v217, 0
v_mov_b32 v218, 0
v_mov_b32 v219, 0
v_mov_b32 v220, 0
v_mov_b32 v221, 0
v_mov_b32 v222, 0
v_mov_b32 v223, 0
v_mov_b32 v224, 0
v_mov_b32 v225, 0
v_mov_b32 v226, 0
v_mov_b32 v227, 0
v_mov_b32 v228, 0
v_mov_b32 v229, 0
v_mov_b32 v230, 0
v_mov_b32 v231, 0
v_mov_b32 v232, 0
v_mov_b32 v233, 0
v_mov_b32 v194, -1
v_mov_b32 v195, -1
v_mov_b32 v196, -1
v_mov_b32 v197, -1
s_barrier
s_mov_b32 s53, 1
s_cmp_lt_u32 s18, 1
s_cbranch_scc1 qsk_222
s_cmp_gt_u32 s43, s18
s_cselect_b32 s53, 0, 1
s_cbranch_scc0 qsk_222
s_lshl_b32 s20, s18, 14
s_xor_b32 s20, s20, s44
buffer_load_dwordx4 v[210:213], v241, s[4:7], s20 offen offset:0 sc1
buffer_load_dwordx4 v[214:217], v241, s[4:7], s20 offen offset:1024 sc1
buffer_load_dwordx4 v[218:221], v241, s[4:7], s20 offen offset:2048 sc1
buffer_load_dwordx4 v[222:225], v241, s[4:7], s20 offen offset:3072 sc1
qsk_222:
s_add_u32 s20, s18, 1
s_cmp_gt_u32 s43, s20
s_cbranch_scc0 qnp_223
s_lshl_b32 s20, s20, 14
s_xor_b32 s20, s20, s44
s_lshl_b32 s21, s35, 10
s_add_u32 s20, s20, s21
buffer_load_dwordx4 v[198:201], v241, s[4:7], s20 offen sc1
qnp_223:
s_cmp_eq_u32 s51, 0
s_cbranch_scc1 cp_224
s_sub_u32 s20, s18, 1
s_lshl_b32 s20, s20, 14
s_xor_b32 s20, s20, s42
buffer_store_dwordx2 v[238:239], v252, s[4:7], s20 offen sc1
s_add_u32 s20, s18, 1
s_lshl_b32 s20, s20, 14
s_xor_b32 s20, s20, s42
buffer_store_dwordx2 v[194:195], v252, s[4:7], s20 offen sc1
cp_224:
s_cmp_ge_u32 s12, 2
s_cbranch_scc1 cp_225
s_sub_u32 s20, s18, 1
s_lshl_b32 s20, s20, 14
s_xor_b32 s20, s20, s52
buffer_store_dwordx2 v[250:251], v246, s[4:7], s20 offen sc1
s_add_u32 s20, s18, 1
s_lshl_b32 s20, s20, 14
s_xor_b32 s20, s20, s52
buffer_store_dwordx2 v[194:195], v246, s[4:7], s20 offen sc1
cp_225:
s_cmp_lt_u32 s12, 2
s_cbranch_scc1 rd_226
s_lshl_b32 s20, s50, 19
s_add_u32 s20, s20, s17
buffer_store_dwordx4 v[194:197], v245, s[4:7], s20 offen sc1
rd_226:
s_add_u32 s20, s18, 3
s_min_u32 s20, s20, 63
s_cmp_gt_u32 s43, s20
s_cbranch_scc1 qnf_227
buffer_load_dword v1, v247, s[4:7], s45 offen sc1
qnf_227:
s_barrier
s_barrier
s_cmp_ge_u32 s12, 2
s_cbranch_scc1 rd_229
s_cmp_eq_u32 s12, 1
s_cbranch_scc1 r1_228
s_lshl_b32 s20, s50, 17
s_add_u32 s20, s20, s48
buffer_store_dwordx4 v[194:197], v241, s[4:7], s20 offen
s_branch rd_229
r1_228:
s_lshl_b32 s20, s50, 16
buffer_store_dwordx4 v[194:197], v245, s[4:7], s20 offen
rd_229:
s_cmp_eq_u32 s53, 0
s_cbranch_scc1 qnl_230
s_waitcnt vmcnt(0)
v_readfirstlane_b32 s43, v1
s_barrier
s_cmp_lt_u32 s18, 1
s_cbranch_scc1 qnl_231
s_cmp_gt_u32 s43, s18
s_cbranch_scc0 qfl_232
qfl_233:
s_lshl_b32 s20, s18, 14
s_xor_b32 s20, s20, s44
s_mov_b32 m0, s49
s_nop 0
buffer_load_dwordx4 v241, s[4:7], s20 offen offset:0 sc1 lds
buffer_load_dwordx4 v241, s[4:7], s20 offen offset:1024 sc1 lds
buffer_load_dwordx4 v241, s[4:7], s20 offen offset:2048 sc1 lds
buffer_load_dwordx4 v241, s[4:7], s20 offen offset:3072 sc1 lds
s_lshl_b32 s20, s18, 14
s_xor_b32 s20, s20, s44
s_add_u32 s20, s20, 4096
s_add_u32 m0, s49, 4096
s_nop 0
buffer_load_dwordx4 v241, s[4:7], s20 offen offset:0 sc1 lds
buffer_load_dwordx4 v241, s[4:7], s20 offen offset:1024 sc1 lds
buffer_load_dwordx4 v241, s[4:7], s20 offen offset:2048 sc1 lds
buffer_load_dwordx4 v241, s[4:7], s20 offen offset:3072 sc1 lds
s_branch qnl_231
qnl_230:
s_lshl_b32 s20, s18, 14
s_xor_b32 s20, s20, s44
s_add_u32 s20, s20, 4096
s_add_u32 m0, s49, 4096
s_nop 0
buffer_load_dwordx4 v241, s[4:7], s20 offen offset:0 sc1 lds
buffer_load_dwordx4 v241, s[4:7], s20 offen offset:1024 sc1 lds
buffer_load_dwordx4 v241, s[4:7], s20 offen offset:2048 sc1 lds
buffer_load_dwordx4 v241, s[4:7], s20 offen offset:3072 sc1 lds
s_and_b32 s20, s18, 3
s_lshl_b32 s38, s20, 16
s_add_u32 s40, s38, s46
s_add_u32 s38, s38, s47
s_lshl_b32 s39, s20, 17
s_add_u32 s39, s39, 2359296
s_xor_b32 s50, s20, 2
s_barrier
v_add_u32 v248, s49, v241
s_waitcnt vmcnt(0)
ds_write_b128 v248, v[210:213] offset:0
ds_write_b128 v248, v[214:217] offset:1024
ds_write_b128 v248, v[218:221] offset:2048
ds_write_b128 v248, v[222:225] offset:3072
qnl_231:
s_waitcnt lgkmcnt(0)
v_mov_b32 v210, 0
v_mov_b32 v211, 0
v_mov_b32 v212, 0
v_mov_b32 v213, 0
v_mov_b32 v214, 0
v_mov_b32 v215, 0
v_mov_b32 v216, 0
v_mov_b32 v217, 0
v_mov_b32 v218, 0
v_mov_b32 v219, 0
v_mov_b32 v220, 0
v_mov_b32 v221, 0
v_mov_b32 v222, 0
v_mov_b32 v223, 0
v_mov_b32 v224, 0
v_mov_b32 v225, 0
s_and_b32 s20, s18, 3
s_lshl_b32 s38, s20, 16
s_add_u32 s40, s38, s46
s_add_u32 s38, s38, s47
s_lshl_b32 s39, s20, 17
s_add_u32 s39, s39, 2359296
s_xor_b32 s50, s20, 2
s_waitcnt vmcnt(0)
v_readfirstlane_b32 s43, v1
s_branch qloop_154
qlast_221:
s_cmp_eq_u32 s51, 0
s_cbranch_scc1 cp_234
s_sub_u32 s20, s18, 1
s_lshl_b32 s20, s20, 14
s_xor_b32 s20, s20, s42
buffer_store_dwordx2 v[238:239], v252, s[4:7], s20 offen sc1
cp_234:
s_cmp_ge_u32 s12, 2
s_cbranch_scc1 cp_235
s_sub_u32 s20, s18, 1
s_lshl_b32 s20, s20, 14
s_xor_b32 s20, s20, s52
buffer_store_dwordx2 v[250:251], v246, s[4:7], s20 offen sc1
cp_235:
s_waitcnt vmcnt(0)
s_endpgm
qF8_3_0_162:
buffer_load_dwordx4 v[206:209], v241, s[4:7], s38 offen offset:3072 sc1
s_add_u32 s19, s19, 1
s_cmp_gt_u32 s19, 1048576
s_cbranch_scc1 L_end
s_waitcnt vmcnt(0)
v_cmp_eq_u32 vcc, -1, v209
s_cbranch_vccnz qF8_3_0_162
s_branch qB8_3_0_163
qF12_2_0_160:
buffer_load_dwordx4 v[202:205], v241, s[4:7], s38 offen offset:2048 sc1
s_add_u32 s19, s19, 1
s_cmp_gt_u32 s19, 1048576
s_cbranch_scc1 L_end
s_waitcnt vmcnt(1)
v_cmp_eq_u32 vcc, -1, v209
s_cbranch_vccnz qF12_3_0_164
s_branch qB12_3_0_165
qB12_3_0_165:
v_smfmac_f32_16x16x64_bf16 v[210:213], v[206:209], v[26:33], v240
v_smfmac_f32_16x16x64_bf16 v[214:217], v[206:209], v[58:65], v240
v_smfmac_f32_16x16x64_bf16 v[218:221], v[206:209], v[90:97], v240
s_waitcnt vmcnt(0)
v_cmp_eq_u32 vcc, -1, v205
v_smfmac_f32_16x16x64_bf16 v[222:225], v[206:209], v[122:129], v240
s_cbranch_vccnz qF4_2_0_166
s_branch qB4_2_0_167
qB4_2_0_167:
v_smfmac_f32_16x16x64_bf16 v[210:213], v[202:205], v[18:25], v240
v_smfmac_f32_16x16x64_bf16 v[214:217], v[202:205], v[50:57], v240
v_smfmac_f32_16x16x64_bf16 v[218:221], v[202:205], v[82:89], v240
v_smfmac_f32_16x16x64_bf16 v[222:225], v[202:205], v[114:121], v240
v_cvt_pk_bf16_f32 v210, v210, v211
v_cvt_pk_bf16_f32 v211, v212, v213
v_smfmac_f32_16x16x64_bf16 v[226:229], v[194:197], v[130:137], v240
v_cvt_pk_bf16_f32 v212, v214, v215
v_cvt_pk_bf16_f32 v213, v216, v217
ds_write_b128 v242, v[210:213] offset:0
s_branch qdone_155
qF4_2_0_166:
buffer_load_dwordx4 v[202:205], v241, s[4:7], s38 offen offset:2048 sc1
s_add_u32 s19, s19, 1
s_cmp_gt_u32 s19, 1048576
s_cbranch_scc1 L_end
s_waitcnt vmcnt(0)
v_cmp_eq_u32 vcc, -1, v205
s_cbranch_vccnz qF4_2_0_166
s_branch qB4_2_0_167
qF12_3_0_164:
buffer_load_dwordx4 v[206:209], v241, s[4:7], s38 offen offset:3072 sc1
s_add_u32 s19, s19, 1
s_cmp_gt_u32 s19, 1048576
s_cbranch_scc1 L_end
s_waitcnt vmcnt(1)
v_cmp_eq_u32 vcc, -1, v205
s_cbranch_vccnz qF12_2_0_160
s_branch qB12_2_0_161
qF14_1_0_158:
buffer_load_dwordx4 v[198:201], v241, s[4:7], s38 offen offset:1024 sc1
s_add_u32 s19, s19, 1
s_cmp_gt_u32 s19, 1048576
s_cbranch_scc1 L_end
s_waitcnt vmcnt(2)
v_cmp_eq_u32 vcc, -1, v205
s_cbranch_vccnz qF14_2_0_168
s_branch qB14_2_0_169
qB14_2_0_169:
v_smfmac_f32_16x16x64_bf16 v[210:213], v[202:205], v[18:25], v240
v_smfmac_f32_16x16x64_bf16 v[214:217], v[202:205], v[50:57], v240
v_smfmac_f32_16x16x64_bf16 v[218:221], v[202:205], v[82:89], v240
s_waitcnt vmcnt(1)
v_cmp_eq_u32 vcc, -1, v209
v_smfmac_f32_16x16x64_bf16 v[222:225], v[202:205], v[114:121], v240
s_cbranch_vccnz qF10_3_0_170
s_branch qB10_3_0_171
qB10_3_0_171:
v_smfmac_f32_16x16x64_bf16 v[210:213], v[206:209], v[26:33], v240
v_smfmac_f32_16x16x64_bf16 v[214:217], v[206:209], v[58:65], v240
v_smfmac_f32_16x16x64_bf16 v[218:221], v[206:209], v[90:97], v240
s_waitcnt vmcnt(0)
v_cmp_eq_u32 vcc, -1, v201
v_smfmac_f32_16x16x64_bf16 v[222:225], v[206:209], v[122:129], v240
s_cbranch_vccnz qF2_1_0_172
s_branch qB2_1_0_173
qB2_1_0_173:
v_smfmac_f32_16x16x64_bf16 v[210:213], v[198:201], v[10:17], v240
v_smfmac_f32_16x16x64_bf16 v[214:217], v[198:201], v[42:49], v240
v_smfmac_f32_16x16x64_bf16 v[218:221], v[198:201], v[74:81], v240
v_smfmac_f32_16x16x64_bf16 v[222:225], v[198:201], v[106:113], v240
v_cvt_pk_bf16_f32 v210, v210, v211
v_cvt_pk_bf16_f32 v211, v212, v213
v_smfmac_f32_16x16x64_bf16 v[226:229], v[194:197], v[130:137], v240
v_cvt_pk_bf16_f32 v212, v214, v215
v_cvt_pk_bf16_f32 v213, v216, v217
ds_write_b128 v242, v[210:213] offset:0
s_branch qdone_155
qF2_1_0_172:
buffer_load_dwordx4 v[198:201], v241, s[4:7], s38 offen offset:1024 sc1
s_add_u32 s19, s19, 1
s_cmp_gt_u32 s19, 1048576
s_cbranch_scc1 L_end
s_waitcnt vmcnt(0)
v_cmp_eq_u32 vcc, -1, v201
s_cbranch_vccnz qF2_1_0_172
s_branch qB2_1_0_173
qF10_3_0_170:
buffer_load_dwordx4 v[206:209], v241, s[4:7], s38 offen offset:3072 sc1
s_add_u32 s19, s19, 1
s_cmp_gt_u32 s19, 1048576
s_cbranch_scc1 L_end
s_waitcnt vmcnt(1)
v_cmp_eq_u32 vcc, -1, v201
s_cbranch_vccnz qF10_1_0_174
s_branch qB10_1_0_175
qB10_1_0_175:
v_smfmac_f32_16x16x64_bf16 v[210:213], v[198:201], v[10:17], v240
v_smfmac_f32_16x16x64_bf16 v[214:217], v[198:201], v[42:49], v240
v_smfmac_f32_16x16x64_bf16 v[218:221], v[198:201], v[74:81], v240
s_waitcnt vmcnt(0)
v_cmp_eq_u32 vcc, -1, v209
v_smfmac_f32_16x16x64_bf16 v[222:225], v[198:201], v[106:113], v240
s_cbranch_vccnz qF8_3_0_162
s_branch qB8_3_0_163
qF10_1_0_174:
buffer_load_dwordx4 v[198:201], v241, s[4:7], s38 offen offset:1024 sc1
s_add_u32 s19, s19, 1
s_cmp_gt_u32 s19, 1048576
s_cbranch_scc1 L_end
s_waitcnt vmcnt(1)
v_cmp_eq_u32 vcc, -1, v209
s_cbranch_vccnz qF10_3_0_170
s_branch qB10_3_0_171
qF14_2_0_168:
buffer_load_dwordx4 v[202:205], v241, s[4:7], s38 offen offset:2048 sc1
s_add_u32 s19, s19, 1
s_cmp_gt_u32 s19, 1048576
s_cbranch_scc1 L_end
s_waitcnt vmcnt(2)
v_cmp_eq_u32 vcc, -1, v209
s_cbranch_vccnz qF14_3_0_176
s_branch qB14_3_0_177
qB14_3_0_177:
v_smfmac_f32_16x16x64_bf16 v[210:213], v[206:209], v[26:33], v240
v_smfmac_f32_16x16x64_bf16 v[214:217], v[206:209], v[58:65], v240
v_smfmac_f32_16x16x64_bf16 v[218:221], v[206:209], v[90:97], v240
s_waitcnt vmcnt(1)
v_cmp_eq_u32 vcc, -1, v201
v_smfmac_f32_16x16x64_bf16 v[222:225], v[206:209], v[122:129], v240
s_cbranch_vccnz qF6_1_0_178
s_branch qB6_1_0_179
qB6_1_0_179:
v_smfmac_f32_16x16x64_bf16 v[210:213], v[198:201], v[10:17], v240
v_smfmac_f32_16x16x64_bf16 v[214:217], v[198:201], v[42:49], v240
v_smfmac_f32_16x16x64_bf16 v[218:221], v[198:201], v[74:81], v240
s_waitcnt vmcnt(0)
v_cmp_eq_u32 vcc, -1, v205
v_smfmac_f32_16x16x64_bf16 v[222:225], v[198:201], v[106:113], v240
s_cbranch_vccnz qF4_2_0_166
s_branch qB4_2_0_167
qF6_1_0_178:
buffer_load_dwordx4 v[198:201], v241, s[4:7], s38 offen offset:1024 sc1
s_add_u32 s19, s19, 1
s_cmp_gt_u32 s19, 1048576
s_cbranch_scc1 L_end
s_waitcnt vmcnt(1)
v_cmp_eq_u32 vcc, -1, v205
s_cbranch_vccnz qF6_2_0_180
s_branch qB6_2_0_181
qB6_2_0_181:
v_smfmac_f32_16x16x64_bf16 v[210:213], v[202:205], v[18:25], v240
v_smfmac_f32_16x16x64_bf16 v[214:217], v[202:205], v[50:57], v240
v_smfmac_f32_16x16x64_bf16 v[218:221], v[202:205], v[82:89], v240
s_waitcnt vmcnt(0)
v_cmp_eq_u32 vcc, -1, v201
v_smfmac_f32_16x16x64_bf16 v[222:225], v[202:205], v[114:121], v240
s_cbranch_vccnz qF2_1_0_172
s_branch qB2_1_0_173
qF6_2_0_180:
buffer_load_dwordx4 v[202:205], v241, s[4:7], s38 offen offset:2048 sc1
s_add_u32 s19, s19, 1
s_cmp_gt_u32 s19, 1048576
s_cbranch_scc1 L_end
s_waitcnt vmcnt(1)
v_cmp_eq_u32 vcc, -1, v201
s_cbranch_vccnz qF6_1_0_178
s_branch qB6_1_0_179
qF14_3_0_176:
buffer_load_dwordx4 v[206:209], v241, s[4:7], s38 offen offset:3072 sc1
s_add_u32 s19, s19, 1
s_cmp_gt_u32 s19, 1048576
s_cbranch_scc1 L_end
s_waitcnt vmcnt(2)
v_cmp_eq_u32 vcc, -1, v201
s_cbranch_vccnz qF14_1_0_158
s_branch qB14_1_0_159
qF15_0_0_156:
buffer_load_dwordx4 v[194:197], v241, s[4:7], s38 offen offset:0 sc1
s_add_u32 s19, s19, 1
s_cmp_gt_u32 s19, 1048576
s_cbranch_scc1 L_end
s_waitcnt vmcnt(3)
v_cmp_eq_u32 vcc, -1, v201
s_cbranch_vccnz qF15_1_0_182
s_branch qB15_1_0_183
qB15_1_0_183:
v_smfmac_f32_16x16x64_bf16 v[210:213], v[198:201], v[10:17], v240
v_smfmac_f32_16x16x64_bf16 v[214:217], v[198:201], v[42:49], v240
v_smfmac_f32_16x16x64_bf16 v[218:221], v[198:201], v[74:81], v240
s_waitcnt vmcnt(2)
v_cmp_eq_u32 vcc, -1, v205
v_smfmac_f32_16x16x64_bf16 v[222:225], v[198:201], v[106:113], v240
s_cbranch_vccnz qF13_2_0_184
s_branch qB13_2_0_185
qB13_2_0_185:
v_smfmac_f32_16x16x64_bf16 v[210:213], v[202:205], v[18:25], v240
v_smfmac_f32_16x16x64_bf16 v[214:217], v[202:205], v[50:57], v240
v_smfmac_f32_16x16x64_bf16 v[218:221], v[202:205], v[82:89], v240
s_waitcnt vmcnt(1)
v_cmp_eq_u32 vcc, -1, v209
v_smfmac_f32_16x16x64_bf16 v[222:225], v[202:205], v[114:121], v240
s_cbranch_vccnz qF9_3_0_186
s_branch qB9_3_0_187
qB9_3_0_187:
v_smfmac_f32_16x16x64_bf16 v[210:213], v[206:209], v[26:33], v240
v_smfmac_f32_16x16x64_bf16 v[214:217], v[206:209], v[58:65], v240
v_smfmac_f32_16x16x64_bf16 v[218:221], v[206:209], v[90:97], v240
s_waitcnt vmcnt(0)
v_cmp_eq_u32 vcc, -1, v197
v_smfmac_f32_16x16x64_bf16 v[222:225], v[206:209], v[122:129], v240
s_cbranch_vccnz qF1_0_0_188
s_branch qB1_0_0_189
qB1_0_0_189:
v_smfmac_f32_16x16x64_bf16 v[210:213], v[194:197], v[2:9], v240
v_smfmac_f32_16x16x64_bf16 v[214:217], v[194:197], v[34:41], v240
v_smfmac_f32_16x16x64_bf16 v[218:221], v[194:197], v[66:73], v240
v_smfmac_f32_16x16x64_bf16 v[222:225], v[194:197], v[98:105], v240
v_cvt_pk_bf16_f32 v210, v210, v211
v_cvt_pk_bf16_f32 v211, v212, v213
v_smfmac_f32_16x16x64_bf16 v[226:229], v[194:197], v[130:137], v240
v_cvt_pk_bf16_f32 v212, v214, v215
v_cvt_pk_bf16_f32 v213, v216, v217
ds_write_b128 v242, v[210:213] offset:0
s_branch qdone_155
qF1_0_0_188:
buffer_load_dwordx4 v[194:197], v241, s[4:7], s38 offen offset:0 sc1
s_add_u32 s19, s19, 1
s_cmp_gt_u32 s19, 1048576
s_cbranch_scc1 L_end
s_waitcnt vmcnt(0)
v_cmp_eq_u32 vcc, -1, v197
s_cbranch_vccnz qF1_0_0_188
s_branch qB1_0_0_189
qF9_3_0_186:
buffer_load_dwordx4 v[206:209], v241, s[4:7], s38 offen offset:3072 sc1
s_add_u32 s19, s19, 1
s_cmp_gt_u32 s19, 1048576
s_cbranch_scc1 L_end
s_waitcnt vmcnt(1)
v_cmp_eq_u32 vcc, -1, v197
s_cbranch_vccnz qF9_0_0_190
s_branch qB9_0_0_191
qB9_0_0_191:
v_smfmac_f32_16x16x64_bf16 v[210:213], v[194:197], v[2:9], v240
v_smfmac_f32_16x16x64_bf16 v[214:217], v[194:197], v[34:41], v240
v_smfmac_f32_16x16x64_bf16 v[218:221], v[194:197], v[66:73], v240
s_waitcnt vmcnt(0)
v_cmp_eq_u32 vcc, -1, v209
v_smfmac_f32_16x16x64_bf16 v[222:225], v[194:197], v[98:105], v240
s_cbranch_vccnz qF8_3_0_162
s_branch qB8_3_0_163
qF9_0_0_190:
buffer_load_dwordx4 v[194:197], v241, s[4:7], s38 offen offset:0 sc1
s_add_u32 s19, s19, 1
s_cmp_gt_u32 s19, 1048576
s_cbranch_scc1 L_end
s_waitcnt vmcnt(1)
v_cmp_eq_u32 vcc, -1, v209
s_cbranch_vccnz qF9_3_0_186
s_branch qB9_3_0_187
qF13_2_0_184:
buffer_load_dwordx4 v[202:205], v241, s[4:7], s38 offen offset:2048 sc1
s_add_u32 s19, s19, 1
s_cmp_gt_u32 s19, 1048576
s_cbranch_scc1 L_end
s_waitcnt vmcnt(2)
v_cmp_eq_u32 vcc, -1, v209
s_cbranch_vccnz qF13_3_0_192
s_branch qB13_3_0_193
qB13_3_0_193:
v_smfmac_f32_16x16x64_bf16 v[210:213], v[206:209], v[26:33], v240
v_smfmac_f32_16x16x64_bf16 v[214:217], v[206:209], v[58:65], v240
v_smfmac_f32_16x16x64_bf16 v[218:221], v[206:209], v[90:97], v240
s_waitcnt vmcnt(1)
v_cmp_eq_u32 vcc, -1, v197
v_smfmac_f32_16x16x64_bf16 v[222:225], v[206:209], v[122:129], v240
s_cbranch_vccnz qF5_0_0_194
s_branch qB5_0_0_195
qB5_0_0_195:
v_smfmac_f32_16x16x64_bf16 v[210:213], v[194:197], v[2:9], v240
v_smfmac_f32_16x16x64_bf16 v[214:217], v[194:197], v[34:41], v240
v_smfmac_f32_16x16x64_bf16 v[218:221], v[194:197], v[66:73], v240
s_waitcnt vmcnt(0)
v_cmp_eq_u32 vcc, -1, v205
v_smfmac_f32_16x16x64_bf16 v[222:225], v[194:197], v[98:105], v240
s_cbranch_vccnz qF4_2_0_166
s_branch qB4_2_0_167
qF5_0_0_194:
buffer_load_dwordx4 v[194:197], v241, s[4:7], s38 offen offset:0 sc1
s_add_u32 s19, s19, 1
s_cmp_gt_u32 s19, 1048576
s_cbranch_scc1 L_end
s_waitcnt vmcnt(1)
v_cmp_eq_u32 vcc, -1, v205
s_cbranch_vccnz qF5_2_0_196
s_branch qB5_2_0_197
qB5_2_0_197:
v_smfmac_f32_16x16x64_bf16 v[210:213], v[202:205], v[18:25], v240
v_smfmac_f32_16x16x64_bf16 v[214:217], v[202:205], v[50:57], v240
v_smfmac_f32_16x16x64_bf16 v[218:221], v[202:205], v[82:89], v240
s_waitcnt vmcnt(0)
v_cmp_eq_u32 vcc, -1, v197
v_smfmac_f32_16x16x64_bf16 v[222:225], v[202:205], v[114:121], v240
s_cbranch_vccnz qF1_0_0_188
s_branch qB1_0_0_189
qF5_2_0_196:
buffer_load_dwordx4 v[202:205], v241, s[4:7], s38 offen offset:2048 sc1
s_add_u32 s19, s19, 1
s_cmp_gt_u32 s19, 1048576
s_cbranch_scc1 L_end
s_waitcnt vmcnt(1)
v_cmp_eq_u32 vcc, -1, v197
s_cbranch_vccnz qF5_0_0_194
s_branch qB5_0_0_195
qF13_3_0_192:
buffer_load_dwordx4 v[206:209], v241, s[4:7], s38 offen offset:3072 sc1
s_add_u32 s19, s19, 1
s_cmp_gt_u32 s19, 1048576
s_cbranch_scc1 L_end
s_waitcnt vmcnt(2)
v_cmp_eq_u32 vcc, -1, v197
s_cbranch_vccnz qF13_0_0_198
s_branch qB13_0_0_199
qB13_0_0_199:
v_smfmac_f32_16x16x64_bf16 v[210:213], v[194:197], v[2:9], v240
v_smfmac_f32_16x16x64_bf16 v[214:217], v[194:197], v[34:41], v240
v_smfmac_f32_16x16x64_bf16 v[218:221], v[194:197], v[66:73], v240
s_waitcnt vmcnt(1)
v_cmp_eq_u32 vcc, -1, v205
v_smfmac_f32_16x16x64_bf16 v[222:225], v[194:197], v[98:105], v240
s_cbranch_vccnz qF12_2_0_160
s_branch qB12_2_0_161
qF13_0_0_198:
buffer_load_dwordx4 v[194:197], v241, s[4:7], s38 offen offset:0 sc1
s_add_u32 s19, s19, 1
s_cmp_gt_u32 s19, 1048576
s_cbranch_scc1 L_end
s_waitcnt vmcnt(2)
v_cmp_eq_u32 vcc, -1, v205
s_cbranch_vccnz qF13_2_0_184
s_branch qB13_2_0_185
qF15_1_0_182:
buffer_load_dwordx4 v[198:201], v241, s[4:7], s38 offen offset:1024 sc1
s_add_u32 s19, s19, 1
s_cmp_gt_u32 s19, 1048576
s_cbranch_scc1 L_end
s_waitcnt vmcnt(3)
v_cmp_eq_u32 vcc, -1, v205
s_cbranch_vccnz qF15_2_0_200
s_branch qB15_2_0_201
qB15_2_0_201:
v_smfmac_f32_16x16x64_bf16 v[210:213], v[202:205], v[18:25], v240
v_smfmac_f32_16x16x64_bf16 v[214:217], v[202:205], v[50:57], v240
v_smfmac_f32_16x16x64_bf16 v[218:221], v[202:205], v[82:89], v240
s_waitcnt vmcnt(2)
v_cmp_eq_u32 vcc, -1, v209
v_smfmac_f32_16x16x64_bf16 v[222:225], v[202:205], v[114:121], v240
s_cbranch_vccnz qF11_3_0_202
s_branch qB11_3_0_203
qB11_3_0_203:
v_smfmac_f32_16x16x64_bf16 v[210:213], v[206:209], v[26:33], v240
v_smfmac_f32_16x16x64_bf16 v[214:217], v[206:209], v[58:65], v240
v_smfmac_f32_16x16x64_bf16 v[218:221], v[206:209], v[90:97], v240
s_waitcnt vmcnt(1)
v_cmp_eq_u32 vcc, -1, v197
v_smfmac_f32_16x16x64_bf16 v[222:225], v[206:209], v[122:129], v240
s_cbranch_vccnz qF3_0_0_204
s_branch qB3_0_0_205
qB3_0_0_205:
v_smfmac_f32_16x16x64_bf16 v[210:213], v[194:197], v[2:9], v240
v_smfmac_f32_16x16x64_bf16 v[214:217], v[194:197], v[34:41], v240
v_smfmac_f32_16x16x64_bf16 v[218:221], v[194:197], v[66:73], v240
s_waitcnt vmcnt(0)
v_cmp_eq_u32 vcc, -1, v201
v_smfmac_f32_16x16x64_bf16 v[222:225], v[194:197], v[98:105], v240
s_cbranch_vccnz qF2_1_0_172
s_branch qB2_1_0_173
qF3_0_0_204:
buffer_load_dwordx4 v[194:197], v241, s[4:7], s38 offen offset:0 sc1
s_add_u32 s19, s19, 1
s_cmp_gt_u32 s19, 1048576
s_cbranch_scc1 L_end
s_waitcnt vmcnt(1)
v_cmp_eq_u32 vcc, -1, v201
s_cbranch_vccnz qF3_1_0_206
s_branch qB3_1_0_207
qB3_1_0_207:
v_smfmac_f32_16x16x64_bf16 v[210:213], v[198:201], v[10:17], v240
v_smfmac_f32_16x16x64_bf16 v[214:217], v[198:201], v[42:49], v240
v_smfmac_f32_16x16x64_bf16 v[218:221], v[198:201], v[74:81], v240
s_waitcnt vmcnt(0)
v_cmp_eq_u32 vcc, -1, v197
v_smfmac_f32_16x16x64_bf16 v[222:225], v[198:201], v[106:113], v240
s_cbranch_vccnz qF1_0_0_188
s_branch qB1_0_0_189
qF3_1_0_206:
buffer_load_dwordx4 v[198:201], v241, s[4:7], s38 offen offset:1024 sc1
s_add_u32 s19, s19, 1
s_cmp_gt_u32 s19, 1048576
s_cbranch_scc1 L_end
s_waitcnt vmcnt(1)
v_cmp_eq_u32 vcc, -1, v197
s_cbranch_vccnz qF3_0_0_204
s_branch qB3_0_0_205
qF11_3_0_202:
buffer_load_dwordx4 v[206:209], v241, s[4:7], s38 offen offset:3072 sc1
s_add_u32 s19, s19, 1
s_cmp_gt_u32 s19, 1048576
s_cbranch_scc1 L_end
s_waitcnt vmcnt(2)
v_cmp_eq_u32 vcc, -1, v197
s_cbranch_vccnz qF11_0_0_208
s_branch qB11_0_0_209
qB11_0_0_209:
v_smfmac_f32_16x16x64_bf16 v[210:213], v[194:197], v[2:9], v240
v_smfmac_f32_16x16x64_bf16 v[214:217], v[194:197], v[34:41], v240
v_smfmac_f32_16x16x64_bf16 v[218:221], v[194:197], v[66:73], v240
s_waitcnt vmcnt(1)
v_cmp_eq_u32 vcc, -1, v201
v_smfmac_f32_16x16x64_bf16 v[222:225], v[194:197], v[98:105], v240
s_cbranch_vccnz qF10_1_0_174
s_branch qB10_1_0_175
qF11_0_0_208:
buffer_load_dwordx4 v[194:197], v241, s[4:7], s38 offen offset:0 sc1
s_add_u32 s19, s19, 1
s_cmp_gt_u32 s19, 1048576
s_cbranch_scc1 L_end
s_waitcnt vmcnt(2)
v_cmp_eq_u32 vcc, -1, v201
s_cbranch_vccnz qF11_1_0_210
s_branch qB11_1_0_211
qB11_1_0_211:
v_smfmac_f32_16x16x64_bf16 v[210:213], v[198:201], v[10:17], v240
v_smfmac_f32_16x16x64_bf16 v[214:217], v[198:201], v[42:49], v240
v_smfmac_f32_16x16x64_bf16 v[218:221], v[198:201], v[74:81], v240
s_waitcnt vmcnt(1)
v_cmp_eq_u32 vcc, -1, v209
v_smfmac_f32_16x16x64_bf16 v[222:225], v[198:201], v[106:113], v240
s_cbranch_vccnz qF9_3_0_186
s_branch qB9_3_0_187
qF11_1_0_210:
buffer_load_dwordx4 v[198:201], v241, s[4:7], s38 offen offset:1024 sc1
s_add_u32 s19, s19, 1
s_cmp_gt_u32 s19, 1048576
s_cbranch_scc1 L_end
s_waitcnt vmcnt(2)
v_cmp_eq_u32 vcc, -1, v209
s_cbranch_vccnz qF11_3_0_202
s_branch qB11_3_0_203
qF15_2_0_200:
buffer_load_dwordx4 v[202:205], v241, s[4:7], s38 offen offset:2048 sc1
s_add_u32 s19, s19, 1
s_cmp_gt_u32 s19, 1048576
s_cbranch_scc1 L_end
s_waitcnt vmcnt(3)
v_cmp_eq_u32 vcc, -1, v209
s_cbranch_vccnz qF15_3_0_212
s_branch qB15_3_0_213
qB15_3_0_213:
v_smfmac_f32_16x16x64_bf16 v[210:213], v[206:209], v[26:33], v240
v_smfmac_f32_16x16x64_bf16 v[214:217], v[206:209], v[58:65], v240
v_smfmac_f32_16x16x64_bf16 v[218:221], v[206:209], v[90:97], v240
s_waitcnt vmcnt(2)
v_cmp_eq_u32 vcc, -1, v197
v_smfmac_f32_16x16x64_bf16 v[222:225], v[206:209], v[122:129], v240
s_cbranch_vccnz qF7_0_0_214
s_branch qB7_0_0_215
qB7_0_0_215:
v_smfmac_f32_16x16x64_bf16 v[210:213], v[194:197], v[2:9], v240
v_smfmac_f32_16x16x64_bf16 v[214:217], v[194:197], v[34:41], v240
v_smfmac_f32_16x16x64_bf16 v[218:221], v[194:197], v[66:73], v240
s_waitcnt vmcnt(1)
v_cmp_eq_u32 vcc, -1, v201
v_smfmac_f32_16x16x64_bf16 v[222:225], v[194:197], v[98:105], v240
s_cbranch_vccnz qF6_1_0_178
s_branch qB6_1_0_179
qF7_0_0_214:
buffer_load_dwordx4 v[194:197], v241, s[4:7], s38 offen offset:0 sc1
s_add_u32 s19, s19, 1
s_cmp_gt_u32 s19, 1048576
s_cbranch_scc1 L_end
s_waitcnt vmcnt(2)
v_cmp_eq_u32 vcc, -1, v201
s_cbranch_vccnz qF7_1_0_216
s_branch qB7_1_0_217
qB7_1_0_217:
v_smfmac_f32_16x16x64_bf16 v[210:213], v[198:201], v[10:17], v240
v_smfmac_f32_16x16x64_bf16 v[214:217], v[198:201], v[42:49], v240
v_smfmac_f32_16x16x64_bf16 v[218:221], v[198:201], v[74:81], v240
s_waitcnt vmcnt(1)
v_cmp_eq_u32 vcc, -1, v205
v_smfmac_f32_16x16x64_bf16 v[222:225], v[198:201], v[106:113], v240
s_cbranch_vccnz qF5_2_0_196
s_branch qB5_2_0_197
qF7_1_0_216:
buffer_load_dwordx4 v[198:201], v241, s[4:7], s38 offen offset:1024 sc1
s_add_u32 s19, s19, 1
s_cmp_gt_u32 s19, 1048576
s_cbranch_scc1 L_end
s_waitcnt vmcnt(2)
v_cmp_eq_u32 vcc, -1, v205
s_cbranch_vccnz qF7_2_0_218
s_branch qB7_2_0_219
qB7_2_0_219:
v_smfmac_f32_16x16x64_bf16 v[210:213], v[202:205], v[18:25], v240
v_smfmac_f32_16x16x64_bf16 v[214:217], v[202:205], v[50:57], v240
v_smfmac_f32_16x16x64_bf16 v[218:221], v[202:205], v[82:89], v240
s_waitcnt vmcnt(1)
v_cmp_eq_u32 vcc, -1, v197
v_smfmac_f32_16x16x64_bf16 v[222:225], v[202:205], v[114:121], v240
s_cbranch_vccnz qF3_0_0_204
s_branch qB3_0_0_205
qF7_2_0_218:
buffer_load_dwordx4 v[202:205], v241, s[4:7], s38 offen offset:2048 sc1
s_add_u32 s19, s19, 1
s_cmp_gt_u32 s19, 1048576
s_cbranch_scc1 L_end
s_waitcnt vmcnt(2)
v_cmp_eq_u32 vcc, -1, v197
s_cbranch_vccnz qF7_0_0_214
s_branch qB7_0_0_215
qF15_3_0_212:
buffer_load_dwordx4 v[206:209], v241, s[4:7], s38 offen offset:3072 sc1
s_add_u32 s19, s19, 1
s_cmp_gt_u32 s19, 1048576
s_cbranch_scc1 L_end
s_waitcnt vmcnt(3)
v_cmp_eq_u32 vcc, -1, v197
s_cbranch_vccnz qF15_0_0_156
s_branch qB15_0_0_157
qfl_232:
s_add_u32 s19, s19, 1
s_cmp_gt_u32 s19, 1048576
s_cbranch_scc1 L_end
buffer_load_dword v1, v247, s[4:7], s45 offen sc1
s_waitcnt vmcnt(0)
v_readfirstlane_b32 s43, v1
s_cmp_gt_u32 s43, s18
s_cbranch_scc0 qfl_232
s_branch qfl_233
qslow_153:
s_branch qloop_236
.p2align 6
s_nop 0
s_nop 0
s_nop 0
s_nop 0
qloop_236:
s_setprio 2
s_barrier
buffer_load_dwordx4 v[194:197], v241, s[4:7], s38 offen offset:0 sc1
s_nop 15
buffer_load_dwordx4 v[198:201], v241, s[4:7], s38 offen offset:1024 sc1
s_nop 15
buffer_load_dwordx4 v[202:205], v241, s[4:7], s38 offen offset:2048 sc1
s_nop 15
buffer_load_dwordx4 v[206:209], v241, s[4:7], s38 offen offset:3072 sc1
s_waitcnt vmcnt(3)
v_max3_u32 v248, v194, v195, v196
v_max_u32 v248, v248, v197
v_cmp_eq_u32 vcc, -1, v248
s_cbranch_vccnz qF15_0_0_238
qB15_0_0_239:
v_smfmac_f32_16x16x64_bf16 v[210:213], v[194:197], v[2:9], v240
s_waitcnt vmcnt(2)
v_max3_u32 v248, v198, v199, v200
v_smfmac_f32_16x16x64_bf16 v[214:217], v[194:197], v[34:41], v240
v_max_u32 v248, v248, v201
v_smfmac_f32_16x16x64_bf16 v[218:221], v[194:197], v[66:73], v240
v_cmp_eq_u32 vcc, -1, v248
v_smfmac_f32_16x16x64_bf16 v[222:225], v[194:197], v[98:105], v240
s_cbranch_vccnz qF14_1_0_240
qB14_1_0_241:
v_smfmac_f32_16x16x64_bf16 v[210:213], v[198:201], v[10:17], v240
s_waitcnt vmcnt(1)
v_max3_u32 v248, v202, v203, v204
v_smfmac_f32_16x16x64_bf16 v[214:217], v[198:201], v[42:49], v240
v_max_u32 v248, v248, v205
v_smfmac_f32_16x16x64_bf16 v[218:221], v[198:201], v[74:81], v240
v_cmp_eq_u32 vcc, -1, v248
v_smfmac_f32_16x16x64_bf16 v[222:225], v[198:201], v[106:113], v240
s_cbranch_vccnz qF12_2_0_242
qB12_2_0_243:
v_smfmac_f32_16x16x64_bf16 v[210:213], v[202:205], v[18:25], v240
s_waitcnt vmcnt(0)
v_max3_u32 v248, v206, v207, v208
v_smfmac_f32_16x16x64_bf16 v[214:217], v[202:205], v[50:57], v240
v_max_u32 v248, v248, v209
v_smfmac_f32_16x16x64_bf16 v[218:221], v[202:205], v[82:89], v240
v_cmp_eq_u32 vcc, -1, v248
v_smfmac_f32_16x16x64_bf16 v[222:225], v[202:205], v[114:121], v240
s_cbranch_vccnz qF8_3_0_244
qB8_3_0_245:
v_smfmac_f32_16x16x64_bf16 v[210:213], v[206:209], v[26:33], v240
v_smfmac_f32_16x16x64_bf16 v[214:217], v[206:209], v[58:65], v240
v_smfmac_f32_16x16x64_bf16 v[218:221], v[206:209], v[90:97], v240
v_smfmac_f32_16x16x64_bf16 v[222:225], v[206:209], v[122:129], v240
v_cvt_pk_bf16_f32 v210, v210, v211
v_cvt_pk_bf16_f32 v211, v212, v213
v_smfmac_f32_16x16x64_bf16 v[226:229], v[194:197], v[130:137], v240
v_cvt_pk_bf16_f32 v212, v214, v215
v_cvt_pk_bf16_f32 v213, v216, v217
ds_write_b128 v242, v[210:213] offset:0
qdone_237:
v_cvt_pk_bf16_f32 v218, v218, v219
v_cvt_pk_bf16_f32 v219, v220, v221
v_cvt_pk_bf16_f32 v220, v222, v223
v_cvt_pk_bf16_f32 v221, v224, v225
ds_write_b128 v242, v[218:221] offset:1024
v_smfmac_f32_16x16x64_bf16 v[230:233], v[194:197], v[162:169], v240
v_smfmac_f32_16x16x64_bf16 v[226:229], v[198:201], v[138:145], v240
v_smfmac_f32_16x16x64_bf16 v[230:233], v[198:201], v[170:177], v240
s_waitcnt lgkmcnt(0)
s_barrier
ds_read_b128 v[218:221], v243
ds_read_b128 v[222:225], v243 offset:512
v_smfmac_f32_16x16x64_bf16 v[226:229], v[202:205], v[146:153], v240
v_smfmac_f32_16x16x64_bf16 v[230:233], v[202:205], v[178:185], v240
v_smfmac_f32_16x16x64_bf16 v[226:229], v[206:209], v[154:161], v240
v_smfmac_f32_16x16x64_bf16 v[230:233], v[206:209], v[186:193], v240
s_waitcnt lgkmcnt(1)
v_mfma_f32_16x16x32_bf16 v[214:217], v[218:221], v[234:237], 0
s_waitcnt lgkmcnt(0)
v_mfma_f32_16x16x32_bf16 v[214:217], v[222:225], v[234:237], v[214:217]
s_nop 2
v_cvt_pk_bf16_f32 v226, v226, v227
v_cvt_pk_bf16_f32 v227, v228, v229
v_cvt_pk_bf16_f32 v228, v230, v231
v_cvt_pk_bf16_f32 v229, v232, v233
ds_write_b128 v242, v[226:229] offset:2048
v_cvt_pk_bf16_f32 v238, v214, v215
v_cvt_pk_bf16_f32 v239, v216, v217
v_min_u32 v238, -2, v238
v_min_u32 v239, -2, v239
buffer_store_dwordx2 v[238:239], v244, s[4:7], s39 offen sc1
s_cmp_ge_u32 s12, 2
s_waitcnt lgkmcnt(0)
s_barrier
s_cbranch_scc1 qnv_302
ds_read_b128 v[218:221], v243 offset:2048
ds_read_b128 v[222:225], v243 offset:2560
s_waitcnt lgkmcnt(1)
v_mfma_f32_16x16x32_bf16 v[214:217], v[234:237], v[218:221], 0
s_waitcnt lgkmcnt(0)
v_mfma_f32_16x16x32_bf16 v[214:217], v[234:237], v[222:225], v[214:217]
s_nop 7
v_cvt_pk_bf16_f32 v250, v214, v215
v_cvt_pk_bf16_f32 v251, v216, v217
v_min_u32 v250, -2, v250
v_min_u32 v251, -2, v251
buffer_store_dwordx2 v[250:251], v246, s[4:7], s40 offen sc1
qnv_302:
v_min_u32 v238, -2, v238
s_add_u32 s18, s18, 1
s_cmp_ge_u32 s18, 64
s_cbranch_scc1 qlast_303
s_setprio 0
v_mov_b32 v210, 0
v_mov_b32 v211, 0
v_mov_b32 v212, 0
v_mov_b32 v213, 0
v_mov_b32 v214, 0
v_mov_b32 v215, 0
v_mov_b32 v216, 0
v_mov_b32 v217, 0
v_mov_b32 v218, 0
v_mov_b32 v219, 0
v_mov_b32 v220, 0
v_mov_b32 v221, 0
v_mov_b32 v222, 0
v_mov_b32 v223, 0
v_mov_b32 v224, 0
v_mov_b32 v225, 0
v_mov_b32 v226, 0
v_mov_b32 v227, 0
v_mov_b32 v228, 0
v_mov_b32 v229, 0
v_mov_b32 v230, 0
v_mov_b32 v231, 0
v_mov_b32 v232, 0
v_mov_b32 v233, 0
v_mov_b32 v194, -1
v_mov_b32 v195, -1
v_mov_b32 v196, -1
v_mov_b32 v197, -1
s_barrier
s_mov_b32 s53, 1
s_cmp_lt_u32 s18, 1
s_cbranch_scc1 qsk_304
s_cmp_gt_u32 s43, s18
s_cselect_b32 s53, 0, 1
s_cbranch_scc0 qsk_304
s_lshl_b32 s20, s18, 14
s_xor_b32 s20, s20, s44
buffer_load_dwordx4 v[210:213], v241, s[4:7], s20 offen offset:0 sc1
buffer_load_dwordx4 v[214:217], v241, s[4:7], s20 offen offset:1024 sc1
buffer_load_dwordx4 v[218:221], v241, s[4:7], s20 offen offset:2048 sc1
buffer_load_dwordx4 v[222:225], v241, s[4:7], s20 offen offset:3072 sc1
qsk_304:
s_add_u32 s20, s18, 1
s_cmp_gt_u32 s43, s20
s_cbranch_scc0 qnp_305
s_lshl_b32 s20, s20, 14
s_xor_b32 s20, s20, s44
s_lshl_b32 s21, s35, 10
s_add_u32 s20, s20, s21
buffer_load_dwordx4 v[198:201], v241, s[4:7], s20 offen sc1
qnp_305:
s_cmp_eq_u32 s51, 0
s_cbranch_scc1 cp_306
s_sub_u32 s20, s18, 1
s_lshl_b32 s20, s20, 14
s_xor_b32 s20, s20, s42
buffer_store_dwordx2 v[238:239], v252, s[4:7], s20 offen sc1
s_add_u32 s20, s18, 1
s_lshl_b32 s20, s20, 14
s_xor_b32 s20, s20, s42
buffer_store_dwordx2 v[194:195], v252, s[4:7], s20 offen sc1
cp_306:
s_cmp_ge_u32 s12, 2
s_cbranch_scc1 cp_307
s_sub_u32 s20, s18, 1
s_lshl_b32 s20, s20, 14
s_xor_b32 s20, s20, s52
buffer_store_dwordx2 v[250:251], v246, s[4:7], s20 offen sc1
s_add_u32 s20, s18, 1
s_lshl_b32 s20, s20, 14
s_xor_b32 s20, s20, s52
buffer_store_dwordx2 v[194:195], v246, s[4:7], s20 offen sc1
cp_307:
s_cmp_lt_u32 s12, 2
s_cbranch_scc1 rd_308
s_lshl_b32 s20, s50, 19
s_add_u32 s20, s20, s17
buffer_store_dwordx4 v[194:197], v245, s[4:7], s20 offen sc1
rd_308:
s_add_u32 s20, s18, 3
s_min_u32 s20, s20, 63
s_cmp_gt_u32 s43, s20
s_cbranch_scc1 qnf_309
buffer_load_dword v1, v247, s[4:7], s45 offen sc1
qnf_309:
s_barrier
s_barrier
s_cmp_ge_u32 s12, 2
s_cbranch_scc1 rd_311
s_cmp_eq_u32 s12, 1
s_cbranch_scc1 r1_310
s_lshl_b32 s20, s50, 17
s_add_u32 s20, s20, s48
buffer_store_dwordx4 v[194:197], v241, s[4:7], s20 offen sc1
s_branch rd_311
r1_310:
s_lshl_b32 s20, s50, 16
buffer_store_dwordx4 v[194:197], v245, s[4:7], s20 offen sc1
rd_311:
s_cmp_eq_u32 s53, 0
s_cbranch_scc1 qnl_312
s_waitcnt vmcnt(0)
v_readfirstlane_b32 s43, v1
s_barrier
s_cmp_lt_u32 s18, 1
s_cbranch_scc1 qnl_313
s_cmp_gt_u32 s43, s18
s_cbranch_scc0 qfl_314
qfl_315:
s_lshl_b32 s20, s18, 14
s_xor_b32 s20, s20, s44
s_mov_b32 m0, s49
s_nop 0
buffer_load_dwordx4 v241, s[4:7], s20 offen offset:0 sc1 lds
buffer_load_dwordx4 v241, s[4:7], s20 offen offset:1024 sc1 lds
buffer_load_dwordx4 v241, s[4:7], s20 offen offset:2048 sc1 lds
buffer_load_dwordx4 v241, s[4:7], s20 offen offset:3072 sc1 lds
s_lshl_b32 s20, s18, 14
s_xor_b32 s20, s20, s44
s_add_u32 s20, s20, 4096
s_add_u32 m0, s49, 4096
s_nop 0
buffer_load_dwordx4 v241, s[4:7], s20 offen offset:0 sc1 lds
buffer_load_dwordx4 v241, s[4:7], s20 offen offset:1024 sc1 lds
buffer_load_dwordx4 v241, s[4:7], s20 offen offset:2048 sc1 lds
buffer_load_dwordx4 v241, s[4:7], s20 offen offset:3072 sc1 lds
s_branch qnl_313
qnl_312:
s_lshl_b32 s20, s18, 14
s_xor_b32 s20, s20, s44
s_add_u32 s20, s20, 4096
s_add_u32 m0, s49, 4096
s_nop 0
buffer_load_dwordx4 v241, s[4:7], s20 offen offset:0 sc1 lds
buffer_load_dwordx4 v241, s[4:7], s20 offen offset:1024 sc1 lds
buffer_load_dwordx4 v241, s[4:7], s20 offen offset:2048 sc1 lds
buffer_load_dwordx4 v241, s[4:7], s20 offen offset:3072 sc1 lds
s_and_b32 s20, s18, 3
s_lshl_b32 s38, s20, 16
s_add_u32 s40, s38, s46
s_add_u32 s38, s38, s47
s_lshl_b32 s39, s20, 17
s_add_u32 s39, s39, 2359296
s_xor_b32 s50, s20, 2
s_barrier
v_add_u32 v248, s49, v241
s_waitcnt vmcnt(0)
ds_write_b128 v248, v[210:213] offset:0
ds_write_b128 v248, v[214:217] offset:1024
ds_write_b128 v248, v[218:221] offset:2048
ds_write_b128 v248, v[222:225] offset:3072
qnl_313:
s_waitcnt lgkmcnt(0)
v_mov_b32 v210, 0
v_mov_b32 v211, 0
v_mov_b32 v212, 0
v_mov_b32 v213, 0
v_mov_b32 v214, 0
v_mov_b32 v215, 0
v_mov_b32 v216, 0
v_mov_b32 v217, 0
v_mov_b32 v218, 0
v_mov_b32 v219, 0
v_mov_b32 v220, 0
v_mov_b32 v221, 0
v_mov_b32 v222, 0
v_mov_b32 v223, 0
v_mov_b32 v224, 0
v_mov_b32 v225, 0
s_and_b32 s20, s18, 3
s_lshl_b32 s38, s20, 16
s_add_u32 s40, s38, s46
s_add_u32 s38, s38, s47
s_lshl_b32 s39, s20, 17
s_add_u32 s39, s39, 2359296
s_xor_b32 s50, s20, 2
s_waitcnt vmcnt(0)
v_readfirstlane_b32 s43, v1
s_branch qloop_236
qlast_303:
s_cmp_eq_u32 s51, 0
s_cbranch_scc1 cp_316
s_sub_u32 s20, s18, 1
s_lshl_b32 s20, s20, 14
s_xor_b32 s20, s20, s42
buffer_store_dwordx2 v[238:239], v252, s[4:7], s20 offen sc1
cp_316:
s_cmp_ge_u32 s12, 2
s_cbranch_scc1 cp_317
s_sub_u32 s20, s18, 1
s_lshl_b32 s20, s20, 14
s_xor_b32 s20, s20, s52
buffer_store_dwordx2 v[250:251], v246, s[4:7], s20 offen sc1
cp_317:
s_waitcnt vmcnt(0)
s_endpgm
qF8_3_0_244:
buffer_load_dwordx4 v[206:209], v241, s[4:7], s38 offen offset:3072 sc1
s_add_u32 s19, s19, 1
s_cmp_gt_u32 s19, 1048576
s_cbranch_scc1 L_end
s_waitcnt vmcnt(0)
v_max3_u32 v248, v206, v207, v208
v_max_u32 v248, v248, v209
v_cmp_eq_u32 vcc, -1, v248
s_cbranch_vccnz qF8_3_0_244
s_branch qB8_3_0_245
qF12_2_0_242:
buffer_load_dwordx4 v[202:205], v241, s[4:7], s38 offen offset:2048 sc1
s_add_u32 s19, s19, 1
s_cmp_gt_u32 s19, 1048576
s_cbranch_scc1 L_end
s_waitcnt vmcnt(1)
v_max3_u32 v248, v206, v207, v208
v_max_u32 v248, v248, v209
v_cmp_eq_u32 vcc, -1, v248
s_cbranch_vccnz qF12_3_0_246
s_branch qB12_3_0_247
qB12_3_0_247:
v_smfmac_f32_16x16x64_bf16 v[210:213], v[206:209], v[26:33], v240
s_waitcnt vmcnt(0)
v_max3_u32 v248, v202, v203, v204
v_smfmac_f32_16x16x64_bf16 v[214:217], v[206:209], v[58:65], v240
v_max_u32 v248, v248, v205
v_smfmac_f32_16x16x64_bf16 v[218:221], v[206:209], v[90:97], v240
v_cmp_eq_u32 vcc, -1, v248
v_smfmac_f32_16x16x64_bf16 v[222:225], v[206:209], v[122:129], v240
s_cbranch_vccnz qF4_2_0_248
s_branch qB4_2_0_249
qB4_2_0_249:
v_smfmac_f32_16x16x64_bf16 v[210:213], v[202:205], v[18:25], v240
v_smfmac_f32_16x16x64_bf16 v[214:217], v[202:205], v[50:57], v240
v_smfmac_f32_16x16x64_bf16 v[218:221], v[202:205], v[82:89], v240
v_smfmac_f32_16x16x64_bf16 v[222:225], v[202:205], v[114:121], v240
v_cvt_pk_bf16_f32 v210, v210, v211
v_cvt_pk_bf16_f32 v211, v212, v213
v_smfmac_f32_16x16x64_bf16 v[226:229], v[194:197], v[130:137], v240
v_cvt_pk_bf16_f32 v212, v214, v215
v_cvt_pk_bf16_f32 v213, v216, v217
ds_write_b128 v242, v[210:213] offset:0
s_branch qdone_237
qF4_2_0_248:
buffer_load_dwordx4 v[202:205], v241, s[4:7], s38 offen offset:2048 sc1
s_add_u32 s19, s19, 1
s_cmp_gt_u32 s19, 1048576
s_cbranch_scc1 L_end
s_waitcnt vmcnt(0)
v_max3_u32 v248, v202, v203, v204
v_max_u32 v248, v248, v205
v_cmp_eq_u32 vcc, -1, v248
s_cbranch_vccnz qF4_2_0_248
s_branch qB4_2_0_249
qF12_3_0_246:
buffer_load_dwordx4 v[206:209], v241, s[4:7], s38 offen offset:3072 sc1
s_add_u32 s19, s19, 1
s_cmp_gt_u32 s19, 1048576
s_cbranch_scc1 L_end
s_waitcnt vmcnt(1)
v_max3_u32 v248, v202, v203, v204
v_max_u32 v248, v248, v205
v_cmp_eq_u32 vcc, -1, v248
s_cbranch_vccnz qF12_2_0_242
s_branch qB12_2_0_243
qF14_1_0_240:
buffer_load_dwordx4 v[198:201], v241, s[4:7], s38 offen offset:1024 sc1
s_add_u32 s19, s19, 1
s_cmp_gt_u32 s19, 1048576
s_cbranch_scc1 L_end
s_waitcnt vmcnt(2)
v_max3_u32 v248, v202, v203, v204
v_max_u32 v248, v248, v205
v_cmp_eq_u32 vcc, -1, v248
s_cbranch_vccnz qF14_2_0_250
s_branch qB14_2_0_251
qB14_2_0_251:
v_smfmac_f32_16x16x64_bf16 v[210:213], v[202:205], v[18:25], v240
s_waitcnt vmcnt(1)
v_max3_u32 v248, v206, v207, v208
v_smfmac_f32_16x16x64_bf16 v[214:217], v[202:205], v[50:57], v240
v_max_u32 v248, v248, v209
v_smfmac_f32_16x16x64_bf16 v[218:221], v[202:205], v[82:89], v240
v_cmp_eq_u32 vcc, -1, v248
v_smfmac_f32_16x16x64_bf16 v[222:225], v[202:205], v[114:121], v240
s_cbranch_vccnz qF10_3_0_252
s_branch qB10_3_0_253
qB10_3_0_253:
v_smfmac_f32_16x16x64_bf16 v[210:213], v[206:209], v[26:33], v240
s_waitcnt vmcnt(0)
v_max3_u32 v248, v198, v199, v200
v_smfmac_f32_16x16x64_bf16 v[214:217], v[206:209], v[58:65], v240
v_max_u32 v248, v248, v201
v_smfmac_f32_16x16x64_bf16 v[218:221], v[206:209], v[90:97], v240
v_cmp_eq_u32 vcc, -1, v248
v_smfmac_f32_16x16x64_bf16 v[222:225], v[206:209], v[122:129], v240
s_cbranch_vccnz qF2_1_0_254
s_branch qB2_1_0_255
qB2_1_0_255:
v_smfmac_f32_16x16x64_bf16 v[210:213], v[198:201], v[10:17], v240
v_smfmac_f32_16x16x64_bf16 v[214:217], v[198:201], v[42:49], v240
v_smfmac_f32_16x16x64_bf16 v[218:221], v[198:201], v[74:81], v240
v_smfmac_f32_16x16x64_bf16 v[222:225], v[198:201], v[106:113], v240
v_cvt_pk_bf16_f32 v210, v210, v211
v_cvt_pk_bf16_f32 v211, v212, v213
v_smfmac_f32_16x16x64_bf16 v[226:229], v[194:197], v[130:137], v240
v_cvt_pk_bf16_f32 v212, v214, v215
v_cvt_pk_bf16_f32 v213, v216, v217
ds_write_b128 v242, v[210:213] offset:0
s_branch qdone_237
qF2_1_0_254:
buffer_load_dwordx4 v[198:201], v241, s[4:7], s38 offen offset:1024 sc1
s_add_u32 s19, s19, 1
s_cmp_gt_u32 s19, 1048576
s_cbranch_scc1 L_end
s_waitcnt vmcnt(0)
v_max3_u32 v248, v198, v199, v200
v_max_u32 v248, v248, v201
v_cmp_eq_u32 vcc, -1, v248
s_cbranch_vccnz qF2_1_0_254
s_branch qB2_1_0_255
qF10_3_0_252:
buffer_load_dwordx4 v[206:209], v241, s[4:7], s38 offen offset:3072 sc1
s_add_u32 s19, s19, 1
s_cmp_gt_u32 s19, 1048576
s_cbranch_scc1 L_end
s_waitcnt vmcnt(1)
v_max3_u32 v248, v198, v199, v200
v_max_u32 v248, v248, v201
v_cmp_eq_u32 vcc, -1, v248
s_cbranch_vccnz qF10_1_0_256
s_branch qB10_1_0_257
qB10_1_0_257:
v_smfmac_f32_16x16x64_bf16 v[210:213], v[198:201], v[10:17], v240
s_waitcnt vmcnt(0)
v_max3_u32 v248, v206, v207, v208
v_smfmac_f32_16x16x64_bf16 v[214:217], v[198:201], v[42:49], v240
v_max_u32 v248, v248, v209
v_smfmac_f32_16x16x64_bf16 v[218:221], v[198:201], v[74:81], v240
v_cmp_eq_u32 vcc, -1, v248
v_smfmac_f32_16x16x64_bf16 v[222:225], v[198:201], v[106:113], v240
s_cbranch_vccnz qF8_3_0_244
s_branch qB8_3_0_245
qF10_1_0_256:
buffer_load_dwordx4 v[198:201], v241, s[4:7], s38 offen offset:1024 sc1
s_add_u32 s19, s19, 1
s_cmp_gt_u32 s19, 1048576
s_cbranch_scc1 L_end
s_waitcnt vmcnt(1)
v_max3_u32 v248, v206, v207, v208
v_max_u32 v248, v248, v209
v_cmp_eq_u32 vcc, -1, v248
s_cbranch_vccnz qF10_3_0_252
s_branch qB10_3_0_253
qF14_2_0_250:
buffer_load_dwordx4 v[202:205], v241, s[4:7], s38 offen offset:2048 sc1
s_add_u32 s19, s19, 1
s_cmp_gt_u32 s19, 1048576
s_cbranch_scc1 L_end
s_waitcnt vmcnt(2)
v_max3_u32 v248, v206, v207, v208
v_max_u32 v248, v248, v209
v_cmp_eq_u32 vcc, -1, v248
s_cbranch_vccnz qF14_3_0_258
s_branch qB14_3_0_259
qB14_3_0_259:
v_smfmac_f32_16x16x64_bf16 v[210:213], v[206:209], v[26:33], v240
s_waitcnt vmcnt(1)
v_max3_u32 v248, v198, v199, v200
v_smfmac_f32_16x16x64_bf16 v[214:217], v[206:209], v[58:65], v240
v_max_u32 v248, v248, v201
v_smfmac_f32_16x16x64_bf16 v[218:221], v[206:209], v[90:97], v240
v_cmp_eq_u32 vcc, -1, v248
v_smfmac_f32_16x16x64_bf16 v[222:225], v[206:209], v[122:129], v240
s_cbranch_vccnz qF6_1_0_260
s_branch qB6_1_0_261
qB6_1_0_261:
v_smfmac_f32_16x16x64_bf16 v[210:213], v[198:201], v[10:17], v240
s_waitcnt vmcnt(0)
v_max3_u32 v248, v202, v203, v204
v_smfmac_f32_16x16x64_bf16 v[214:217], v[198:201], v[42:49], v240
v_max_u32 v248, v248, v205
v_smfmac_f32_16x16x64_bf16 v[218:221], v[198:201], v[74:81], v240
v_cmp_eq_u32 vcc, -1, v248
v_smfmac_f32_16x16x64_bf16 v[222:225], v[198:201], v[106:113], v240
s_cbranch_vccnz qF4_2_0_248
s_branch qB4_2_0_249
qF6_1_0_260:
buffer_load_dwordx4 v[198:201], v241, s[4:7], s38 offen offset:1024 sc1
s_add_u32 s19, s19, 1
s_cmp_gt_u32 s19, 1048576
s_cbranch_scc1 L_end
s_waitcnt vmcnt(1)
v_max3_u32 v248, v202, v203, v204
v_max_u32 v248, v248, v205
v_cmp_eq_u32 vcc, -1, v248
s_cbranch_vccnz qF6_2_0_262
s_branch qB6_2_0_263
qB6_2_0_263:
v_smfmac_f32_16x16x64_bf16 v[210:213], v[202:205], v[18:25], v240
s_waitcnt vmcnt(0)
v_max3_u32 v248, v198, v199, v200
v_smfmac_f32_16x16x64_bf16 v[214:217], v[202:205], v[50:57], v240
v_max_u32 v248, v248, v201
v_smfmac_f32_16x16x64_bf16 v[218:221], v[202:205], v[82:89], v240
v_cmp_eq_u32 vcc, -1, v248
v_smfmac_f32_16x16x64_bf16 v[222:225], v[202:205], v[114:121], v240
s_cbranch_vccnz qF2_1_0_254
s_branch qB2_1_0_255
qF6_2_0_262:
buffer_load_dwordx4 v[202:205], v241, s[4:7], s38 offen offset:2048 sc1
s_add_u32 s19, s19, 1
s_cmp_gt_u32 s19, 1048576
s_cbranch_scc1 L_end
s_waitcnt vmcnt(1)
v_max3_u32 v248, v198, v199, v200
v_max_u32 v248, v248, v201
v_cmp_eq_u32 vcc, -1, v248
s_cbranch_vccnz qF6_1_0_260
s_branch qB6_1_0_261
qF14_3_0_258:
buffer_load_dwordx4 v[206:209], v241, s[4:7], s38 offen offset:3072 sc1
s_add_u32 s19, s19, 1
s_cmp_gt_u32 s19, 1048576
s_cbranch_scc1 L_end
s_waitcnt vmcnt(2)
v_max3_u32 v248, v198, v199, v200
v_max_u32 v248, v248, v201
v_cmp_eq_u32 vcc, -1, v248
s_cbranch_vccnz qF14_1_0_240
s_branch qB14_1_0_241
qF15_0_0_238:
buffer_load_dwordx4 v[194:197], v241, s[4:7], s38 offen offset:0 sc1
s_add_u32 s19, s19, 1
s_cmp_gt_u32 s19, 1048576
s_cbranch_scc1 L_end
s_waitcnt vmcnt(3)
v_max3_u32 v248, v198, v199, v200
v_max_u32 v248, v248, v201
v_cmp_eq_u32 vcc, -1, v248
s_cbranch_vccnz qF15_1_0_264
s_branch qB15_1_0_265
qB15_1_0_265:
v_smfmac_f32_16x16x64_bf16 v[210:213], v[198:201], v[10:17], v240
s_waitcnt vmcnt(2)
v_max3_u32 v248, v202, v203, v204
v_smfmac_f32_16x16x64_bf16 v[214:217], v[198:201], v[42:49], v240
v_max_u32 v248, v248, v205
v_smfmac_f32_16x16x64_bf16 v[218:221], v[198:201], v[74:81], v240
v_cmp_eq_u32 vcc, -1, v248
v_smfmac_f32_16x16x64_bf16 v[222:225], v[198:201], v[106:113], v240
s_cbranch_vccnz qF13_2_0_266
s_branch qB13_2_0_267
qB13_2_0_267:
v_smfmac_f32_16x16x64_bf16 v[210:213], v[202:205], v[18:25], v240
s_waitcnt vmcnt(1)
v_max3_u32 v248, v206, v207, v208
v_smfmac_f32_16x16x64_bf16 v[214:217], v[202:205], v[50:57], v240
v_max_u32 v248, v248, v209
v_smfmac_f32_16x16x64_bf16 v[218:221], v[202:205], v[82:89], v240
v_cmp_eq_u32 vcc, -1, v248
v_smfmac_f32_16x16x64_bf16 v[222:225], v[202:205], v[114:121], v240
s_cbranch_vccnz qF9_3_0_268
s_branch qB9_3_0_269
qB9_3_0_269:
v_smfmac_f32_16x16x64_bf16 v[210:213], v[206:209], v[26:33], v240
s_waitcnt vmcnt(0)
v_max3_u32 v248, v194, v195, v196
v_smfmac_f32_16x16x64_bf16 v[214:217], v[206:209], v[58:65], v240
v_max_u32 v248, v248, v197
v_smfmac_f32_16x16x64_bf16 v[218:221], v[206:209], v[90:97], v240
v_cmp_eq_u32 vcc, -1, v248
v_smfmac_f32_16x16x64_bf16 v[222:225], v[206:209], v[122:129], v240
s_cbranch_vccnz qF1_0_0_270
s_branch qB1_0_0_271
qB1_0_0_271:
v_smfmac_f32_16x16x64_bf16 v[210:213], v[194:197], v[2:9], v240
v_smfmac_f32_16x16x64_bf16 v[214:217], v[194:197], v[34:41], v240
v_smfmac_f32_16x16x64_bf16 v[218:221], v[194:197], v[66:73], v240
v_smfmac_f32_16x16x64_bf16 v[222:225], v[194:197], v[98:105], v240
v_cvt_pk_bf16_f32 v210, v210, v211
v_cvt_pk_bf16_f32 v211, v212, v213
v_smfmac_f32_16x16x64_bf16 v[226:229], v[194:197], v[130:137], v240
v_cvt_pk_bf16_f32 v212, v214, v215
v_cvt_pk_bf16_f32 v213, v216, v217
ds_write_b128 v242, v[210:213] offset:0
s_branch qdone_237
qF1_0_0_270:
buffer_load_dwordx4 v[194:197], v241, s[4:7], s38 offen offset:0 sc1
s_add_u32 s19, s19, 1
s_cmp_gt_u32 s19, 1048576
s_cbranch_scc1 L_end
s_waitcnt vmcnt(0)
v_max3_u32 v248, v194, v195, v196
v_max_u32 v248, v248, v197
v_cmp_eq_u32 vcc, -1, v248
s_cbranch_vccnz qF1_0_0_270
s_branch qB1_0_0_271
qF9_3_0_268:
buffer_load_dwordx4 v[206:209], v241, s[4:7], s38 offen offset:3072 sc1
s_add_u32 s19, s19, 1
s_cmp_gt_u32 s19, 1048576
s_cbranch_scc1 L_end
s_waitcnt vmcnt(1)
v_max3_u32 v248, v194, v195, v196
v_max_u32 v248, v248, v197
v_cmp_eq_u32 vcc, -1, v248
s_cbranch_vccnz qF9_0_0_272
s_branch qB9_0_0_273
qB9_0_0_273:
v_smfmac_f32_16x16x64_bf16 v[210:213], v[194:197], v[2:9], v240
s_waitcnt vmcnt(0)
v_max3_u32 v248, v206, v207, v208
v_smfmac_f32_16x16x64_bf16 v[214:217], v[194:197], v[34:41], v240
v_max_u32 v248, v248, v209
v_smfmac_f32_16x16x64_bf16 v[218:221], v[194:197], v[66:73], v240
v_cmp_eq_u32 vcc, -1, v248
v_smfmac_f32_16x16x64_bf16 v[222:225], v[194:197], v[98:105], v240
s_cbranch_vccnz qF8_3_0_244
s_branch qB8_3_0_245
qF9_0_0_272:
buffer_load_dwordx4 v[194:197], v241, s[4:7], s38 offen offset:0 sc1
s_add_u32 s19, s19, 1
s_cmp_gt_u32 s19, 1048576
s_cbranch_scc1 L_end
s_waitcnt vmcnt(1)
v_max3_u32 v248, v206, v207, v208
v_max_u32 v248, v248, v209
v_cmp_eq_u32 vcc, -1, v248
s_cbranch_vccnz qF9_3_0_268
s_branch qB9_3_0_269
qF13_2_0_266:
buffer_load_dwordx4 v[202:205], v241, s[4:7], s38 offen offset:2048 sc1
s_add_u32 s19, s19, 1
s_cmp_gt_u32 s19, 1048576
s_cbranch_scc1 L_end
s_waitcnt vmcnt(2)
v_max3_u32 v248, v206, v207, v208
v_max_u32 v248, v248, v209
v_cmp_eq_u32 vcc, -1, v248
s_cbranch_vccnz qF13_3_0_274
s_branch qB13_3_0_275
qB13_3_0_275:
v_smfmac_f32_16x16x64_bf16 v[210:213], v[206:209], v[26:33], v240
s_waitcnt vmcnt(1)
v_max3_u32 v248, v194, v195, v196
v_smfmac_f32_16x16x64_bf16 v[214:217], v[206:209], v[58:65], v240
v_max_u32 v248, v248, v197
v_smfmac_f32_16x16x64_bf16 v[218:221], v[206:209], v[90:97], v240
v_cmp_eq_u32 vcc, -1, v248
v_smfmac_f32_16x16x64_bf16 v[222:225], v[206:209], v[122:129], v240
s_cbranch_vccnz qF5_0_0_276
s_branch qB5_0_0_277
qB5_0_0_277:
v_smfmac_f32_16x16x64_bf16 v[210:213], v[194:197], v[2:9], v240
s_waitcnt vmcnt(0)
v_max3_u32 v248, v202, v203, v204
v_smfmac_f32_16x16x64_bf16 v[214:217], v[194:197], v[34:41], v240
v_max_u32 v248, v248, v205
v_smfmac_f32_16x16x64_bf16 v[218:221], v[194:197], v[66:73], v240
v_cmp_eq_u32 vcc, -1, v248
v_smfmac_f32_16x16x64_bf16 v[222:225], v[194:197], v[98:105], v240
s_cbranch_vccnz qF4_2_0_248
s_branch qB4_2_0_249
qF5_0_0_276:
buffer_load_dwordx4 v[194:197], v241, s[4:7], s38 offen offset:0 sc1
s_add_u32 s19, s19, 1
s_cmp_gt_u32 s19, 1048576
s_cbranch_scc1 L_end
s_waitcnt vmcnt(1)
v_max3_u32 v248, v202, v203, v204
v_max_u32 v248, v248, v205
v_cmp_eq_u32 vcc, -1, v248
s_cbranch_vccnz qF5_2_0_278
s_branch qB5_2_0_279
qB5_2_0_279:
v_smfmac_f32_16x16x64_bf16 v[210:213], v[202:205], v[18:25], v240
s_waitcnt vmcnt(0)
v_max3_u32 v248, v194, v195, v196
v_smfmac_f32_16x16x64_bf16 v[214:217], v[202:205], v[50:57], v240
v_max_u32 v248, v248, v197
v_smfmac_f32_16x16x64_bf16 v[218:221], v[202:205], v[82:89], v240
v_cmp_eq_u32 vcc, -1, v248
v_smfmac_f32_16x16x64_bf16 v[222:225], v[202:205], v[114:121], v240
s_cbranch_vccnz qF1_0_0_270
s_branch qB1_0_0_271
qF5_2_0_278:
buffer_load_dwordx4 v[202:205], v241, s[4:7], s38 offen offset:2048 sc1
s_add_u32 s19, s19, 1
s_cmp_gt_u32 s19, 1048576
s_cbranch_scc1 L_end
s_waitcnt vmcnt(1)
v_max3_u32 v248, v194, v195, v196
v_max_u32 v248, v248, v197
v_cmp_eq_u32 vcc, -1, v248
s_cbranch_vccnz qF5_0_0_276
s_branch qB5_0_0_277
qF13_3_0_274:
buffer_load_dwordx4 v[206:209], v241, s[4:7], s38 offen offset:3072 sc1
s_add_u32 s19, s19, 1
s_cmp_gt_u32 s19, 1048576
s_cbranch_scc1 L_end
s_waitcnt vmcnt(2)
v_max3_u32 v248, v194, v195, v196
v_max_u32 v248, v248, v197
v_cmp_eq_u32 vcc, -1, v248
s_cbranch_vccnz qF13_0_0_280
s_branch qB13_0_0_281
qB13_0_0_281:
v_smfmac_f32_16x16x64_bf16 v[210:213], v[194:197], v[2:9], v240
s_waitcnt vmcnt(1)
v_max3_u32 v248, v202, v203, v204
v_smfmac_f32_16x16x64_bf16 v[214:217], v[194:197], v[34:41], v240
v_max_u32 v248, v248, v205
v_smfmac_f32_16x16x64_bf16 v[218:221], v[194:197], v[66:73], v240
v_cmp_eq_u32 vcc, -1, v248
v_smfmac_f32_16x16x64_bf16 v[222:225], v[194:197], v[98:105], v240
s_cbranch_vccnz qF12_2_0_242
s_branch qB12_2_0_243
qF13_0_0_280:
buffer_load_dwordx4 v[194:197], v241, s[4:7], s38 offen offset:0 sc1
s_add_u32 s19, s19, 1
s_cmp_gt_u32 s19, 1048576
s_cbranch_scc1 L_end
s_waitcnt vmcnt(2)
v_max3_u32 v248, v202, v203, v204
v_max_u32 v248, v248, v205
v_cmp_eq_u32 vcc, -1, v248
s_cbranch_vccnz qF13_2_0_266
s_branch qB13_2_0_267
qF15_1_0_264:
buffer_load_dwordx4 v[198:201], v241, s[4:7], s38 offen offset:1024 sc1
s_add_u32 s19, s19, 1
s_cmp_gt_u32 s19, 1048576
s_cbranch_scc1 L_end
s_waitcnt vmcnt(3)
v_max3_u32 v248, v202, v203, v204
v_max_u32 v248, v248, v205
v_cmp_eq_u32 vcc, -1, v248
s_cbranch_vccnz qF15_2_0_282
s_branch qB15_2_0_283
qB15_2_0_283:
v_smfmac_f32_16x16x64_bf16 v[210:213], v[202:205], v[18:25], v240
s_waitcnt vmcnt(2)
v_max3_u32 v248, v206, v207, v208
v_smfmac_f32_16x16x64_bf16 v[214:217], v[202:205], v[50:57], v240
v_max_u32 v248, v248, v209
v_smfmac_f32_16x16x64_bf16 v[218:221], v[202:205], v[82:89], v240
v_cmp_eq_u32 vcc, -1, v248
v_smfmac_f32_16x16x64_bf16 v[222:225], v[202:205], v[114:121], v240
s_cbranch_vccnz qF11_3_0_284
s_branch qB11_3_0_285
qB11_3_0_285:
v_smfmac_f32_16x16x64_bf16 v[210:213], v[206:209], v[26:33], v240
s_waitcnt vmcnt(1)
v_max3_u32 v248, v194, v195, v196
v_smfmac_f32_16x16x64_bf16 v[214:217], v[206:209], v[58:65], v240
v_max_u32 v248, v248, v197
v_smfmac_f32_16x16x64_bf16 v[218:221], v[206:209], v[90:97], v240
v_cmp_eq_u32 vcc, -1, v248
v_smfmac_f32_16x16x64_bf16 v[222:225], v[206:209], v[122:129], v240
s_cbranch_vccnz qF3_0_0_286
s_branch qB3_0_0_287
qB3_0_0_287:
v_smfmac_f32_16x16x64_bf16 v[210:213], v[194:197], v[2:9], v240
s_waitcnt vmcnt(0)
v_max3_u32 v248, v198, v199, v200
v_smfmac_f32_16x16x64_bf16 v[214:217], v[194:197], v[34:41], v240
v_max_u32 v248, v248, v201
v_smfmac_f32_16x16x64_bf16 v[218:221], v[194:197], v[66:73], v240
v_cmp_eq_u32 vcc, -1, v248
v_smfmac_f32_16x16x64_bf16 v[222:225], v[194:197], v[98:105], v240
s_cbranch_vccnz qF2_1_0_254
s_branch qB2_1_0_255
qF3_0_0_286:
buffer_load_dwordx4 v[194:197], v241, s[4:7], s38 offen offset:0 sc1
s_add_u32 s19, s19, 1
s_cmp_gt_u32 s19, 1048576
s_cbranch_scc1 L_end
s_waitcnt vmcnt(1)
v_max3_u32 v248, v198, v199, v200
v_max_u32 v248, v248, v201
v_cmp_eq_u32 vcc, -1, v248
s_cbranch_vccnz qF3_1_0_288
s_branch qB3_1_0_289
qB3_1_0_289:
v_smfmac_f32_16x16x64_bf16 v[210:213], v[198:201], v[10:17], v240
s_waitcnt vmcnt(0)
v_max3_u32 v248, v194, v195, v196
v_smfmac_f32_16x16x64_bf16 v[214:217], v[198:201], v[42:49], v240
v_max_u32 v248, v248, v197
v_smfmac_f32_16x16x64_bf16 v[218:221], v[198:201], v[74:81], v240
v_cmp_eq_u32 vcc, -1, v248
v_smfmac_f32_16x16x64_bf16 v[222:225], v[198:201], v[106:113], v240
s_cbranch_vccnz qF1_0_0_270
s_branch qB1_0_0_271
qF3_1_0_288:
buffer_load_dwordx4 v[198:201], v241, s[4:7], s38 offen offset:1024 sc1
s_add_u32 s19, s19, 1
s_cmp_gt_u32 s19, 1048576
s_cbranch_scc1 L_end
s_waitcnt vmcnt(1)
v_max3_u32 v248, v194, v195, v196
v_max_u32 v248, v248, v197
v_cmp_eq_u32 vcc, -1, v248
s_cbranch_vccnz qF3_0_0_286
s_branch qB3_0_0_287
qF11_3_0_284:
buffer_load_dwordx4 v[206:209], v241, s[4:7], s38 offen offset:3072 sc1
s_add_u32 s19, s19, 1
s_cmp_gt_u32 s19, 1048576
s_cbranch_scc1 L_end
s_waitcnt vmcnt(2)
v_max3_u32 v248, v194, v195, v196
v_max_u32 v248, v248, v197
v_cmp_eq_u32 vcc, -1, v248
s_cbranch_vccnz qF11_0_0_290
s_branch qB11_0_0_291
qB11_0_0_291:
v_smfmac_f32_16x16x64_bf16 v[210:213], v[194:197], v[2:9], v240
s_waitcnt vmcnt(1)
v_max3_u32 v248, v198, v199, v200
v_smfmac_f32_16x16x64_bf16 v[214:217], v[194:197], v[34:41], v240
v_max_u32 v248, v248, v201
v_smfmac_f32_16x16x64_bf16 v[218:221], v[194:197], v[66:73], v240
v_cmp_eq_u32 vcc, -1, v248
v_smfmac_f32_16x16x64_bf16 v[222:225], v[194:197], v[98:105], v240
s_cbranch_vccnz qF10_1_0_256
s_branch qB10_1_0_257
qF11_0_0_290:
buffer_load_dwordx4 v[194:197], v241, s[4:7], s38 offen offset:0 sc1
s_add_u32 s19, s19, 1
s_cmp_gt_u32 s19, 1048576
s_cbranch_scc1 L_end
s_waitcnt vmcnt(2)
v_max3_u32 v248, v198, v199, v200
v_max_u32 v248, v248, v201
v_cmp_eq_u32 vcc, -1, v248
s_cbranch_vccnz qF11_1_0_292
s_branch qB11_1_0_293
qB11_1_0_293:
v_smfmac_f32_16x16x64_bf16 v[210:213], v[198:201], v[10:17], v240
s_waitcnt vmcnt(1)
v_max3_u32 v248, v206, v207, v208
v_smfmac_f32_16x16x64_bf16 v[214:217], v[198:201], v[42:49], v240
v_max_u32 v248, v248, v209
v_smfmac_f32_16x16x64_bf16 v[218:221], v[198:201], v[74:81], v240
v_cmp_eq_u32 vcc, -1, v248
v_smfmac_f32_16x16x64_bf16 v[222:225], v[198:201], v[106:113], v240
s_cbranch_vccnz qF9_3_0_268
s_branch qB9_3_0_269
qF11_1_0_292:
buffer_load_dwordx4 v[198:201], v241, s[4:7], s38 offen offset:1024 sc1
s_add_u32 s19, s19, 1
s_cmp_gt_u32 s19, 1048576
s_cbranch_scc1 L_end
s_waitcnt vmcnt(2)
v_max3_u32 v248, v206, v207, v208
v_max_u32 v248, v248, v209
v_cmp_eq_u32 vcc, -1, v248
s_cbranch_vccnz qF11_3_0_284
s_branch qB11_3_0_285
qF15_2_0_282:
buffer_load_dwordx4 v[202:205], v241, s[4:7], s38 offen offset:2048 sc1
s_add_u32 s19, s19, 1
s_cmp_gt_u32 s19, 1048576
s_cbranch_scc1 L_end
s_waitcnt vmcnt(3)
v_max3_u32 v248, v206, v207, v208
v_max_u32 v248, v248, v209
v_cmp_eq_u32 vcc, -1, v248
s_cbranch_vccnz qF15_3_0_294
s_branch qB15_3_0_295
qB15_3_0_295:
v_smfmac_f32_16x16x64_bf16 v[210:213], v[206:209], v[26:33], v240
s_waitcnt vmcnt(2)
v_max3_u32 v248, v194, v195, v196
v_smfmac_f32_16x16x64_bf16 v[214:217], v[206:209], v[58:65], v240
v_max_u32 v248, v248, v197
v_smfmac_f32_16x16x64_bf16 v[218:221], v[206:209], v[90:97], v240
v_cmp_eq_u32 vcc, -1, v248
v_smfmac_f32_16x16x64_bf16 v[222:225], v[206:209], v[122:129], v240
s_cbranch_vccnz qF7_0_0_296
s_branch qB7_0_0_297
qB7_0_0_297:
v_smfmac_f32_16x16x64_bf16 v[210:213], v[194:197], v[2:9], v240
s_waitcnt vmcnt(1)
v_max3_u32 v248, v198, v199, v200
v_smfmac_f32_16x16x64_bf16 v[214:217], v[194:197], v[34:41], v240
v_max_u32 v248, v248, v201
v_smfmac_f32_16x16x64_bf16 v[218:221], v[194:197], v[66:73], v240
v_cmp_eq_u32 vcc, -1, v248
v_smfmac_f32_16x16x64_bf16 v[222:225], v[194:197], v[98:105], v240
s_cbranch_vccnz qF6_1_0_260
s_branch qB6_1_0_261
qF7_0_0_296:
buffer_load_dwordx4 v[194:197], v241, s[4:7], s38 offen offset:0 sc1
s_add_u32 s19, s19, 1
s_cmp_gt_u32 s19, 1048576
s_cbranch_scc1 L_end
s_waitcnt vmcnt(2)
v_max3_u32 v248, v198, v199, v200
v_max_u32 v248, v248, v201
v_cmp_eq_u32 vcc, -1, v248
s_cbranch_vccnz qF7_1_0_298
s_branch qB7_1_0_299
qB7_1_0_299:
v_smfmac_f32_16x16x64_bf16 v[210:213], v[198:201], v[10:17], v240
s_waitcnt vmcnt(1)
v_max3_u32 v248, v202, v203, v204
v_smfmac_f32_16x16x64_bf16 v[214:217], v[198:201], v[42:49], v240
v_max_u32 v248, v248, v205
v_smfmac_f32_16x16x64_bf16 v[218:221], v[198:201], v[74:81], v240
v_cmp_eq_u32 vcc, -1, v248
v_smfmac_f32_16x16x64_bf16 v[222:225], v[198:201], v[106:113], v240
s_cbranch_vccnz qF5_2_0_278
s_branch qB5_2_0_279
qF7_1_0_298:
buffer_load_dwordx4 v[198:201], v241, s[4:7], s38 offen offset:1024 sc1
s_add_u32 s19, s19, 1
s_cmp_gt_u32 s19, 1048576
s_cbranch_scc1 L_end
s_waitcnt vmcnt(2)
v_max3_u32 v248, v202, v203, v204
v_max_u32 v248, v248, v205
v_cmp_eq_u32 vcc, -1, v248
s_cbranch_vccnz qF7_2_0_300
s_branch qB7_2_0_301
qB7_2_0_301:
v_smfmac_f32_16x16x64_bf16 v[210:213], v[202:205], v[18:25], v240
s_waitcnt vmcnt(1)
v_max3_u32 v248, v194, v195, v196
v_smfmac_f32_16x16x64_bf16 v[214:217], v[202:205], v[50:57], v240
v_max_u32 v248, v248, v197
v_smfmac_f32_16x16x64_bf16 v[218:221], v[202:205], v[82:89], v240
v_cmp_eq_u32 vcc, -1, v248
v_smfmac_f32_16x16x64_bf16 v[222:225], v[202:205], v[114:121], v240
s_cbranch_vccnz qF3_0_0_286
s_branch qB3_0_0_287
qF7_2_0_300:
buffer_load_dwordx4 v[202:205], v241, s[4:7], s38 offen offset:2048 sc1
s_add_u32 s19, s19, 1
s_cmp_gt_u32 s19, 1048576
s_cbranch_scc1 L_end
s_waitcnt vmcnt(2)
v_max3_u32 v248, v194, v195, v196
v_max_u32 v248, v248, v197
v_cmp_eq_u32 vcc, -1, v248
s_cbranch_vccnz qF7_0_0_296
s_branch qB7_0_0_297
qF15_3_0_294:
buffer_load_dwordx4 v[206:209], v241, s[4:7], s38 offen offset:3072 sc1
s_add_u32 s19, s19, 1
s_cmp_gt_u32 s19, 1048576
s_cbranch_scc1 L_end
s_waitcnt vmcnt(3)
v_max3_u32 v248, v194, v195, v196
v_max_u32 v248, v248, v197
v_cmp_eq_u32 vcc, -1, v248
s_cbranch_vccnz qF15_0_0_238
s_branch qB15_0_0_239
qfl_314:
s_add_u32 s19, s19, 1
s_cmp_gt_u32 s19, 1048576
s_cbranch_scc1 L_end
buffer_load_dword v1, v247, s[4:7], s45 offen sc1
s_waitcnt vmcnt(0)
v_readfirstlane_b32 s43, v1
s_cmp_gt_u32 s43, s18
s_cbranch_scc0 qfl_314
s_branch qfl_315
chainA_144:
s_lshl_b32 s20, s34, 19
s_lshl_b32 s21, s12, 17
s_add_u32 s20, s20, s21
s_lshl_b32 s21, s35, 8
s_add_u32 s20, s20, s21
v_bfe_u32 v239, v0, 4, 2
v_lshlrev_b32 v237, 11, v239
v_bfe_u32 v239, v0, 0, 4
v_lshl_add_u32 v237, v239, 4, v237
v_add_u32 v237, s20, v237
s_load_dwordx2 s[8:9], s[0:1], 88
s_mov_b32 s10, 8388608
s_mov_b32 s11, 0x20000
s_waitcnt lgkmcnt(0)
s_mov_b32 s20, 0
buffer_load_dwordx4 v[2:5], v237, s[8:11], s20 offen
s_mov_b32 s21, 8192
buffer_load_dwordx4 v[6:9], v237, s[8:11], s21 offen
s_mov_b32 s20, 16384
buffer_load_dwordx4 v[10:13], v237, s[8:11], s20 offen
s_mov_b32 s21, 24576
buffer_load_dwordx4 v[14:17], v237, s[8:11], s21 offen
s_mov_b32 s20, 32768
buffer_load_dwordx4 v[18:21], v237, s[8:11], s20 offen
s_mov_b32 s21, 40960
buffer_load_dwordx4 v[22:25], v237, s[8:11], s21 offen
s_mov_b32 s20, 49152
buffer_load_dwordx4 v[26:29], v237, s[8:11], s20 offen
s_mov_b32 s21, 57344
buffer_load_dwordx4 v[30:33], v237, s[8:11], s21 offen
s_mov_b32 s20, 65536
buffer_load_dwordx4 v[34:37], v237, s[8:11], s20 offen
s_mov_b32 s21, 73728
buffer_load_dwordx4 v[38:41], v237, s[8:11], s21 offen
s_mov_b32 s20, 81920
buffer_load_dwordx4 v[42:45], v237, s[8:11], s20 offen
s_mov_b32 s21, 90112
buffer_load_dwordx4 v[46:49], v237, s[8:11], s21 offen
s_mov_b32 s20, 98304
buffer_load_dwordx4 v[50:53], v237, s[8:11], s20 offen
s_mov_b32 s21, 106496
buffer_load_dwordx4 v[54:57], v237, s[8:11], s21 offen
s_mov_b32 s20, 114688
buffer_load_dwordx4 v[58:61], v237, s[8:11], s20 offen
s_mov_b32 s21, 122880
buffer_load_dwordx4 v[62:65], v237, s[8:11], s21 offen
s_load_dwordx2 s[8:9], s[0:1], 56
s_mov_b32 s10, 16384
s_mov_b32 s11, 0x20000
s_waitcnt lgkmcnt(0)
s_mov_b32 s51, s12
s_lshl_b32 s20, s14, 6
s_lshl_b32 s21, s51, 4
s_add_u32 s20, s20, s21
v_bfe_u32 v239, v0, 0, 4
v_lshlrev_b32 v230, 11, v239
v_bfe_u32 v239, v0, 4, 1
v_lshl_add_u32 v230, v239, 3, v230
v_bfe_u32 v239, v0, 5, 1
v_lshl_add_u32 v230, v239, 2, v230
v_add_u32 v230, s20, v230
buffer_load_dword v208, v230, s[8:11], 0 offen
v_and_b32 v239, 7, v0
v_lshlrev_b32 v239, 5, v239
buffer_load_dwordx2 v[224:225], v239, s[28:31], 0 offen sc1
s_lshl_b32 s20, s13, 14
s_lshl_b32 s21, s14, 9
s_add_u32 s20, s20, s21
s_lshl_b32 s21, s51, 7
s_add_u32 s20, s20, s21
v_bfe_u32 v239, v0, 0, 4
v_lshlrev_b32 v238, 4, v239
v_bfe_u32 v239, v0, 4, 1
v_lshl_add_u32 v238, v239, 3, v238
v_bfe_u32 v239, v0, 5, 1
v_lshl_add_u32 v238, v239, 2, v238
v_add_u32 v238, s20, v238
v_and_b32 v239, 8, v0
v_cmp_ne_u32 vcc, 0, v239
v_mov_b32 v239, 2147483632
s_nop 0
v_cndmask_b32 v238, v238, v239, vcc
v_lshlrev_b32 v229, 4, v0
s_xor_b32 s20, s12, 0
s_lshl_b32 s20, s20, 10
s_add_u32 s20, s20, 12288
v_add_u32 v233, s20, v229
s_xor_b32 s20, s12, 1
s_lshl_b32 s20, s20, 10
s_add_u32 s20, s20, 12288
v_add_u32 v234, s20, v229
s_xor_b32 s20, s12, 2
s_lshl_b32 s20, s20, 10
s_add_u32 s20, s20, 12288
v_add_u32 v235, s20, v229
s_xor_b32 s20, s12, 3
s_lshl_b32 s20, s20, 10
s_add_u32 s20, s20, 12288
v_add_u32 v236, s20, v229
s_lshl_b32 s26, s34, 1
s_lshr_b32 s20, s12, 1
s_add_u32 s26, s26, s20
s_and_b32 s27, s12, 1
s_lshl_b32 s47, s26, 12
s_add_u32 s47, s47, 2359296
s_lshl_b32 s48, s26, 11
s_lshl_b32 s20, s27, 10
s_add_u32 s48, s48, s20
s_add_u32 s48, s48, 2883584
s_lshl_b32 s49, s14, 14
s_lshl_b32 s20, s51, 11
s_add_u32 s49, s49, s20
s_lshr_b32 s21, s12, 1
s_lshl_b32 s20, s21, 14
s_add_u32 s20, s20, 16384
v_add_u32 v231, s20, v229
s_lshl_b32 s20, s21, 14
s_lshl_b32 s22, s27, 12
s_add_u32 s20, s20, s22
s_add_u32 s20, s20, 24576
v_add_u32 v232, s20, v229
v_mov_b32 v228, 0x4444
v_and_b32 v239, 8, v0
v_cmp_ne_u32 vcc, 0, v239
v_mov_b32 v239, 0xeeee
s_nop 0
v_cndmask_b32 v228, v228, v239, vcc
v_and_b32 v239, 15, v0
v_mov_b32 v220, 0
v_mov_b32 v240, 0x3f80
v_cmp_eq_u32 vcc, 0, v239
s_nop 1
v_cndmask_b32 v220, v220, v240, vcc
v_mov_b32 v240, 0x3f800000
v_cmp_eq_u32 vcc, 1, v239
s_nop 1
v_cndmask_b32 v220, v220, v240, vcc
v_mov_b32 v221, 0
v_mov_b32 v240, 0x3f80
v_cmp_eq_u32 vcc, 2, v239
s_nop 1
v_cndmask_b32 v221, v221, v240, vcc
v_mov_b32 v240, 0x3f800000
v_cmp_eq_u32 vcc, 3, v239
s_nop 1
v_cndmask_b32 v221, v221, v240, vcc
v_mov_b32 v222, 0
v_mov_b32 v240, 0x3f80
v_cmp_eq_u32 vcc, 4, v239
s_nop 1
v_cndmask_b32 v222, v222, v240, vcc
v_mov_b32 v240, 0x3f800000
v_cmp_eq_u32 vcc, 5, v239
s_nop 1
v_cndmask_b32 v222, v222, v240, vcc
v_mov_b32 v223, 0
v_mov_b32 v240, 0x3f80
v_cmp_eq_u32 vcc, 6, v239
s_nop 1
v_cndmask_b32 v223, v223, v240, vcc
v_mov_b32 v240, 0x3f800000
v_cmp_eq_u32 vcc, 7, v239
s_nop 1
v_cndmask_b32 v223, v223, v240, vcc
v_mov_b32 v239, 4284592614
v_cmp_gt_u32 vcc, 32, v0
s_nop 1
v_cndmask_b32 v212, 0, v239, vcc
v_mov_b32 v216, 0x3f803f80
v_cndmask_b32 v213, 0, v239, vcc
v_mov_b32 v217, 0x3f803f80
v_cndmask_b32 v214, 0, v239, vcc
v_mov_b32 v218, 0x3f803f80
v_cndmask_b32 v215, 0, v239, vcc
v_mov_b32 v219, 0x3f803f80
s_mov_b32 s46, 1040356334
v_mov_b32 v192, 0
v_mov_b32 v193, 0
v_mov_b32 v194, 0
v_mov_b32 v195, 0
v_mov_b32 v196, 0
v_mov_b32 v197, 0
v_mov_b32 v198, 0
v_mov_b32 v199, 0
s_mul_i32 s20, s12, 19584
s_add_u32 s20, s20, 81920
v_bfe_u32 v239, v0, 4, 2
v_lshlrev_b32 v237, 8, v239
v_bfe_u32 v239, v0, 4, 2
v_lshl_add_u32 v237, v239, 5, v237
v_bfe_u32 v239, v0, 0, 4
v_lshl_add_u32 v237, v239, 4, v237
v_add_u32 v237, s20, v237
s_waitcnt vmcnt(17)
ds_write_b128 v237, v[2:5] offset:0
s_waitcnt vmcnt(16)
ds_write_b128 v237, v[6:9] offset:1216
s_waitcnt vmcnt(15)
ds_write_b128 v237, v[10:13] offset:2432
s_waitcnt vmcnt(14)
ds_write_b128 v237, v[14:17] offset:3648
s_waitcnt vmcnt(13)
ds_write_b128 v237, v[18:21] offset:4864
s_waitcnt vmcnt(12)
ds_write_b128 v237, v[22:25] offset:6080
s_waitcnt vmcnt(11)
ds_write_b128 v237, v[26:29] offset:7296
s_waitcnt vmcnt(10)
ds_write_b128 v237, v[30:33] offset:8512
s_waitcnt lgkmcnt(0)
s_waitcnt vmcnt(9)
ds_write_b128 v237, v[34:37] offset:9856
s_waitcnt vmcnt(8)
ds_write_b128 v237, v[38:41] offset:11072
s_waitcnt vmcnt(7)
ds_write_b128 v237, v[42:45] offset:12288
s_waitcnt vmcnt(6)
ds_write_b128 v237, v[46:49] offset:13504
s_waitcnt vmcnt(5)
ds_write_b128 v237, v[50:53] offset:14720
s_waitcnt vmcnt(4)
ds_write_b128 v237, v[54:57] offset:15936
s_waitcnt vmcnt(3)
ds_write_b128 v237, v[58:61] offset:17152
s_waitcnt vmcnt(2)
ds_write_b128 v237, v[62:65] offset:18368
s_waitcnt lgkmcnt(0)
s_lshl_b32 s20, s12, 6
s_add_u32 s20, s20, 81920
v_bfe_u32 v239, v0, 0, 2
v_lshlrev_b32 v230, 3, v239
v_add_u32 v230, s20, v230
v_bfe_u32 v239, v0, 5, 1
v_mul_u32_u24 v239, 2432, v239
v_add_u32 v230, v230, v239
v_bfe_u32 v239, v0, 4, 1
v_mul_u32_u24 v239, 1216, v239
v_add_u32 v230, v230, v239
v_bfe_u32 v239, v0, 2, 1
v_mul_u32_u24 v239, 288, v239
v_add_u32 v230, v230, v239
v_bfe_u32 v239, v0, 3, 1
v_mul_u32_u24 v239, 9856, v239
v_add_u32 v230, v230, v239
s_barrier
s_xor_b32 s20, s12, 0
s_mul_i32 s20, s20, 19584
v_add_u32 v237, s20, v230
ds_read_b64_tr_b16 v[2:3], v237 offset:0
ds_read_b64_tr_b16 v[4:5], v237 offset:576
ds_read_b64_tr_b16 v[6:7], v237 offset:4864
ds_read_b64_tr_b16 v[8:9], v237 offset:5440
ds_read_b64_tr_b16 v[34:35], v237 offset:32
ds_read_b64_tr_b16 v[36:37], v237 offset:608
ds_read_b64_tr_b16 v[38:39], v237 offset:4896
ds_read_b64_tr_b16 v[40:41], v237 offset:5472
s_waitcnt lgkmcnt(4)
s_xor_b32 s20, s12, 1
s_mul_i32 s20, s20, 19584
v_add_u32 v237, s20, v230
ds_read_b64_tr_b16 v[10:11], v237 offset:0
ds_read_b64_tr_b16 v[12:13], v237 offset:576
ds_read_b64_tr_b16 v[14:15], v237 offset:4864
ds_read_b64_tr_b16 v[16:17], v237 offset:5440
ds_read_b64_tr_b16 v[42:43], v237 offset:32
ds_read_b64_tr_b16 v[44:45], v237 offset:608
ds_read_b64_tr_b16 v[46:47], v237 offset:4896
ds_read_b64_tr_b16 v[48:49], v237 offset:5472
s_waitcnt lgkmcnt(4)
s_xor_b32 s20, s12, 2
s_mul_i32 s20, s20, 19584
v_add_u32 v237, s20, v230
ds_read_b64_tr_b16 v[18:19], v237 offset:0
ds_read_b64_tr_b16 v[20:21], v237 offset:576
ds_read_b64_tr_b16 v[22:23], v237 offset:4864
ds_read_b64_tr_b16 v[24:25], v237 offset:5440
ds_read_b64_tr_b16 v[50:51], v237 offset:32
ds_read_b64_tr_b16 v[52:53], v237 offset:608
ds_read_b64_tr_b16 v[54:55], v237 offset:4896
ds_read_b64_tr_b16 v[56:57], v237 offset:5472
s_waitcnt lgkmcnt(4)
s_xor_b32 s20, s12, 3
s_mul_i32 s20, s20, 19584
v_add_u32 v237, s20, v230
ds_read_b64_tr_b16 v[26:27], v237 offset:0
ds_read_b64_tr_b16 v[28:29], v237 offset:576
ds_read_b64_tr_b16 v[30:31], v237 offset:4864
ds_read_b64_tr_b16 v[32:33], v237 offset:5440
ds_read_b64_tr_b16 v[58:59], v237 offset:32
ds_read_b64_tr_b16 v[60:61], v237 offset:608
ds_read_b64_tr_b16 v[62:63], v237 offset:4896
ds_read_b64_tr_b16 v[64:65], v237 offset:5472
s_waitcnt lgkmcnt(4)
s_waitcnt vmcnt(0) lgkmcnt(0)
v_bfe_u32 v239, v0, 4, 1
v_lshlrev_b32 v230, 8, v239
v_bfe_u32 v239, v0, 0, 4
v_lshl_add_u32 v230, v239, 4, v230
s_lshl_b32 s20, s35, 16
s_lshl_b32 s21, s12, 14
s_add_u32 s20, s20, s21
s_lshl_b32 s21, s34, 7
s_add_u32 s20, s20, s21
v_bfe_u32 v239, v0, 5, 1
v_lshlrev_b32 v237, 12, v239
v_bfe_u32 v239, v0, 3, 1
v_lshl_add_u32 v237, v239, 11, v237
v_bfe_u32 v239, v0, 0, 3
v_lshl_add_u32 v237, v239, 4, v237
v_bfe_u32 v239, v0, 4, 1
v_lshl_add_u32 v237, v239, 3, v237
v_add_u32 v237, s20, v237
s_cmp_lg_u32 s16, 0
s_cbranch_scc1 rdy_318
v_and_b32 v239, 7, v0
v_lshlrev_b32 v239, 5, v239
s_branch rdy_322
rdy_319:
buffer_load_dwordx2 v[224:225], v239, s[28:31], 0 offen sc1
rdy_322:
s_mov_b32 s20, 0
s_waitcnt vmcnt(0)
v_readlane_b32 s21, v225, 0
s_nop 0
s_lshr_b32 s21, s21, 8
s_add_u32 s20, s20, s21
v_readlane_b32 s21, v225, 1
s_nop 0
s_lshr_b32 s21, s21, 8
s_add_u32 s20, s20, s21
v_readlane_b32 s21, v225, 2
s_nop 0
s_lshr_b32 s21, s21, 8
s_add_u32 s20, s20, s21
v_readlane_b32 s21, v225, 3
s_nop 0
s_lshr_b32 s21, s21, 8
s_add_u32 s20, s20, s21
v_readlane_b32 s21, v225, 4
s_nop 0
s_lshr_b32 s21, s21, 8
s_add_u32 s20, s20, s21
v_readlane_b32 s21, v225, 5
s_nop 0
s_lshr_b32 s21, s21, 8
s_add_u32 s20, s20, s21
v_readlane_b32 s21, v225, 6
s_nop 0
s_lshr_b32 s21, s21, 8
s_add_u32 s20, s20, s21
v_readlane_b32 s21, v225, 7
s_nop 0
s_lshr_b32 s21, s21, 8
s_add_u32 s20, s20, s21
s_and_b32 s21, s20, 0xfff
s_cmp_ge_u32 s21, 256
s_cbranch_scc1 rdy_320
s_add_u32 s19, s19, 1
s_cmp_gt_u32 s19, 1048576
s_cbranch_scc1 L_end
s_sleep 8
s_branch rdy_319
rdy_320:
s_lshr_b32 s20, s20, 12
s_cmp_gt_u32 s20, 16
s_cselect_b32 s17, 8192, 0
v_and_b32 v225, 0xfffff, v225
v_cmp_ne_u32 vcc, -1, v224
s_cbranch_vccnz L_restart
v_cmp_ne_u32 vcc, 0x2000, v225
s_cbranch_vccnz L_restart
rdy_318:
s_xor_b32 s44, s44, s17
s_xor_b32 s45, s45, s17
s_setprio 1
s_mov_b32 s38, 2097152
v_min_u32 v208, -2, v208
s_cmp_lg_u32 s16, 0
s_cbranch_scc1 aslow_323
buffer_store_dword v208, v238, s[4:7], s38 offen
s_barrier
aloop_324:
s_cmp_ge_u32 s18, 63
s_cbranch_scc1 aend_325
s_cmp_lt_u32 s18, 1
s_cbranch_scc1 a0_326
ds_read_b128 v[66:69], v231 offset:0
ds_read_b128 v[70:73], v231 offset:1024
ds_read_b128 v[74:77], v231 offset:2048
ds_read_b128 v[78:81], v231 offset:3072
ds_read_b128 v[82:85], v231 offset:4096
ds_read_b128 v[86:89], v231 offset:5120
ds_read_b128 v[90:93], v231 offset:6144
ds_read_b128 v[94:97], v231 offset:7168
ds_read_b128 v[98:101], v232 offset:0
ds_read_b128 v[102:105], v232 offset:1024
ds_read_b128 v[106:109], v232 offset:2048
ds_read_b128 v[110:113], v232 offset:3072
a0_327:
s_and_b32 s20, s18, 3
s_add_u32 s22, s18, 1
s_and_b32 s22, s22, 3
s_lshl_b32 s39, s20, 17
s_add_u32 s39, s39, s47
s_lshl_b32 s21, s20, 16
s_add_u32 s40, s21, s48
s_lshl_b32 s41, s20, 19
s_add_u32 s41, s41, s17
s_add_u32 s50, s41, s49
s_lshl_b32 s38, s22, 16
s_add_u32 s38, s38, 2097152
s_waitcnt vmcnt(0) lgkmcnt(0)
s_barrier
s_branch al_329
.p2align 6
s_nop 0
al_329:
s_barrier
buffer_load_dwordx4 v[114:117], v229, s[4:7], s39 offen offset:0 sc1
s_nop 11
buffer_load_dwordx4 v[118:121], v229, s[4:7], s39 offen offset:1024 sc1
s_nop 11
buffer_load_dwordx4 v[122:125], v229, s[4:7], s39 offen offset:2048 sc1
s_nop 11
buffer_load_dwordx4 v[126:129], v229, s[4:7], s39 offen offset:3072 sc1
s_waitcnt vmcnt(3)
v_cmp_eq_u32 vcc, -1, v117
s_cbranch_vccnz aF15_0_0_331
aB15_0_0_332:
v_mfma_f32_16x16x32_bf16 v[146:149], v[114:117], v[114:117], v[212:215]
v_mfma_f32_16x16x32_bf16 v[138:141], v[66:69], v[114:117], 0
s_waitcnt vmcnt(2)
v_cmp_eq_u32 vcc, -1, v121
v_mfma_f32_16x16x32_bf16 v[142:145], v[82:85], v[114:117], 0
s_cbranch_vccnz aF14_1_0_333
aB14_1_0_334:
v_mfma_f32_16x16x32_bf16 v[146:149], v[118:121], v[118:121], v[146:149]
v_mfma_f32_16x16x32_bf16 v[138:141], v[70:73], v[118:121], v[138:141]
s_waitcnt vmcnt(1)
v_cmp_eq_u32 vcc, -1, v125
v_mfma_f32_16x16x32_bf16 v[142:145], v[86:89], v[118:121], v[142:145]
s_cbranch_vccnz aF12_2_0_335
aB12_2_0_336:
v_mfma_f32_16x16x32_bf16 v[146:149], v[122:125], v[122:125], v[146:149]
v_mfma_f32_16x16x32_bf16 v[138:141], v[74:77], v[122:125], v[138:141]
s_waitcnt vmcnt(0)
v_cmp_eq_u32 vcc, -1, v129
v_mfma_f32_16x16x32_bf16 v[142:145], v[90:93], v[122:125], v[142:145]
s_cbranch_vccnz aF8_3_0_337
aB8_3_0_338:
v_mfma_f32_16x16x32_bf16 v[146:149], v[126:129], v[126:129], v[146:149]
buffer_load_dwordx4 v[130:133], v230, s[4:7], s40 offen offset:0 sc1
v_mfma_f32_16x16x32_bf16 v[138:141], v[78:81], v[126:129], v[138:141]
buffer_load_dwordx4 v[134:137], v230, s[4:7], s40 offen offset:512 sc1
v_mfma_f32_16x16x32_bf16 v[142:145], v[94:97], v[126:129], v[142:145]
adone_330:
s_barrier
s_nop 0
v_max3_f32 v240, v146, v147, v148
s_nop 1
v_max3_f32 v240, v240, v149, v138
v_max3_f32 v239, v139, v140, v141
s_nop 0
v_max3_f32 v240, v240, v142, v143
v_max3_f32 v239, v239, v144, v145
v_max_f32 v240, v240, v239
v_max_f32 v239, v240, v239
s_nop 1
v_permlane32_swap_b32 v240, v239
v_max_f32 v224, v240, v239
v_max_f32 v225, v240, v239
s_nop 1
v_permlane16_swap_b32 v224, v225
v_max_f32 v240, v224, v225
v_mul_f32 v240, s46, v240
v_fma_f32 v138, v138, s46, -v240
v_fma_f32 v139, v139, s46, -v240
v_fma_f32 v140, v140, s46, -v240
v_fma_f32 v141, v141, s46, -v240
v_exp_f32 v138, v138
v_exp_f32 v139, v139
v_exp_f32 v140, v140
v_exp_f32 v141, v141
v_fma_f32 v142, v142, s46, -v240
v_fma_f32 v143, v143, s46, -v240
v_fma_f32 v144, v144, s46, -v240
v_fma_f32 v145, v145, s46, -v240
v_exp_f32 v142, v142
v_exp_f32 v143, v143
v_exp_f32 v144, v144
v_exp_f32 v145, v145
v_cvt_pk_bf16_f32 v150, v138, v139
v_cvt_pk_bf16_f32 v151, v140, v141
v_cvt_pk_bf16_f32 v152, v142, v143
v_cvt_pk_bf16_f32 v153, v144, v145
v_fma_f32 v146, v146, s46, -v240
v_fma_f32 v147, v147, s46, -v240
v_mfma_f32_16x16x32_bf16 v[172:175], v[216:219], v[150:153], 0
v_fma_f32 v148, v148, s46, -v240
v_fma_f32 v149, v149, s46, -v240
v_mfma_f32_16x16x32_bf16 v[156:159], v[98:101], v[150:153], 0
v_exp_f32 v146, v146
v_mfma_f32_16x16x32_bf16 v[160:163], v[102:105], v[150:153], 0
v_exp_f32 v147, v147
v_mfma_f32_16x16x32_bf16 v[164:167], v[106:109], v[150:153], 0
v_exp_f32 v148, v148
v_mfma_f32_16x16x32_bf16 v[168:171], v[110:113], v[150:153], 0
v_exp_f32 v149, v149
v_cvt_pk_bf16_f32 v154, v146, v147
v_cvt_pk_bf16_f32 v155, v148, v149
vc_395:
s_waitcnt vmcnt(0)
s_nop 0
v_mfma_f32_16x16x16_bf16 v[224:227], v[216:217], v[154:155], v[172:175]
v_max3_u32 v239, v131, v133, v135
v_mfma_f32_16x16x16_bf16 v[114:117], v[130:131], v[154:155], v[156:159]
v_max_u32 v239, v239, v137
v_cmp_eq_u32 vcc, -1, v239
v_mfma_f32_16x16x16_bf16 v[118:121], v[132:133], v[154:155], v[160:163]
s_nop 0
v_rcp_f32 v240, v224
v_mfma_f32_16x16x16_bf16 v[122:125], v[134:135], v[154:155], v[164:167]
v_mul_f32 v114, v114, v240
v_mul_f32 v115, v115, v240
v_mfma_f32_16x16x16_bf16 v[126:129], v[136:137], v[154:155], v[168:171]
v_mul_f32 v116, v116, v240
v_mul_f32 v117, v117, v240
v_mov_b32_dpp v240, v240 row_shr:8 row_mask:0xf bank_mask:0xc
v_mul_f32 v118, v118, v240
v_mul_f32 v119, v119, v240
v_mul_f32 v120, v120, v240
v_mul_f32 v121, v121, v240
v_mul_f32_dpp v114, v122, v240 row_shr:8 row_mask:0xf bank_mask:0xc
v_mul_f32_dpp v115, v123, v240 row_shr:8 row_mask:0xf bank_mask:0xc
v_mul_f32_dpp v116, v124, v240 row_shr:8 row_mask:0xf bank_mask:0xc
v_mul_f32_dpp v117, v125, v240 row_shr:8 row_mask:0xf bank_mask:0xc
v_mul_f32_dpp v118, v126, v240 row_shr:8 row_mask:0xf bank_mask:0xc
v_mul_f32_dpp v119, v127, v240 row_shr:8 row_mask:0xf bank_mask:0xc
v_cvt_pk_bf16_f32 v176, v114, v115
v_mul_f32_dpp v120, v128, v240 row_shr:8 row_mask:0xf bank_mask:0xc
v_mul_f32_dpp v121, v129, v240 row_shr:8 row_mask:0xf bank_mask:0xc
v_cvt_pk_bf16_f32 v177, v116, v117
v_cvt_pk_bf16_f32 v178, v118, v119
v_cvt_pk_bf16_f32 v179, v120, v121
ds_write_b128 v233, v[176:179]
s_cbranch_vccnz vr_396
v_smfmac_f32_16x16x64_bf16 v[192:195], v[176:179], v[2:9], v228
v_smfmac_f32_16x16x64_bf16 v[196:199], v[176:179], v[34:41], v228
s_waitcnt lgkmcnt(0)
s_barrier
ds_read_b128 v[180:183], v234
ds_read_b128 v[184:187], v235
ds_read_b128 v[188:191], v236
s_waitcnt lgkmcnt(2)
v_smfmac_f32_16x16x64_bf16 v[192:195], v[180:183], v[10:17], v228
v_smfmac_f32_16x16x64_bf16 v[196:199], v[180:183], v[42:49], v228
s_waitcnt lgkmcnt(1)
v_smfmac_f32_16x16x64_bf16 v[192:195], v[184:187], v[18:25], v228
v_smfmac_f32_16x16x64_bf16 v[196:199], v[184:187], v[50:57], v228
s_waitcnt lgkmcnt(0)
v_smfmac_f32_16x16x64_bf16 v[192:195], v[188:191], v[26:33], v228
v_smfmac_f32_16x16x64_bf16 v[196:199], v[188:191], v[58:65], v228
s_nop 7
v_permlane32_swap_b32 v192, v196
v_permlane32_swap_b32 v193, v197
v_permlane32_swap_b32 v194, v198
v_permlane32_swap_b32 v195, v199
v_add_f32 v224, v192, v196
v_add_f32 v225, v193, v197
v_add_f32 v226, v194, v198
v_add_f32 v227, v195, v199
v_cvt_pk_bf16_f32 v224, v224, v225
v_cvt_pk_bf16_f32 v225, v226, v227
v_min_u32 v225, -2, v225
buffer_store_dwordx2 v[224:225], v237, s[4:7], s41 offen sc1
s_barrier
v_mov_b32 v192, 0
v_mov_b32 v193, 0
v_mov_b32 v194, 0
v_mov_b32 v195, 0
v_mov_b32 v196, 0
v_mov_b32 v197, 0
v_mov_b32 v198, 0
v_mov_b32 v199, 0
s_add_u32 s18, s18, 1
s_branch al_397
.p2align 6
s_nop 0
s_nop 0
al_397:
s_barrier
rr_398:
buffer_load_dwordx4 v[200:203], v229, s[4:7], s50 offen offset:0 sc1
buffer_load_dwordx4 v[204:207], v229, s[4:7], s50 offen offset:1024 sc1
s_waitcnt vmcnt(1)
v_mfma_f32_16x16x32_bf16 v[208:211], v[200:203], v[220:223], 0
v_max_u32 v239, v201, v203
s_waitcnt vmcnt(0)
v_mfma_f32_16x16x32_bf16 v[208:211], v[204:207], v[220:223], v[208:211]
v_max3_u32 v239, v239, v205, v207
v_cmp_eq_u32 vcc, -1, v239
s_cbranch_vccnz rr_399
s_nop 4
v_permlane32_swap_b32 v208, v210
v_permlane32_swap_b32 v209, v211
v_add_f32 v208, v208, v210
v_add_f32 v209, v209, v211
v_cvt_pk_bf16_f32 v208, v208, v209
v_min_u32 v208, -2, v208
buffer_store_dword v208, v238, s[4:7], s38 offen
s_barrier
s_branch aloop_324
aend_325:
s_waitcnt vmcnt(0) lgkmcnt(0)
s_endpgm
a0_326:
s_and_b32 s20, s45, 0xffffff7f
v_and_b32 v239, 1, v0
v_lshlrev_b32 v239, 7, v239
a0_328:
s_add_u32 s19, s19, 1
s_cmp_gt_u32 s19, 1048576
s_cbranch_scc1 L_end
buffer_load_dword v240, v239, s[4:7], s20 offen sc1
s_waitcnt vmcnt(0)
v_cmp_ge_u32 vcc, s18, v240
s_cbranch_vccnz a0_328
s_and_b32 s21, s12, 1
s_mul_i32 s21, s21, 33554432
s_lshl_b32 s20, s18, 14
s_xor_b32 s20, s20, s44
s_sub_u32 s20, s20, s21
s_add_u32 s21, s20, 4096
s_and_b32 s22, s12, 1
s_lshl_b32 s22, s22, 12
s_add_u32 s22, s22, s20
s_add_u32 s22, s22, 33554432
buffer_load_dwordx4 v[66:69], v229, s[4:7], s20 offen offset:0 sc1
buffer_load_dwordx4 v[70:73], v229, s[4:7], s20 offen offset:1024 sc1
buffer_load_dwordx4 v[74:77], v229, s[4:7], s20 offen offset:2048 sc1
buffer_load_dwordx4 v[78:81], v229, s[4:7], s20 offen offset:3072 sc1
buffer_load_dwordx4 v[82:85], v229, s[4:7], s21 offen offset:0 sc1
buffer_load_dwordx4 v[86:89], v229, s[4:7], s21 offen offset:1024 sc1
buffer_load_dwordx4 v[90:93], v229, s[4:7], s21 offen offset:2048 sc1
buffer_load_dwordx4 v[94:97], v229, s[4:7], s21 offen offset:3072 sc1
buffer_load_dwordx4 v[98:101], v229, s[4:7], s22 offen offset:0 sc1
buffer_load_dwordx4 v[102:105], v229, s[4:7], s22 offen offset:1024 sc1
buffer_load_dwordx4 v[106:109], v229, s[4:7], s22 offen offset:2048 sc1
buffer_load_dwordx4 v[110:113], v229, s[4:7], s22 offen offset:3072 sc1
s_branch a0_327
aF8_3_0_337:
buffer_load_dwordx4 v[126:129], v229, s[4:7], s39 offen offset:3072 sc1
s_add_u32 s19, s19, 1
s_cmp_gt_u32 s19, 1048576
s_cbranch_scc1 L_end
s_waitcnt vmcnt(0)
v_cmp_eq_u32 vcc, -1, v129
s_cbranch_vccnz aF8_3_0_337
s_branch aB8_3_0_338
aF12_2_0_335:
buffer_load_dwordx4 v[122:125], v229, s[4:7], s39 offen offset:2048 sc1
s_add_u32 s19, s19, 1
s_cmp_gt_u32 s19, 1048576
s_cbranch_scc1 L_end
s_waitcnt vmcnt(1)
v_cmp_eq_u32 vcc, -1, v129
s_cbranch_vccnz aF12_3_0_339
s_branch aB12_3_0_340
aB12_3_0_340:
v_mfma_f32_16x16x32_bf16 v[146:149], v[126:129], v[126:129], v[146:149]
v_mfma_f32_16x16x32_bf16 v[138:141], v[78:81], v[126:129], v[138:141]
s_waitcnt vmcnt(0)
v_cmp_eq_u32 vcc, -1, v125
v_mfma_f32_16x16x32_bf16 v[142:145], v[94:97], v[126:129], v[142:145]
s_cbranch_vccnz aF4_2_0_341
s_branch aB4_2_0_342
aB4_2_0_342:
v_mfma_f32_16x16x32_bf16 v[146:149], v[122:125], v[122:125], v[146:149]
buffer_load_dwordx4 v[130:133], v230, s[4:7], s40 offen offset:0 sc1
v_mfma_f32_16x16x32_bf16 v[138:141], v[74:77], v[122:125], v[138:141]
buffer_load_dwordx4 v[134:137], v230, s[4:7], s40 offen offset:512 sc1
v_mfma_f32_16x16x32_bf16 v[142:145], v[90:93], v[122:125], v[142:145]
s_branch adone_330
aF4_2_0_341:
buffer_load_dwordx4 v[122:125], v229, s[4:7], s39 offen offset:2048 sc1
s_add_u32 s19, s19, 1
s_cmp_gt_u32 s19, 1048576
s_cbranch_scc1 L_end
s_waitcnt vmcnt(0)
v_cmp_eq_u32 vcc, -1, v125
s_cbranch_vccnz aF4_2_0_341
s_branch aB4_2_0_342
aF12_3_0_339:
buffer_load_dwordx4 v[126:129], v229, s[4:7], s39 offen offset:3072 sc1
s_add_u32 s19, s19, 1
s_cmp_gt_u32 s19, 1048576
s_cbranch_scc1 L_end
s_waitcnt vmcnt(1)
v_cmp_eq_u32 vcc, -1, v125
s_cbranch_vccnz aF12_2_0_335
s_branch aB12_2_0_336
aF14_1_0_333:
buffer_load_dwordx4 v[118:121], v229, s[4:7], s39 offen offset:1024 sc1
s_add_u32 s19, s19, 1
s_cmp_gt_u32 s19, 1048576
s_cbranch_scc1 L_end
s_waitcnt vmcnt(2)
v_cmp_eq_u32 vcc, -1, v125
s_cbranch_vccnz aF14_2_0_343
s_branch aB14_2_0_344
aB14_2_0_344:
v_mfma_f32_16x16x32_bf16 v[146:149], v[122:125], v[122:125], v[146:149]
v_mfma_f32_16x16x32_bf16 v[138:141], v[74:77], v[122:125], v[138:141]
s_waitcnt vmcnt(1)
v_cmp_eq_u32 vcc, -1, v129
v_mfma_f32_16x16x32_bf16 v[142:145], v[90:93], v[122:125], v[142:145]
s_cbranch_vccnz aF10_3_0_345
s_branch aB10_3_0_346
aB10_3_0_346:
v_mfma_f32_16x16x32_bf16 v[146:149], v[126:129], v[126:129], v[146:149]
v_mfma_f32_16x16x32_bf16 v[138:141], v[78:81], v[126:129], v[138:141]
s_waitcnt vmcnt(0)
v_cmp_eq_u32 vcc, -1, v121
v_mfma_f32_16x16x32_bf16 v[142:145], v[94:97], v[126:129], v[142:145]
s_cbranch_vccnz aF2_1_0_347
s_branch aB2_1_0_348
aB2_1_0_348:
v_mfma_f32_16x16x32_bf16 v[146:149], v[118:121], v[118:121], v[146:149]
buffer_load_dwordx4 v[130:133], v230, s[4:7], s40 offen offset:0 sc1
v_mfma_f32_16x16x32_bf16 v[138:141], v[70:73], v[118:121], v[138:141]
buffer_load_dwordx4 v[134:137], v230, s[4:7], s40 offen offset:512 sc1
v_mfma_f32_16x16x32_bf16 v[142:145], v[86:89], v[118:121], v[142:145]
s_branch adone_330
aF2_1_0_347:
buffer_load_dwordx4 v[118:121], v229, s[4:7], s39 offen offset:1024 sc1
s_add_u32 s19, s19, 1
s_cmp_gt_u32 s19, 1048576
s_cbranch_scc1 L_end
s_waitcnt vmcnt(0)
v_cmp_eq_u32 vcc, -1, v121
s_cbranch_vccnz aF2_1_0_347
s_branch aB2_1_0_348
aF10_3_0_345:
buffer_load_dwordx4 v[126:129], v229, s[4:7], s39 offen offset:3072 sc1
s_add_u32 s19, s19, 1
s_cmp_gt_u32 s19, 1048576
s_cbranch_scc1 L_end
s_waitcnt vmcnt(1)
v_cmp_eq_u32 vcc, -1, v121
s_cbranch_vccnz aF10_1_0_349
s_branch aB10_1_0_350
aB10_1_0_350:
v_mfma_f32_16x16x32_bf16 v[146:149], v[118:121], v[118:121], v[146:149]
v_mfma_f32_16x16x32_bf16 v[138:141], v[70:73], v[118:121], v[138:141]
s_waitcnt vmcnt(0)
v_cmp_eq_u32 vcc, -1, v129
v_mfma_f32_16x16x32_bf16 v[142:145], v[86:89], v[118:121], v[142:145]
s_cbranch_vccnz aF8_3_0_337
s_branch aB8_3_0_338
aF10_1_0_349:
buffer_load_dwordx4 v[118:121], v229, s[4:7], s39 offen offset:1024 sc1
s_add_u32 s19, s19, 1
s_cmp_gt_u32 s19, 1048576
s_cbranch_scc1 L_end
s_waitcnt vmcnt(1)
v_cmp_eq_u32 vcc, -1, v129
s_cbranch_vccnz aF10_3_0_345
s_branch aB10_3_0_346
aF14_2_0_343:
buffer_load_dwordx4 v[122:125], v229, s[4:7], s39 offen offset:2048 sc1
s_add_u32 s19, s19, 1
s_cmp_gt_u32 s19, 1048576
s_cbranch_scc1 L_end
s_waitcnt vmcnt(2)
v_cmp_eq_u32 vcc, -1, v129
s_cbranch_vccnz aF14_3_0_351
s_branch aB14_3_0_352
aB14_3_0_352:
v_mfma_f32_16x16x32_bf16 v[146:149], v[126:129], v[126:129], v[146:149]
v_mfma_f32_16x16x32_bf16 v[138:141], v[78:81], v[126:129], v[138:141]
s_waitcnt vmcnt(1)
v_cmp_eq_u32 vcc, -1, v121
v_mfma_f32_16x16x32_bf16 v[142:145], v[94:97], v[126:129], v[142:145]
s_cbranch_vccnz aF6_1_0_353
s_branch aB6_1_0_354
aB6_1_0_354:
v_mfma_f32_16x16x32_bf16 v[146:149], v[118:121], v[118:121], v[146:149]
v_mfma_f32_16x16x32_bf16 v[138:141], v[70:73], v[118:121], v[138:141]
s_waitcnt vmcnt(0)
v_cmp_eq_u32 vcc, -1, v125
v_mfma_f32_16x16x32_bf16 v[142:145], v[86:89], v[118:121], v[142:145]
s_cbranch_vccnz aF4_2_0_341
s_branch aB4_2_0_342
aF6_1_0_353:
buffer_load_dwordx4 v[118:121], v229, s[4:7], s39 offen offset:1024 sc1
s_add_u32 s19, s19, 1
s_cmp_gt_u32 s19, 1048576
s_cbranch_scc1 L_end
s_waitcnt vmcnt(1)
v_cmp_eq_u32 vcc, -1, v125
s_cbranch_vccnz aF6_2_0_355
s_branch aB6_2_0_356
aB6_2_0_356:
v_mfma_f32_16x16x32_bf16 v[146:149], v[122:125], v[122:125], v[146:149]
v_mfma_f32_16x16x32_bf16 v[138:141], v[74:77], v[122:125], v[138:141]
s_waitcnt vmcnt(0)
v_cmp_eq_u32 vcc, -1, v121
v_mfma_f32_16x16x32_bf16 v[142:145], v[90:93], v[122:125], v[142:145]
s_cbranch_vccnz aF2_1_0_347
s_branch aB2_1_0_348
aF6_2_0_355:
buffer_load_dwordx4 v[122:125], v229, s[4:7], s39 offen offset:2048 sc1
s_add_u32 s19, s19, 1
s_cmp_gt_u32 s19, 1048576
s_cbranch_scc1 L_end
s_waitcnt vmcnt(1)
v_cmp_eq_u32 vcc, -1, v121
s_cbranch_vccnz aF6_1_0_353
s_branch aB6_1_0_354
aF14_3_0_351:
buffer_load_dwordx4 v[126:129], v229, s[4:7], s39 offen offset:3072 sc1
s_add_u32 s19, s19, 1
s_cmp_gt_u32 s19, 1048576
s_cbranch_scc1 L_end
s_waitcnt vmcnt(2)
v_cmp_eq_u32 vcc, -1, v121
s_cbranch_vccnz aF14_1_0_333
s_branch aB14_1_0_334
aF15_0_0_331:
buffer_load_dwordx4 v[114:117], v229, s[4:7], s39 offen offset:0 sc1
s_add_u32 s19, s19, 1
s_cmp_gt_u32 s19, 1048576
s_cbranch_scc1 L_end
s_waitcnt vmcnt(3)
v_cmp_eq_u32 vcc, -1, v121
s_cbranch_vccnz aF15_1_0_357
s_branch aB15_1_0_358
aB15_1_0_358:
v_mfma_f32_16x16x32_bf16 v[146:149], v[118:121], v[118:121], v[212:215]
v_mfma_f32_16x16x32_bf16 v[138:141], v[70:73], v[118:121], 0
s_waitcnt vmcnt(2)
v_cmp_eq_u32 vcc, -1, v125
v_mfma_f32_16x16x32_bf16 v[142:145], v[86:89], v[118:121], 0
s_cbranch_vccnz aF13_2_0_359
s_branch aB13_2_0_360
aB13_2_0_360:
v_mfma_f32_16x16x32_bf16 v[146:149], v[122:125], v[122:125], v[146:149]
v_mfma_f32_16x16x32_bf16 v[138:141], v[74:77], v[122:125], v[138:141]
s_waitcnt vmcnt(1)
v_cmp_eq_u32 vcc, -1, v129
v_mfma_f32_16x16x32_bf16 v[142:145], v[90:93], v[122:125], v[142:145]
s_cbranch_vccnz aF9_3_0_361
s_branch aB9_3_0_362
aB9_3_0_362:
v_mfma_f32_16x16x32_bf16 v[146:149], v[126:129], v[126:129], v[146:149]
v_mfma_f32_16x16x32_bf16 v[138:141], v[78:81], v[126:129], v[138:141]
s_waitcnt vmcnt(0)
v_cmp_eq_u32 vcc, -1, v117
v_mfma_f32_16x16x32_bf16 v[142:145], v[94:97], v[126:129], v[142:145]
s_cbranch_vccnz aF1_0_0_363
s_branch aB1_0_0_364
aB1_0_0_364:
v_mfma_f32_16x16x32_bf16 v[146:149], v[114:117], v[114:117], v[146:149]
buffer_load_dwordx4 v[130:133], v230, s[4:7], s40 offen offset:0 sc1
v_mfma_f32_16x16x32_bf16 v[138:141], v[66:69], v[114:117], v[138:141]
buffer_load_dwordx4 v[134:137], v230, s[4:7], s40 offen offset:512 sc1
v_mfma_f32_16x16x32_bf16 v[142:145], v[82:85], v[114:117], v[142:145]
s_branch adone_330
aF1_0_0_363:
buffer_load_dwordx4 v[114:117], v229, s[4:7], s39 offen offset:0 sc1
s_add_u32 s19, s19, 1
s_cmp_gt_u32 s19, 1048576
s_cbranch_scc1 L_end
s_waitcnt vmcnt(0)
v_cmp_eq_u32 vcc, -1, v117
s_cbranch_vccnz aF1_0_0_363
s_branch aB1_0_0_364
aF9_3_0_361:
buffer_load_dwordx4 v[126:129], v229, s[4:7], s39 offen offset:3072 sc1
s_add_u32 s19, s19, 1
s_cmp_gt_u32 s19, 1048576
s_cbranch_scc1 L_end
s_waitcnt vmcnt(1)
v_cmp_eq_u32 vcc, -1, v117
s_cbranch_vccnz aF9_0_0_365
s_branch aB9_0_0_366
aB9_0_0_366:
v_mfma_f32_16x16x32_bf16 v[146:149], v[114:117], v[114:117], v[146:149]
v_mfma_f32_16x16x32_bf16 v[138:141], v[66:69], v[114:117], v[138:141]
s_waitcnt vmcnt(0)
v_cmp_eq_u32 vcc, -1, v129
v_mfma_f32_16x16x32_bf16 v[142:145], v[82:85], v[114:117], v[142:145]
s_cbranch_vccnz aF8_3_0_337
s_branch aB8_3_0_338
aF9_0_0_365:
buffer_load_dwordx4 v[114:117], v229, s[4:7], s39 offen offset:0 sc1
s_add_u32 s19, s19, 1
s_cmp_gt_u32 s19, 1048576
s_cbranch_scc1 L_end
s_waitcnt vmcnt(1)
v_cmp_eq_u32 vcc, -1, v129
s_cbranch_vccnz aF9_3_0_361
s_branch aB9_3_0_362
aF13_2_0_359:
buffer_load_dwordx4 v[122:125], v229, s[4:7], s39 offen offset:2048 sc1
s_add_u32 s19, s19, 1
s_cmp_gt_u32 s19, 1048576
s_cbranch_scc1 L_end
s_waitcnt vmcnt(2)
v_cmp_eq_u32 vcc, -1, v129
s_cbranch_vccnz aF13_3_0_367
s_branch aB13_3_0_368
aB13_3_0_368:
v_mfma_f32_16x16x32_bf16 v[146:149], v[126:129], v[126:129], v[146:149]
v_mfma_f32_16x16x32_bf16 v[138:141], v[78:81], v[126:129], v[138:141]
s_waitcnt vmcnt(1)
v_cmp_eq_u32 vcc, -1, v117
v_mfma_f32_16x16x32_bf16 v[142:145], v[94:97], v[126:129], v[142:145]
s_cbranch_vccnz aF5_0_0_369
s_branch aB5_0_0_370
aB5_0_0_370:
v_mfma_f32_16x16x32_bf16 v[146:149], v[114:117], v[114:117], v[146:149]
v_mfma_f32_16x16x32_bf16 v[138:141], v[66:69], v[114:117], v[138:141]
s_waitcnt vmcnt(0)
v_cmp_eq_u32 vcc, -1, v125
v_mfma_f32_16x16x32_bf16 v[142:145], v[82:85], v[114:117], v[142:145]
s_cbranch_vccnz aF4_2_0_341
s_branch aB4_2_0_342
aF5_0_0_369:
buffer_load_dwordx4 v[114:117], v229, s[4:7], s39 offen offset:0 sc1
s_add_u32 s19, s19, 1
s_cmp_gt_u32 s19, 1048576
s_cbranch_scc1 L_end
s_waitcnt vmcnt(1)
v_cmp_eq_u32 vcc, -1, v125
s_cbranch_vccnz aF5_2_0_371
s_branch aB5_2_0_372
aB5_2_0_372:
v_mfma_f32_16x16x32_bf16 v[146:149], v[122:125], v[122:125], v[146:149]
v_mfma_f32_16x16x32_bf16 v[138:141], v[74:77], v[122:125], v[138:141]
s_waitcnt vmcnt(0)
v_cmp_eq_u32 vcc, -1, v117
v_mfma_f32_16x16x32_bf16 v[142:145], v[90:93], v[122:125], v[142:145]
s_cbranch_vccnz aF1_0_0_363
s_branch aB1_0_0_364
aF5_2_0_371:
buffer_load_dwordx4 v[122:125], v229, s[4:7], s39 offen offset:2048 sc1
s_add_u32 s19, s19, 1
s_cmp_gt_u32 s19, 1048576
s_cbranch_scc1 L_end
s_waitcnt vmcnt(1)
v_cmp_eq_u32 vcc, -1, v117
s_cbranch_vccnz aF5_0_0_369
s_branch aB5_0_0_370
aF13_3_0_367:
buffer_load_dwordx4 v[126:129], v229, s[4:7], s39 offen offset:3072 sc1
s_add_u32 s19, s19, 1
s_cmp_gt_u32 s19, 1048576
s_cbranch_scc1 L_end
s_waitcnt vmcnt(2)
v_cmp_eq_u32 vcc, -1, v117
s_cbranch_vccnz aF13_0_0_373
s_branch aB13_0_0_374
aB13_0_0_374:
v_mfma_f32_16x16x32_bf16 v[146:149], v[114:117], v[114:117], v[146:149]
v_mfma_f32_16x16x32_bf16 v[138:141], v[66:69], v[114:117], v[138:141]
s_waitcnt vmcnt(1)
v_cmp_eq_u32 vcc, -1, v125
v_mfma_f32_16x16x32_bf16 v[142:145], v[82:85], v[114:117], v[142:145]
s_cbranch_vccnz aF12_2_0_335
s_branch aB12_2_0_336
aF13_0_0_373:
buffer_load_dwordx4 v[114:117], v229, s[4:7], s39 offen offset:0 sc1
s_add_u32 s19, s19, 1
s_cmp_gt_u32 s19, 1048576
s_cbranch_scc1 L_end
s_waitcnt vmcnt(2)
v_cmp_eq_u32 vcc, -1, v125
s_cbranch_vccnz aF13_2_0_359
s_branch aB13_2_0_360
aF15_1_0_357:
buffer_load_dwordx4 v[118:121], v229, s[4:7], s39 offen offset:1024 sc1
s_add_u32 s19, s19, 1
s_cmp_gt_u32 s19, 1048576
s_cbranch_scc1 L_end
s_waitcnt vmcnt(3)
v_cmp_eq_u32 vcc, -1, v125
s_cbranch_vccnz aF15_2_0_375
s_branch aB15_2_0_376
aB15_2_0_376:
v_mfma_f32_16x16x32_bf16 v[146:149], v[122:125], v[122:125], v[212:215]
v_mfma_f32_16x16x32_bf16 v[138:141], v[74:77], v[122:125], 0
s_waitcnt vmcnt(2)
v_cmp_eq_u32 vcc, -1, v129
v_mfma_f32_16x16x32_bf16 v[142:145], v[90:93], v[122:125], 0
s_cbranch_vccnz aF11_3_0_377
s_branch aB11_3_0_378
aB11_3_0_378:
v_mfma_f32_16x16x32_bf16 v[146:149], v[126:129], v[126:129], v[146:149]
v_mfma_f32_16x16x32_bf16 v[138:141], v[78:81], v[126:129], v[138:141]
s_waitcnt vmcnt(1)
v_cmp_eq_u32 vcc, -1, v117
v_mfma_f32_16x16x32_bf16 v[142:145], v[94:97], v[126:129], v[142:145]
s_cbranch_vccnz aF3_0_0_379
s_branch aB3_0_0_380
aB3_0_0_380:
v_mfma_f32_16x16x32_bf16 v[146:149], v[114:117], v[114:117], v[146:149]
v_mfma_f32_16x16x32_bf16 v[138:141], v[66:69], v[114:117], v[138:141]
s_waitcnt vmcnt(0)
v_cmp_eq_u32 vcc, -1, v121
v_mfma_f32_16x16x32_bf16 v[142:145], v[82:85], v[114:117], v[142:145]
s_cbranch_vccnz aF2_1_0_347
s_branch aB2_1_0_348
aF3_0_0_379:
buffer_load_dwordx4 v[114:117], v229, s[4:7], s39 offen offset:0 sc1
s_add_u32 s19, s19, 1
s_cmp_gt_u32 s19, 1048576
s_cbranch_scc1 L_end
s_waitcnt vmcnt(1)
v_cmp_eq_u32 vcc, -1, v121
s_cbranch_vccnz aF3_1_0_381
s_branch aB3_1_0_382
aB3_1_0_382:
v_mfma_f32_16x16x32_bf16 v[146:149], v[118:121], v[118:121], v[146:149]
v_mfma_f32_16x16x32_bf16 v[138:141], v[70:73], v[118:121], v[138:141]
s_waitcnt vmcnt(0)
v_cmp_eq_u32 vcc, -1, v117
v_mfma_f32_16x16x32_bf16 v[142:145], v[86:89], v[118:121], v[142:145]
s_cbranch_vccnz aF1_0_0_363
s_branch aB1_0_0_364
aF3_1_0_381:
buffer_load_dwordx4 v[118:121], v229, s[4:7], s39 offen offset:1024 sc1
s_add_u32 s19, s19, 1
s_cmp_gt_u32 s19, 1048576
s_cbranch_scc1 L_end
s_waitcnt vmcnt(1)
v_cmp_eq_u32 vcc, -1, v117
s_cbranch_vccnz aF3_0_0_379
s_branch aB3_0_0_380
aF11_3_0_377:
buffer_load_dwordx4 v[126:129], v229, s[4:7], s39 offen offset:3072 sc1
s_add_u32 s19, s19, 1
s_cmp_gt_u32 s19, 1048576
s_cbranch_scc1 L_end
s_waitcnt vmcnt(2)
v_cmp_eq_u32 vcc, -1, v117
s_cbranch_vccnz aF11_0_0_383
s_branch aB11_0_0_384
aB11_0_0_384:
v_mfma_f32_16x16x32_bf16 v[146:149], v[114:117], v[114:117], v[146:149]
v_mfma_f32_16x16x32_bf16 v[138:141], v[66:69], v[114:117], v[138:141]
s_waitcnt vmcnt(1)
v_cmp_eq_u32 vcc, -1, v121
v_mfma_f32_16x16x32_bf16 v[142:145], v[82:85], v[114:117], v[142:145]
s_cbranch_vccnz aF10_1_0_349
s_branch aB10_1_0_350
aF11_0_0_383:
buffer_load_dwordx4 v[114:117], v229, s[4:7], s39 offen offset:0 sc1
s_add_u32 s19, s19, 1
s_cmp_gt_u32 s19, 1048576
s_cbranch_scc1 L_end
s_waitcnt vmcnt(2)
v_cmp_eq_u32 vcc, -1, v121
s_cbranch_vccnz aF11_1_0_385
s_branch aB11_1_0_386
aB11_1_0_386:
v_mfma_f32_16x16x32_bf16 v[146:149], v[118:121], v[118:121], v[146:149]
v_mfma_f32_16x16x32_bf16 v[138:141], v[70:73], v[118:121], v[138:141]
s_waitcnt vmcnt(1)
v_cmp_eq_u32 vcc, -1, v129
v_mfma_f32_16x16x32_bf16 v[142:145], v[86:89], v[118:121], v[142:145]
s_cbranch_vccnz aF9_3_0_361
s_branch aB9_3_0_362
aF11_1_0_385:
buffer_load_dwordx4 v[118:121], v229, s[4:7], s39 offen offset:1024 sc1
s_add_u32 s19, s19, 1
s_cmp_gt_u32 s19, 1048576
s_cbranch_scc1 L_end
s_waitcnt vmcnt(2)
v_cmp_eq_u32 vcc, -1, v129
s_cbranch_vccnz aF11_3_0_377
s_branch aB11_3_0_378
aF15_2_0_375:
buffer_load_dwordx4 v[122:125], v229, s[4:7], s39 offen offset:2048 sc1
s_add_u32 s19, s19, 1
s_cmp_gt_u32 s19, 1048576
s_cbranch_scc1 L_end
s_waitcnt vmcnt(3)
v_cmp_eq_u32 vcc, -1, v129
s_cbranch_vccnz aF15_3_0_387
s_branch aB15_3_0_388
aB15_3_0_388:
v_mfma_f32_16x16x32_bf16 v[146:149], v[126:129], v[126:129], v[212:215]
v_mfma_f32_16x16x32_bf16 v[138:141], v[78:81], v[126:129], 0
s_waitcnt vmcnt(2)
v_cmp_eq_u32 vcc, -1, v117
v_mfma_f32_16x16x32_bf16 v[142:145], v[94:97], v[126:129], 0
s_cbranch_vccnz aF7_0_0_389
s_branch aB7_0_0_390
aB7_0_0_390:
v_mfma_f32_16x16x32_bf16 v[146:149], v[114:117], v[114:117], v[146:149]
v_mfma_f32_16x16x32_bf16 v[138:141], v[66:69], v[114:117], v[138:141]
s_waitcnt vmcnt(1)
v_cmp_eq_u32 vcc, -1, v121
v_mfma_f32_16x16x32_bf16 v[142:145], v[82:85], v[114:117], v[142:145]
s_cbranch_vccnz aF6_1_0_353
s_branch aB6_1_0_354
aF7_0_0_389:
buffer_load_dwordx4 v[114:117], v229, s[4:7], s39 offen offset:0 sc1
s_add_u32 s19, s19, 1
s_cmp_gt_u32 s19, 1048576
s_cbranch_scc1 L_end
s_waitcnt vmcnt(2)
v_cmp_eq_u32 vcc, -1, v121
s_cbranch_vccnz aF7_1_0_391
s_branch aB7_1_0_392
aB7_1_0_392:
v_mfma_f32_16x16x32_bf16 v[146:149], v[118:121], v[118:121], v[146:149]
v_mfma_f32_16x16x32_bf16 v[138:141], v[70:73], v[118:121], v[138:141]
s_waitcnt vmcnt(1)
v_cmp_eq_u32 vcc, -1, v125
v_mfma_f32_16x16x32_bf16 v[142:145], v[86:89], v[118:121], v[142:145]
s_cbranch_vccnz aF5_2_0_371
s_branch aB5_2_0_372
aF7_1_0_391:
buffer_load_dwordx4 v[118:121], v229, s[4:7], s39 offen offset:1024 sc1
s_add_u32 s19, s19, 1
s_cmp_gt_u32 s19, 1048576
s_cbranch_scc1 L_end
s_waitcnt vmcnt(2)
v_cmp_eq_u32 vcc, -1, v125
s_cbranch_vccnz aF7_2_0_393
s_branch aB7_2_0_394
aB7_2_0_394:
v_mfma_f32_16x16x32_bf16 v[146:149], v[122:125], v[122:125], v[146:149]
v_mfma_f32_16x16x32_bf16 v[138:141], v[74:77], v[122:125], v[138:141]
s_waitcnt vmcnt(1)
v_cmp_eq_u32 vcc, -1, v117
v_mfma_f32_16x16x32_bf16 v[142:145], v[90:93], v[122:125], v[142:145]
s_cbranch_vccnz aF3_0_0_379
s_branch aB3_0_0_380
aF7_2_0_393:
buffer_load_dwordx4 v[122:125], v229, s[4:7], s39 offen offset:2048 sc1
s_add_u32 s19, s19, 1
s_cmp_gt_u32 s19, 1048576
s_cbranch_scc1 L_end
s_waitcnt vmcnt(2)
v_cmp_eq_u32 vcc, -1, v117
s_cbranch_vccnz aF7_0_0_389
s_branch aB7_0_0_390
aF15_3_0_387:
buffer_load_dwordx4 v[126:129], v229, s[4:7], s39 offen offset:3072 sc1
s_add_u32 s19, s19, 1
s_cmp_gt_u32 s19, 1048576
s_cbranch_scc1 L_end
s_waitcnt vmcnt(3)
v_cmp_eq_u32 vcc, -1, v117
s_cbranch_vccnz aF15_0_0_331
s_branch aB15_0_0_332
vr_396:
buffer_load_dwordx4 v[130:133], v230, s[4:7], s40 offen offset:0 sc1
buffer_load_dwordx4 v[134:137], v230, s[4:7], s40 offen offset:512 sc1
s_add_u32 s19, s19, 1
s_cmp_gt_u32 s19, 1048576
s_cbranch_scc1 L_end
s_branch vc_395
rr_399:
s_add_u32 s19, s19, 1
s_cmp_gt_u32 s19, 1048576
s_cbranch_scc1 L_end
s_branch rr_398
aslow_323:
buffer_store_dword v208, v238, s[4:7], s38 offen sc1
s_barrier
aloop_400:
s_cmp_ge_u32 s18, 63
s_cbranch_scc1 aend_401
s_cmp_lt_u32 s18, 1
s_cbranch_scc1 a0_402
ds_read_b128 v[66:69], v231 offset:0
ds_read_b128 v[70:73], v231 offset:1024
ds_read_b128 v[74:77], v231 offset:2048
ds_read_b128 v[78:81], v231 offset:3072
ds_read_b128 v[82:85], v231 offset:4096
ds_read_b128 v[86:89], v231 offset:5120
ds_read_b128 v[90:93], v231 offset:6144
ds_read_b128 v[94:97], v231 offset:7168
ds_read_b128 v[98:101], v232 offset:0
ds_read_b128 v[102:105], v232 offset:1024
ds_read_b128 v[106:109], v232 offset:2048
ds_read_b128 v[110:113], v232 offset:3072
a0_403:
s_and_b32 s20, s18, 3
s_add_u32 s22, s18, 1
s_and_b32 s22, s22, 3
s_lshl_b32 s39, s20, 17
s_add_u32 s39, s39, s47
s_lshl_b32 s21, s20, 16
s_add_u32 s40, s21, s48
s_lshl_b32 s41, s20, 19
s_add_u32 s41, s41, s17
s_add_u32 s50, s41, s49
s_lshl_b32 s38, s22, 16
s_add_u32 s38, s38, 2097152
s_waitcnt vmcnt(0) lgkmcnt(0)
s_barrier
s_branch al_405
.p2align 6
s_nop 0
al_405:
s_barrier
buffer_load_dwordx4 v[114:117], v229, s[4:7], s39 offen offset:0 sc1
s_nop 11
buffer_load_dwordx4 v[118:121], v229, s[4:7], s39 offen offset:1024 sc1
s_nop 11
buffer_load_dwordx4 v[122:125], v229, s[4:7], s39 offen offset:2048 sc1
s_nop 11
buffer_load_dwordx4 v[126:129], v229, s[4:7], s39 offen offset:3072 sc1
s_waitcnt vmcnt(3)
v_max3_u32 v239, v114, v115, v116
v_max_u32 v239, v239, v117
v_cmp_eq_u32 vcc, -1, v239
s_cbranch_vccnz aF15_0_0_407
aB15_0_0_408:
v_mfma_f32_16x16x32_bf16 v[146:149], v[114:117], v[114:117], v[212:215]
s_waitcnt vmcnt(2)
v_max3_u32 v239, v118, v119, v120
v_mfma_f32_16x16x32_bf16 v[138:141], v[66:69], v[114:117], 0
v_max_u32 v239, v239, v121
v_mfma_f32_16x16x32_bf16 v[142:145], v[82:85], v[114:117], 0
v_cmp_eq_u32 vcc, -1, v239
s_cbranch_vccnz aF14_1_0_409
aB14_1_0_410:
v_mfma_f32_16x16x32_bf16 v[146:149], v[118:121], v[118:121], v[146:149]
s_waitcnt vmcnt(1)
v_max3_u32 v239, v122, v123, v124
v_mfma_f32_16x16x32_bf16 v[138:141], v[70:73], v[118:121], v[138:141]
v_max_u32 v239, v239, v125
v_mfma_f32_16x16x32_bf16 v[142:145], v[86:89], v[118:121], v[142:145]
v_cmp_eq_u32 vcc, -1, v239
s_cbranch_vccnz aF12_2_0_411
aB12_2_0_412:
v_mfma_f32_16x16x32_bf16 v[146:149], v[122:125], v[122:125], v[146:149]
s_waitcnt vmcnt(0)
v_max3_u32 v239, v126, v127, v128
v_mfma_f32_16x16x32_bf16 v[138:141], v[74:77], v[122:125], v[138:141]
v_max_u32 v239, v239, v129
v_mfma_f32_16x16x32_bf16 v[142:145], v[90:93], v[122:125], v[142:145]
v_cmp_eq_u32 vcc, -1, v239
s_cbranch_vccnz aF8_3_0_413
aB8_3_0_414:
v_mfma_f32_16x16x32_bf16 v[146:149], v[126:129], v[126:129], v[146:149]
buffer_load_dwordx4 v[130:133], v230, s[4:7], s40 offen offset:0 sc1
v_mfma_f32_16x16x32_bf16 v[138:141], v[78:81], v[126:129], v[138:141]
buffer_load_dwordx4 v[134:137], v230, s[4:7], s40 offen offset:512 sc1
v_mfma_f32_16x16x32_bf16 v[142:145], v[94:97], v[126:129], v[142:145]
adone_406:
s_barrier
s_nop 0
v_max3_f32 v240, v146, v147, v148
s_nop 1
v_max3_f32 v240, v240, v149, v138
v_max3_f32 v239, v139, v140, v141
s_nop 0
v_max3_f32 v240, v240, v142, v143
v_max3_f32 v239, v239, v144, v145
v_max_f32 v240, v240, v239
v_max_f32 v239, v240, v239
s_nop 1
v_permlane32_swap_b32 v240, v239
v_max_f32 v224, v240, v239
v_max_f32 v225, v240, v239
s_nop 1
v_permlane16_swap_b32 v224, v225
v_max_f32 v240, v224, v225
v_mul_f32 v240, s46, v240
v_fma_f32 v138, v138, s46, -v240
v_fma_f32 v139, v139, s46, -v240
v_fma_f32 v140, v140, s46, -v240
v_fma_f32 v141, v141, s46, -v240
v_exp_f32 v138, v138
v_exp_f32 v139, v139
v_exp_f32 v140, v140
v_exp_f32 v141, v141
v_fma_f32 v142, v142, s46, -v240
v_fma_f32 v143, v143, s46, -v240
v_fma_f32 v144, v144, s46, -v240
v_fma_f32 v145, v145, s46, -v240
v_exp_f32 v142, v142
v_exp_f32 v143, v143
v_exp_f32 v144, v144
v_exp_f32 v145, v145
v_cvt_pk_bf16_f32 v150, v138, v139
v_cvt_pk_bf16_f32 v151, v140, v141
v_cvt_pk_bf16_f32 v152, v142, v143
v_cvt_pk_bf16_f32 v153, v144, v145
v_fma_f32 v146, v146, s46, -v240
v_fma_f32 v147, v147, s46, -v240
v_mfma_f32_16x16x32_bf16 v[172:175], v[216:219], v[150:153], 0
v_fma_f32 v148, v148, s46, -v240
v_fma_f32 v149, v149, s46, -v240
v_mfma_f32_16x16x32_bf16 v[156:159], v[98:101], v[150:153], 0
v_exp_f32 v146, v146
v_mfma_f32_16x16x32_bf16 v[160:163], v[102:105], v[150:153], 0
v_exp_f32 v147, v147
v_mfma_f32_16x16x32_bf16 v[164:167], v[106:109], v[150:153], 0
v_exp_f32 v148, v148
v_mfma_f32_16x16x32_bf16 v[168:171], v[110:113], v[150:153], 0
v_exp_f32 v149, v149
v_cvt_pk_bf16_f32 v154, v146, v147
v_cvt_pk_bf16_f32 v155, v148, v149
vc_471:
s_waitcnt vmcnt(0)
s_nop 0
v_mfma_f32_16x16x16_bf16 v[224:227], v[216:217], v[154:155], v[172:175]
v_max3_u32 v239, v131, v133, v135
v_mfma_f32_16x16x16_bf16 v[114:117], v[130:131], v[154:155], v[156:159]
v_max_u32 v239, v239, v137
v_cmp_eq_u32 vcc, -1, v239
v_mfma_f32_16x16x16_bf16 v[118:121], v[132:133], v[154:155], v[160:163]
s_nop 0
v_rcp_f32 v240, v224
v_mfma_f32_16x16x16_bf16 v[122:125], v[134:135], v[154:155], v[164:167]
v_mul_f32 v114, v114, v240
v_mul_f32 v115, v115, v240
v_mfma_f32_16x16x16_bf16 v[126:129], v[136:137], v[154:155], v[168:171]
v_mul_f32 v116, v116, v240
v_mul_f32 v117, v117, v240
v_mov_b32_dpp v240, v240 row_shr:8 row_mask:0xf bank_mask:0xc
v_mul_f32 v118, v118, v240
v_mul_f32 v119, v119, v240
v_mul_f32 v120, v120, v240
v_mul_f32 v121, v121, v240
v_mul_f32_dpp v114, v122, v240 row_shr:8 row_mask:0xf bank_mask:0xc
v_mul_f32_dpp v115, v123, v240 row_shr:8 row_mask:0xf bank_mask:0xc
v_mul_f32_dpp v116, v124, v240 row_shr:8 row_mask:0xf bank_mask:0xc
v_mul_f32_dpp v117, v125, v240 row_shr:8 row_mask:0xf bank_mask:0xc
v_mul_f32_dpp v118, v126, v240 row_shr:8 row_mask:0xf bank_mask:0xc
v_mul_f32_dpp v119, v127, v240 row_shr:8 row_mask:0xf bank_mask:0xc
v_cvt_pk_bf16_f32 v176, v114, v115
v_mul_f32_dpp v120, v128, v240 row_shr:8 row_mask:0xf bank_mask:0xc
v_mul_f32_dpp v121, v129, v240 row_shr:8 row_mask:0xf bank_mask:0xc
v_cvt_pk_bf16_f32 v177, v116, v117
v_cvt_pk_bf16_f32 v178, v118, v119
v_cvt_pk_bf16_f32 v179, v120, v121
ds_write_b128 v233, v[176:179]
s_cbranch_vccnz vr_472
v_smfmac_f32_16x16x64_bf16 v[192:195], v[176:179], v[2:9], v228
v_smfmac_f32_16x16x64_bf16 v[196:199], v[176:179], v[34:41], v228
s_waitcnt lgkmcnt(0)
s_barrier
ds_read_b128 v[180:183], v234
ds_read_b128 v[184:187], v235
ds_read_b128 v[188:191], v236
s_waitcnt lgkmcnt(2)
v_smfmac_f32_16x16x64_bf16 v[192:195], v[180:183], v[10:17], v228
v_smfmac_f32_16x16x64_bf16 v[196:199], v[180:183], v[42:49], v228
s_waitcnt lgkmcnt(1)
v_smfmac_f32_16x16x64_bf16 v[192:195], v[184:187], v[18:25], v228
v_smfmac_f32_16x16x64_bf16 v[196:199], v[184:187], v[50:57], v228
s_waitcnt lgkmcnt(0)
v_smfmac_f32_16x16x64_bf16 v[192:195], v[188:191], v[26:33], v228
v_smfmac_f32_16x16x64_bf16 v[196:199], v[188:191], v[58:65], v228
s_nop 7
v_permlane32_swap_b32 v192, v196
v_permlane32_swap_b32 v193, v197
v_permlane32_swap_b32 v194, v198
v_permlane32_swap_b32 v195, v199
v_add_f32 v224, v192, v196
v_add_f32 v225, v193, v197
v_add_f32 v226, v194, v198
v_add_f32 v227, v195, v199
v_cvt_pk_bf16_f32 v224, v224, v225
v_cvt_pk_bf16_f32 v225, v226, v227
v_min_u32 v225, -2, v225
buffer_store_dwordx2 v[224:225], v237, s[4:7], s41 offen sc1
s_barrier
v_mov_b32 v192, 0
v_mov_b32 v193, 0
v_mov_b32 v194, 0
v_mov_b32 v195, 0
v_mov_b32 v196, 0
v_mov_b32 v197, 0
v_mov_b32 v198, 0
v_mov_b32 v199, 0
s_add_u32 s18, s18, 1
s_branch al_473
.p2align 6
s_nop 0
s_nop 0
al_473:
s_barrier
rr_474:
buffer_load_dwordx4 v[200:203], v229, s[4:7], s50 offen offset:0 sc1
buffer_load_dwordx4 v[204:207], v229, s[4:7], s50 offen offset:1024 sc1
s_waitcnt vmcnt(1)
v_mfma_f32_16x16x32_bf16 v[208:211], v[200:203], v[220:223], 0
v_max_u32 v239, v201, v203
s_waitcnt vmcnt(0)
v_mfma_f32_16x16x32_bf16 v[208:211], v[204:207], v[220:223], v[208:211]
v_max3_u32 v239, v239, v205, v207
v_cmp_eq_u32 vcc, -1, v239
s_cbranch_vccnz rr_475
s_nop 4
v_permlane32_swap_b32 v208, v210
v_permlane32_swap_b32 v209, v211
v_add_f32 v208, v208, v210
v_add_f32 v209, v209, v211
v_cvt_pk_bf16_f32 v208, v208, v209
v_min_u32 v208, -2, v208
buffer_store_dword v208, v238, s[4:7], s38 offen sc1
s_barrier
s_branch aloop_400
aend_401:
s_waitcnt vmcnt(0) lgkmcnt(0)
s_endpgm
a0_402:
s_and_b32 s20, s45, 0xffffff7f
v_and_b32 v239, 1, v0
v_lshlrev_b32 v239, 7, v239
a0_404:
s_add_u32 s19, s19, 1
s_cmp_gt_u32 s19, 1048576
s_cbranch_scc1 L_end
buffer_load_dword v240, v239, s[4:7], s20 offen sc1
s_waitcnt vmcnt(0)
v_cmp_ge_u32 vcc, s18, v240
s_cbranch_vccnz a0_404
s_and_b32 s21, s12, 1
s_mul_i32 s21, s21, 33554432
s_lshl_b32 s20, s18, 14
s_xor_b32 s20, s20, s44
s_sub_u32 s20, s20, s21
s_add_u32 s21, s20, 4096
s_and_b32 s22, s12, 1
s_lshl_b32 s22, s22, 12
s_add_u32 s22, s22, s20
s_add_u32 s22, s22, 33554432
buffer_load_dwordx4 v[66:69], v229, s[4:7], s20 offen offset:0 sc1
buffer_load_dwordx4 v[70:73], v229, s[4:7], s20 offen offset:1024 sc1
buffer_load_dwordx4 v[74:77], v229, s[4:7], s20 offen offset:2048 sc1
buffer_load_dwordx4 v[78:81], v229, s[4:7], s20 offen offset:3072 sc1
buffer_load_dwordx4 v[82:85], v229, s[4:7], s21 offen offset:0 sc1
buffer_load_dwordx4 v[86:89], v229, s[4:7], s21 offen offset:1024 sc1
buffer_load_dwordx4 v[90:93], v229, s[4:7], s21 offen offset:2048 sc1
buffer_load_dwordx4 v[94:97], v229, s[4:7], s21 offen offset:3072 sc1
buffer_load_dwordx4 v[98:101], v229, s[4:7], s22 offen offset:0 sc1
buffer_load_dwordx4 v[102:105], v229, s[4:7], s22 offen offset:1024 sc1
buffer_load_dwordx4 v[106:109], v229, s[4:7], s22 offen offset:2048 sc1
buffer_load_dwordx4 v[110:113], v229, s[4:7], s22 offen offset:3072 sc1
s_branch a0_403
aF8_3_0_413:
buffer_load_dwordx4 v[126:129], v229, s[4:7], s39 offen offset:3072 sc1
s_add_u32 s19, s19, 1
s_cmp_gt_u32 s19, 1048576
s_cbranch_scc1 L_end
s_waitcnt vmcnt(0)
v_max3_u32 v239, v126, v127, v128
v_max_u32 v239, v239, v129
v_cmp_eq_u32 vcc, -1, v239
s_cbranch_vccnz aF8_3_0_413
s_branch aB8_3_0_414
aF12_2_0_411:
buffer_load_dwordx4 v[122:125], v229, s[4:7], s39 offen offset:2048 sc1
s_add_u32 s19, s19, 1
s_cmp_gt_u32 s19, 1048576
s_cbranch_scc1 L_end
s_waitcnt vmcnt(1)
v_max3_u32 v239, v126, v127, v128
v_max_u32 v239, v239, v129
v_cmp_eq_u32 vcc, -1, v239
s_cbranch_vccnz aF12_3_0_415
s_branch aB12_3_0_416
aB12_3_0_416:
v_mfma_f32_16x16x32_bf16 v[146:149], v[126:129], v[126:129], v[146:149]
s_waitcnt vmcnt(0)
v_max3_u32 v239, v122, v123, v124
v_mfma_f32_16x16x32_bf16 v[138:141], v[78:81], v[126:129], v[138:141]
v_max_u32 v239, v239, v125
v_mfma_f32_16x16x32_bf16 v[142:145], v[94:97], v[126:129], v[142:145]
v_cmp_eq_u32 vcc, -1, v239
s_cbranch_vccnz aF4_2_0_417
s_branch aB4_2_0_418
aB4_2_0_418:
v_mfma_f32_16x16x32_bf16 v[146:149], v[122:125], v[122:125], v[146:149]
buffer_load_dwordx4 v[130:133], v230, s[4:7], s40 offen offset:0 sc1
v_mfma_f32_16x16x32_bf16 v[138:141], v[74:77], v[122:125], v[138:141]
buffer_load_dwordx4 v[134:137], v230, s[4:7], s40 offen offset:512 sc1
v_mfma_f32_16x16x32_bf16 v[142:145], v[90:93], v[122:125], v[142:145]
s_branch adone_406
aF4_2_0_417:
buffer_load_dwordx4 v[122:125], v229, s[4:7], s39 offen offset:2048 sc1
s_add_u32 s19, s19, 1
s_cmp_gt_u32 s19, 1048576
s_cbranch_scc1 L_end
s_waitcnt vmcnt(0)
v_max3_u32 v239, v122, v123, v124
v_max_u32 v239, v239, v125
v_cmp_eq_u32 vcc, -1, v239
s_cbranch_vccnz aF4_2_0_417
s_branch aB4_2_0_418
aF12_3_0_415:
buffer_load_dwordx4 v[126:129], v229, s[4:7], s39 offen offset:3072 sc1
s_add_u32 s19, s19, 1
s_cmp_gt_u32 s19, 1048576
s_cbranch_scc1 L_end
s_waitcnt vmcnt(1)
v_max3_u32 v239, v122, v123, v124
v_max_u32 v239, v239, v125
v_cmp_eq_u32 vcc, -1, v239
s_cbranch_vccnz aF12_2_0_411
s_branch aB12_2_0_412
aF14_1_0_409:
buffer_load_dwordx4 v[118:121], v229, s[4:7], s39 offen offset:1024 sc1
s_add_u32 s19, s19, 1
s_cmp_gt_u32 s19, 1048576
s_cbranch_scc1 L_end
s_waitcnt vmcnt(2)
v_max3_u32 v239, v122, v123, v124
v_max_u32 v239, v239, v125
v_cmp_eq_u32 vcc, -1, v239
s_cbranch_vccnz aF14_2_0_419
s_branch aB14_2_0_420
aB14_2_0_420:
v_mfma_f32_16x16x32_bf16 v[146:149], v[122:125], v[122:125], v[146:149]
s_waitcnt vmcnt(1)
v_max3_u32 v239, v126, v127, v128
v_mfma_f32_16x16x32_bf16 v[138:141], v[74:77], v[122:125], v[138:141]
v_max_u32 v239, v239, v129
v_mfma_f32_16x16x32_bf16 v[142:145], v[90:93], v[122:125], v[142:145]
v_cmp_eq_u32 vcc, -1, v239
s_cbranch_vccnz aF10_3_0_421
s_branch aB10_3_0_422
aB10_3_0_422:
v_mfma_f32_16x16x32_bf16 v[146:149], v[126:129], v[126:129], v[146:149]
s_waitcnt vmcnt(0)
v_max3_u32 v239, v118, v119, v120
v_mfma_f32_16x16x32_bf16 v[138:141], v[78:81], v[126:129], v[138:141]
v_max_u32 v239, v239, v121
v_mfma_f32_16x16x32_bf16 v[142:145], v[94:97], v[126:129], v[142:145]
v_cmp_eq_u32 vcc, -1, v239
s_cbranch_vccnz aF2_1_0_423
s_branch aB2_1_0_424
aB2_1_0_424:
v_mfma_f32_16x16x32_bf16 v[146:149], v[118:121], v[118:121], v[146:149]
buffer_load_dwordx4 v[130:133], v230, s[4:7], s40 offen offset:0 sc1
v_mfma_f32_16x16x32_bf16 v[138:141], v[70:73], v[118:121], v[138:141]
buffer_load_dwordx4 v[134:137], v230, s[4:7], s40 offen offset:512 sc1
v_mfma_f32_16x16x32_bf16 v[142:145], v[86:89], v[118:121], v[142:145]
s_branch adone_406
aF2_1_0_423:
buffer_load_dwordx4 v[118:121], v229, s[4:7], s39 offen offset:1024 sc1
s_add_u32 s19, s19, 1
s_cmp_gt_u32 s19, 1048576
s_cbranch_scc1 L_end
s_waitcnt vmcnt(0)
v_max3_u32 v239, v118, v119, v120
v_max_u32 v239, v239, v121
v_cmp_eq_u32 vcc, -1, v239
s_cbranch_vccnz aF2_1_0_423
s_branch aB2_1_0_424
aF10_3_0_421:
buffer_load_dwordx4 v[126:129], v229, s[4:7], s39 offen offset:3072 sc1
s_add_u32 s19, s19, 1
s_cmp_gt_u32 s19, 1048576
s_cbranch_scc1 L_end
s_waitcnt vmcnt(1)
v_max3_u32 v239, v118, v119, v120
v_max_u32 v239, v239, v121
v_cmp_eq_u32 vcc, -1, v239
s_cbranch_vccnz aF10_1_0_425
s_branch aB10_1_0_426
aB10_1_0_426:
v_mfma_f32_16x16x32_bf16 v[146:149], v[118:121], v[118:121], v[146:149]
s_waitcnt vmcnt(0)
v_max3_u32 v239, v126, v127, v128
v_mfma_f32_16x16x32_bf16 v[138:141], v[70:73], v[118:121], v[138:141]
v_max_u32 v239, v239, v129
v_mfma_f32_16x16x32_bf16 v[142:145], v[86:89], v[118:121], v[142:145]
v_cmp_eq_u32 vcc, -1, v239
s_cbranch_vccnz aF8_3_0_413
s_branch aB8_3_0_414
aF10_1_0_425:
buffer_load_dwordx4 v[118:121], v229, s[4:7], s39 offen offset:1024 sc1
s_add_u32 s19, s19, 1
s_cmp_gt_u32 s19, 1048576
s_cbranch_scc1 L_end
s_waitcnt vmcnt(1)
v_max3_u32 v239, v126, v127, v128
v_max_u32 v239, v239, v129
v_cmp_eq_u32 vcc, -1, v239
s_cbranch_vccnz aF10_3_0_421
s_branch aB10_3_0_422
aF14_2_0_419:
buffer_load_dwordx4 v[122:125], v229, s[4:7], s39 offen offset:2048 sc1
s_add_u32 s19, s19, 1
s_cmp_gt_u32 s19, 1048576
s_cbranch_scc1 L_end
s_waitcnt vmcnt(2)
v_max3_u32 v239, v126, v127, v128
v_max_u32 v239, v239, v129
v_cmp_eq_u32 vcc, -1, v239
s_cbranch_vccnz aF14_3_0_427
s_branch aB14_3_0_428
aB14_3_0_428:
v_mfma_f32_16x16x32_bf16 v[146:149], v[126:129], v[126:129], v[146:149]
s_waitcnt vmcnt(1)
v_max3_u32 v239, v118, v119, v120
v_mfma_f32_16x16x32_bf16 v[138:141], v[78:81], v[126:129], v[138:141]
v_max_u32 v239, v239, v121
v_mfma_f32_16x16x32_bf16 v[142:145], v[94:97], v[126:129], v[142:145]
v_cmp_eq_u32 vcc, -1, v239
s_cbranch_vccnz aF6_1_0_429
s_branch aB6_1_0_430
aB6_1_0_430:
v_mfma_f32_16x16x32_bf16 v[146:149], v[118:121], v[118:121], v[146:149]
s_waitcnt vmcnt(0)
v_max3_u32 v239, v122, v123, v124
v_mfma_f32_16x16x32_bf16 v[138:141], v[70:73], v[118:121], v[138:141]
v_max_u32 v239, v239, v125
v_mfma_f32_16x16x32_bf16 v[142:145], v[86:89], v[118:121], v[142:145]
v_cmp_eq_u32 vcc, -1, v239
s_cbranch_vccnz aF4_2_0_417
s_branch aB4_2_0_418
aF6_1_0_429:
buffer_load_dwordx4 v[118:121], v229, s[4:7], s39 offen offset:1024 sc1
s_add_u32 s19, s19, 1
s_cmp_gt_u32 s19, 1048576
s_cbranch_scc1 L_end
s_waitcnt vmcnt(1)
v_max3_u32 v239, v122, v123, v124
v_max_u32 v239, v239, v125
v_cmp_eq_u32 vcc, -1, v239
s_cbranch_vccnz aF6_2_0_431
s_branch aB6_2_0_432
aB6_2_0_432:
v_mfma_f32_16x16x32_bf16 v[146:149], v[122:125], v[122:125], v[146:149]
s_waitcnt vmcnt(0)
v_max3_u32 v239, v118, v119, v120
v_mfma_f32_16x16x32_bf16 v[138:141], v[74:77], v[122:125], v[138:141]
v_max_u32 v239, v239, v121
v_mfma_f32_16x16x32_bf16 v[142:145], v[90:93], v[122:125], v[142:145]
v_cmp_eq_u32 vcc, -1, v239
s_cbranch_vccnz aF2_1_0_423
s_branch aB2_1_0_424
aF6_2_0_431:
buffer_load_dwordx4 v[122:125], v229, s[4:7], s39 offen offset:2048 sc1
s_add_u32 s19, s19, 1
s_cmp_gt_u32 s19, 1048576
s_cbranch_scc1 L_end
s_waitcnt vmcnt(1)
v_max3_u32 v239, v118, v119, v120
v_max_u32 v239, v239, v121
v_cmp_eq_u32 vcc, -1, v239
s_cbranch_vccnz aF6_1_0_429
s_branch aB6_1_0_430
aF14_3_0_427:
buffer_load_dwordx4 v[126:129], v229, s[4:7], s39 offen offset:3072 sc1
s_add_u32 s19, s19, 1
s_cmp_gt_u32 s19, 1048576
s_cbranch_scc1 L_end
s_waitcnt vmcnt(2)
v_max3_u32 v239, v118, v119, v120
v_max_u32 v239, v239, v121
v_cmp_eq_u32 vcc, -1, v239
s_cbranch_vccnz aF14_1_0_409
s_branch aB14_1_0_410
aF15_0_0_407:
buffer_load_dwordx4 v[114:117], v229, s[4:7], s39 offen offset:0 sc1
s_add_u32 s19, s19, 1
s_cmp_gt_u32 s19, 1048576
s_cbranch_scc1 L_end
s_waitcnt vmcnt(3)
v_max3_u32 v239, v118, v119, v120
v_max_u32 v239, v239, v121
v_cmp_eq_u32 vcc, -1, v239
s_cbranch_vccnz aF15_1_0_433
s_branch aB15_1_0_434
aB15_1_0_434:
v_mfma_f32_16x16x32_bf16 v[146:149], v[118:121], v[118:121], v[212:215]
s_waitcnt vmcnt(2)
v_max3_u32 v239, v122, v123, v124
v_mfma_f32_16x16x32_bf16 v[138:141], v[70:73], v[118:121], 0
v_max_u32 v239, v239, v125
v_mfma_f32_16x16x32_bf16 v[142:145], v[86:89], v[118:121], 0
v_cmp_eq_u32 vcc, -1, v239
s_cbranch_vccnz aF13_2_0_435
s_branch aB13_2_0_436
aB13_2_0_436:
v_mfma_f32_16x16x32_bf16 v[146:149], v[122:125], v[122:125], v[146:149]
s_waitcnt vmcnt(1)
v_max3_u32 v239, v126, v127, v128
v_mfma_f32_16x16x32_bf16 v[138:141], v[74:77], v[122:125], v[138:141]
v_max_u32 v239, v239, v129
v_mfma_f32_16x16x32_bf16 v[142:145], v[90:93], v[122:125], v[142:145]
v_cmp_eq_u32 vcc, -1, v239
s_cbranch_vccnz aF9_3_0_437
s_branch aB9_3_0_438
aB9_3_0_438:
v_mfma_f32_16x16x32_bf16 v[146:149], v[126:129], v[126:129], v[146:149]
s_waitcnt vmcnt(0)
v_max3_u32 v239, v114, v115, v116
v_mfma_f32_16x16x32_bf16 v[138:141], v[78:81], v[126:129], v[138:141]
v_max_u32 v239, v239, v117
v_mfma_f32_16x16x32_bf16 v[142:145], v[94:97], v[126:129], v[142:145]
v_cmp_eq_u32 vcc, -1, v239
s_cbranch_vccnz aF1_0_0_439
s_branch aB1_0_0_440
aB1_0_0_440:
v_mfma_f32_16x16x32_bf16 v[146:149], v[114:117], v[114:117], v[146:149]
buffer_load_dwordx4 v[130:133], v230, s[4:7], s40 offen offset:0 sc1
v_mfma_f32_16x16x32_bf16 v[138:141], v[66:69], v[114:117], v[138:141]
buffer_load_dwordx4 v[134:137], v230, s[4:7], s40 offen offset:512 sc1
v_mfma_f32_16x16x32_bf16 v[142:145], v[82:85], v[114:117], v[142:145]
s_branch adone_406
aF1_0_0_439:
buffer_load_dwordx4 v[114:117], v229, s[4:7], s39 offen offset:0 sc1
s_add_u32 s19, s19, 1
s_cmp_gt_u32 s19, 1048576
s_cbranch_scc1 L_end
s_waitcnt vmcnt(0)
v_max3_u32 v239, v114, v115, v116
v_max_u32 v239, v239, v117
v_cmp_eq_u32 vcc, -1, v239
s_cbranch_vccnz aF1_0_0_439
s_branch aB1_0_0_440
aF9_3_0_437:
buffer_load_dwordx4 v[126:129], v229, s[4:7], s39 offen offset:3072 sc1
s_add_u32 s19, s19, 1
s_cmp_gt_u32 s19, 1048576
s_cbranch_scc1 L_end
s_waitcnt vmcnt(1)
v_max3_u32 v239, v114, v115, v116
v_max_u32 v239, v239, v117
v_cmp_eq_u32 vcc, -1, v239
s_cbranch_vccnz aF9_0_0_441
s_branch aB9_0_0_442
aB9_0_0_442:
v_mfma_f32_16x16x32_bf16 v[146:149], v[114:117], v[114:117], v[146:149]
s_waitcnt vmcnt(0)
v_max3_u32 v239, v126, v127, v128
v_mfma_f32_16x16x32_bf16 v[138:141], v[66:69], v[114:117], v[138:141]
v_max_u32 v239, v239, v129
v_mfma_f32_16x16x32_bf16 v[142:145], v[82:85], v[114:117], v[142:145]
v_cmp_eq_u32 vcc, -1, v239
s_cbranch_vccnz aF8_3_0_413
s_branch aB8_3_0_414
aF9_0_0_441:
buffer_load_dwordx4 v[114:117], v229, s[4:7], s39 offen offset:0 sc1
s_add_u32 s19, s19, 1
s_cmp_gt_u32 s19, 1048576
s_cbranch_scc1 L_end
s_waitcnt vmcnt(1)
v_max3_u32 v239, v126, v127, v128
v_max_u32 v239, v239, v129
v_cmp_eq_u32 vcc, -1, v239
s_cbranch_vccnz aF9_3_0_437
s_branch aB9_3_0_438
aF13_2_0_435:
buffer_load_dwordx4 v[122:125], v229, s[4:7], s39 offen offset:2048 sc1
s_add_u32 s19, s19, 1
s_cmp_gt_u32 s19, 1048576
s_cbranch_scc1 L_end
s_waitcnt vmcnt(2)
v_max3_u32 v239, v126, v127, v128
v_max_u32 v239, v239, v129
v_cmp_eq_u32 vcc, -1, v239
s_cbranch_vccnz aF13_3_0_443
s_branch aB13_3_0_444
aB13_3_0_444:
v_mfma_f32_16x16x32_bf16 v[146:149], v[126:129], v[126:129], v[146:149]
s_waitcnt vmcnt(1)
v_max3_u32 v239, v114, v115, v116
v_mfma_f32_16x16x32_bf16 v[138:141], v[78:81], v[126:129], v[138:141]
v_max_u32 v239, v239, v117
v_mfma_f32_16x16x32_bf16 v[142:145], v[94:97], v[126:129], v[142:145]
v_cmp_eq_u32 vcc, -1, v239
s_cbranch_vccnz aF5_0_0_445
s_branch aB5_0_0_446
aB5_0_0_446:
v_mfma_f32_16x16x32_bf16 v[146:149], v[114:117], v[114:117], v[146:149]
s_waitcnt vmcnt(0)
v_max3_u32 v239, v122, v123, v124
v_mfma_f32_16x16x32_bf16 v[138:141], v[66:69], v[114:117], v[138:141]
v_max_u32 v239, v239, v125
v_mfma_f32_16x16x32_bf16 v[142:145], v[82:85], v[114:117], v[142:145]
v_cmp_eq_u32 vcc, -1, v239
s_cbranch_vccnz aF4_2_0_417
s_branch aB4_2_0_418
aF5_0_0_445:
buffer_load_dwordx4 v[114:117], v229, s[4:7], s39 offen offset:0 sc1
s_add_u32 s19, s19, 1
s_cmp_gt_u32 s19, 1048576
s_cbranch_scc1 L_end
s_waitcnt vmcnt(1)
v_max3_u32 v239, v122, v123, v124
v_max_u32 v239, v239, v125
v_cmp_eq_u32 vcc, -1, v239
s_cbranch_vccnz aF5_2_0_447
s_branch aB5_2_0_448
aB5_2_0_448:
v_mfma_f32_16x16x32_bf16 v[146:149], v[122:125], v[122:125], v[146:149]
s_waitcnt vmcnt(0)
v_max3_u32 v239, v114, v115, v116
v_mfma_f32_16x16x32_bf16 v[138:141], v[74:77], v[122:125], v[138:141]
v_max_u32 v239, v239, v117
v_mfma_f32_16x16x32_bf16 v[142:145], v[90:93], v[122:125], v[142:145]
v_cmp_eq_u32 vcc, -1, v239
s_cbranch_vccnz aF1_0_0_439
s_branch aB1_0_0_440
aF5_2_0_447:
buffer_load_dwordx4 v[122:125], v229, s[4:7], s39 offen offset:2048 sc1
s_add_u32 s19, s19, 1
s_cmp_gt_u32 s19, 1048576
s_cbranch_scc1 L_end
s_waitcnt vmcnt(1)
v_max3_u32 v239, v114, v115, v116
v_max_u32 v239, v239, v117
v_cmp_eq_u32 vcc, -1, v239
s_cbranch_vccnz aF5_0_0_445
s_branch aB5_0_0_446
aF13_3_0_443:
buffer_load_dwordx4 v[126:129], v229, s[4:7], s39 offen offset:3072 sc1
s_add_u32 s19, s19, 1
s_cmp_gt_u32 s19, 1048576
s_cbranch_scc1 L_end
s_waitcnt vmcnt(2)
v_max3_u32 v239, v114, v115, v116
v_max_u32 v239, v239, v117
v_cmp_eq_u32 vcc, -1, v239
s_cbranch_vccnz aF13_0_0_449
s_branch aB13_0_0_450
aB13_0_0_450:
v_mfma_f32_16x16x32_bf16 v[146:149], v[114:117], v[114:117], v[146:149]
s_waitcnt vmcnt(1)
v_max3_u32 v239, v122, v123, v124
v_mfma_f32_16x16x32_bf16 v[138:141], v[66:69], v[114:117], v[138:141]
v_max_u32 v239, v239, v125
v_mfma_f32_16x16x32_bf16 v[142:145], v[82:85], v[114:117], v[142:145]
v_cmp_eq_u32 vcc, -1, v239
s_cbranch_vccnz aF12_2_0_411
s_branch aB12_2_0_412
aF13_0_0_449:
buffer_load_dwordx4 v[114:117], v229, s[4:7], s39 offen offset:0 sc1
s_add_u32 s19, s19, 1
s_cmp_gt_u32 s19, 1048576
s_cbranch_scc1 L_end
s_waitcnt vmcnt(2)
v_max3_u32 v239, v122, v123, v124
v_max_u32 v239, v239, v125
v_cmp_eq_u32 vcc, -1, v239
s_cbranch_vccnz aF13_2_0_435
s_branch aB13_2_0_436
aF15_1_0_433:
buffer_load_dwordx4 v[118:121], v229, s[4:7], s39 offen offset:1024 sc1
s_add_u32 s19, s19, 1
s_cmp_gt_u32 s19, 1048576
s_cbranch_scc1 L_end
s_waitcnt vmcnt(3)
v_max3_u32 v239, v122, v123, v124
v_max_u32 v239, v239, v125
v_cmp_eq_u32 vcc, -1, v239
s_cbranch_vccnz aF15_2_0_451
s_branch aB15_2_0_452
aB15_2_0_452:
v_mfma_f32_16x16x32_bf16 v[146:149], v[122:125], v[122:125], v[212:215]
s_waitcnt vmcnt(2)
v_max3_u32 v239, v126, v127, v128
v_mfma_f32_16x16x32_bf16 v[138:141], v[74:77], v[122:125], 0
v_max_u32 v239, v239, v129
v_mfma_f32_16x16x32_bf16 v[142:145], v[90:93], v[122:125], 0
v_cmp_eq_u32 vcc, -1, v239
s_cbranch_vccnz aF11_3_0_453
s_branch aB11_3_0_454
aB11_3_0_454:
v_mfma_f32_16x16x32_bf16 v[146:149], v[126:129], v[126:129], v[146:149]
s_waitcnt vmcnt(1)
v_max3_u32 v239, v114, v115, v116
v_mfma_f32_16x16x32_bf16 v[138:141], v[78:81], v[126:129], v[138:141]
v_max_u32 v239, v239, v117
v_mfma_f32_16x16x32_bf16 v[142:145], v[94:97], v[126:129], v[142:145]
v_cmp_eq_u32 vcc, -1, v239
s_cbranch_vccnz aF3_0_0_455
s_branch aB3_0_0_456
aB3_0_0_456:
v_mfma_f32_16x16x32_bf16 v[146:149], v[114:117], v[114:117], v[146:149]
s_waitcnt vmcnt(0)
v_max3_u32 v239, v118, v119, v120
v_mfma_f32_16x16x32_bf16 v[138:141], v[66:69], v[114:117], v[138:141]
v_max_u32 v239, v239, v121
v_mfma_f32_16x16x32_bf16 v[142:145], v[82:85], v[114:117], v[142:145]
v_cmp_eq_u32 vcc, -1, v239
s_cbranch_vccnz aF2_1_0_423
s_branch aB2_1_0_424
aF3_0_0_455:
buffer_load_dwordx4 v[114:117], v229, s[4:7], s39 offen offset:0 sc1
s_add_u32 s19, s19, 1
s_cmp_gt_u32 s19, 1048576
s_cbranch_scc1 L_end
s_waitcnt vmcnt(1)
v_max3_u32 v239, v118, v119, v120
v_max_u32 v239, v239, v121
v_cmp_eq_u32 vcc, -1, v239
s_cbranch_vccnz aF3_1_0_457
s_branch aB3_1_0_458
aB3_1_0_458:
v_mfma_f32_16x16x32_bf16 v[146:149], v[118:121], v[118:121], v[146:149]
s_waitcnt vmcnt(0)
v_max3_u32 v239, v114, v115, v116
v_mfma_f32_16x16x32_bf16 v[138:141], v[70:73], v[118:121], v[138:141]
v_max_u32 v239, v239, v117
v_mfma_f32_16x16x32_bf16 v[142:145], v[86:89], v[118:121], v[142:145]
v_cmp_eq_u32 vcc, -1, v239
s_cbranch_vccnz aF1_0_0_439
s_branch aB1_0_0_440
aF3_1_0_457:
buffer_load_dwordx4 v[118:121], v229, s[4:7], s39 offen offset:1024 sc1
s_add_u32 s19, s19, 1
s_cmp_gt_u32 s19, 1048576
s_cbranch_scc1 L_end
s_waitcnt vmcnt(1)
v_max3_u32 v239, v114, v115, v116
v_max_u32 v239, v239, v117
v_cmp_eq_u32 vcc, -1, v239
s_cbranch_vccnz aF3_0_0_455
s_branch aB3_0_0_456
aF11_3_0_453:
buffer_load_dwordx4 v[126:129], v229, s[4:7], s39 offen offset:3072 sc1
s_add_u32 s19, s19, 1
s_cmp_gt_u32 s19, 1048576
s_cbranch_scc1 L_end
s_waitcnt vmcnt(2)
v_max3_u32 v239, v114, v115, v116
v_max_u32 v239, v239, v117
v_cmp_eq_u32 vcc, -1, v239
s_cbranch_vccnz aF11_0_0_459
s_branch aB11_0_0_460
aB11_0_0_460:
v_mfma_f32_16x16x32_bf16 v[146:149], v[114:117], v[114:117], v[146:149]
s_waitcnt vmcnt(1)
v_max3_u32 v239, v118, v119, v120
v_mfma_f32_16x16x32_bf16 v[138:141], v[66:69], v[114:117], v[138:141]
v_max_u32 v239, v239, v121
v_mfma_f32_16x16x32_bf16 v[142:145], v[82:85], v[114:117], v[142:145]
v_cmp_eq_u32 vcc, -1, v239
s_cbranch_vccnz aF10_1_0_425
s_branch aB10_1_0_426
aF11_0_0_459:
buffer_load_dwordx4 v[114:117], v229, s[4:7], s39 offen offset:0 sc1
s_add_u32 s19, s19, 1
s_cmp_gt_u32 s19, 1048576
s_cbranch_scc1 L_end
s_waitcnt vmcnt(2)
v_max3_u32 v239, v118, v119, v120
v_max_u32 v239, v239, v121
v_cmp_eq_u32 vcc, -1, v239
s_cbranch_vccnz aF11_1_0_461
s_branch aB11_1_0_462
aB11_1_0_462:
v_mfma_f32_16x16x32_bf16 v[146:149], v[118:121], v[118:121], v[146:149]
s_waitcnt vmcnt(1)
v_max3_u32 v239, v126, v127, v128
v_mfma_f32_16x16x32_bf16 v[138:141], v[70:73], v[118:121], v[138:141]
v_max_u32 v239, v239, v129
v_mfma_f32_16x16x32_bf16 v[142:145], v[86:89], v[118:121], v[142:145]
v_cmp_eq_u32 vcc, -1, v239
s_cbranch_vccnz aF9_3_0_437
s_branch aB9_3_0_438
aF11_1_0_461:
buffer_load_dwordx4 v[118:121], v229, s[4:7], s39 offen offset:1024 sc1
s_add_u32 s19, s19, 1
s_cmp_gt_u32 s19, 1048576
s_cbranch_scc1 L_end
s_waitcnt vmcnt(2)
v_max3_u32 v239, v126, v127, v128
v_max_u32 v239, v239, v129
v_cmp_eq_u32 vcc, -1, v239
s_cbranch_vccnz aF11_3_0_453
s_branch aB11_3_0_454
aF15_2_0_451:
buffer_load_dwordx4 v[122:125], v229, s[4:7], s39 offen offset:2048 sc1
s_add_u32 s19, s19, 1
s_cmp_gt_u32 s19, 1048576
s_cbranch_scc1 L_end
s_waitcnt vmcnt(3)
v_max3_u32 v239, v126, v127, v128
v_max_u32 v239, v239, v129
v_cmp_eq_u32 vcc, -1, v239
s_cbranch_vccnz aF15_3_0_463
s_branch aB15_3_0_464
aB15_3_0_464:
v_mfma_f32_16x16x32_bf16 v[146:149], v[126:129], v[126:129], v[212:215]
s_waitcnt vmcnt(2)
v_max3_u32 v239, v114, v115, v116
v_mfma_f32_16x16x32_bf16 v[138:141], v[78:81], v[126:129], 0
v_max_u32 v239, v239, v117
v_mfma_f32_16x16x32_bf16 v[142:145], v[94:97], v[126:129], 0
v_cmp_eq_u32 vcc, -1, v239
s_cbranch_vccnz aF7_0_0_465
s_branch aB7_0_0_466
aB7_0_0_466:
v_mfma_f32_16x16x32_bf16 v[146:149], v[114:117], v[114:117], v[146:149]
s_waitcnt vmcnt(1)
v_max3_u32 v239, v118, v119, v120
v_mfma_f32_16x16x32_bf16 v[138:141], v[66:69], v[114:117], v[138:141]
v_max_u32 v239, v239, v121
v_mfma_f32_16x16x32_bf16 v[142:145], v[82:85], v[114:117], v[142:145]
v_cmp_eq_u32 vcc, -1, v239
s_cbranch_vccnz aF6_1_0_429
s_branch aB6_1_0_430
aF7_0_0_465:
buffer_load_dwordx4 v[114:117], v229, s[4:7], s39 offen offset:0 sc1
s_add_u32 s19, s19, 1
s_cmp_gt_u32 s19, 1048576
s_cbranch_scc1 L_end
s_waitcnt vmcnt(2)
v_max3_u32 v239, v118, v119, v120
v_max_u32 v239, v239, v121
v_cmp_eq_u32 vcc, -1, v239
s_cbranch_vccnz aF7_1_0_467
s_branch aB7_1_0_468
aB7_1_0_468:
v_mfma_f32_16x16x32_bf16 v[146:149], v[118:121], v[118:121], v[146:149]
s_waitcnt vmcnt(1)
v_max3_u32 v239, v122, v123, v124
v_mfma_f32_16x16x32_bf16 v[138:141], v[70:73], v[118:121], v[138:141]
v_max_u32 v239, v239, v125
v_mfma_f32_16x16x32_bf16 v[142:145], v[86:89], v[118:121], v[142:145]
v_cmp_eq_u32 vcc, -1, v239
s_cbranch_vccnz aF5_2_0_447
s_branch aB5_2_0_448
aF7_1_0_467:
buffer_load_dwordx4 v[118:121], v229, s[4:7], s39 offen offset:1024 sc1
s_add_u32 s19, s19, 1
s_cmp_gt_u32 s19, 1048576
s_cbranch_scc1 L_end
s_waitcnt vmcnt(2)
v_max3_u32 v239, v122, v123, v124
v_max_u32 v239, v239, v125
v_cmp_eq_u32 vcc, -1, v239
s_cbranch_vccnz aF7_2_0_469
s_branch aB7_2_0_470
aB7_2_0_470:
v_mfma_f32_16x16x32_bf16 v[146:149], v[122:125], v[122:125], v[146:149]
s_waitcnt vmcnt(1)
v_max3_u32 v239, v114, v115, v116
v_mfma_f32_16x16x32_bf16 v[138:141], v[74:77], v[122:125], v[138:141]
v_max_u32 v239, v239, v117
v_mfma_f32_16x16x32_bf16 v[142:145], v[90:93], v[122:125], v[142:145]
v_cmp_eq_u32 vcc, -1, v239
s_cbranch_vccnz aF3_0_0_455
s_branch aB3_0_0_456
aF7_2_0_469:
buffer_load_dwordx4 v[122:125], v229, s[4:7], s39 offen offset:2048 sc1
s_add_u32 s19, s19, 1
s_cmp_gt_u32 s19, 1048576
s_cbranch_scc1 L_end
s_waitcnt vmcnt(2)
v_max3_u32 v239, v114, v115, v116
v_max_u32 v239, v239, v117
v_cmp_eq_u32 vcc, -1, v239
s_cbranch_vccnz aF7_0_0_465
s_branch aB7_0_0_466
aF15_3_0_463:
buffer_load_dwordx4 v[126:129], v229, s[4:7], s39 offen offset:3072 sc1
s_add_u32 s19, s19, 1
s_cmp_gt_u32 s19, 1048576
s_cbranch_scc1 L_end
s_waitcnt vmcnt(3)
v_max3_u32 v239, v114, v115, v116
v_max_u32 v239, v239, v117
v_cmp_eq_u32 vcc, -1, v239
s_cbranch_vccnz aF15_0_0_407
s_branch aB15_0_0_408
vr_472:
buffer_load_dwordx4 v[130:133], v230, s[4:7], s40 offen offset:0 sc1
buffer_load_dwordx4 v[134:137], v230, s[4:7], s40 offen offset:512 sc1
s_add_u32 s19, s19, 1
s_cmp_gt_u32 s19, 1048576
s_cbranch_scc1 L_end
s_branch vc_471
rr_475:
s_add_u32 s19, s19, 1
s_cmp_gt_u32 s19, 1048576
s_cbranch_scc1 L_end
s_branch rr_474
L_text_end:
s_endpgm
.section .rodata,"a"
.p2align 6
.amdhsa_kernel concat_heads__ssm_conv_h3__memory_aug_recurrent_mem_tr__prompt_kernel
  .amdhsa_next_free_vgpr 256
  .amdhsa_next_free_sgpr 102
  .amdhsa_accum_offset 256
  .amdhsa_group_segment_fixed_size 0
  .amdhsa_kernarg_size 128
  .amdhsa_user_sgpr_count 2
  .amdhsa_user_sgpr_kernarg_segment_ptr 1
  .amdhsa_system_sgpr_workgroup_id_x 1
  .amdhsa_float_denorm_mode_32 3
.end_amdhsa_kernel
```
